```python
import torch

def _softmax(x, axis=-1):
    return torch.softmax(x, dim=axis)

def _gelu(x):
    return torch.nn.functional.gelu(x, approximate='tanh')

def _silu(x):
    return torch.nn.functional.silu(x)

def _sigmoid(x):
    return torch.sigmoid(x)

def _layernorm(x, axis=-1, eps=1e-05):
    m = x.mean(dim=axis, keepdim=True)
    v = x.var(dim=axis, keepdim=True, unbiased=False)
    return (x - m) / torch.sqrt(v + eps)

def _scatter_add(tgt, idx, src, axis=0):
    return tgt.clone().index_add_(axis, idx, src)

def _segment_sum(src, seg, n):
    out = torch.zeros((n,) + src.shape[1:], dtype=src.dtype)
    return out.index_add_(0, seg, src)

def _pad(x, pw):
    flat = tuple((v for pair in reversed(pw) for v in pair))
    return torch.nn.functional.pad(x, flat)
kernel_name = 'gated_mix__memory_aug_recurrent_mem_tr__moe_arch_mod__prompt'

def setup_inputs():

    _w = lambda a: (lambda t: t.to(torch.bfloat16) if t.is_floating_point() else t)(torch.as_tensor(a))

    def _A_setup():
        B, S, Dm = (1, 2048, 1024)
        H, Dh = (32, 128)
        M, seg = (8, 32)
        seg = min(seg, S)
        S = S // seg * seg
        return {'x': _w((lambda *s: torch.randn(*s, dtype=torch.bfloat16) * 0.05)(B, S, Dm)), 'mem0': _w((lambda *s: torch.randn(*s, dtype=torch.bfloat16) * 0.8)(B, M, Dm)), 'Wq': _w((lambda *s: torch.randn(*s, dtype=torch.bfloat16) * 3.2)(Dm, H, Dh) * Dm ** (-0.5)), 'Wk': _w((lambda *s: torch.randn(*s, dtype=torch.bfloat16) * 3.2)(Dm, H, Dh) * Dm ** (-0.5)), 'Wv': _w((lambda *s: torch.randn(*s, dtype=torch.bfloat16) * 0.8)(Dm, H, Dh) * Dm ** (-0.5)), 'Wo': _w((lambda *s: torch.randn(*s, dtype=torch.bfloat16) * 0.8)(H, Dh, Dm) * (H * Dh) ** (-0.5)), 'seg_len': seg}
    _A_in = _A_setup()

    def _B_setup():
        B, S, D, F, C = (1, 2048, 1024, 3584, 8)
        return {'x': _w((lambda *s: torch.randn(*s, dtype=torch.bfloat16) * 0.05)(B, S, D)), 'w_r': _w((lambda *s: torch.randn(*s, dtype=torch.bfloat16) * 1.6)(D)), 'w_gate': _w((lambda *s: torch.randn(*s, dtype=torch.bfloat16) * 0.1)(D, F)), 'w_up': _w((lambda *s: torch.randn(*s, dtype=torch.bfloat16) * 0.1)(D, F)), 'w_down': _w((lambda *s: torch.randn(*s, dtype=torch.bfloat16) * 0.1)(F, D))}
    _B_in = _B_setup()
    return {'A_x': _A_in['x'], 'A_mem0': _A_in['mem0'], 'A_Wq': _A_in['Wq'], 'A_Wk': _A_in['Wk'], 'A_Wv': _A_in['Wv'], 'A_Wo': _A_in['Wo'], 'A_seg_len': _A_in['seg_len'], 'B_x': _B_in['x'], 'B_w_r': _B_in['w_r'], 'B_w_gate': _B_in['w_gate'], 'B_w_up': _B_in['w_up'], 'B_w_down': _B_in['w_down'], 'gate_w': _w((lambda *s: torch.randn(*s, dtype=torch.bfloat16) * 0.05)(1024) * 16.0)}

def reference(A_x, A_mem0, A_Wq, A_Wk, A_Wv, A_Wo, A_seg_len, B_x, B_w_r, B_w_gate, B_w_up, B_w_down, gate_w):

    def _A_ref(x, mem0, Wq, Wk, Wv, Wo, seg_len):
        B, S, Dm = x.shape
        H, Dh = (Wq.shape[1], Wq.shape[2])
        M = mem0.shape[1]
        scale = Dh ** (-0.5)
        n_seg = S // seg_len
        L = M + seg_len
        idx = torch.arange(L)
        mask = (idx[:, None] < M) | (idx[:, None] >= idx[None, :])
        mem = mem0
        outs = []
        for s in range(n_seg):
            xs = x[:, s * seg_len:(s + 1) * seg_len, :].clone()
            h = torch.concatenate([mem, xs], axis=1)
            q = torch.einsum('btd,dhe->bhte', h, Wq)
            k = torch.einsum('btd,dhe->bhte', h, Wk)
            v = torch.einsum('btd,dhe->bhte', h, Wv)
            scores = torch.einsum('bhqe,bhke->bhqk', q, k) * scale
            scores = torch.where(mask[None, None], scores, -1000000000.0)
            p = _softmax(scores, axis=-1)
            o = torch.einsum('bhqk,bhke->bhqe', p, v)
            o = torch.einsum('bhte,hed->btd', o, Wo)
            mem = o[:, :M, :].clone()
            outs.append(o[:, M:, :])
        return torch.concatenate(outs, axis=1)

    def _B_ref(x, w_r, w_gate, w_up, w_down):
        B, S, D = x.shape
        C = 8
        r = x @ w_r
        idx = torch.argsort(-r, axis=-1)[:, :C]
        idx_e = (lambda x, n, axis: torch.repeat_interleave(x, n, dim=axis))(idx.reshape(B, C, 1), D, axis=2)
        x_sel = (lambda x, i, axis: torch.take_along_dim(x, i, dim=axis))(x, idx_e, axis=1)
        g = _silu(x_sel @ w_gate)
        u = x_sel @ w_up
        y = g * u @ w_down
        r_sel = _sigmoid((lambda x, i, axis: torch.take_along_dim(x, i, dim=axis))(r, idx, axis=1))
        y = y * r_sel.reshape(B, C, 1)
        b_off = (torch.arange(B) * S).reshape(B, 1)
        flat_idx = (idx + b_off).reshape(B * C)
        zero = (x * 0.0).reshape(B * S, D)
        upd = _scatter_add(zero, flat_idx, y.reshape(B * C, D), axis=0)
        return x + upd.reshape(B, S, D)
    x = A_x
    g = _sigmoid((x * gate_w).sum(-1, keepdims=True))
    a = _A_ref(x, A_mem0, A_Wq, A_Wk, A_Wv, A_Wo, A_seg_len)
    b = _B_ref(x, B_w_r, B_w_gate, B_w_up, B_w_down)
    return g * a + (1 - g) * b
```

```asm
; @launch grid=(256,1,1) block=(256,1,1) lds=163840
.amdgcn_target "amdgcn-amd-amdhsa--gfx950"
.text
.globl gated_mix__memory_aug_recurrent_mem_tr__moe_arch_mod__prompt_kernel
.p2align 8
.type gated_mix__memory_aug_recurrent_mem_tr__moe_arch_mod__prompt_kernel,@function
gated_mix__memory_aug_recurrent_mem_tr__moe_arch_mod__prompt_kernel:
    s_cmp_ge_u32 s2, 256
    s_cbranch_scc1 L_end0
    s_load_dwordx16 s[64:79], s[0:1], 0
    s_load_dwordx16 s[80:95], s[0:1], 64
    s_getreg_b32 s100, hwreg(HW_REG_XCC_ID)
    s_and_b32 s100, s100, 7
    v_lshrrev_b32 v1, 6, v0
    v_and_b32 v0, 63, v0
    v_readfirstlane_b32 s32, v1
    s_mov_b32 s35, 262144
    s_lshr_b32 s36, s2, 3
    s_lshl_b32 s37, s32, 5
    s_add_u32 s36, s36, s37
    s_getpc_b64 s[28:29]
L_pc_1:
    s_add_u32 s28, s28, L_code0-L_pc_1
    s_addc_u32 s29, s29, 0
    s_and_b32 s29, s29, 0xffff
    s_mov_b32 s30, L_code1-L_code0
    s_mov_b32 s31, 0x20000
    v_lshlrev_b32 v2, 7, v0
    v_lshl_add_u32 v2, s36, 13, v2
    buffer_load_dword v253, v2, s[28:31], 0 offen
L_code0:
    s_waitcnt lgkmcnt(0)
    s_mov_b32 s4, s94
    s_and_b32 s5, s95, 0xffff
    s_mov_b32 s6, 0x10000000
    s_mov_b32 s7, 0x20000
    s_mov_b32 s8, s92
    s_and_b32 s9, s93, 0xffff
    s_mov_b32 s10, 0x100
    s_mov_b32 s11, 0x20000
    v_mov_b32 v4, -1
    v_mov_b32 v5, -1
    v_mov_b32 v6, -1
    v_mov_b32 v7, -1
    s_lshl_b32 s36, s2, 2
    s_add_u32 s36, s36, s32
    s_lshl_b32 s37, s36, 10
    s_add_u32 s37, s37, 0xe440000
    s_bfe_u32 s38, s36, 0x50003
    s_mul_i32 s38, s38, 0x208000
    s_bfe_u32 s39, s36, 0x20001
    s_lshl_b32 s39, s39, 12
    s_add_u32 s38, s38, s39
    s_and_b32 s39, s36, 1
    s_lshl_b32 s39, s39, 10
    s_add_u32 s38, s38, s39
    s_add_u32 s38, s38, 0xa000000
    s_cmp_ge_u32 s36, 768
    s_cselect_b32 s37, s38, s37
    s_lshl_b32 s36, s36, 8
    s_add_u32 s36, s36, 0xe400000
    v_lshlrev_b32 v2, 4, v0
    v_lshlrev_b32 v3, 2, v0
    buffer_store_dwordx4 v[4:7], v2, s[4:7], s37 offen sc1
    buffer_store_dword v4, v3, s[4:7], s36 offen sc1
    s_lshr_b32 s38, s2, 3
    s_lshl_b32 s38, s38, 2
    s_add_u32 s38, s38, s32
    s_lshr_b32 s39, s38, 5
    s_and_b32 s38, s38, 31
    s_and_b32 s42, s100, 3
    s_mov_b64 s[40:41], s[70:71]
    s_cmp_eq_u32 s39, 1
    s_cselect_b64 s[40:41], s[72:73], s[40:41]
    s_cmp_eq_u32 s39, 2
    s_cselect_b64 s[40:41], s[68:69], s[40:41]
    s_cmp_eq_u32 s39, 3
    s_cselect_b64 s[40:41], s[74:75], s[40:41]
    s_cselect_b32 s43, 11, 13
    s_cselect_b32 s44, 21, 11
    s_lshl_b32 s42, s42, s44
    s_add_u32 s44, s43, 5
    s_lshl_b32 s38, s38, s44
    s_add_u32 s38, s38, s42
    v_lshrrev_b32 v8, 1, v0
    v_lshlrev_b32 v8, s43, v8
    v_and_b32 v9, 1, v0
    v_lshl_add_u32 v8, v9, 10, v8
    s_and_b32 s42, s100, 3
    s_cmp_eq_u32 s42, 3
    s_cselect_b32 s42, 0, 0x40000000
    v_lshlrev_b32 v9, 29, v9
    v_add3_u32 v9, v8, v9, s42
    v_add_u32 v8, 384, v8
    s_lshr_b32 s42, s100, 2
    s_lshl_b32 s42, s42, 30
    s_add_u32 s38, s38, s42
    s_mov_b32 s12, s40
    s_and_b32 s13, s41, 0xffff
    s_mov_b32 s14, 0x800000
    s_mov_b32 s15, 0x20000
    s_lshl_b32 s63, s100, 5
    s_lshr_b32 s37, s2, 3
    s_lshl_b32 s36, 1, s37
    v_mov_b32 v254, s36
    s_cmp_eq_u32 s32, 0
    s_cselect_b32 s36, s63, 0x40000000
    v_mov_b32 v13, 0x40000000
    v_mov_b32 v255, s36
    v_cmp_eq_u32 vcc, 0, v0
    s_nop 1
    v_cndmask_b32 v255, v13, v255, vcc
    s_add_u32 s63, s63, s37
    buffer_load_dword v252, v8, s[12:15], s38 offen
    buffer_load_dword v252, v9, s[12:15], s38 offen offset:0x780
    s_branch L_go
L_redo:
    v_mov_b32 v12, 0
    v_mov_b32 v13, 163836
    s_waitcnt vmcnt(0) lgkmcnt(0)
    s_cmp_lg_u32 s32, 0
    s_cbranch_scc1 L_tk
    s_and_b32 s36, s63, 0xe0
L_cl:
    v_readfirstlane_b32 s38, v254
    s_nop 0
    s_ff0_i32_b32 s37, s38
    s_cmp_lt_i32 s37, 0
    s_cbranch_scc1 L_full
    s_lshl_b32 s38, 1, s37
    v_mov_b32 v254, s38
    s_mov_b64 exec, 1
    buffer_atomic_or v254, v12, s[8:11], s36 offen sc0 sc1
    s_mov_b64 exec, -1
    s_waitcnt vmcnt(0)
    v_readfirstlane_b32 s38, v254
    s_nop 0
    s_bitcmp1_b32 s38, s37
    s_cbranch_scc1 L_cl
    s_add_u32 s36, s36, s37
    s_branch L_tk_w
L_full:
    v_mov_b32 v1, 1
    s_mov_b64 exec, 1
    buffer_atomic_add v1, v12, s[8:11], 0 offen offset:232 sc0 sc1
    s_mov_b64 exec, -1
    s_waitcnt vmcnt(0)
    v_readfirstlane_b32 s37, v1
L_ov:
    v_lshlrev_b32 v3, 5, v0
    v_min_u32 v3, 0xe4, v3
    v_cmp_eq_u32 vcc, 9, v0
    s_nop 1
    v_cndmask_b32 v1, 0, 4, vcc
    v_add_u32 v3, v3, v1
    buffer_load_dword v1, v3, s[8:11], 0 offen sc1
    s_waitcnt vmcnt(0)
    v_bcnt_u32_b32 v3, v1, 0
    s_nop 0
    v_readlane_b32 s38, v3, 0
    v_readlane_b32 s39, v3, 1
    s_nop 0
    s_add_u32 s38, s38, s39
    v_readlane_b32 s39, v3, 2
    s_nop 0
    s_add_u32 s38, s38, s39
    v_readlane_b32 s39, v3, 3
    s_nop 0
    s_add_u32 s38, s38, s39
    v_readlane_b32 s39, v3, 4
    s_nop 0
    s_add_u32 s38, s38, s39
    v_readlane_b32 s39, v3, 5
    s_nop 0
    s_add_u32 s38, s38, s39
    v_readlane_b32 s39, v3, 6
    s_nop 0
    s_add_u32 s38, s38, s39
    v_readlane_b32 s39, v3, 7
    s_nop 0
    s_add_u32 s38, s38, s39
    v_readlane_b32 s39, v1, 9
    s_nop 0
    s_add_u32 s38, s38, s39
    s_cmp_ge_u32 s38, 256
    s_cbranch_scc1 L_ov1
    s_sleep 4
    s_sub_u32 s35, s35, 1
    s_cbranch_scc0 L_ov
    s_endpgm
L_ov1:
    s_mov_b32 s36, -1
L_ov2:
    s_add_u32 s36, s36, 1
    s_cmp_ge_u32 s36, 256
    s_cbranch_scc1 L_tk_w
    s_lshr_b32 s39, s36, 5
    v_readlane_b32 s38, v1, s39
    s_nop 0
    s_bitcmp1_b32 s38, s36
    s_cbranch_scc1 L_ov2
    s_sub_u32 s37, s37, 1
    s_cbranch_scc0 L_ov2
L_tk_w:
    v_mov_b32 v1, s36
    ds_write_b32 v13, v1
    s_waitcnt lgkmcnt(0)
L_tk:
    s_barrier
    ds_read_b32 v1, v13
    v_mov_b32 v254, 0
    v_mov_b32 v255, 0x40000000
    s_waitcnt lgkmcnt(0)
    v_readfirstlane_b32 s63, v1
    s_nop 0
    s_cmp_ge_u32 s63, 256
    s_cbranch_scc1 L_end0
L_go:
    s_lshr_b32 s33, s63, 4
    s_and_b32 s34, s63, 15
    s_cmp_lt_u32 s63, 128
    s_cbranch_scc1 L_chain
    s_bfe_u32 s33, s63, 0x20005
    s_lshl_b32 s33, s33, 3
    s_and_b32 s36, s63, 7
    s_add_u32 s36, s36, s33
    s_bfe_u32 s34, s63, 0x20003
    s_cmp_eq_u32 s34, 0
    s_cbranch_scc1 L_k
    s_cmp_eq_u32 s34, 1
    s_cbranch_scc1 L_v
    s_cmp_eq_u32 s34, 2
    s_cbranch_scc1 L_q
    s_branch L_o
L_end0:
    s_endpgm
L_chain:
    s_bitcmp1_b32 s34, 0
    s_cselect_b64 s[2:3], s[70:71], s[68:69]
    s_mov_b32 s12, s2
    s_and_b32 s13, s3, 0xffff
    s_mov_b32 s14, 0x800000
    s_mov_b32 s15, 0x20000
    s_mov_b32 s20, s72
    s_and_b32 s21, s73, 0xffff
    s_mov_b32 s22, 0x800000
    s_mov_b32 s23, 0x20000
    s_mov_b32 s24, s74
    s_and_b32 s25, s75, 0xffff
    s_mov_b32 s26, 0x800000
    s_mov_b32 s27, 0x20000
    s_mov_b32 s28, s66
    s_and_b32 s29, s67, 0xffff
    s_mov_b32 s30, 0x4000
    s_mov_b32 s31, 0x20000
    s_getpc_b64 s[2:3]
L_pc:
    s_add_u32 s2, s2, L_loop-L_pc
    s_addc_u32 s3, s3, 0
    s_mov_b32 s16, s2
    s_and_b32 s17, s3, 0xffff
    s_mov_b32 s18, 0x0
    s_mov_b32 s19, 0x20000
    s_mov_b32 s18, L_loop_end-L_loop
    s_lshl_b32 s49, s32, 13
    v_lshlrev_b32 v16, 7, v0
    buffer_load_dword v252, v16, s[16:19], s49 offen
    v_bfe_u32 v16, v0, 3, 3
    v_lshlrev_b32 v219, 11, v16
    v_bfe_u32 v16, v0, 0, 3
    v_lshl_add_u32 v219, v16, 4, v219
    s_lshl_b32 s49, s33, 2
    s_add_u32 s49, s49, s32
    s_lshl_b32 s49, s49, 18
    s_lshl_b32 s50, s34, 7
    s_add_u32 s49, s49, s50
    s_add_u32 s50, s49, 0x0
    buffer_load_dwordx4 a[192:195], v219, s[24:27], s50 offen nt
    s_add_u32 s50, s49, 0x4000
    buffer_load_dwordx4 a[196:199], v219, s[24:27], s50 offen nt
    s_add_u32 s50, s49, 0x8000
    buffer_load_dwordx4 a[200:203], v219, s[24:27], s50 offen nt
    s_add_u32 s50, s49, 0xc000
    buffer_load_dwordx4 a[204:207], v219, s[24:27], s50 offen nt
    s_add_u32 s50, s49, 0x10000
    buffer_load_dwordx4 a[208:211], v219, s[24:27], s50 offen nt
    s_add_u32 s50, s49, 0x14000
    buffer_load_dwordx4 a[212:215], v219, s[24:27], s50 offen nt
    s_add_u32 s50, s49, 0x18000
    buffer_load_dwordx4 a[216:219], v219, s[24:27], s50 offen nt
    s_add_u32 s50, s49, 0x1c000
    buffer_load_dwordx4 a[220:223], v219, s[24:27], s50 offen nt
    s_add_u32 s50, s49, 0x20000
    buffer_load_dwordx4 a[224:227], v219, s[24:27], s50 offen nt
    s_add_u32 s50, s49, 0x24000
    buffer_load_dwordx4 a[228:231], v219, s[24:27], s50 offen nt
    s_add_u32 s50, s49, 0x28000
    buffer_load_dwordx4 a[232:235], v219, s[24:27], s50 offen nt
    s_add_u32 s50, s49, 0x2c000
    buffer_load_dwordx4 a[236:239], v219, s[24:27], s50 offen nt
    s_add_u32 s50, s49, 0x30000
    buffer_load_dwordx4 a[240:243], v219, s[24:27], s50 offen nt
    s_add_u32 s50, s49, 0x34000
    buffer_load_dwordx4 a[244:247], v219, s[24:27], s50 offen nt
    s_add_u32 s50, s49, 0x38000
    buffer_load_dwordx4 a[248:251], v219, s[24:27], s50 offen nt
    s_add_u32 s50, s49, 0x3c000
    buffer_load_dwordx4 a[252:255], v219, s[24:27], s50 offen nt
    v_bfe_u32 v16, v0, 2, 4
    v_lshlrev_b32 v216, 13, v16
    v_bfe_u32 v16, v0, 0, 2
    v_lshl_add_u32 v216, v16, 4, v216
    v_bfe_u32 v16, v0, 3, 3
    v_lshlrev_b32 v220, 13, v16
    v_bfe_u32 v16, v0, 0, 3
    v_lshl_add_u32 v220, v16, 4, v220
    s_lshl_b32 s49, s32, 21
    s_lshl_b32 s50, s33, 10
    s_add_u32 s49, s49, s50
    s_lshl_b32 s50, s34, 6
    s_add_u32 s54, s49, s50
    s_and_b32 s56, s54, 0xffffff80
    v_lshlrev_b32 v1, 4, v0
    v_lshlrev_b32 v2, 2, v0
    v_mov_b32 v7, -1
    v_and_b32 v16, 8, v0
    v_cmp_eq_u32 vcc, 0, v16
    v_mov_b32 v17, 0xeeee
    v_mov_b32 v18, 0x4444
    v_cndmask_b32 v6, v17, v18, vcc
    s_mov_b32 s36, 0
    s_lshl_b32 s49, s33, 15
    s_and_b32 s49, s49, 0x30000
    s_add_u32 s49, s49, 0xe440000
    s_lshl_b32 s50, s32, 12
    s_add_u32 s37, s49, s50
    s_lshl_b32 s50, s34, 10
    s_add_u32 s49, s49, s50
    s_lshl_b32 s50, s32, 8
    s_add_u32 s38, s49, s50
    s_and_b32 s50, s33, 1
    s_lshl_b32 s50, s50, 7
    s_add_u32 s38, s38, s50
    s_lshl_b32 s49, s33, 16
    s_add_u32 s39, s49, 0xe480000
    s_mul_i32 s50, s32, 6144
    s_add_u32 s40, s39, s50
    s_add_u32 s41, s40, 4096
    s_lshr_b32 s50, s34, 2
    s_mul_i32 s50, s50, 6144
    s_add_u32 s39, s39, s50
    s_mov_b32 s53, 0x3e0293ee
    s_and_b32 s49, s32, 1
    s_lshl_b32 s49, s49, 1
    v_lshrrev_b32 v16, 5, v0
    v_add_u32 v16, s49, v16
    v_and_b32 v17, 31, v0
    v_lshlrev_b32 v17, 2, v17
    s_bfe_u32 s50, s34, 0x10001
    s_lshl_b32 s50, s50, 10
    s_lshr_b32 s49, s32, 1
    s_lshl_b32 s51, s49, 7
    s_add_u32 s51, s51, s50
    s_lshl_b32 s49, s49, 9
    s_add_u32 s49, s49, s50
    s_add_u32 s49, s49, 2048
    v_lshl_add_u32 v18, v16, 8, v17
    v_add_u32 v18, s51, v18
    v_lshl_add_u32 v17, v16, 7, v17
    v_add_u32 v19, s49, v17
    s_bitcmp1_b32 s34, 0
    s_cselect_b64 s[0:1], -1, 0
    s_cselect_b32 s49, 0, 0x40000000
    v_cndmask_b32 v3, v18, v19, s[0:1]
    v_add_u32 v5, s49, v19
    s_and_b32 s49, s34, 1
    s_lshl_b32 s49, s49, 9
    s_add_u32 s49, s49, s50
    s_add_u32 s49, s49, 4096
    s_cmp_lt_u32 s32, 2
    s_cselect_b32 s49, s49, 0x40000000
    v_add_u32 v4, s49, v17
    v_bfe_u32 v17, v0, 3, 2
    v_xor_b32 v17, v17, v16
    v_lshlrev_b32 v17, 5, v17
    v_lshl_add_u32 v17, v16, 7, v17
    v_and_b32 v18, 3, v0
    v_lshl_add_u32 v17, v18, 3, v17
    v_bfe_u32 v18, v0, 2, 1
    v_lshl_add_u32 v17, v18, 2, v17
    v_add_u32 v11, 2048, v17
    s_lshr_b32 s49, s32, 1
    s_lshl_b32 s49, s49, 10
    v_add_u32 v10, s49, v17
    v_bfe_u32 v16, v0, 4, 1
    v_lshrrev_b32 v17, 5, v0
    v_lshl_add_u32 v16, v16, 1, v17
    s_mul_i32 s49, s32, 3072
    v_bfe_u32 v17, v0, 2, 2
    v_and_b32 v19, 3, v0
    v_xor_b32 v18, v17, v16
    v_lshlrev_b32 v18, 5, v18
    v_lshl_add_u32 v18, v17, 7, v18
    v_lshl_add_u32 v18, v19, 3, v18
    v_add_u32 v8, s49, v18
    v_bfe_u32 v17, v0, 3, 1
    v_and_b32 v18, 1, v0
    v_lshl_add_u32 v17, v17, 1, v18
    v_bfe_u32 v19, v0, 1, 2
    v_xor_b32 v18, v17, v16
    v_lshlrev_b32 v18, 5, v18
    v_lshl_add_u32 v18, v17, 7, v18
    v_lshl_add_u32 v18, v19, 3, v18
    v_add_u32 v9, s49, v18
    v_cndmask_b32 v8, v8, v9, s[0:1]
    v_mov_b32 v188, 0x3f803f80
    v_mov_b32 v180, 0
    v_mov_b32 v189, 0x3f803f80
    v_mov_b32 v181, 0
    v_mov_b32 v190, 0x3f803f80
    v_mov_b32 v182, 0
    v_mov_b32 v191, 0x3f803f80
    v_mov_b32 v183, 0
    v_mov_b32 v196, 0x3f003f00
    v_mov_b32 v186, 0
    v_mov_b32 v197, 0x3f003f00
    v_mov_b32 v187, 0
    v_and_b32 v16, 8, v0
    v_cmp_eq_u32 vcc, 0, v16
    v_mov_b32 v17, 0x7f800000
    v_mov_b32 v18, 0xff800000
    v_cndmask_b32 v22, v17, v18, vcc
    v_and_b32 v16, 3, v0
    v_lshlrev_b32 v17, 4, v16
    v_mov_b32 v18, 0x3f80
    v_lshlrev_b32 v17, v17, v18
    v_cmp_gt_u32 vcc, 2, v16
    s_nop 1
    v_cndmask_b32 v17, 0, v17, vcc
    v_bfe_u32 v16, v0, 2, 2
    v_cmp_eq_u32 vcc, 0, v16
    s_nop 1
    v_cndmask_b32 v192, 0, v17, vcc
    v_cmp_eq_u32 vcc, 1, v16
    s_nop 1
    v_cndmask_b32 v193, 0, v17, vcc
    v_cmp_eq_u32 vcc, 2, v16
    s_nop 1
    v_cndmask_b32 v194, 0, v17, vcc
    v_cmp_eq_u32 vcc, 3, v16
    s_nop 1
    v_cndmask_b32 v195, 0, v17, vcc
    v_bfe_u32 v16, v0, 0, 5
    v_lshlrev_b32 v194, 2, v16
    v_bfe_u32 v16, v0, 5, 1
    v_lshl_add_u32 v194, v16, 30, v194
    s_and_b32 s50, s33, 1
    s_lshl_b32 s50, s50, 7
    v_bfe_u32 v16, v0, 4, 2
    v_lshlrev_b32 v195, 8, v16
    v_bfe_u32 v16, v0, 0, 4
    v_lshl_add_u32 v195, v16, 3, v195
    v_add_u32 v195, s50, v195
    s_lshl_b32 s49, s32, 2
    s_add_u32 s49, s49, 20480
    v_add_u32 v14, s49, v1
    v_bfe_u32 v17, v0, 0, 1
    v_lshlrev_b32 v16, 2, v17
    v_bfe_u32 v17, v0, 3, 2
    v_lshl_add_u32 v16, v17, 0, v16
    v_lshlrev_b32 v17, 4, v16
    v_add_u32 v15, 20480, v17
    v_bfe_u32 v18, v0, 5, 1
    v_lshlrev_b32 v17, 1, v18
    v_xor_b32 v16, v16, v17
    v_lshlrev_b32 v16, 4, v16
    v_lshl_add_u32 v16, v17, 7, v16
    v_bfe_u32 v17, v0, 2, 1
    v_lshl_add_u32 v16, v17, 7, v16
    v_bfe_u32 v17, v0, 1, 1
    v_lshl_add_u32 v16, v17, 3, v16
    s_lshl_b32 s49, s32, 9
    s_add_u32 s49, s49, 12288
    v_add_u32 v13, s49, v16
    v_bfe_u32 v16, v0, 3, 1
    v_lshlrev_b32 v16, 9, v16
    v_lshrrev_b32 v17, 4, v0
    v_lshl_add_u32 v16, v17, 7, v16
    v_and_b32 v17, 2, v17
    v_and_b32 v18, 7, v0
    v_xor_b32 v17, v17, v18
    v_lshl_add_u32 v16, v17, 4, v16
    s_lshl_b32 s49, s32, 11
    s_add_u32 s49, s49, 12288
    v_add_u32 v12, s49, v16
    s_mul_i32 s51, s32, 20480
    s_add_u32 s51, s51, 32768
    v_bfe_u32 v16, v0, 0, 6
    v_lshlrev_b32 v217, 4, v16
    v_bfe_u32 v16, v0, 5, 1
    v_lshl_add_u32 v217, v16, 5, v217
    v_add_u32 v217, s51, v217
    v_bfe_u32 v16, v0, 0, 6
    v_lshlrev_b32 v221, 4, v16
    v_bfe_u32 v16, v0, 4, 1
    v_lshl_add_u32 v221, v16, 5, v221
    v_bfe_u32 v16, v0, 5, 1
    v_lshl_add_u32 v221, v16, 7, v221
    v_add_u32 v221, s51, v221
    v_bfe_u32 v16, v0, 2, 1
    v_lshlrev_b32 v218, 11, v16
    v_bfe_u32 v16, v0, 2, 1
    v_lshl_add_u32 v218, v16, 6, v218
    v_bfe_u32 v16, v0, 4, 2
    v_lshl_add_u32 v218, v16, 9, v218
    v_bfe_u32 v16, v0, 4, 1
    v_lshl_add_u32 v218, v16, 5, v218
    v_bfe_u32 v16, v0, 5, 1
    v_lshl_add_u32 v218, v16, 5, v218
    v_bfe_u32 v16, v0, 3, 1
    v_lshl_add_u32 v218, v16, 7, v218
    v_bfe_u32 v16, v0, 0, 2
    v_lshl_add_u32 v218, v16, 3, v218
    v_add_u32 v218, s51, v218
    s_waitcnt vmcnt(16)
    s_barrier
    buffer_atomic_or v254, v255, s[8:11], 0 offen sc0 sc1
    s_add_u32 s50, s56, 0x0
    buffer_load_dwordx4 a[0:3], v220, s[12:15], s50 offen nt
    s_add_u32 s50, s56, 0x10000
    buffer_load_dwordx4 a[4:7], v220, s[12:15], s50 offen nt
    s_add_u32 s50, s56, 0x20000
    buffer_load_dwordx4 a[8:11], v220, s[12:15], s50 offen nt
    s_add_u32 s50, s56, 0x30000
    buffer_load_dwordx4 a[12:15], v220, s[12:15], s50 offen nt
    s_add_u32 s50, s56, 0x40000
    buffer_load_dwordx4 a[16:19], v220, s[12:15], s50 offen nt
    s_add_u32 s50, s56, 0x50000
    buffer_load_dwordx4 a[20:23], v220, s[12:15], s50 offen nt
    s_add_u32 s50, s56, 0x60000
    buffer_load_dwordx4 a[24:27], v220, s[12:15], s50 offen nt
    s_add_u32 s50, s56, 0x70000
    buffer_load_dwordx4 a[28:31], v220, s[12:15], s50 offen nt
    s_add_u32 s50, s54, 0x0
    buffer_load_dwordx4 a[32:35], v216, s[20:23], s50 offen
    s_add_u32 s50, s54, 0x20000
    buffer_load_dwordx4 a[36:39], v216, s[20:23], s50 offen
    s_add_u32 s50, s54, 0x40000
    buffer_load_dwordx4 a[40:43], v216, s[20:23], s50 offen
    s_add_u32 s50, s54, 0x60000
    buffer_load_dwordx4 a[44:47], v216, s[20:23], s50 offen
    s_cmp_eq_u32 s32, 0
    s_cbranch_scc1 L_hk0
    s_cmp_eq_u32 s32, 1
    s_cbranch_scc1 L_hk1
    s_cmp_eq_u32 s32, 2
    s_cbranch_scc1 L_hk2
    s_branch L_hk3
L_hkret0:
    s_waitcnt vmcnt(12)
    v_mov_b32 v17, 163832
    s_cmp_lg_u32 s32, 0
    s_cbranch_scc1 L_cf_2
    v_readfirstlane_b32 s49, v254
    s_nop 1
    v_mov_b32 v16, s49
    ds_write_b32 v17, v16
    s_waitcnt lgkmcnt(0)
L_cf_2:
    s_barrier
    ds_read_b32 v16, v17
    s_waitcnt lgkmcnt(0)
    v_readfirstlane_b32 s49, v16
    s_nop 0
    s_bitcmp1_b32 s49, s63
    s_cbranch_scc1 L_redo
    ds_write_b128 v217, a[192:195] offset:0
    ds_write_b128 v217, a[196:199] offset:1056
    ds_write_b128 v217, a[200:203] offset:2112
    ds_write_b128 v217, a[204:207] offset:3168
    ds_write_b128 v217, a[208:211] offset:4224
    ds_write_b128 v217, a[212:215] offset:5280
    ds_write_b128 v217, a[216:219] offset:6336
    ds_write_b128 v217, a[220:223] offset:7392
    s_waitcnt lgkmcnt(0)
    ds_write_b128 v217, a[224:227] offset:8448
    ds_write_b128 v217, a[228:231] offset:9504
    ds_write_b128 v217, a[232:235] offset:10560
    ds_write_b128 v217, a[236:239] offset:11616
    ds_write_b128 v217, a[240:243] offset:12672
    ds_write_b128 v217, a[244:247] offset:13728
    ds_write_b128 v217, a[248:251] offset:14784
    ds_write_b128 v217, a[252:255] offset:15840
    s_waitcnt lgkmcnt(0)
    ds_read_b64_tr_b16 a[192:193], v218 offset:0
    ds_read_b64_tr_b16 a[194:195], v218 offset:256
    ds_read_b64_tr_b16 a[196:197], v218 offset:4224
    ds_read_b64_tr_b16 a[198:199], v218 offset:4480
    ds_read_b64_tr_b16 a[200:201], v218 offset:8448
    ds_read_b64_tr_b16 a[202:203], v218 offset:8704
    ds_read_b64_tr_b16 a[204:205], v218 offset:12672
    ds_read_b64_tr_b16 a[206:207], v218 offset:12928
    s_waitcnt lgkmcnt(0)
    ds_read_b64_tr_b16 a[208:209], v218 offset:32
    ds_read_b64_tr_b16 a[210:211], v218 offset:288
    ds_read_b64_tr_b16 a[212:213], v218 offset:4256
    ds_read_b64_tr_b16 a[214:215], v218 offset:4512
    ds_read_b64_tr_b16 a[216:217], v218 offset:8480
    ds_read_b64_tr_b16 a[218:219], v218 offset:8736
    ds_read_b64_tr_b16 a[220:221], v218 offset:12704
    ds_read_b64_tr_b16 a[222:223], v218 offset:12960
    s_waitcnt lgkmcnt(0)
    ds_read_b64_tr_b16 a[224:225], v218 offset:64
    ds_read_b64_tr_b16 a[226:227], v218 offset:320
    ds_read_b64_tr_b16 a[228:229], v218 offset:4288
    ds_read_b64_tr_b16 a[230:231], v218 offset:4544
    ds_read_b64_tr_b16 a[232:233], v218 offset:8512
    ds_read_b64_tr_b16 a[234:235], v218 offset:8768
    ds_read_b64_tr_b16 a[236:237], v218 offset:12736
    ds_read_b64_tr_b16 a[238:239], v218 offset:12992
    s_waitcnt lgkmcnt(0)
    ds_read_b64_tr_b16 a[240:241], v218 offset:96
    ds_read_b64_tr_b16 a[242:243], v218 offset:352
    ds_read_b64_tr_b16 a[244:245], v218 offset:4320
    ds_read_b64_tr_b16 a[246:247], v218 offset:4576
    ds_read_b64_tr_b16 a[248:249], v218 offset:8544
    ds_read_b64_tr_b16 a[250:251], v218 offset:8800
    ds_read_b64_tr_b16 a[252:253], v218 offset:12768
    ds_read_b64_tr_b16 a[254:255], v218 offset:13024
    s_waitcnt lgkmcnt(0)
    v_bfe_u32 v16, v0, 5, 1
    v_lshlrev_b32 v218, 11, v16
    v_bfe_u32 v16, v0, 5, 1
    v_lshl_add_u32 v218, v16, 7, v218
    v_bfe_u32 v16, v0, 4, 1
    v_lshl_add_u32 v218, v16, 9, v218
    v_bfe_u32 v16, v0, 4, 1
    v_lshl_add_u32 v218, v16, 5, v218
    v_bfe_u32 v16, v0, 3, 1
    v_lshl_add_u32 v218, v16, 10, v218
    v_bfe_u32 v16, v0, 3, 1
    v_lshl_add_u32 v218, v16, 6, v218
    v_bfe_u32 v16, v0, 2, 1
    v_lshl_add_u32 v218, v16, 7, v218
    v_bfe_u32 v16, v0, 0, 2
    v_lshl_add_u32 v218, v16, 3, v218
    v_add_u32 v218, s51, v218
    v_bfe_u32 v16, v0, 5, 1
    v_lshlrev_b32 v219, 10, v16
    v_bfe_u32 v16, v0, 5, 1
    v_lshl_add_u32 v219, v16, 8, v219
    v_bfe_u32 v16, v0, 4, 1
    v_lshl_add_u32 v219, v16, 8, v219
    v_bfe_u32 v16, v0, 4, 1
    v_lshl_add_u32 v219, v16, 5, v219
    v_bfe_u32 v16, v0, 3, 1
    v_lshl_add_u32 v219, v16, 9, v219
    v_bfe_u32 v16, v0, 3, 1
    v_lshl_add_u32 v219, v16, 7, v219
    v_bfe_u32 v16, v0, 2, 1
    v_lshl_add_u32 v219, v16, 6, v219
    v_bfe_u32 v16, v0, 0, 2
    v_lshl_add_u32 v219, v16, 3, v219
    v_add_u32 v219, s51, v219
    s_add_u32 s50, s56, 0x80000
    buffer_load_dwordx4 a[48:51], v220, s[12:15], s50 offen nt
    s_add_u32 s50, s56, 0x90000
    buffer_load_dwordx4 a[52:55], v220, s[12:15], s50 offen nt
    s_add_u32 s50, s56, 0xa0000
    buffer_load_dwordx4 a[56:59], v220, s[12:15], s50 offen nt
    s_add_u32 s50, s56, 0xb0000
    buffer_load_dwordx4 a[60:63], v220, s[12:15], s50 offen nt
    s_add_u32 s50, s56, 0xc0000
    buffer_load_dwordx4 a[64:67], v220, s[12:15], s50 offen nt
    s_add_u32 s50, s56, 0xd0000
    buffer_load_dwordx4 a[68:71], v220, s[12:15], s50 offen nt
    s_add_u32 s50, s56, 0xe0000
    buffer_load_dwordx4 a[72:75], v220, s[12:15], s50 offen nt
    s_add_u32 s50, s56, 0xf0000
    buffer_load_dwordx4 a[76:79], v220, s[12:15], s50 offen nt
    s_cmp_eq_u32 s32, 0
    s_cbranch_scc1 L_hk4
    s_cmp_eq_u32 s32, 1
    s_cbranch_scc1 L_hk5
    s_cmp_eq_u32 s32, 2
    s_cbranch_scc1 L_hk6
    s_branch L_hk7
L_hkret1:
    s_waitcnt vmcnt(12)
    ds_write_b128 v217, a[0:3] offset:0
    ds_write_b128 v217, a[4:7] offset:1088
    ds_write_b128 v217, a[8:11] offset:2176
    ds_write_b128 v217, a[12:15] offset:3264
    ds_write_b128 v217, a[16:19] offset:4352
    ds_write_b128 v217, a[20:23] offset:5440
    ds_write_b128 v217, a[24:27] offset:6528
    ds_write_b128 v217, a[28:31] offset:7616
    s_waitcnt lgkmcnt(4)
    ds_read_b64_tr_b16 a[0:1], v218 offset:0
    ds_read_b64_tr_b16 a[2:3], v218 offset:256
    ds_read_b64_tr_b16 a[4:5], v218 offset:4352
    ds_read_b64_tr_b16 a[6:7], v218 offset:4608
    ds_read_b64_tr_b16 a[8:9], v218 offset:32
    ds_read_b64_tr_b16 a[10:11], v218 offset:288
    ds_read_b64_tr_b16 a[12:13], v218 offset:4384
    ds_read_b64_tr_b16 a[14:15], v218 offset:4640
    s_waitcnt lgkmcnt(4)
    ds_read_b64_tr_b16 a[16:17], v218 offset:64
    ds_read_b64_tr_b16 a[18:19], v218 offset:320
    ds_read_b64_tr_b16 a[20:21], v218 offset:4416
    ds_read_b64_tr_b16 a[22:23], v218 offset:4672
    ds_read_b64_tr_b16 a[24:25], v218 offset:96
    ds_read_b64_tr_b16 a[26:27], v218 offset:352
    ds_read_b64_tr_b16 a[28:29], v218 offset:4448
    ds_read_b64_tr_b16 a[30:31], v218 offset:4704
    s_add_u32 s50, s54, 0x80000
    buffer_load_dwordx4 a[80:83], v216, s[20:23], s50 offen
    s_add_u32 s50, s54, 0xa0000
    buffer_load_dwordx4 a[84:87], v216, s[20:23], s50 offen
    s_add_u32 s50, s54, 0xc0000
    buffer_load_dwordx4 a[88:91], v216, s[20:23], s50 offen
    s_add_u32 s50, s54, 0xe0000
    buffer_load_dwordx4 a[92:95], v216, s[20:23], s50 offen
    s_cmp_eq_u32 s32, 0
    s_cbranch_scc1 L_hk16
    s_cmp_eq_u32 s32, 1
    s_cbranch_scc1 L_hk17
    s_cmp_eq_u32 s32, 2
    s_cbranch_scc1 L_hk18
    s_branch L_hk19
L_hkret4:
    s_waitcnt vmcnt(12) lgkmcnt(0)
    ds_write_b128 v221, a[32:35] offset:9216
    ds_write_b128 v221, a[36:39] offset:10496
    ds_write_b128 v221, a[40:43] offset:11776
    ds_write_b128 v221, a[44:47] offset:13056
    ds_read_b64_tr_b16 a[32:33], v219 offset:9216
    ds_read_b64_tr_b16 a[34:35], v219 offset:9344
    ds_read_b64_tr_b16 a[36:37], v219 offset:11776
    ds_read_b64_tr_b16 a[38:39], v219 offset:11904
    ds_read_b64_tr_b16 a[40:41], v219 offset:9248
    ds_read_b64_tr_b16 a[42:43], v219 offset:9376
    ds_read_b64_tr_b16 a[44:45], v219 offset:11808
    ds_read_b64_tr_b16 a[46:47], v219 offset:11936
    s_waitcnt lgkmcnt(0)
    s_add_u32 s50, s56, 0x100000
    buffer_load_dwordx4 a[96:99], v220, s[12:15], s50 offen nt
    s_add_u32 s50, s56, 0x110000
    buffer_load_dwordx4 a[100:103], v220, s[12:15], s50 offen nt
    s_add_u32 s50, s56, 0x120000
    buffer_load_dwordx4 a[104:107], v220, s[12:15], s50 offen nt
    s_add_u32 s50, s56, 0x130000
    buffer_load_dwordx4 a[108:111], v220, s[12:15], s50 offen nt
    s_add_u32 s50, s56, 0x140000
    buffer_load_dwordx4 a[112:115], v220, s[12:15], s50 offen nt
    s_add_u32 s50, s56, 0x150000
    buffer_load_dwordx4 a[116:119], v220, s[12:15], s50 offen nt
    s_add_u32 s50, s56, 0x160000
    buffer_load_dwordx4 a[120:123], v220, s[12:15], s50 offen nt
    s_add_u32 s50, s56, 0x170000
    buffer_load_dwordx4 a[124:127], v220, s[12:15], s50 offen nt
    s_cmp_eq_u32 s32, 0
    s_cbranch_scc1 L_hk8
    s_cmp_eq_u32 s32, 1
    s_cbranch_scc1 L_hk9
    s_cmp_eq_u32 s32, 2
    s_cbranch_scc1 L_hk10
    s_branch L_hk11
L_hkret2:
    s_waitcnt vmcnt(12)
    ds_write_b128 v217, a[48:51] offset:0
    ds_write_b128 v217, a[52:55] offset:1088
    ds_write_b128 v217, a[56:59] offset:2176
    ds_write_b128 v217, a[60:63] offset:3264
    ds_write_b128 v217, a[64:67] offset:4352
    ds_write_b128 v217, a[68:71] offset:5440
    ds_write_b128 v217, a[72:75] offset:6528
    ds_write_b128 v217, a[76:79] offset:7616
    s_waitcnt lgkmcnt(4)
    ds_read_b64_tr_b16 a[48:49], v218 offset:0
    ds_read_b64_tr_b16 a[50:51], v218 offset:256
    ds_read_b64_tr_b16 a[52:53], v218 offset:4352
    ds_read_b64_tr_b16 a[54:55], v218 offset:4608
    ds_read_b64_tr_b16 a[56:57], v218 offset:32
    ds_read_b64_tr_b16 a[58:59], v218 offset:288
    ds_read_b64_tr_b16 a[60:61], v218 offset:4384
    ds_read_b64_tr_b16 a[62:63], v218 offset:4640
    s_waitcnt lgkmcnt(4)
    ds_read_b64_tr_b16 a[64:65], v218 offset:64
    ds_read_b64_tr_b16 a[66:67], v218 offset:320
    ds_read_b64_tr_b16 a[68:69], v218 offset:4416
    ds_read_b64_tr_b16 a[70:71], v218 offset:4672
    ds_read_b64_tr_b16 a[72:73], v218 offset:96
    ds_read_b64_tr_b16 a[74:75], v218 offset:352
    ds_read_b64_tr_b16 a[76:77], v218 offset:4448
    ds_read_b64_tr_b16 a[78:79], v218 offset:4704
    s_add_u32 s50, s54, 0x100000
    buffer_load_dwordx4 a[128:131], v216, s[20:23], s50 offen
    s_add_u32 s50, s54, 0x120000
    buffer_load_dwordx4 a[132:135], v216, s[20:23], s50 offen
    s_add_u32 s50, s54, 0x140000
    buffer_load_dwordx4 a[136:139], v216, s[20:23], s50 offen
    s_add_u32 s50, s54, 0x160000
    buffer_load_dwordx4 a[140:143], v216, s[20:23], s50 offen
    s_cmp_eq_u32 s32, 0
    s_cbranch_scc1 L_hk20
    s_cmp_eq_u32 s32, 1
    s_cbranch_scc1 L_hk21
    s_cmp_eq_u32 s32, 2
    s_cbranch_scc1 L_hk22
    s_branch L_hk23
L_hkret5:
    s_waitcnt vmcnt(12) lgkmcnt(0)
    ds_write_b128 v221, a[80:83] offset:9216
    ds_write_b128 v221, a[84:87] offset:10496
    ds_write_b128 v221, a[88:91] offset:11776
    ds_write_b128 v221, a[92:95] offset:13056
    ds_read_b64_tr_b16 a[80:81], v219 offset:9216
    ds_read_b64_tr_b16 a[82:83], v219 offset:9344
    ds_read_b64_tr_b16 a[84:85], v219 offset:11776
    ds_read_b64_tr_b16 a[86:87], v219 offset:11904
    ds_read_b64_tr_b16 a[88:89], v219 offset:9248
    ds_read_b64_tr_b16 a[90:91], v219 offset:9376
    ds_read_b64_tr_b16 a[92:93], v219 offset:11808
    ds_read_b64_tr_b16 a[94:95], v219 offset:11936
    s_waitcnt lgkmcnt(0)
    v_bfe_u32 v16, v0, 0, 3
    v_lshlrev_b32 v18, 11, v16
    v_bfe_u32 v16, v0, 3, 3
    v_lshl_add_u32 v18, v16, 4, v18
    s_lshl_b32 s49, s32, 9
    buffer_load_dwordx4 v[28:31], v18, s[28:31], s49 offen offset:0
    buffer_load_dwordx4 v[32:35], v18, s[28:31], s49 offen offset:128
    buffer_load_dwordx4 v[36:39], v18, s[28:31], s49 offen offset:256
    buffer_load_dwordx4 v[40:43], v18, s[28:31], s49 offen offset:384
    v_lshlrev_b32 v17, 5, v0
    v_min_u32 v17, 0xe4, v17
    v_cmp_eq_u32 vcc, 9, v0
    s_nop 1
    v_cndmask_b32 v16, 0, 4, vcc
    v_add_u32 v17, v17, v16
    buffer_load_dword v16, v17, s[8:11], 0 offen sc1
    s_add_u32 s50, s56, 0x180000
    buffer_load_dwordx4 a[144:147], v220, s[12:15], s50 offen nt
    s_add_u32 s50, s56, 0x190000
    buffer_load_dwordx4 a[148:151], v220, s[12:15], s50 offen nt
    s_add_u32 s50, s56, 0x1a0000
    buffer_load_dwordx4 a[152:155], v220, s[12:15], s50 offen nt
    s_add_u32 s50, s56, 0x1b0000
    buffer_load_dwordx4 a[156:159], v220, s[12:15], s50 offen nt
    s_add_u32 s50, s56, 0x1c0000
    buffer_load_dwordx4 a[160:163], v220, s[12:15], s50 offen nt
    s_add_u32 s50, s56, 0x1d0000
    buffer_load_dwordx4 a[164:167], v220, s[12:15], s50 offen nt
    s_add_u32 s50, s56, 0x1e0000
    buffer_load_dwordx4 a[168:171], v220, s[12:15], s50 offen nt
    s_add_u32 s50, s56, 0x1f0000
    buffer_load_dwordx4 a[172:175], v220, s[12:15], s50 offen nt
    s_cmp_eq_u32 s32, 0
    s_cbranch_scc1 L_hk12
    s_cmp_eq_u32 s32, 1
    s_cbranch_scc1 L_hk13
    s_cmp_eq_u32 s32, 2
    s_cbranch_scc1 L_hk14
    s_branch L_hk15
L_hkret3:
    s_waitcnt vmcnt(17)
    ds_write_b128 v217, a[96:99] offset:0
    ds_write_b128 v217, a[100:103] offset:1088
    ds_write_b128 v217, a[104:107] offset:2176
    ds_write_b128 v217, a[108:111] offset:3264
    ds_write_b128 v217, a[112:115] offset:4352
    ds_write_b128 v217, a[116:119] offset:5440
    ds_write_b128 v217, a[120:123] offset:6528
    ds_write_b128 v217, a[124:127] offset:7616
    s_waitcnt lgkmcnt(4)
    ds_read_b64_tr_b16 a[96:97], v218 offset:0
    ds_read_b64_tr_b16 a[98:99], v218 offset:256
    ds_read_b64_tr_b16 a[100:101], v218 offset:4352
    ds_read_b64_tr_b16 a[102:103], v218 offset:4608
    ds_read_b64_tr_b16 a[104:105], v218 offset:32
    ds_read_b64_tr_b16 a[106:107], v218 offset:288
    ds_read_b64_tr_b16 a[108:109], v218 offset:4384
    ds_read_b64_tr_b16 a[110:111], v218 offset:4640
    s_waitcnt lgkmcnt(4)
    ds_read_b64_tr_b16 a[112:113], v218 offset:64
    ds_read_b64_tr_b16 a[114:115], v218 offset:320
    ds_read_b64_tr_b16 a[116:117], v218 offset:4416
    ds_read_b64_tr_b16 a[118:119], v218 offset:4672
    ds_read_b64_tr_b16 a[120:121], v218 offset:96
    ds_read_b64_tr_b16 a[122:123], v218 offset:352
    ds_read_b64_tr_b16 a[124:125], v218 offset:4448
    ds_read_b64_tr_b16 a[126:127], v218 offset:4704
    s_add_u32 s50, s54, 0x180000
    buffer_load_dwordx4 a[176:179], v216, s[20:23], s50 offen
    s_add_u32 s50, s54, 0x1a0000
    buffer_load_dwordx4 a[180:183], v216, s[20:23], s50 offen
    s_add_u32 s50, s54, 0x1c0000
    buffer_load_dwordx4 a[184:187], v216, s[20:23], s50 offen
    s_add_u32 s50, s54, 0x1e0000
    buffer_load_dwordx4 a[188:191], v216, s[20:23], s50 offen
    s_cmp_eq_u32 s32, 0
    s_cbranch_scc1 L_hk24
    s_cmp_eq_u32 s32, 1
    s_cbranch_scc1 L_hk25
    s_cmp_eq_u32 s32, 2
    s_cbranch_scc1 L_hk26
    s_branch L_hk27
L_hkret6:
    s_waitcnt vmcnt(12) lgkmcnt(0)
    ds_write_b128 v221, a[128:131] offset:9216
    ds_write_b128 v221, a[132:135] offset:10496
    ds_write_b128 v221, a[136:139] offset:11776
    ds_write_b128 v221, a[140:143] offset:13056
    ds_read_b64_tr_b16 a[128:129], v219 offset:9216
    ds_read_b64_tr_b16 a[130:131], v219 offset:9344
    ds_read_b64_tr_b16 a[132:133], v219 offset:11776
    ds_read_b64_tr_b16 a[134:135], v219 offset:11904
    ds_read_b64_tr_b16 a[136:137], v219 offset:9248
    ds_read_b64_tr_b16 a[138:139], v219 offset:9376
    ds_read_b64_tr_b16 a[140:141], v219 offset:11808
    ds_read_b64_tr_b16 a[142:143], v219 offset:11936
    s_waitcnt lgkmcnt(0)
    s_branch L_wi_5
L_wi_3:
    v_lshlrev_b32 v17, 5, v0
    v_min_u32 v17, 0xe4, v17
    v_cmp_eq_u32 vcc, 9, v0
    s_nop 1
    v_cndmask_b32 v16, 0, 4, vcc
    v_add_u32 v17, v17, v16
    buffer_load_dword v16, v17, s[8:11], 0 offen sc1
    s_waitcnt vmcnt(0)
L_wi_5:
    v_bcnt_u32_b32 v17, v16, 0
    s_nop 0
    v_readlane_b32 s49, v17, 0
    v_readlane_b32 s50, v17, 1
    s_nop 0
    s_add_u32 s49, s49, s50
    v_readlane_b32 s50, v17, 2
    s_nop 0
    s_add_u32 s49, s49, s50
    v_readlane_b32 s50, v17, 3
    s_nop 0
    s_add_u32 s49, s49, s50
    v_readlane_b32 s50, v17, 4
    s_nop 0
    s_add_u32 s49, s49, s50
    v_readlane_b32 s50, v17, 5
    s_nop 0
    s_add_u32 s49, s49, s50
    v_readlane_b32 s50, v17, 6
    s_nop 0
    s_add_u32 s49, s49, s50
    v_readlane_b32 s50, v17, 7
    s_nop 0
    s_add_u32 s49, s49, s50
    v_readlane_b32 s50, v16, 9
    s_nop 0
    s_add_u32 s49, s49, s50
    v_readlane_b32 s62, v16, 8
    s_nop 0
    s_lshr_b32 s50, s62, 16
    s_add_u32 s49, s49, s50
    s_cmp_ge_u32 s49, 272
    s_cbranch_scc1 L_wiok_4
    s_sleep 8
    s_sub_u32 s35, s35, 1
    s_cbranch_scc0 L_wi_3
    s_endpgm
L_wiok_4:
    s_and_b32 s62, s62, 0xffff
    s_cmp_gt_u32 s62, 8
    s_cselect_b32 s62, 0x2000, 0
    s_lshr_b32 s49, s63, 5
    v_readlane_b32 s101, v17, s49
    s_lshl_b32 s49, s63, 2
    s_add_u32 s49, s49, s32
    s_lshl_b32 s49, s49, 9
    s_add_u32 s50, s49, 0x3fe00
    v_cmp_gt_u32 vcc, 4, v0
    v_mov_b32 v16, s50
    s_nop 0
    v_cndmask_b32 v16, v16, 0, vcc
    v_min_u32 v17, 11, v0
    v_lshl_add_u32 v17, v17, 7, v16
    s_add_u32 s49, s49, 0xe440000
    buffer_load_dword v252, v17, s[4:7], s49 offen sc1
    v_bfe_u32 v16, v0, 0, 3
    v_lshlrev_b32 v253, 7, v16
    v_bfe_u32 v16, v0, 3, 3
    v_lshl_add_u32 v253, v16, 28, v253
    s_lshl_b32 s49, s33, 2
    s_add_u32 s49, s49, s32
    s_lshl_b32 s51, s49, 8
    s_add_u32 s51, s51, 0xe430000
    s_lshr_b32 s50, s51, 8
    s_xor_b32 s50, s50, s62
    s_and_b32 s50, s50, 0x2000
    s_xor_b32 s51, s51, s50
    v_bfe_u32 v16, v0, 0, 1
    v_lshlrev_b32 v23, 7, v16
    v_add_u32 v23, s51, v23
    s_mul_i32 s42, s49, 0x208000
    s_lshr_b32 s50, s42, 8
    s_xor_b32 s50, s50, s62
    s_and_b32 s50, s50, 0x2000
    s_xor_b32 s42, s42, s50
    s_add_u32 s44, s42, 0x4000000
    s_add_u32 s42, s42, 0x0
    s_add_u32 s43, s42, 4096
    s_add_u32 s45, s44, 4096
    s_and_b32 s50, s34, 7
    s_lshl_b32 s50, s50, 10
    s_cmp_lt_u32 s34, 8
    s_cselect_b32 s55, s42, s44
    s_add_u32 s55, s55, s50
    s_add_u32 s55, s55, 0x4000
    s_lshl_b32 s46, s34, 1
    s_lshr_b32 s50, s32, 1
    s_add_u32 s46, s46, s50
    s_mul_i32 s46, s46, 0x208000
    s_and_b32 s50, s32, 1
    s_lshl_b32 s50, s50, 12
    s_add_u32 s46, s46, s50
    s_add_u32 s46, s46, 0xa000000
    s_lshr_b32 s50, s46, 8
    s_xor_b32 s50, s50, s62
    s_and_b32 s50, s50, 0x2000
    s_xor_b32 s46, s46, s50
    s_lshl_b32 s50, s33, 8
    s_add_u32 s47, s46, s50
    s_and_b32 s50, s50, 1024
    s_add_u32 s46, s46, s50
    s_xor_b32 s57, s46, 1024
    s_lshl_b32 s49, s33, 1
    s_lshr_b32 s50, s34, 3
    s_add_u32 s49, s49, s50
    s_mul_i32 s48, s49, 0x208000
    s_lshr_b32 s50, s48, 8
    s_xor_b32 s50, s50, s62
    s_and_b32 s50, s50, 0x2000
    s_xor_b32 s48, s48, s50
    s_bfe_u32 s50, s34, 0x10002
    s_lshl_b32 s50, s50, 12
    s_add_u32 s48, s48, s50
    s_add_u32 s48, s48, 0x7fff800
    s_mov_b32 s56, 0
    s_mov_b32 s0, 0x810892af
    s_mov_b32 s1, 0x8080
    s_mov_b32 s54, 0
    s_mov_b32 s2, s53
    buffer_load_dword v24, v23, s[4:7], 0 offen sc1
    v_min_u32 v28, -2, v28
    v_min_u32 v29, -2, v29
    v_min_u32 v30, -2, v30
    v_min_u32 v31, -2, v31
    s_nop 0
    v_min_u32 v32, -2, v32
    v_min_u32 v33, -2, v33
    v_min_u32 v34, -2, v34
    v_min_u32 v35, -2, v35
    s_nop 0
    v_min_u32 v36, -2, v36
    v_min_u32 v37, -2, v37
    v_min_u32 v38, -2, v38
    v_min_u32 v39, -2, v39
    s_nop 0
    v_min_u32 v40, -2, v40
    v_min_u32 v41, -2, v41
    v_min_u32 v42, -2, v42
    v_min_u32 v43, -2, v43
    s_mov_b32 s52, 0
    v_mov_b32 v44, 0
    v_mov_b32 v45, 0
    v_mov_b32 v46, 0
    v_mov_b32 v47, 0
    s_nop 0
    v_mov_b32 v48, 0
    v_mov_b32 v49, 0
    v_mov_b32 v50, 0
    v_mov_b32 v51, 0
    s_nop 0
    v_mov_b32 v52, 0
    v_mov_b32 v53, 0
    v_mov_b32 v54, 0
    v_mov_b32 v55, 0
    s_nop 0
    v_mov_b32 v56, 0
    v_mov_b32 v57, 0
    v_mov_b32 v58, 0
    v_mov_b32 v59, 0
    s_nop 0
    v_mov_b32 v60, 0
    v_mov_b32 v61, 0
    v_mov_b32 v62, 0
    v_mov_b32 v63, 0
    s_nop 0
    v_mov_b32 v64, 0
    v_mov_b32 v65, 0
    v_mov_b32 v66, 0
    v_mov_b32 v67, 0
    s_nop 0
    v_mov_b32 v172, 0
    v_mov_b32 v173, 0
    v_mov_b32 v174, 0
    v_mov_b32 v175, 0
    s_waitcnt vmcnt(6)
    ds_write_b128 v217, a[144:147] offset:0
    ds_write_b128 v217, a[148:151] offset:1088
    ds_write_b128 v217, a[152:155] offset:2176
    ds_write_b128 v217, a[156:159] offset:3264
    ds_write_b128 v217, a[160:163] offset:4352
    ds_write_b128 v217, a[164:167] offset:5440
    ds_write_b128 v217, a[168:171] offset:6528
    ds_write_b128 v217, a[172:175] offset:7616
    s_waitcnt lgkmcnt(4)
    ds_read_b64_tr_b16 a[144:145], v218 offset:0
    ds_read_b64_tr_b16 a[146:147], v218 offset:256
    ds_read_b64_tr_b16 a[148:149], v218 offset:4352
    ds_read_b64_tr_b16 a[150:151], v218 offset:4608
    ds_read_b64_tr_b16 a[152:153], v218 offset:32
    ds_read_b64_tr_b16 a[154:155], v218 offset:288
    ds_read_b64_tr_b16 a[156:157], v218 offset:4384
    ds_read_b64_tr_b16 a[158:159], v218 offset:4640
    s_waitcnt lgkmcnt(4)
    ds_read_b64_tr_b16 a[160:161], v218 offset:64
    ds_read_b64_tr_b16 a[162:163], v218 offset:320
    ds_read_b64_tr_b16 a[164:165], v218 offset:4416
    ds_read_b64_tr_b16 a[166:167], v218 offset:4672
    ds_read_b64_tr_b16 a[168:169], v218 offset:96
    ds_read_b64_tr_b16 a[170:171], v218 offset:352
    ds_read_b64_tr_b16 a[172:173], v218 offset:4448
    ds_read_b64_tr_b16 a[174:175], v218 offset:4704
    s_waitcnt vmcnt(2) lgkmcnt(0)
    ds_write_b128 v221, a[176:179] offset:9216
    ds_write_b128 v221, a[180:183] offset:10496
    ds_write_b128 v221, a[184:187] offset:11776
    ds_write_b128 v221, a[188:191] offset:13056
    ds_read_b64_tr_b16 a[176:177], v219 offset:9216
    ds_read_b64_tr_b16 a[178:179], v219 offset:9344
    ds_read_b64_tr_b16 a[180:181], v219 offset:11776
    ds_read_b64_tr_b16 a[182:183], v219 offset:11904
    ds_read_b64_tr_b16 a[184:185], v219 offset:9248
    ds_read_b64_tr_b16 a[186:187], v219 offset:9376
    ds_read_b64_tr_b16 a[188:189], v219 offset:11808
    ds_read_b64_tr_b16 a[190:191], v219 offset:11936
    s_waitcnt lgkmcnt(0)
    s_waitcnt vmcnt(0)
    v_readlane_b32 s51, v24, 0
    v_readlane_b32 s50, v24, 1
    s_add_u32 s49, s36, 1
    s_min_u32 s49, s49, 64
    s_min_i32 s50, s50, s51
    s_max_i32 s56, s56, s50
    s_cmp_lt_i32 s56, s49
    s_cbranch_scc1 L_c_nokv
    s_sub_u32 s49, s55, 0x4000
    buffer_load_dword v252, v253, s[4:7], s49 offen sc1
    buffer_load_dwordx4 v[132:135], v1, s[4:7], s44 offen offset:0 sc1
    buffer_load_dwordx4 v[136:139], v1, s[4:7], s44 offen offset:1024 sc1
    buffer_load_dwordx4 v[140:143], v1, s[4:7], s44 offen offset:2048 sc1
    buffer_load_dwordx4 v[144:147], v1, s[4:7], s44 offen offset:3072 sc1
    buffer_load_dwordx4 v[148:151], v1, s[4:7], s45 offen offset:0 sc1
    buffer_load_dwordx4 v[152:155], v1, s[4:7], s45 offen offset:1024 sc1
    buffer_load_dwordx4 v[156:159], v1, s[4:7], s45 offen offset:2048 sc1
    buffer_load_dwordx4 v[160:163], v1, s[4:7], s45 offen offset:3072 sc1
    buffer_load_dwordx4 v[100:103], v1, s[4:7], s42 offen offset:0 sc1
    buffer_load_dwordx4 v[104:107], v1, s[4:7], s42 offen offset:1024 sc1
    buffer_load_dwordx4 v[108:111], v1, s[4:7], s42 offen offset:2048 sc1
    buffer_load_dwordx4 v[112:115], v1, s[4:7], s42 offen offset:3072 sc1
    buffer_load_dwordx4 v[116:119], v1, s[4:7], s43 offen offset:0 sc1
    buffer_load_dwordx4 v[120:123], v1, s[4:7], s43 offen offset:1024 sc1
    buffer_load_dwordx4 v[124:127], v1, s[4:7], s43 offen offset:2048 sc1
    buffer_load_dwordx4 v[128:131], v1, s[4:7], s43 offen offset:3072 sc1
    s_branch L_c_kvok
L_c_nokv:
    s_add_u32 s42, s42, 0x40000000
    s_add_u32 s43, s43, 0x40000000
    s_add_u32 s44, s44, 0x40000000
L_c_kvok:
    s_cmp_lt_u32 s101, 32
    v_smfmac_f32_16x16x64_bf16 v[44:47], v[28:31], a[0:7], v6
    v_smfmac_f32_16x16x64_bf16 v[48:51], v[28:31], a[8:15], v6
    v_smfmac_f32_16x16x64_bf16 v[52:55], v[28:31], a[16:23], v6
    v_smfmac_f32_16x16x64_bf16 v[56:59], v[28:31], a[24:31], v6
    v_smfmac_f32_16x16x64_bf16 v[44:47], v[32:35], a[48:55], v6
    v_smfmac_f32_16x16x64_bf16 v[48:51], v[32:35], a[56:63], v6
    v_smfmac_f32_16x16x64_bf16 v[52:55], v[32:35], a[64:71], v6
    v_smfmac_f32_16x16x64_bf16 v[56:59], v[32:35], a[72:79], v6
    v_smfmac_f32_16x16x64_bf16 v[44:47], v[36:39], a[96:103], v6
    v_smfmac_f32_16x16x64_bf16 v[48:51], v[36:39], a[104:111], v6
    v_smfmac_f32_16x16x64_bf16 v[52:55], v[36:39], a[112:119], v6
    v_smfmac_f32_16x16x64_bf16 v[56:59], v[36:39], a[120:127], v6
    v_smfmac_f32_16x16x64_bf16 v[44:47], v[40:43], a[144:151], v6
    v_smfmac_f32_16x16x64_bf16 v[48:51], v[40:43], a[152:159], v6
    v_smfmac_f32_16x16x64_bf16 v[52:55], v[40:43], a[160:167], v6
    v_smfmac_f32_16x16x64_bf16 v[56:59], v[40:43], a[168:175], v6
    s_cbranch_scc1 L_T1_i
    s_branch L_T1
    .p2align 6
L_loop:
    s_waitcnt vmcnt(3)
    v_cmp_eq_u32 vcc, -1, v31
    v_smfmac_f32_16x16x64_bf16 v[44:47], v[28:31], a[0:7], v6
    v_smfmac_f32_16x16x64_bf16 v[48:51], v[28:31], a[8:15], v6
    s_cbranch_vccnz L_Z
    s_waitcnt vmcnt(2)
    v_cmp_eq_u32 vcc, -1, v35
    v_smfmac_f32_16x16x64_bf16 v[52:55], v[28:31], a[16:23], v6
    v_smfmac_f32_16x16x64_bf16 v[56:59], v[28:31], a[24:31], v6
    s_cbranch_vccnz L_G14_1
    v_smfmac_f32_16x16x64_bf16 v[44:47], v[32:35], a[48:55], v6
    v_smfmac_f32_16x16x64_bf16 v[48:51], v[32:35], a[56:63], v6
    s_waitcnt vmcnt(1)
    v_cmp_eq_u32 vcc, -1, v39
    v_smfmac_f32_16x16x64_bf16 v[52:55], v[32:35], a[64:71], v6
    v_smfmac_f32_16x16x64_bf16 v[56:59], v[32:35], a[72:79], v6
    s_cbranch_vccnz L_G12_2
    v_smfmac_f32_16x16x64_bf16 v[44:47], v[36:39], a[96:103], v6
    v_smfmac_f32_16x16x64_bf16 v[48:51], v[36:39], a[104:111], v6
    s_waitcnt vmcnt(0)
    v_cmp_eq_u32 vcc, -1, v43
    v_smfmac_f32_16x16x64_bf16 v[52:55], v[36:39], a[112:119], v6
    v_smfmac_f32_16x16x64_bf16 v[56:59], v[36:39], a[120:127], v6
    s_cbranch_vccnz L_F8_3
    v_smfmac_f32_16x16x64_bf16 v[44:47], v[40:43], a[144:151], v6
    v_smfmac_f32_16x16x64_bf16 v[48:51], v[40:43], a[152:159], v6
    v_smfmac_f32_16x16x64_bf16 v[52:55], v[40:43], a[160:167], v6
    v_smfmac_f32_16x16x64_bf16 v[56:59], v[40:43], a[168:175], v6
L_T1:
    v_permlane32_swap_b32 v44, v46
    v_permlane32_swap_b32 v45, v47
    v_permlane32_swap_b32 v48, v50
    v_permlane32_swap_b32 v49, v51
    v_pk_add_f32 v[232:233], v[44:45], v[46:47]
    v_pk_add_f32 v[234:235], v[48:49], v[50:51]
    ds_write2st64_b64 v8, v[232:233], v[234:235] offset0:0 offset1:1
    v_permlane32_swap_b32 v52, v54
    v_permlane32_swap_b32 v53, v55
    v_permlane32_swap_b32 v56, v58
    v_permlane32_swap_b32 v57, v59
    v_pk_add_f32 v[236:237], v[52:53], v[54:55]
    v_pk_add_f32 v[238:239], v[56:57], v[58:59]
    ds_write2st64_b64 v8, v[236:237], v[238:239] offset0:2 offset1:3
    v_smfmac_f32_16x16x64_bf16 v[60:63], v[28:31], a[32:39], v6
    buffer_load_dwordx4 v[120:123], v1, s[4:7], s43 offen offset:1024 sc1
    v_smfmac_f32_16x16x64_bf16 v[64:67], v[28:31], a[40:47], v6
    v_smfmac_f32_16x16x64_bf16 v[60:63], v[32:35], a[80:87], v6
    buffer_load_dwordx4 v[124:127], v1, s[4:7], s43 offen offset:2048 sc1
    v_smfmac_f32_16x16x64_bf16 v[64:67], v[32:35], a[88:95], v6
    s_waitcnt lgkmcnt(0)
    s_barrier
    ds_read2st64_b32 v[92:93], v10 offset0:0 offset1:2
    ds_read2st64_b32 v[94:95], v10 offset0:12 offset1:14
    ds_read2st64_b32 v[96:97], v10 offset0:24 offset1:26
    ds_read2st64_b32 v[98:99], v10 offset0:36 offset1:38
    v_smfmac_f32_16x16x64_bf16 v[60:63], v[36:39], a[128:135], v6
    buffer_load_dwordx4 v[128:131], v1, s[4:7], s43 offen offset:3072 sc1
    v_smfmac_f32_16x16x64_bf16 v[64:67], v[36:39], a[136:143], v6
    v_smfmac_f32_16x16x64_bf16 v[60:63], v[40:43], a[176:183], v6
    v_smfmac_f32_16x16x64_bf16 v[64:67], v[40:43], a[184:191], v6
    s_waitcnt lgkmcnt(2)
    v_pk_add_f32 v[92:93], v[92:93], v[94:95]
    s_waitcnt lgkmcnt(0)
    v_pk_add_f32 v[96:97], v[96:97], v[98:99]
    v_pk_add_f32 v[92:93], v[92:93], v[96:97]
    v_cvt_pk_bf16_f32 v20, v92, v93
    buffer_store_dword v20, v3, s[4:7], s39 offen
    v_permlane32_swap_b32 v60, v62
    v_permlane32_swap_b32 v61, v63
    v_permlane32_swap_b32 v64, v66
    v_permlane32_swap_b32 v65, v67
    v_pk_add_f32 v[240:241], v[60:61], v[62:63]
    v_pk_add_f32 v[242:243], v[64:65], v[66:67]
    ds_write2st64_b64 v9, v[240:241], v[242:243] offset0:4 offset1:5
    s_add_u32 s42, s42, 0x4000
    s_add_u32 s43, s43, 0x4000
    s_cmp_eq_u32 s36, s52
    s_cbranch_scc1 L_sp
L_spr:
    s_waitcnt lgkmcnt(0)
    s_barrier
    ds_read2st64_b32 v[92:93], v11 offset0:0 offset1:2
    ds_read2st64_b32 v[94:95], v11 offset0:12 offset1:14
    ds_read2st64_b32 v[96:97], v11 offset0:24 offset1:26
    ds_read2st64_b32 v[98:99], v11 offset0:36 offset1:38
    buffer_load_dwordx4 v[68:71], v1, s[4:7], s40 offen offset:0 sc1
    buffer_load_dwordx4 v[76:79], v1, s[4:7], s40 offen offset:1024 sc1
    s_waitcnt lgkmcnt(2)
    v_pk_add_f32 v[92:93], v[92:93], v[94:95]
    s_waitcnt lgkmcnt(0)
    v_pk_add_f32 v[96:97], v[96:97], v[98:99]
    v_pk_add_f32 v[92:93], v[92:93], v[96:97]
    v_cvt_pk_bf16_f32 v21, v92, v93
    buffer_store_dword v21, v4, s[4:7], s39 offen
    buffer_load_dwordx4 v[84:87], v1, s[4:7], s40 offen offset:2048 sc1
    buffer_load_dwordx4 v[88:91], v1, s[4:7], s40 offen offset:3072 sc1
L_h2:
    s_waitcnt vmcnt(4)
    v_mfma_f32_16x16x32_bf16 v[164:167], v[100:103], v[68:71], 0
    v_mov_b32_dpp v72, v68 row_ror:8 row_mask:0xf bank_mask:0xf
    v_mov_b32_dpp v73, v69 row_ror:8 row_mask:0xf bank_mask:0xf
    v_mfma_f32_16x16x32_bf16 v[168:171], v[116:119], v[68:71], 0
    v_mov_b32_dpp v74, v70 row_ror:8 row_mask:0xf bank_mask:0xf
    v_mov_b32_dpp v75, v71 row_ror:8 row_mask:0xf bank_mask:0xf
    s_waitcnt vmcnt(3)
    v_mfma_f32_16x16x32_bf16 v[164:167], v[108:111], v[76:79], v[164:167]
    v_max_u32 v19, v71, v79
    v_cmp_eq_u32 vcc, -1, v19
    v_mfma_f32_16x16x32_bf16 v[168:171], v[124:127], v[76:79], v[168:171]
    v_mov_b32_dpp v80, v76 row_ror:8 row_mask:0xf bank_mask:0xf
    v_mov_b32_dpp v81, v77 row_ror:8 row_mask:0xf bank_mask:0xf
    v_mfma_f32_16x16x32_bf16 v[164:167], v[104:107], v[72:75], v[164:167]
    v_mov_b32_dpp v82, v78 row_ror:8 row_mask:0xf bank_mask:0xf
    v_mov_b32_dpp v83, v79 row_ror:8 row_mask:0xf bank_mask:0xf
    v_mfma_f32_16x16x32_bf16 v[168:171], v[120:123], v[72:75], v[168:171]
    s_cbranch_vccnz L_r2
    v_mfma_f32_16x16x32_bf16 v[164:167], v[112:115], v[80:83], v[164:167]
    v_mfma_f32_16x16x32_bf16 v[168:171], v[128:131], v[80:83], v[168:171]
L_h2k:
    s_waitcnt vmcnt(1)
    v_smfmac_f32_16x16x64_bf16 v[172:175], v[84:87], v[68:75], v6
    s_waitcnt vmcnt(0)
    v_smfmac_f32_16x16x64_bf16 v[172:175], v[88:91], v[76:83], v6
    buffer_load_dwordx4 v[92:95], v1, s[4:7], s41 offen offset:0 sc1
    buffer_load_dwordx4 v[96:99], v1, s[4:7], s41 offen offset:1024 sc1
    v_max_u32 v19, v87, v91
    v_cmp_eq_u32 vcc, -1, v19
    v_max3_f32 v16, v22, v164, v165
    v_max3_f32 v16, v16, v166, v167
    v_max3_f32 v16, v16, v168, v169
    v_max3_f32 v16, v16, v170, v171
    v_permlane32_swap_b32 v172, v174
    v_permlane32_swap_b32 v173, v175
    v_pk_add_f32 v[172:173], v[172:173], v[174:175]
    v_max3_f32 v16, v16, v172, v173
    v_mov_b32 v17, v16
    s_cbranch_vccnz L_r2k
L_sj:
    buffer_load_dwordx4 v[132:135], v1, s[4:7], s44 offen offset:0 sc1
    v_permlane32_swap_b32 v16, v17
    v_max_f32 v16, v16, v17
    v_mov_b32 v17, v16
    buffer_load_dwordx4 v[136:139], v1, s[4:7], s44 offen offset:1024 sc1
    s_nop 0
    v_permlane16_swap_b32 v16, v17
    v_max_f32 v16, v16, v17
    v_mul_f32 v16, s53, v16
    v_fma_f32 v172, v172, s53, -v16
    v_fma_f32 v173, v173, s53, -v16
    v_fma_f32 v164, v164, s53, -v16
    v_fma_f32 v165, v165, s53, -v16
    v_fma_f32 v166, v166, s53, -v16
    v_fma_f32 v167, v167, s53, -v16
    v_fma_f32 v168, v168, s53, -v16
    v_fma_f32 v169, v169, s53, -v16
    v_fma_f32 v170, v170, s53, -v16
    v_fma_f32 v171, v171, s53, -v16
    v_exp_f32 v172, v172
    v_exp_f32 v173, v173
    v_exp_f32 v164, v164
    v_exp_f32 v165, v165
    v_exp_f32 v166, v166
    v_exp_f32 v167, v167
    v_exp_f32 v168, v168
    v_exp_f32 v169, v169
    v_exp_f32 v170, v170
    v_exp_f32 v171, v171
    v_cvt_pk_bf16_f32 v176, v164, v165
    v_cvt_pk_bf16_f32 v177, v166, v167
    v_cvt_pk_bf16_f32 v178, v168, v169
    v_cvt_pk_bf16_f32 v179, v170, v171
    v_cvt_pk_bf16_f32 v184, v172, v173
    v_cvt_pk_bf16_f32 v185, v172, v173
    v_mfma_f32_16x16x32_bf16 v[52:55], v[188:191], v[176:179], 0
    buffer_load_dwordx4 v[140:143], v1, s[4:7], s44 offen offset:2048 sc1
    v_mov_b32_dpp v180, v176 row_shr:8 row_mask:0xf bank_mask:0xc
    v_mov_b32_dpp v181, v177 row_shr:8 row_mask:0xf bank_mask:0xc
    v_mfma_f32_16x16x32_bf16 v[44:47], v[200:203], v[176:179], 0
    v_mov_b32_dpp v182, v178 row_shr:8 row_mask:0xf bank_mask:0xc
    v_mov_b32_dpp v183, v179 row_shr:8 row_mask:0xf bank_mask:0xc
    v_mfma_f32_16x16x32_bf16 v[48:51], v[208:211], v[176:179], 0
    buffer_load_dwordx4 v[144:147], v1, s[4:7], s44 offen offset:3072 sc1
    v_permlane32_swap_b32 v184, v185
    v_mfma_f32_16x16x32_bf16 v[44:47], v[204:207], v[180:183], v[44:47]
    s_waitcnt vmcnt(4)
    v_max_u32 v19, v95, v99
    v_cmp_eq_u32 vcc, -1, v19
    v_mfma_f32_16x16x32_bf16 v[48:51], v[212:215], v[180:183], v[48:51]
    v_mov_b32_dpp v186, v184 row_shr:8 row_mask:0xf bank_mask:0xc
    v_mov_b32_dpp v187, v185 row_shr:8 row_mask:0xf bank_mask:0xc
    v_mfma_f32_16x16x16_bf16 v[52:55], v[196:197], v[184:185], v[52:55]
    s_cbranch_vccnz L_r2v
L_h2v:
    v_smfmac_f32_16x16x64_bf16 v[216:219], v[92:95], a[192:199], v6
    buffer_load_dwordx4 v[148:151], v1, s[4:7], s45 offen offset:0 sc1
    v_smfmac_f32_16x16x64_bf16 v[216:219], v[96:99], a[200:207], v6
    buffer_load_dwordx4 v[152:155], v1, s[4:7], s45 offen offset:1024 sc1
    v_smfmac_f32_16x16x64_bf16 v[220:223], v[92:95], a[208:215], v6
    buffer_load_dwordx4 v[156:159], v1, s[4:7], s45 offen offset:2048 sc1
    v_rcp_f32 v17, v52
    v_smfmac_f32_16x16x64_bf16 v[220:223], v[96:99], a[216:223], v6
    buffer_load_dwordx4 v[160:163], v1, s[4:7], s45 offen offset:3072 sc1
    v_cvt_pk_bf16_f32 v232, v216, v217
    v_smfmac_f32_16x16x64_bf16 v[224:227], v[92:95], a[224:231], v6
    v_cvt_pk_bf16_f32 v233, v218, v219
    v_smfmac_f32_16x16x64_bf16 v[224:227], v[96:99], a[232:239], v6
    v_cvt_pk_bf16_f32 v234, v220, v221
    v_smfmac_f32_16x16x64_bf16 v[228:231], v[92:95], a[240:247], v6
    ds_write_b32 v14, v17
    v_cvt_pk_bf16_f32 v235, v222, v223
    v_smfmac_f32_16x16x64_bf16 v[228:231], v[96:99], a[248:255], v6
    v_cvt_pk_bf16_f32 v236, v224, v225
    v_mfma_f32_16x16x32_bf16 v[44:47], v[232:235], v[184:187], v[44:47]
    v_cvt_pk_bf16_f32 v237, v226, v227
    s_nop 1
    v_cvt_pk_bf16_f32 v238, v228, v229
    v_cvt_pk_bf16_f32 v239, v230, v231
    s_nop 1
    v_mfma_f32_16x16x32_bf16 v[48:51], v[236:239], v[184:187], v[48:51]
    ds_write_b128 v12, v[44:47]
    s_nop 4
    ds_write_b128 v12, v[48:51] offset:1024
    s_add_u32 s55, s55, 0x4000
    buffer_store_dword v20, v5, s[4:7], s48 offen sc1
    buffer_store_dword v21, v4, s[4:7], s48 offen sc1
    s_waitcnt lgkmcnt(0)
    s_barrier
    ds_read_b128 v[64:67], v15
    ds_read_b64 v[56:57], v13 offset:0
    ds_read_b64 v[58:59], v13 offset:2048
    ds_read_b64 v[60:61], v13 offset:4096
    ds_read_b64 v[62:63], v13 offset:6144
    buffer_load_dword v252, v253, s[4:7], s55 offen sc1
    s_waitcnt lgkmcnt(3)
    v_pk_mul_f32 v[56:57], v[56:57], v[64:65] op_sel:[0,0] op_sel_hi:[1,0]
    s_waitcnt lgkmcnt(2)
    v_pk_fma_f32 v[56:57], v[58:59], v[64:65], v[56:57] op_sel:[0,1,0] op_sel_hi:[1,1,1]
    s_waitcnt lgkmcnt(1)
    v_pk_fma_f32 v[56:57], v[60:61], v[66:67], v[56:57] op_sel:[0,0,0] op_sel_hi:[1,0,1]
    s_waitcnt lgkmcnt(0)
    v_pk_fma_f32 v[56:57], v[62:63], v[66:67], v[56:57] op_sel:[0,1,0] op_sel_hi:[1,1,1]
    v_cvt_pk_bf16_f32 v16, v56, v57
    buffer_store_dword v16, v2, s[4:7], s47 offen sc1
    s_waitcnt vmcnt(4)
    v_mfma_f32_16x16x32_bf16 v[216:219], v[132:135], a[192:195], 0
    buffer_load_dword v24, v23, s[4:7], s54 offen sc1
    v_mfma_f32_16x16x32_bf16 v[220:223], v[148:151], a[192:195], 0
    buffer_load_dwordx4 v[100:103], v1, s[4:7], s42 offen offset:0 sc1
    v_mfma_f32_16x16x32_bf16 v[216:219], v[136:139], a[196:199], v[216:219]
    buffer_load_dwordx4 v[104:107], v1, s[4:7], s42 offen offset:1024 sc1
    v_mfma_f32_16x16x32_bf16 v[220:223], v[152:155], a[196:199], v[220:223]
    buffer_load_dwordx4 v[108:111], v1, s[4:7], s42 offen offset:2048 sc1
    v_mfma_f32_16x16x32_bf16 v[216:219], v[140:143], a[200:203], v[216:219]
    buffer_load_dwordx4 v[112:115], v1, s[4:7], s42 offen offset:3072 sc1
    v_mfma_f32_16x16x32_bf16 v[220:223], v[156:159], a[200:203], v[220:223]
    s_bitcmp1_b32 s38, 14
    v_mfma_f32_16x16x32_bf16 v[216:219], v[144:147], a[204:207], v[216:219]
    s_cselect_b32 s49, 3, 1
    v_mfma_f32_16x16x32_bf16 v[220:223], v[160:163], a[204:207], v[220:223]
    s_lshl_b32 s49, s49, 14
    v_mfma_f32_16x16x32_bf16 v[224:227], v[132:135], a[208:211], 0
    s_xor_b32 s38, s38, s49
    v_mfma_f32_16x16x32_bf16 v[228:231], v[148:151], a[208:211], 0
    s_xor_b32 s37, s37, s49
    v_mfma_f32_16x16x32_bf16 v[224:227], v[136:139], a[212:215], v[224:227]
    s_xor_b32 s49, s38, 0x8000
    v_cvt_pk_bf16_f32 v200, v216, v217
    v_mfma_f32_16x16x32_bf16 v[228:231], v[152:155], a[212:215], v[228:231]
    buffer_store_dword v7, v194, s[4:7], s49 offen
    v_cvt_pk_bf16_f32 v201, v218, v219
    v_mfma_f32_16x16x32_bf16 v[224:227], v[140:143], a[216:219], v[224:227]
    s_xor_b32 s39, s39, 0x8000
    v_cvt_pk_bf16_f32 v202, v220, v221
    v_mfma_f32_16x16x32_bf16 v[228:231], v[156:159], a[216:219], v[228:231]
    buffer_store_dword v7, v3, s[4:7], s39 offen
    v_cvt_pk_bf16_f32 v203, v222, v223
    v_mfma_f32_16x16x32_bf16 v[224:227], v[144:147], a[220:223], v[224:227]
    buffer_store_dword v7, v4, s[4:7], s39 offen
    v_mfma_f32_16x16x32_bf16 v[228:231], v[160:163], a[220:223], v[228:231]
    s_xor_b32 s40, s40, 0x8000
    v_mfma_f32_16x16x32_bf16 v[232:235], v[132:135], a[224:227], 0
    s_xor_b32 s41, s41, 0x8000
    v_mfma_f32_16x16x32_bf16 v[236:239], v[148:151], a[224:227], 0
    s_add_u32 s48, s48, 0x4000
    v_mfma_f32_16x16x32_bf16 v[232:235], v[136:139], a[228:231], v[232:235]
    s_add_u32 s47, s47, 0x4000
    v_cvt_pk_bf16_f32 v204, v224, v225
    v_mfma_f32_16x16x32_bf16 v[236:239], v[152:155], a[228:231], v[236:239]
    s_add_u32 s44, s44, 0x4000
    v_cvt_pk_bf16_f32 v205, v226, v227
    v_mfma_f32_16x16x32_bf16 v[232:235], v[140:143], a[232:235], v[232:235]
    s_add_u32 s45, s45, 0x4000
    v_cvt_pk_bf16_f32 v206, v228, v229
    v_mfma_f32_16x16x32_bf16 v[236:239], v[156:159], a[232:235], v[236:239]
    v_cvt_pk_bf16_f32 v207, v230, v231
    v_mfma_f32_16x16x32_bf16 v[232:235], v[144:147], a[236:239], v[232:235]
    v_mfma_f32_16x16x32_bf16 v[236:239], v[160:163], a[236:239], v[236:239]
    v_mfma_f32_16x16x32_bf16 v[240:243], v[132:135], a[240:243], 0
    buffer_load_dwordx2 v[166:167], v195, s[4:7], s46 offen sc1
    buffer_load_dwordx2 v[170:171], v195, s[4:7], s57 offen sc1
    v_mfma_f32_16x16x32_bf16 v[244:247], v[148:151], a[240:243], 0
    v_mfma_f32_16x16x32_bf16 v[240:243], v[136:139], a[244:247], v[240:243]
    v_cvt_pk_bf16_f32 v208, v232, v233
    v_mfma_f32_16x16x32_bf16 v[244:247], v[152:155], a[244:247], v[244:247]
    v_cvt_pk_bf16_f32 v209, v234, v235
    v_mfma_f32_16x16x32_bf16 v[240:243], v[140:143], a[248:251], v[240:243]
    v_cvt_pk_bf16_f32 v210, v236, v237
    v_mfma_f32_16x16x32_bf16 v[244:247], v[156:159], a[248:251], v[244:247]
    v_cvt_pk_bf16_f32 v211, v238, v239
    v_mfma_f32_16x16x32_bf16 v[240:243], v[144:147], a[252:255], v[240:243]
    v_mfma_f32_16x16x32_bf16 v[244:247], v[160:163], a[252:255], v[244:247]
    s_nop 3
    s_nop 0
    s_nop 3
    buffer_load_dwordx4 v[116:119], v1, s[4:7], s43 offen offset:0 sc1
    s_nop 0
    s_nop 0
    v_cvt_pk_bf16_f32 v212, v240, v241
    v_cvt_pk_bf16_f32 v213, v242, v243
    v_cvt_pk_bf16_f32 v214, v244, v245
    v_cvt_pk_bf16_f32 v215, v246, v247
L_h3:
    s_waitcnt vmcnt(2)
    v_mfma_f32_16x16x16_bf16 v[176:179], v[192:193], v[166:167], 0
    s_waitcnt vmcnt(1)
    v_mfma_f32_16x16x16_bf16 v[176:179], v[192:193], v[170:171], v[176:179]
    v_max_u32 v16, v167, v171
    v_cmp_eq_u32 vcc, -1, v16
    s_cbranch_vccnz L_r3
L_h3ok:
    v_cvt_pk_bf16_f32 v16, v176, v177
    buffer_store_dword v16, v194, s[4:7], s38 offen
    s_add_u32 s36, s36, 1
    s_bitcmp1_b64 s[0:1], s36
    s_cselect_b32 s54, 0, 0x40000000
    s_add_u32 s46, s46, 0x4000
    s_add_u32 s57, s57, 0x4000
    v_mov_b32 v44, 0
    v_mov_b32 v45, 0
    v_mov_b32 v46, 0
    v_mov_b32 v47, 0
    s_nop 0
    v_mov_b32 v48, 0
    v_mov_b32 v49, 0
    v_mov_b32 v50, 0
    v_mov_b32 v51, 0
    s_nop 0
    v_mov_b32 v52, 0
    v_mov_b32 v53, 0
    v_mov_b32 v54, 0
    v_mov_b32 v55, 0
    s_nop 0
    v_mov_b32 v56, 0
    v_mov_b32 v57, 0
    v_mov_b32 v58, 0
    v_mov_b32 v59, 0
    buffer_load_dwordx4 v[28:31], v1, s[4:7], s37 offen offset:0 sc1
    v_mov_b32 v60, 0
    v_mov_b32 v61, 0
    v_mov_b32 v62, 0
    v_mov_b32 v63, 0
    s_nop 0
    v_mov_b32 v64, 0
    v_mov_b32 v65, 0
    v_mov_b32 v66, 0
    v_mov_b32 v67, 0
    s_nop 0
    v_mov_b32 v216, 0
    v_mov_b32 v217, 0
    v_mov_b32 v218, 0
    v_mov_b32 v219, 0
    buffer_load_dwordx4 v[32:35], v1, s[4:7], s37 offen offset:1024 sc1
    v_mov_b32 v220, 0
    v_mov_b32 v221, 0
    v_mov_b32 v222, 0
    v_mov_b32 v223, 0
    s_nop 0
    v_mov_b32 v224, 0
    v_mov_b32 v225, 0
    v_mov_b32 v226, 0
    v_mov_b32 v227, 0
    s_nop 0
    v_mov_b32 v228, 0
    v_mov_b32 v229, 0
    v_mov_b32 v230, 0
    v_mov_b32 v231, 0
    buffer_load_dwordx4 v[36:39], v1, s[4:7], s37 offen offset:2048 sc1
    v_mov_b32 v172, 0
    v_mov_b32 v173, 0
    v_mov_b32 v174, 0
    v_mov_b32 v175, 0
    v_readlane_b32 s51, v24, 0
    v_readlane_b32 s50, v24, 1
    s_add_u32 s49, s36, 2
    s_min_u32 s49, s49, 64
    s_min_i32 s50, s50, s51
    s_max_i32 s56, s56, s50
    s_cmp_lt_i32 s56, s49
    buffer_load_dwordx4 v[40:43], v1, s[4:7], s37 offen offset:3072 sc1
    s_cbranch_scc0 L_loop
    s_branch L_kvw
    .p2align 6
L_hk0:
    s_branch L_hk28
L_G15_0:
L_Z:
    buffer_load_dwordx4 v[28:31], v1, s[4:7], s37 offen offset:0 sc1
    s_nop 1
    v_mov_b64 v[44:45], 0
    v_mov_b64 v[46:47], 0
    s_nop 1
    v_mov_b64 v[48:49], 0
    v_mov_b64 v[50:51], 0
L_dr0:
    s_waitcnt vmcnt(3)
    v_cmp_eq_u32 vcc, -1, v35
    s_cbranch_vccnz L_G15_1
    v_smfmac_f32_16x16x64_bf16 v[44:47], v[32:35], a[48:55], v6
    v_smfmac_f32_16x16x64_bf16 v[48:51], v[32:35], a[56:63], v6
    s_waitcnt vmcnt(2)
    v_cmp_eq_u32 vcc, -1, v39
    v_smfmac_f32_16x16x64_bf16 v[52:55], v[32:35], a[64:71], v6
    v_smfmac_f32_16x16x64_bf16 v[56:59], v[32:35], a[72:79], v6
    s_cbranch_vccnz L_G13_2
    v_smfmac_f32_16x16x64_bf16 v[44:47], v[36:39], a[96:103], v6
    v_smfmac_f32_16x16x64_bf16 v[48:51], v[36:39], a[104:111], v6
    s_waitcnt vmcnt(1)
    v_cmp_eq_u32 vcc, -1, v43
    v_smfmac_f32_16x16x64_bf16 v[52:55], v[36:39], a[112:119], v6
    v_smfmac_f32_16x16x64_bf16 v[56:59], v[36:39], a[120:127], v6
    s_cbranch_vccnz L_G9_3
    v_smfmac_f32_16x16x64_bf16 v[44:47], v[40:43], a[144:151], v6
    v_smfmac_f32_16x16x64_bf16 v[48:51], v[40:43], a[152:159], v6
    s_waitcnt vmcnt(0)
    v_cmp_eq_u32 vcc, -1, v31
    v_smfmac_f32_16x16x64_bf16 v[52:55], v[40:43], a[160:167], v6
    v_smfmac_f32_16x16x64_bf16 v[56:59], v[40:43], a[168:175], v6
    s_cbranch_vccnz L_F1_0
    v_smfmac_f32_16x16x64_bf16 v[44:47], v[28:31], a[0:7], v6
    v_smfmac_f32_16x16x64_bf16 v[48:51], v[28:31], a[8:15], v6
    v_smfmac_f32_16x16x64_bf16 v[52:55], v[28:31], a[16:23], v6
    v_smfmac_f32_16x16x64_bf16 v[56:59], v[28:31], a[24:31], v6
    s_branch L_T1
L_hk1:
    s_branch L_hk29
    .p2align 6
L_hk2:
    s_branch L_hk30
L_G15_1:
    buffer_load_dwordx4 v[32:35], v1, s[4:7], s37 offen offset:1024 sc1
L_dr1:
    s_waitcnt vmcnt(3)
    v_cmp_eq_u32 vcc, -1, v39
    s_cbranch_vccnz L_G15_2
    v_smfmac_f32_16x16x64_bf16 v[44:47], v[36:39], a[96:103], v6
    v_smfmac_f32_16x16x64_bf16 v[48:51], v[36:39], a[104:111], v6
    s_waitcnt vmcnt(2)
    v_cmp_eq_u32 vcc, -1, v43
    v_smfmac_f32_16x16x64_bf16 v[52:55], v[36:39], a[112:119], v6
    v_smfmac_f32_16x16x64_bf16 v[56:59], v[36:39], a[120:127], v6
    s_cbranch_vccnz L_G11_3
    v_smfmac_f32_16x16x64_bf16 v[44:47], v[40:43], a[144:151], v6
    v_smfmac_f32_16x16x64_bf16 v[48:51], v[40:43], a[152:159], v6
    s_waitcnt vmcnt(1)
    v_cmp_eq_u32 vcc, -1, v31
    v_smfmac_f32_16x16x64_bf16 v[52:55], v[40:43], a[160:167], v6
    v_smfmac_f32_16x16x64_bf16 v[56:59], v[40:43], a[168:175], v6
    s_cbranch_vccnz L_G3_0
    v_smfmac_f32_16x16x64_bf16 v[44:47], v[28:31], a[0:7], v6
    v_smfmac_f32_16x16x64_bf16 v[48:51], v[28:31], a[8:15], v6
    s_waitcnt vmcnt(0)
    v_cmp_eq_u32 vcc, -1, v35
    v_smfmac_f32_16x16x64_bf16 v[52:55], v[28:31], a[16:23], v6
    v_smfmac_f32_16x16x64_bf16 v[56:59], v[28:31], a[24:31], v6
    s_cbranch_vccnz L_F2_1
    v_smfmac_f32_16x16x64_bf16 v[44:47], v[32:35], a[48:55], v6
    v_smfmac_f32_16x16x64_bf16 v[48:51], v[32:35], a[56:63], v6
    v_smfmac_f32_16x16x64_bf16 v[52:55], v[32:35], a[64:71], v6
    v_smfmac_f32_16x16x64_bf16 v[56:59], v[32:35], a[72:79], v6
    s_branch L_T1
L_hk3:
    s_branch L_hk31
    .p2align 6
L_hk4:
    s_branch L_hk32
L_G15_2:
    buffer_load_dwordx4 v[36:39], v1, s[4:7], s37 offen offset:2048 sc1
L_dr2:
    s_waitcnt vmcnt(3)
    v_cmp_eq_u32 vcc, -1, v43
    s_cbranch_vccnz L_G15_3
    v_smfmac_f32_16x16x64_bf16 v[44:47], v[40:43], a[144:151], v6
    v_smfmac_f32_16x16x64_bf16 v[48:51], v[40:43], a[152:159], v6
    s_waitcnt vmcnt(2)
    v_cmp_eq_u32 vcc, -1, v31
    v_smfmac_f32_16x16x64_bf16 v[52:55], v[40:43], a[160:167], v6
    v_smfmac_f32_16x16x64_bf16 v[56:59], v[40:43], a[168:175], v6
    s_cbranch_vccnz L_G7_0
    v_smfmac_f32_16x16x64_bf16 v[44:47], v[28:31], a[0:7], v6
    v_smfmac_f32_16x16x64_bf16 v[48:51], v[28:31], a[8:15], v6
    s_waitcnt vmcnt(1)
    v_cmp_eq_u32 vcc, -1, v35
    v_smfmac_f32_16x16x64_bf16 v[52:55], v[28:31], a[16:23], v6
    v_smfmac_f32_16x16x64_bf16 v[56:59], v[28:31], a[24:31], v6
    s_cbranch_vccnz L_G6_1
    v_smfmac_f32_16x16x64_bf16 v[44:47], v[32:35], a[48:55], v6
    v_smfmac_f32_16x16x64_bf16 v[48:51], v[32:35], a[56:63], v6
    s_waitcnt vmcnt(0)
    v_cmp_eq_u32 vcc, -1, v39
    v_smfmac_f32_16x16x64_bf16 v[52:55], v[32:35], a[64:71], v6
    v_smfmac_f32_16x16x64_bf16 v[56:59], v[32:35], a[72:79], v6
    s_cbranch_vccnz L_F4_2
    v_smfmac_f32_16x16x64_bf16 v[44:47], v[36:39], a[96:103], v6
    v_smfmac_f32_16x16x64_bf16 v[48:51], v[36:39], a[104:111], v6
    v_smfmac_f32_16x16x64_bf16 v[52:55], v[36:39], a[112:119], v6
    v_smfmac_f32_16x16x64_bf16 v[56:59], v[36:39], a[120:127], v6
    s_branch L_T1
L_hk5:
    s_branch L_hk33
    .p2align 6
L_hk6:
    s_branch L_hk34
L_G15_3:
    buffer_load_dwordx4 v[40:43], v1, s[4:7], s37 offen offset:3072 sc1
    s_sub_u32 s35, s35, 1
    s_cbranch_scc1 L_end0
L_dr3:
    s_waitcnt vmcnt(3)
    v_cmp_eq_u32 vcc, -1, v31
    s_cbranch_vccnz L_G15_0
    v_smfmac_f32_16x16x64_bf16 v[44:47], v[28:31], a[0:7], v6
    v_smfmac_f32_16x16x64_bf16 v[48:51], v[28:31], a[8:15], v6
    s_waitcnt vmcnt(2)
    v_cmp_eq_u32 vcc, -1, v35
    v_smfmac_f32_16x16x64_bf16 v[52:55], v[28:31], a[16:23], v6
    v_smfmac_f32_16x16x64_bf16 v[56:59], v[28:31], a[24:31], v6
    s_cbranch_vccnz L_G14_1
    v_smfmac_f32_16x16x64_bf16 v[44:47], v[32:35], a[48:55], v6
    v_smfmac_f32_16x16x64_bf16 v[48:51], v[32:35], a[56:63], v6
    s_waitcnt vmcnt(1)
    v_cmp_eq_u32 vcc, -1, v39
    v_smfmac_f32_16x16x64_bf16 v[52:55], v[32:35], a[64:71], v6
    v_smfmac_f32_16x16x64_bf16 v[56:59], v[32:35], a[72:79], v6
    s_cbranch_vccnz L_G12_2
    v_smfmac_f32_16x16x64_bf16 v[44:47], v[36:39], a[96:103], v6
    v_smfmac_f32_16x16x64_bf16 v[48:51], v[36:39], a[104:111], v6
    s_waitcnt vmcnt(0)
    v_cmp_eq_u32 vcc, -1, v43
    v_smfmac_f32_16x16x64_bf16 v[52:55], v[36:39], a[112:119], v6
    v_smfmac_f32_16x16x64_bf16 v[56:59], v[36:39], a[120:127], v6
    s_cbranch_vccnz L_F8_3
    v_smfmac_f32_16x16x64_bf16 v[44:47], v[40:43], a[144:151], v6
    v_smfmac_f32_16x16x64_bf16 v[48:51], v[40:43], a[152:159], v6
    v_smfmac_f32_16x16x64_bf16 v[52:55], v[40:43], a[160:167], v6
    v_smfmac_f32_16x16x64_bf16 v[56:59], v[40:43], a[168:175], v6
    s_branch L_T1
L_hk7:
    s_branch L_hk35
    .p2align 6
L_hk8:
    s_branch L_hk36
L_G7_0:
    buffer_load_dwordx4 v[28:31], v1, s[4:7], s37 offen offset:0 sc1
L_dr4:
    s_waitcnt vmcnt(2)
    v_cmp_eq_u32 vcc, -1, v35
    s_cbranch_vccnz L_G7_1
    v_smfmac_f32_16x16x64_bf16 v[44:47], v[32:35], a[48:55], v6
    v_smfmac_f32_16x16x64_bf16 v[48:51], v[32:35], a[56:63], v6
    s_waitcnt vmcnt(1)
    v_cmp_eq_u32 vcc, -1, v39
    v_smfmac_f32_16x16x64_bf16 v[52:55], v[32:35], a[64:71], v6
    v_smfmac_f32_16x16x64_bf16 v[56:59], v[32:35], a[72:79], v6
    s_cbranch_vccnz L_G5_2
    v_smfmac_f32_16x16x64_bf16 v[44:47], v[36:39], a[96:103], v6
    v_smfmac_f32_16x16x64_bf16 v[48:51], v[36:39], a[104:111], v6
    v_smfmac_f32_16x16x64_bf16 v[52:55], v[36:39], a[112:119], v6
    v_smfmac_f32_16x16x64_bf16 v[56:59], v[36:39], a[120:127], v6
    s_waitcnt vmcnt(0)
    v_cmp_eq_u32 vcc, -1, v31
    s_cbranch_vccnz L_F1_0
    v_smfmac_f32_16x16x64_bf16 v[44:47], v[28:31], a[0:7], v6
    v_smfmac_f32_16x16x64_bf16 v[48:51], v[28:31], a[8:15], v6
    v_smfmac_f32_16x16x64_bf16 v[52:55], v[28:31], a[16:23], v6
    v_smfmac_f32_16x16x64_bf16 v[56:59], v[28:31], a[24:31], v6
    s_branch L_T1
L_hk9:
    s_branch L_hk37
    .p2align 6
L_hk10:
    s_branch L_hk38
L_G7_1:
    buffer_load_dwordx4 v[32:35], v1, s[4:7], s37 offen offset:1024 sc1
L_dr5:
    s_waitcnt vmcnt(2)
    v_cmp_eq_u32 vcc, -1, v39
    s_cbranch_vccnz L_G7_2
    v_smfmac_f32_16x16x64_bf16 v[44:47], v[36:39], a[96:103], v6
    v_smfmac_f32_16x16x64_bf16 v[48:51], v[36:39], a[104:111], v6
    s_waitcnt vmcnt(1)
    v_cmp_eq_u32 vcc, -1, v31
    v_smfmac_f32_16x16x64_bf16 v[52:55], v[36:39], a[112:119], v6
    v_smfmac_f32_16x16x64_bf16 v[56:59], v[36:39], a[120:127], v6
    s_cbranch_vccnz L_G3_0
    v_smfmac_f32_16x16x64_bf16 v[44:47], v[28:31], a[0:7], v6
    v_smfmac_f32_16x16x64_bf16 v[48:51], v[28:31], a[8:15], v6
    v_smfmac_f32_16x16x64_bf16 v[52:55], v[28:31], a[16:23], v6
    v_smfmac_f32_16x16x64_bf16 v[56:59], v[28:31], a[24:31], v6
    s_waitcnt vmcnt(0)
    v_cmp_eq_u32 vcc, -1, v35
    s_cbranch_vccnz L_F2_1
    v_smfmac_f32_16x16x64_bf16 v[44:47], v[32:35], a[48:55], v6
    v_smfmac_f32_16x16x64_bf16 v[48:51], v[32:35], a[56:63], v6
    v_smfmac_f32_16x16x64_bf16 v[52:55], v[32:35], a[64:71], v6
    v_smfmac_f32_16x16x64_bf16 v[56:59], v[32:35], a[72:79], v6
    s_branch L_T1
L_hk11:
    s_branch L_hk39
    .p2align 6
L_hk12:
    s_branch L_hk40
L_G7_2:
    buffer_load_dwordx4 v[36:39], v1, s[4:7], s37 offen offset:2048 sc1
    s_sub_u32 s35, s35, 1
    s_cbranch_scc1 L_end0
L_dr6:
    s_waitcnt vmcnt(2)
    v_cmp_eq_u32 vcc, -1, v31
    s_cbranch_vccnz L_G7_0
    v_smfmac_f32_16x16x64_bf16 v[44:47], v[28:31], a[0:7], v6
    v_smfmac_f32_16x16x64_bf16 v[48:51], v[28:31], a[8:15], v6
    s_waitcnt vmcnt(1)
    v_cmp_eq_u32 vcc, -1, v35
    v_smfmac_f32_16x16x64_bf16 v[52:55], v[28:31], a[16:23], v6
    v_smfmac_f32_16x16x64_bf16 v[56:59], v[28:31], a[24:31], v6
    s_cbranch_vccnz L_G6_1
    v_smfmac_f32_16x16x64_bf16 v[44:47], v[32:35], a[48:55], v6
    v_smfmac_f32_16x16x64_bf16 v[48:51], v[32:35], a[56:63], v6
    v_smfmac_f32_16x16x64_bf16 v[52:55], v[32:35], a[64:71], v6
    v_smfmac_f32_16x16x64_bf16 v[56:59], v[32:35], a[72:79], v6
    s_waitcnt vmcnt(0)
    v_cmp_eq_u32 vcc, -1, v39
    s_cbranch_vccnz L_F4_2
    v_smfmac_f32_16x16x64_bf16 v[44:47], v[36:39], a[96:103], v6
    v_smfmac_f32_16x16x64_bf16 v[48:51], v[36:39], a[104:111], v6
    v_smfmac_f32_16x16x64_bf16 v[52:55], v[36:39], a[112:119], v6
    v_smfmac_f32_16x16x64_bf16 v[56:59], v[36:39], a[120:127], v6
    s_branch L_T1
L_hk13:
    s_branch L_hk41
    .p2align 6
L_hk14:
    s_branch L_hk42
L_G11_0:
    buffer_load_dwordx4 v[28:31], v1, s[4:7], s37 offen offset:0 sc1
L_dr7:
    s_waitcnt vmcnt(2)
    v_cmp_eq_u32 vcc, -1, v35
    s_cbranch_vccnz L_G11_1
    v_smfmac_f32_16x16x64_bf16 v[44:47], v[32:35], a[48:55], v6
    v_smfmac_f32_16x16x64_bf16 v[48:51], v[32:35], a[56:63], v6
    s_waitcnt vmcnt(1)
    v_cmp_eq_u32 vcc, -1, v43
    v_smfmac_f32_16x16x64_bf16 v[52:55], v[32:35], a[64:71], v6
    v_smfmac_f32_16x16x64_bf16 v[56:59], v[32:35], a[72:79], v6
    s_cbranch_vccnz L_G9_3
    v_smfmac_f32_16x16x64_bf16 v[44:47], v[40:43], a[144:151], v6
    v_smfmac_f32_16x16x64_bf16 v[48:51], v[40:43], a[152:159], v6
    v_smfmac_f32_16x16x64_bf16 v[52:55], v[40:43], a[160:167], v6
    v_smfmac_f32_16x16x64_bf16 v[56:59], v[40:43], a[168:175], v6
    s_waitcnt vmcnt(0)
    v_cmp_eq_u32 vcc, -1, v31
    s_cbranch_vccnz L_F1_0
    v_smfmac_f32_16x16x64_bf16 v[44:47], v[28:31], a[0:7], v6
    v_smfmac_f32_16x16x64_bf16 v[48:51], v[28:31], a[8:15], v6
    v_smfmac_f32_16x16x64_bf16 v[52:55], v[28:31], a[16:23], v6
    v_smfmac_f32_16x16x64_bf16 v[56:59], v[28:31], a[24:31], v6
    s_branch L_T1
L_hk15:
    s_branch L_hk43
    .p2align 6
L_hk16:
    s_branch L_hk44
L_G11_1:
    buffer_load_dwordx4 v[32:35], v1, s[4:7], s37 offen offset:1024 sc1
L_dr8:
    s_waitcnt vmcnt(2)
    v_cmp_eq_u32 vcc, -1, v43
    s_cbranch_vccnz L_G11_3
    v_smfmac_f32_16x16x64_bf16 v[44:47], v[40:43], a[144:151], v6
    v_smfmac_f32_16x16x64_bf16 v[48:51], v[40:43], a[152:159], v6
    s_waitcnt vmcnt(1)
    v_cmp_eq_u32 vcc, -1, v31
    v_smfmac_f32_16x16x64_bf16 v[52:55], v[40:43], a[160:167], v6
    v_smfmac_f32_16x16x64_bf16 v[56:59], v[40:43], a[168:175], v6
    s_cbranch_vccnz L_G3_0
    v_smfmac_f32_16x16x64_bf16 v[44:47], v[28:31], a[0:7], v6
    v_smfmac_f32_16x16x64_bf16 v[48:51], v[28:31], a[8:15], v6
    v_smfmac_f32_16x16x64_bf16 v[52:55], v[28:31], a[16:23], v6
    v_smfmac_f32_16x16x64_bf16 v[56:59], v[28:31], a[24:31], v6
    s_waitcnt vmcnt(0)
    v_cmp_eq_u32 vcc, -1, v35
    s_cbranch_vccnz L_F2_1
    v_smfmac_f32_16x16x64_bf16 v[44:47], v[32:35], a[48:55], v6
    v_smfmac_f32_16x16x64_bf16 v[48:51], v[32:35], a[56:63], v6
    v_smfmac_f32_16x16x64_bf16 v[52:55], v[32:35], a[64:71], v6
    v_smfmac_f32_16x16x64_bf16 v[56:59], v[32:35], a[72:79], v6
    s_branch L_T1
L_hk17:
    s_branch L_hk45
    .p2align 6
L_hk18:
    s_branch L_hk46
L_G11_3:
    buffer_load_dwordx4 v[40:43], v1, s[4:7], s37 offen offset:3072 sc1
    s_sub_u32 s35, s35, 1
    s_cbranch_scc1 L_end0
L_dr9:
    s_waitcnt vmcnt(2)
    v_cmp_eq_u32 vcc, -1, v31
    s_cbranch_vccnz L_G11_0
    v_smfmac_f32_16x16x64_bf16 v[44:47], v[28:31], a[0:7], v6
    v_smfmac_f32_16x16x64_bf16 v[48:51], v[28:31], a[8:15], v6
    s_waitcnt vmcnt(1)
    v_cmp_eq_u32 vcc, -1, v35
    v_smfmac_f32_16x16x64_bf16 v[52:55], v[28:31], a[16:23], v6
    v_smfmac_f32_16x16x64_bf16 v[56:59], v[28:31], a[24:31], v6
    s_cbranch_vccnz L_G10_1
    v_smfmac_f32_16x16x64_bf16 v[44:47], v[32:35], a[48:55], v6
    v_smfmac_f32_16x16x64_bf16 v[48:51], v[32:35], a[56:63], v6
    v_smfmac_f32_16x16x64_bf16 v[52:55], v[32:35], a[64:71], v6
    v_smfmac_f32_16x16x64_bf16 v[56:59], v[32:35], a[72:79], v6
    s_waitcnt vmcnt(0)
    v_cmp_eq_u32 vcc, -1, v43
    s_cbranch_vccnz L_F8_3
    v_smfmac_f32_16x16x64_bf16 v[44:47], v[40:43], a[144:151], v6
    v_smfmac_f32_16x16x64_bf16 v[48:51], v[40:43], a[152:159], v6
    v_smfmac_f32_16x16x64_bf16 v[52:55], v[40:43], a[160:167], v6
    v_smfmac_f32_16x16x64_bf16 v[56:59], v[40:43], a[168:175], v6
    s_branch L_T1
L_hk19:
    s_branch L_hk47
    .p2align 6
L_hk20:
    s_branch L_hk48
L_G13_0:
    buffer_load_dwordx4 v[28:31], v1, s[4:7], s37 offen offset:0 sc1
L_dr10:
    s_waitcnt vmcnt(2)
    v_cmp_eq_u32 vcc, -1, v39
    s_cbranch_vccnz L_G13_2
    v_smfmac_f32_16x16x64_bf16 v[44:47], v[36:39], a[96:103], v6
    v_smfmac_f32_16x16x64_bf16 v[48:51], v[36:39], a[104:111], v6
    s_waitcnt vmcnt(1)
    v_cmp_eq_u32 vcc, -1, v43
    v_smfmac_f32_16x16x64_bf16 v[52:55], v[36:39], a[112:119], v6
    v_smfmac_f32_16x16x64_bf16 v[56:59], v[36:39], a[120:127], v6
    s_cbranch_vccnz L_G9_3
    v_smfmac_f32_16x16x64_bf16 v[44:47], v[40:43], a[144:151], v6
    v_smfmac_f32_16x16x64_bf16 v[48:51], v[40:43], a[152:159], v6
    v_smfmac_f32_16x16x64_bf16 v[52:55], v[40:43], a[160:167], v6
    v_smfmac_f32_16x16x64_bf16 v[56:59], v[40:43], a[168:175], v6
    s_waitcnt vmcnt(0)
    v_cmp_eq_u32 vcc, -1, v31
    s_cbranch_vccnz L_F1_0
    v_smfmac_f32_16x16x64_bf16 v[44:47], v[28:31], a[0:7], v6
    v_smfmac_f32_16x16x64_bf16 v[48:51], v[28:31], a[8:15], v6
    v_smfmac_f32_16x16x64_bf16 v[52:55], v[28:31], a[16:23], v6
    v_smfmac_f32_16x16x64_bf16 v[56:59], v[28:31], a[24:31], v6
    s_branch L_T1
L_hk21:
    s_branch L_hk49
    .p2align 6
L_hk22:
    s_branch L_hk50
L_G13_2:
    buffer_load_dwordx4 v[36:39], v1, s[4:7], s37 offen offset:2048 sc1
L_dr11:
    s_waitcnt vmcnt(2)
    v_cmp_eq_u32 vcc, -1, v43
    s_cbranch_vccnz L_G13_3
    v_smfmac_f32_16x16x64_bf16 v[44:47], v[40:43], a[144:151], v6
    v_smfmac_f32_16x16x64_bf16 v[48:51], v[40:43], a[152:159], v6
    s_waitcnt vmcnt(1)
    v_cmp_eq_u32 vcc, -1, v31
    v_smfmac_f32_16x16x64_bf16 v[52:55], v[40:43], a[160:167], v6
    v_smfmac_f32_16x16x64_bf16 v[56:59], v[40:43], a[168:175], v6
    s_cbranch_vccnz L_G5_0
    v_smfmac_f32_16x16x64_bf16 v[44:47], v[28:31], a[0:7], v6
    v_smfmac_f32_16x16x64_bf16 v[48:51], v[28:31], a[8:15], v6
    v_smfmac_f32_16x16x64_bf16 v[52:55], v[28:31], a[16:23], v6
    v_smfmac_f32_16x16x64_bf16 v[56:59], v[28:31], a[24:31], v6
    s_waitcnt vmcnt(0)
    v_cmp_eq_u32 vcc, -1, v39
    s_cbranch_vccnz L_F4_2
    v_smfmac_f32_16x16x64_bf16 v[44:47], v[36:39], a[96:103], v6
    v_smfmac_f32_16x16x64_bf16 v[48:51], v[36:39], a[104:111], v6
    v_smfmac_f32_16x16x64_bf16 v[52:55], v[36:39], a[112:119], v6
    v_smfmac_f32_16x16x64_bf16 v[56:59], v[36:39], a[120:127], v6
    s_branch L_T1
L_hk23:
    s_branch L_hk51
    .p2align 6
L_hk24:
    s_branch L_hk52
L_G13_3:
    buffer_load_dwordx4 v[40:43], v1, s[4:7], s37 offen offset:3072 sc1
    s_sub_u32 s35, s35, 1
    s_cbranch_scc1 L_end0
L_dr12:
    s_waitcnt vmcnt(2)
    v_cmp_eq_u32 vcc, -1, v31
    s_cbranch_vccnz L_G13_0
    v_smfmac_f32_16x16x64_bf16 v[44:47], v[28:31], a[0:7], v6
    v_smfmac_f32_16x16x64_bf16 v[48:51], v[28:31], a[8:15], v6
    s_waitcnt vmcnt(1)
    v_cmp_eq_u32 vcc, -1, v39
    v_smfmac_f32_16x16x64_bf16 v[52:55], v[28:31], a[16:23], v6
    v_smfmac_f32_16x16x64_bf16 v[56:59], v[28:31], a[24:31], v6
    s_cbranch_vccnz L_G12_2
    v_smfmac_f32_16x16x64_bf16 v[44:47], v[36:39], a[96:103], v6
    v_smfmac_f32_16x16x64_bf16 v[48:51], v[36:39], a[104:111], v6
    v_smfmac_f32_16x16x64_bf16 v[52:55], v[36:39], a[112:119], v6
    v_smfmac_f32_16x16x64_bf16 v[56:59], v[36:39], a[120:127], v6
    s_waitcnt vmcnt(0)
    v_cmp_eq_u32 vcc, -1, v43
    s_cbranch_vccnz L_F8_3
    v_smfmac_f32_16x16x64_bf16 v[44:47], v[40:43], a[144:151], v6
    v_smfmac_f32_16x16x64_bf16 v[48:51], v[40:43], a[152:159], v6
    v_smfmac_f32_16x16x64_bf16 v[52:55], v[40:43], a[160:167], v6
    v_smfmac_f32_16x16x64_bf16 v[56:59], v[40:43], a[168:175], v6
    s_branch L_T1
L_hk25:
    s_branch L_hk53
    .p2align 6
L_hk26:
    s_branch L_hk54
L_G14_1:
    buffer_load_dwordx4 v[32:35], v1, s[4:7], s37 offen offset:1024 sc1
L_dr13:
    s_waitcnt vmcnt(2)
    v_cmp_eq_u32 vcc, -1, v39
    s_cbranch_vccnz L_G14_2
    v_smfmac_f32_16x16x64_bf16 v[44:47], v[36:39], a[96:103], v6
    v_smfmac_f32_16x16x64_bf16 v[48:51], v[36:39], a[104:111], v6
    s_waitcnt vmcnt(1)
    v_cmp_eq_u32 vcc, -1, v43
    v_smfmac_f32_16x16x64_bf16 v[52:55], v[36:39], a[112:119], v6
    v_smfmac_f32_16x16x64_bf16 v[56:59], v[36:39], a[120:127], v6
    s_cbranch_vccnz L_G10_3
    v_smfmac_f32_16x16x64_bf16 v[44:47], v[40:43], a[144:151], v6
    v_smfmac_f32_16x16x64_bf16 v[48:51], v[40:43], a[152:159], v6
    v_smfmac_f32_16x16x64_bf16 v[52:55], v[40:43], a[160:167], v6
    v_smfmac_f32_16x16x64_bf16 v[56:59], v[40:43], a[168:175], v6
    s_waitcnt vmcnt(0)
    v_cmp_eq_u32 vcc, -1, v35
    s_cbranch_vccnz L_F2_1
    v_smfmac_f32_16x16x64_bf16 v[44:47], v[32:35], a[48:55], v6
    v_smfmac_f32_16x16x64_bf16 v[48:51], v[32:35], a[56:63], v6
    v_smfmac_f32_16x16x64_bf16 v[52:55], v[32:35], a[64:71], v6
    v_smfmac_f32_16x16x64_bf16 v[56:59], v[32:35], a[72:79], v6
    s_branch L_T1
L_hk27:
    s_branch L_hk55
    .p2align 6
L_hk28:
    s_branch L_hk56
L_G14_2:
    buffer_load_dwordx4 v[36:39], v1, s[4:7], s37 offen offset:2048 sc1
L_dr14:
    s_waitcnt vmcnt(2)
    v_cmp_eq_u32 vcc, -1, v43
    s_cbranch_vccnz L_G14_3
    v_smfmac_f32_16x16x64_bf16 v[44:47], v[40:43], a[144:151], v6
    v_smfmac_f32_16x16x64_bf16 v[48:51], v[40:43], a[152:159], v6
    s_waitcnt vmcnt(1)
    v_cmp_eq_u32 vcc, -1, v35
    v_smfmac_f32_16x16x64_bf16 v[52:55], v[40:43], a[160:167], v6
    v_smfmac_f32_16x16x64_bf16 v[56:59], v[40:43], a[168:175], v6
    s_cbranch_vccnz L_G6_1
    v_smfmac_f32_16x16x64_bf16 v[44:47], v[32:35], a[48:55], v6
    v_smfmac_f32_16x16x64_bf16 v[48:51], v[32:35], a[56:63], v6
    v_smfmac_f32_16x16x64_bf16 v[52:55], v[32:35], a[64:71], v6
    v_smfmac_f32_16x16x64_bf16 v[56:59], v[32:35], a[72:79], v6
    s_waitcnt vmcnt(0)
    v_cmp_eq_u32 vcc, -1, v39
    s_cbranch_vccnz L_F4_2
    v_smfmac_f32_16x16x64_bf16 v[44:47], v[36:39], a[96:103], v6
    v_smfmac_f32_16x16x64_bf16 v[48:51], v[36:39], a[104:111], v6
    v_smfmac_f32_16x16x64_bf16 v[52:55], v[36:39], a[112:119], v6
    v_smfmac_f32_16x16x64_bf16 v[56:59], v[36:39], a[120:127], v6
    s_branch L_T1
L_hk29:
    s_branch L_hk57
    .p2align 6
L_hk30:
    s_branch L_hk58
L_G14_3:
    buffer_load_dwordx4 v[40:43], v1, s[4:7], s37 offen offset:3072 sc1
    s_sub_u32 s35, s35, 1
    s_cbranch_scc1 L_end0
L_dr15:
    s_waitcnt vmcnt(2)
    v_cmp_eq_u32 vcc, -1, v35
    s_cbranch_vccnz L_G14_1
    v_smfmac_f32_16x16x64_bf16 v[44:47], v[32:35], a[48:55], v6
    v_smfmac_f32_16x16x64_bf16 v[48:51], v[32:35], a[56:63], v6
    s_waitcnt vmcnt(1)
    v_cmp_eq_u32 vcc, -1, v39
    v_smfmac_f32_16x16x64_bf16 v[52:55], v[32:35], a[64:71], v6
    v_smfmac_f32_16x16x64_bf16 v[56:59], v[32:35], a[72:79], v6
    s_cbranch_vccnz L_G12_2
    v_smfmac_f32_16x16x64_bf16 v[44:47], v[36:39], a[96:103], v6
    v_smfmac_f32_16x16x64_bf16 v[48:51], v[36:39], a[104:111], v6
    v_smfmac_f32_16x16x64_bf16 v[52:55], v[36:39], a[112:119], v6
    v_smfmac_f32_16x16x64_bf16 v[56:59], v[36:39], a[120:127], v6
    s_waitcnt vmcnt(0)
    v_cmp_eq_u32 vcc, -1, v43
    s_cbranch_vccnz L_F8_3
    v_smfmac_f32_16x16x64_bf16 v[44:47], v[40:43], a[144:151], v6
    v_smfmac_f32_16x16x64_bf16 v[48:51], v[40:43], a[152:159], v6
    v_smfmac_f32_16x16x64_bf16 v[52:55], v[40:43], a[160:167], v6
    v_smfmac_f32_16x16x64_bf16 v[56:59], v[40:43], a[168:175], v6
    s_branch L_T1
L_hk31:
    s_branch L_hk59
    .p2align 6
L_hk32:
    s_branch L_hk60
L_G3_0:
    buffer_load_dwordx4 v[28:31], v1, s[4:7], s37 offen offset:0 sc1
L_dr16:
    s_waitcnt vmcnt(1)
    v_cmp_eq_u32 vcc, -1, v35
    s_cbranch_vccnz L_G3_1
    v_smfmac_f32_16x16x64_bf16 v[44:47], v[32:35], a[48:55], v6
    v_smfmac_f32_16x16x64_bf16 v[48:51], v[32:35], a[56:63], v6
    v_smfmac_f32_16x16x64_bf16 v[52:55], v[32:35], a[64:71], v6
    v_smfmac_f32_16x16x64_bf16 v[56:59], v[32:35], a[72:79], v6
    s_waitcnt vmcnt(0)
    v_cmp_eq_u32 vcc, -1, v31
    s_cbranch_vccnz L_F1_0
    v_smfmac_f32_16x16x64_bf16 v[44:47], v[28:31], a[0:7], v6
    v_smfmac_f32_16x16x64_bf16 v[48:51], v[28:31], a[8:15], v6
    v_smfmac_f32_16x16x64_bf16 v[52:55], v[28:31], a[16:23], v6
    v_smfmac_f32_16x16x64_bf16 v[56:59], v[28:31], a[24:31], v6
    s_branch L_T1
L_hk33:
    s_branch L_hk61
    .p2align 6
L_hk34:
    s_branch L_hk62
L_G3_1:
    buffer_load_dwordx4 v[32:35], v1, s[4:7], s37 offen offset:1024 sc1
    s_sub_u32 s35, s35, 1
    s_cbranch_scc1 L_end0
L_dr17:
    s_waitcnt vmcnt(1)
    v_cmp_eq_u32 vcc, -1, v31
    s_cbranch_vccnz L_G3_0
    v_smfmac_f32_16x16x64_bf16 v[44:47], v[28:31], a[0:7], v6
    v_smfmac_f32_16x16x64_bf16 v[48:51], v[28:31], a[8:15], v6
    v_smfmac_f32_16x16x64_bf16 v[52:55], v[28:31], a[16:23], v6
    v_smfmac_f32_16x16x64_bf16 v[56:59], v[28:31], a[24:31], v6
    s_waitcnt vmcnt(0)
    v_cmp_eq_u32 vcc, -1, v35
    s_cbranch_vccnz L_F2_1
    v_smfmac_f32_16x16x64_bf16 v[44:47], v[32:35], a[48:55], v6
    v_smfmac_f32_16x16x64_bf16 v[48:51], v[32:35], a[56:63], v6
    v_smfmac_f32_16x16x64_bf16 v[52:55], v[32:35], a[64:71], v6
    v_smfmac_f32_16x16x64_bf16 v[56:59], v[32:35], a[72:79], v6
    s_branch L_T1
L_hk35:
    s_branch L_hk63
    .p2align 6
L_hk36:
    s_branch L_hk64
L_G5_0:
    buffer_load_dwordx4 v[28:31], v1, s[4:7], s37 offen offset:0 sc1
L_dr18:
    s_waitcnt vmcnt(1)
    v_cmp_eq_u32 vcc, -1, v39
    s_cbranch_vccnz L_G5_2
    v_smfmac_f32_16x16x64_bf16 v[44:47], v[36:39], a[96:103], v6
    v_smfmac_f32_16x16x64_bf16 v[48:51], v[36:39], a[104:111], v6
    v_smfmac_f32_16x16x64_bf16 v[52:55], v[36:39], a[112:119], v6
    v_smfmac_f32_16x16x64_bf16 v[56:59], v[36:39], a[120:127], v6
    s_waitcnt vmcnt(0)
    v_cmp_eq_u32 vcc, -1, v31
    s_cbranch_vccnz L_F1_0
    v_smfmac_f32_16x16x64_bf16 v[44:47], v[28:31], a[0:7], v6
    v_smfmac_f32_16x16x64_bf16 v[48:51], v[28:31], a[8:15], v6
    v_smfmac_f32_16x16x64_bf16 v[52:55], v[28:31], a[16:23], v6
    v_smfmac_f32_16x16x64_bf16 v[56:59], v[28:31], a[24:31], v6
    s_branch L_T1
L_hk37:
    s_branch L_hk65
    .p2align 6
L_hk38:
    s_branch L_hk66
L_G5_2:
    buffer_load_dwordx4 v[36:39], v1, s[4:7], s37 offen offset:2048 sc1
    s_sub_u32 s35, s35, 1
    s_cbranch_scc1 L_end0
L_dr19:
    s_waitcnt vmcnt(1)
    v_cmp_eq_u32 vcc, -1, v31
    s_cbranch_vccnz L_G5_0
    v_smfmac_f32_16x16x64_bf16 v[44:47], v[28:31], a[0:7], v6
    v_smfmac_f32_16x16x64_bf16 v[48:51], v[28:31], a[8:15], v6
    v_smfmac_f32_16x16x64_bf16 v[52:55], v[28:31], a[16:23], v6
    v_smfmac_f32_16x16x64_bf16 v[56:59], v[28:31], a[24:31], v6
    s_waitcnt vmcnt(0)
    v_cmp_eq_u32 vcc, -1, v39
    s_cbranch_vccnz L_F4_2
    v_smfmac_f32_16x16x64_bf16 v[44:47], v[36:39], a[96:103], v6
    v_smfmac_f32_16x16x64_bf16 v[48:51], v[36:39], a[104:111], v6
    v_smfmac_f32_16x16x64_bf16 v[52:55], v[36:39], a[112:119], v6
    v_smfmac_f32_16x16x64_bf16 v[56:59], v[36:39], a[120:127], v6
    s_branch L_T1
L_hk39:
    s_branch L_hk67
    .p2align 6
L_hk40:
    s_branch L_hk68
L_G6_1:
    buffer_load_dwordx4 v[32:35], v1, s[4:7], s37 offen offset:1024 sc1
L_dr20:
    s_waitcnt vmcnt(1)
    v_cmp_eq_u32 vcc, -1, v39
    s_cbranch_vccnz L_G6_2
    v_smfmac_f32_16x16x64_bf16 v[44:47], v[36:39], a[96:103], v6
    v_smfmac_f32_16x16x64_bf16 v[48:51], v[36:39], a[104:111], v6
    v_smfmac_f32_16x16x64_bf16 v[52:55], v[36:39], a[112:119], v6
    v_smfmac_f32_16x16x64_bf16 v[56:59], v[36:39], a[120:127], v6
    s_waitcnt vmcnt(0)
    v_cmp_eq_u32 vcc, -1, v35
    s_cbranch_vccnz L_F2_1
    v_smfmac_f32_16x16x64_bf16 v[44:47], v[32:35], a[48:55], v6
    v_smfmac_f32_16x16x64_bf16 v[48:51], v[32:35], a[56:63], v6
    v_smfmac_f32_16x16x64_bf16 v[52:55], v[32:35], a[64:71], v6
    v_smfmac_f32_16x16x64_bf16 v[56:59], v[32:35], a[72:79], v6
    s_branch L_T1
L_hk41:
    s_branch L_hk69
    .p2align 6
L_hk42:
    s_branch L_hk70
L_G6_2:
    buffer_load_dwordx4 v[36:39], v1, s[4:7], s37 offen offset:2048 sc1
    s_sub_u32 s35, s35, 1
    s_cbranch_scc1 L_end0
L_dr21:
    s_waitcnt vmcnt(1)
    v_cmp_eq_u32 vcc, -1, v35
    s_cbranch_vccnz L_G6_1
    v_smfmac_f32_16x16x64_bf16 v[44:47], v[32:35], a[48:55], v6
    v_smfmac_f32_16x16x64_bf16 v[48:51], v[32:35], a[56:63], v6
    v_smfmac_f32_16x16x64_bf16 v[52:55], v[32:35], a[64:71], v6
    v_smfmac_f32_16x16x64_bf16 v[56:59], v[32:35], a[72:79], v6
    s_waitcnt vmcnt(0)
    v_cmp_eq_u32 vcc, -1, v39
    s_cbranch_vccnz L_F4_2
    v_smfmac_f32_16x16x64_bf16 v[44:47], v[36:39], a[96:103], v6
    v_smfmac_f32_16x16x64_bf16 v[48:51], v[36:39], a[104:111], v6
    v_smfmac_f32_16x16x64_bf16 v[52:55], v[36:39], a[112:119], v6
    v_smfmac_f32_16x16x64_bf16 v[56:59], v[36:39], a[120:127], v6
    s_branch L_T1
L_hk43:
    s_branch L_hk71
    .p2align 6
L_hk44:
    s_branch L_hkret4
L_G9_0:
    buffer_load_dwordx4 v[28:31], v1, s[4:7], s37 offen offset:0 sc1
L_dr22:
    s_waitcnt vmcnt(1)
    v_cmp_eq_u32 vcc, -1, v43
    s_cbranch_vccnz L_G9_3
    v_smfmac_f32_16x16x64_bf16 v[44:47], v[40:43], a[144:151], v6
    v_smfmac_f32_16x16x64_bf16 v[48:51], v[40:43], a[152:159], v6
    v_smfmac_f32_16x16x64_bf16 v[52:55], v[40:43], a[160:167], v6
    v_smfmac_f32_16x16x64_bf16 v[56:59], v[40:43], a[168:175], v6
    s_waitcnt vmcnt(0)
    v_cmp_eq_u32 vcc, -1, v31
    s_cbranch_vccnz L_F1_0
    v_smfmac_f32_16x16x64_bf16 v[44:47], v[28:31], a[0:7], v6
    v_smfmac_f32_16x16x64_bf16 v[48:51], v[28:31], a[8:15], v6
    v_smfmac_f32_16x16x64_bf16 v[52:55], v[28:31], a[16:23], v6
    v_smfmac_f32_16x16x64_bf16 v[56:59], v[28:31], a[24:31], v6
    s_branch L_T1
L_hk45:
    s_branch L_hkret4
    .p2align 6
L_hk46:
    s_branch L_hkret4
L_G9_3:
    buffer_load_dwordx4 v[40:43], v1, s[4:7], s37 offen offset:3072 sc1
    s_sub_u32 s35, s35, 1
    s_cbranch_scc1 L_end0
L_dr23:
    s_waitcnt vmcnt(1)
    v_cmp_eq_u32 vcc, -1, v31
    s_cbranch_vccnz L_G9_0
    v_smfmac_f32_16x16x64_bf16 v[44:47], v[28:31], a[0:7], v6
    v_smfmac_f32_16x16x64_bf16 v[48:51], v[28:31], a[8:15], v6
    v_smfmac_f32_16x16x64_bf16 v[52:55], v[28:31], a[16:23], v6
    v_smfmac_f32_16x16x64_bf16 v[56:59], v[28:31], a[24:31], v6
    s_waitcnt vmcnt(0)
    v_cmp_eq_u32 vcc, -1, v43
    s_cbranch_vccnz L_F8_3
    v_smfmac_f32_16x16x64_bf16 v[44:47], v[40:43], a[144:151], v6
    v_smfmac_f32_16x16x64_bf16 v[48:51], v[40:43], a[152:159], v6
    v_smfmac_f32_16x16x64_bf16 v[52:55], v[40:43], a[160:167], v6
    v_smfmac_f32_16x16x64_bf16 v[56:59], v[40:43], a[168:175], v6
    s_branch L_T1
L_hk47:
    s_branch L_hkret4
    .p2align 6
L_hk48:
    s_branch L_hkret5
L_G10_1:
    buffer_load_dwordx4 v[32:35], v1, s[4:7], s37 offen offset:1024 sc1
L_dr24:
    s_waitcnt vmcnt(1)
    v_cmp_eq_u32 vcc, -1, v43
    s_cbranch_vccnz L_G10_3
    v_smfmac_f32_16x16x64_bf16 v[44:47], v[40:43], a[144:151], v6
    v_smfmac_f32_16x16x64_bf16 v[48:51], v[40:43], a[152:159], v6
    v_smfmac_f32_16x16x64_bf16 v[52:55], v[40:43], a[160:167], v6
    v_smfmac_f32_16x16x64_bf16 v[56:59], v[40:43], a[168:175], v6
    s_waitcnt vmcnt(0)
    v_cmp_eq_u32 vcc, -1, v35
    s_cbranch_vccnz L_F2_1
    v_smfmac_f32_16x16x64_bf16 v[44:47], v[32:35], a[48:55], v6
    v_smfmac_f32_16x16x64_bf16 v[48:51], v[32:35], a[56:63], v6
    v_smfmac_f32_16x16x64_bf16 v[52:55], v[32:35], a[64:71], v6
    v_smfmac_f32_16x16x64_bf16 v[56:59], v[32:35], a[72:79], v6
    s_branch L_T1
L_hk49:
    s_branch L_hkret5
    .p2align 6
L_hk50:
    s_branch L_hkret5
L_G10_3:
    buffer_load_dwordx4 v[40:43], v1, s[4:7], s37 offen offset:3072 sc1
    s_sub_u32 s35, s35, 1
    s_cbranch_scc1 L_end0
L_dr25:
    s_waitcnt vmcnt(1)
    v_cmp_eq_u32 vcc, -1, v35
    s_cbranch_vccnz L_G10_1
    v_smfmac_f32_16x16x64_bf16 v[44:47], v[32:35], a[48:55], v6
    v_smfmac_f32_16x16x64_bf16 v[48:51], v[32:35], a[56:63], v6
    v_smfmac_f32_16x16x64_bf16 v[52:55], v[32:35], a[64:71], v6
    v_smfmac_f32_16x16x64_bf16 v[56:59], v[32:35], a[72:79], v6
    s_waitcnt vmcnt(0)
    v_cmp_eq_u32 vcc, -1, v43
    s_cbranch_vccnz L_F8_3
    v_smfmac_f32_16x16x64_bf16 v[44:47], v[40:43], a[144:151], v6
    v_smfmac_f32_16x16x64_bf16 v[48:51], v[40:43], a[152:159], v6
    v_smfmac_f32_16x16x64_bf16 v[52:55], v[40:43], a[160:167], v6
    v_smfmac_f32_16x16x64_bf16 v[56:59], v[40:43], a[168:175], v6
    s_branch L_T1
L_hk51:
    s_branch L_hkret5
    .p2align 6
L_hk52:
    s_branch L_hkret6
L_G12_2:
    buffer_load_dwordx4 v[36:39], v1, s[4:7], s37 offen offset:2048 sc1
L_dr26:
    s_waitcnt vmcnt(1)
    v_cmp_eq_u32 vcc, -1, v43
    s_cbranch_vccnz L_G12_3
    v_smfmac_f32_16x16x64_bf16 v[44:47], v[40:43], a[144:151], v6
    v_smfmac_f32_16x16x64_bf16 v[48:51], v[40:43], a[152:159], v6
    v_smfmac_f32_16x16x64_bf16 v[52:55], v[40:43], a[160:167], v6
    v_smfmac_f32_16x16x64_bf16 v[56:59], v[40:43], a[168:175], v6
    s_waitcnt vmcnt(0)
    v_cmp_eq_u32 vcc, -1, v39
    s_cbranch_vccnz L_F4_2
    v_smfmac_f32_16x16x64_bf16 v[44:47], v[36:39], a[96:103], v6
    v_smfmac_f32_16x16x64_bf16 v[48:51], v[36:39], a[104:111], v6
    v_smfmac_f32_16x16x64_bf16 v[52:55], v[36:39], a[112:119], v6
    v_smfmac_f32_16x16x64_bf16 v[56:59], v[36:39], a[120:127], v6
    s_branch L_T1
L_hk53:
    s_branch L_hkret6
    .p2align 6
L_hk54:
    s_branch L_hkret6
L_G12_3:
    buffer_load_dwordx4 v[40:43], v1, s[4:7], s37 offen offset:3072 sc1
    s_sub_u32 s35, s35, 1
    s_cbranch_scc1 L_end0
L_dr27:
    s_waitcnt vmcnt(1)
    v_cmp_eq_u32 vcc, -1, v39
    s_cbranch_vccnz L_G12_2
    v_smfmac_f32_16x16x64_bf16 v[44:47], v[36:39], a[96:103], v6
    v_smfmac_f32_16x16x64_bf16 v[48:51], v[36:39], a[104:111], v6
    v_smfmac_f32_16x16x64_bf16 v[52:55], v[36:39], a[112:119], v6
    v_smfmac_f32_16x16x64_bf16 v[56:59], v[36:39], a[120:127], v6
    s_waitcnt vmcnt(0)
    v_cmp_eq_u32 vcc, -1, v43
    s_cbranch_vccnz L_F8_3
    v_smfmac_f32_16x16x64_bf16 v[44:47], v[40:43], a[144:151], v6
    v_smfmac_f32_16x16x64_bf16 v[48:51], v[40:43], a[152:159], v6
    v_smfmac_f32_16x16x64_bf16 v[52:55], v[40:43], a[160:167], v6
    v_smfmac_f32_16x16x64_bf16 v[56:59], v[40:43], a[168:175], v6
    s_branch L_T1
L_hk55:
    s_branch L_hkret6
    .p2align 6
L_hk56:
    s_branch L_hkret0
L_P1_0:
    s_waitcnt vmcnt(3)
    v_max3_u32 v16, v28, v29, v30
    v_max_u32 v16, v16, v31
    v_cmp_eq_u32 vcc, -1, v16
    s_cbranch_vccz L_V1_0
L_F1_0:
    buffer_load_dwordx4 v[28:31], v1, s[4:7], s37 offen offset:0 sc1
    s_sub_u32 s35, s35, 1
    s_cbranch_scc0 L_P1_0
    s_endpgm
    .p2align 6
L_hk57:
    s_branch L_hkret0
L_V1_0:
    v_smfmac_f32_16x16x64_bf16 v[44:47], v[28:31], a[0:7], v6
    v_smfmac_f32_16x16x64_bf16 v[48:51], v[28:31], a[8:15], v6
    v_smfmac_f32_16x16x64_bf16 v[52:55], v[28:31], a[16:23], v6
    v_smfmac_f32_16x16x64_bf16 v[56:59], v[28:31], a[24:31], v6
    s_branch L_T1
    .p2align 6
L_hk58:
    s_branch L_hkret0
L_P2_1:
    s_waitcnt vmcnt(3)
    v_max3_u32 v16, v32, v33, v34
    v_max_u32 v16, v16, v35
    v_cmp_eq_u32 vcc, -1, v16
    s_cbranch_vccz L_V2_1
L_F2_1:
    buffer_load_dwordx4 v[32:35], v1, s[4:7], s37 offen offset:1024 sc1
    s_sub_u32 s35, s35, 1
    s_cbranch_scc0 L_P2_1
    s_endpgm
    .p2align 6
L_hk59:
    s_branch L_hkret0
L_V2_1:
    v_smfmac_f32_16x16x64_bf16 v[44:47], v[32:35], a[48:55], v6
    v_smfmac_f32_16x16x64_bf16 v[48:51], v[32:35], a[56:63], v6
    v_smfmac_f32_16x16x64_bf16 v[52:55], v[32:35], a[64:71], v6
    v_smfmac_f32_16x16x64_bf16 v[56:59], v[32:35], a[72:79], v6
    s_branch L_T1
    .p2align 6
L_hk60:
    s_branch L_hkret1
L_P4_2:
    s_waitcnt vmcnt(3)
    v_max3_u32 v16, v36, v37, v38
    v_max_u32 v16, v16, v39
    v_cmp_eq_u32 vcc, -1, v16
    s_cbranch_vccz L_V4_2
L_F4_2:
    buffer_load_dwordx4 v[36:39], v1, s[4:7], s37 offen offset:2048 sc1
    s_sub_u32 s35, s35, 1
    s_cbranch_scc0 L_P4_2
    s_endpgm
    .p2align 6
L_hk61:
    s_branch L_hkret1
L_V4_2:
    v_smfmac_f32_16x16x64_bf16 v[44:47], v[36:39], a[96:103], v6
    v_smfmac_f32_16x16x64_bf16 v[48:51], v[36:39], a[104:111], v6
    v_smfmac_f32_16x16x64_bf16 v[52:55], v[36:39], a[112:119], v6
    v_smfmac_f32_16x16x64_bf16 v[56:59], v[36:39], a[120:127], v6
    s_branch L_T1
    .p2align 6
L_hk62:
    s_branch L_hkret1
L_P8_3:
    s_waitcnt vmcnt(3)
    v_max3_u32 v16, v40, v41, v42
    v_max_u32 v16, v16, v43
    v_cmp_eq_u32 vcc, -1, v16
    s_cbranch_vccz L_V8_3
L_F8_3:
    buffer_load_dwordx4 v[40:43], v1, s[4:7], s37 offen offset:3072 sc1
    s_sub_u32 s35, s35, 1
    s_cbranch_scc0 L_P8_3
    s_endpgm
    .p2align 6
L_hk63:
    s_branch L_hkret1
L_V8_3:
    v_smfmac_f32_16x16x64_bf16 v[44:47], v[40:43], a[144:151], v6
    v_smfmac_f32_16x16x64_bf16 v[48:51], v[40:43], a[152:159], v6
    v_smfmac_f32_16x16x64_bf16 v[52:55], v[40:43], a[160:167], v6
    v_smfmac_f32_16x16x64_bf16 v[56:59], v[40:43], a[168:175], v6
    s_branch L_T1
L_sp:
    s_cmp_eq_u32 s36, 63
    s_cbranch_scc1 L_c_tail
    s_mov_b32 s52, 63
    s_cmp_ge_i32 s56, 1
    s_cbranch_scc1 L_sp3
L_sp1:
    buffer_load_dword v24, v23, s[4:7], 0 offen sc1
    s_waitcnt vmcnt(0)
    v_readlane_b32 s51, v24, 0
    v_readlane_b32 s50, v24, 1
    s_add_u32 s49, s36, 1
    s_min_u32 s49, s49, 64
    s_min_i32 s50, s50, s51
    s_max_i32 s56, s56, s50
    s_cmp_lt_i32 s56, s49
    s_cbranch_scc1 L_sp2
L_sp7:
    s_sub_u32 s42, s42, 0x40004000
    s_sub_u32 s43, s43, 0x40004000
    s_sub_u32 s44, s44, 0x40000000
    s_sub_u32 s49, s55, 0x4000
    buffer_load_dword v252, v253, s[4:7], s49 offen sc1
    buffer_load_dwordx4 v[132:135], v1, s[4:7], s44 offen offset:0 sc1
    buffer_load_dwordx4 v[136:139], v1, s[4:7], s44 offen offset:1024 sc1
    buffer_load_dwordx4 v[140:143], v1, s[4:7], s44 offen offset:2048 sc1
    buffer_load_dwordx4 v[144:147], v1, s[4:7], s44 offen offset:3072 sc1
    buffer_load_dwordx4 v[148:151], v1, s[4:7], s45 offen offset:0 sc1
    buffer_load_dwordx4 v[152:155], v1, s[4:7], s45 offen offset:1024 sc1
    buffer_load_dwordx4 v[156:159], v1, s[4:7], s45 offen offset:2048 sc1
    buffer_load_dwordx4 v[160:163], v1, s[4:7], s45 offen offset:3072 sc1
    buffer_load_dwordx4 v[100:103], v1, s[4:7], s42 offen offset:0 sc1
    buffer_load_dwordx4 v[104:107], v1, s[4:7], s42 offen offset:1024 sc1
    buffer_load_dwordx4 v[108:111], v1, s[4:7], s42 offen offset:2048 sc1
    buffer_load_dwordx4 v[112:115], v1, s[4:7], s42 offen offset:3072 sc1
    buffer_load_dwordx4 v[116:119], v1, s[4:7], s43 offen offset:0 sc1
    buffer_load_dwordx4 v[120:123], v1, s[4:7], s43 offen offset:1024 sc1
    buffer_load_dwordx4 v[124:127], v1, s[4:7], s43 offen offset:2048 sc1
    buffer_load_dwordx4 v[128:131], v1, s[4:7], s43 offen offset:3072 sc1
    s_add_u32 s42, s42, 0x4000
    s_add_u32 s43, s43, 0x4000
L_sp3:
    s_add_u32 s44, s44, 0x4000
    s_add_u32 s45, s45, 0x4000
    s_waitcnt vmcnt(8) lgkmcnt(0)
    v_mfma_f32_16x16x32_bf16 v[216:219], v[132:135], a[192:195], 0
    v_mfma_f32_16x16x32_bf16 v[220:223], v[148:151], a[192:195], 0
    v_mfma_f32_16x16x32_bf16 v[216:219], v[136:139], a[196:199], v[216:219]
    v_mfma_f32_16x16x32_bf16 v[220:223], v[152:155], a[196:199], v[220:223]
    v_mfma_f32_16x16x32_bf16 v[216:219], v[140:143], a[200:203], v[216:219]
    v_mfma_f32_16x16x32_bf16 v[220:223], v[156:159], a[200:203], v[220:223]
    v_mfma_f32_16x16x32_bf16 v[216:219], v[144:147], a[204:207], v[216:219]
    v_mfma_f32_16x16x32_bf16 v[220:223], v[160:163], a[204:207], v[220:223]
    v_mfma_f32_16x16x32_bf16 v[224:227], v[132:135], a[208:211], 0
    v_mfma_f32_16x16x32_bf16 v[228:231], v[148:151], a[208:211], 0
    v_mfma_f32_16x16x32_bf16 v[224:227], v[136:139], a[212:215], v[224:227]
    v_cvt_pk_bf16_f32 v200, v216, v217
    v_mfma_f32_16x16x32_bf16 v[228:231], v[152:155], a[212:215], v[228:231]
    v_cvt_pk_bf16_f32 v201, v218, v219
    v_mfma_f32_16x16x32_bf16 v[224:227], v[140:143], a[216:219], v[224:227]
    v_cvt_pk_bf16_f32 v202, v220, v221
    v_mfma_f32_16x16x32_bf16 v[228:231], v[156:159], a[216:219], v[228:231]
    v_cvt_pk_bf16_f32 v203, v222, v223
    v_mfma_f32_16x16x32_bf16 v[224:227], v[144:147], a[220:223], v[224:227]
    v_mfma_f32_16x16x32_bf16 v[228:231], v[160:163], a[220:223], v[228:231]
    v_mfma_f32_16x16x32_bf16 v[232:235], v[132:135], a[224:227], 0
    buffer_load_dword v24, v23, s[4:7], 0 offen sc1
    v_mfma_f32_16x16x32_bf16 v[236:239], v[148:151], a[224:227], 0
    v_mfma_f32_16x16x32_bf16 v[232:235], v[136:139], a[228:231], v[232:235]
    v_cvt_pk_bf16_f32 v204, v224, v225
    v_mfma_f32_16x16x32_bf16 v[236:239], v[152:155], a[228:231], v[236:239]
    v_cvt_pk_bf16_f32 v205, v226, v227
    v_mfma_f32_16x16x32_bf16 v[232:235], v[140:143], a[232:235], v[232:235]
    v_cvt_pk_bf16_f32 v206, v228, v229
    v_mfma_f32_16x16x32_bf16 v[236:239], v[156:159], a[232:235], v[236:239]
    v_cvt_pk_bf16_f32 v207, v230, v231
    v_mfma_f32_16x16x32_bf16 v[232:235], v[144:147], a[236:239], v[232:235]
    v_mfma_f32_16x16x32_bf16 v[236:239], v[160:163], a[236:239], v[236:239]
    v_mfma_f32_16x16x32_bf16 v[240:243], v[132:135], a[240:243], 0
    v_mfma_f32_16x16x32_bf16 v[244:247], v[148:151], a[240:243], 0
    v_mfma_f32_16x16x32_bf16 v[240:243], v[136:139], a[244:247], v[240:243]
    v_cvt_pk_bf16_f32 v208, v232, v233
    v_mfma_f32_16x16x32_bf16 v[244:247], v[152:155], a[244:247], v[244:247]
    v_cvt_pk_bf16_f32 v209, v234, v235
    v_mfma_f32_16x16x32_bf16 v[240:243], v[140:143], a[248:251], v[240:243]
    v_cvt_pk_bf16_f32 v210, v236, v237
    v_mfma_f32_16x16x32_bf16 v[244:247], v[156:159], a[248:251], v[244:247]
    v_cvt_pk_bf16_f32 v211, v238, v239
    v_mfma_f32_16x16x32_bf16 v[240:243], v[144:147], a[252:255], v[240:243]
    v_mfma_f32_16x16x32_bf16 v[244:247], v[160:163], a[252:255], v[244:247]
    v_mov_b32 v216, 0
    v_mov_b32 v217, 0
    v_mov_b32 v218, 0
    v_mov_b32 v219, 0
    s_nop 0
    v_mov_b32 v220, 0
    v_mov_b32 v221, 0
    v_mov_b32 v222, 0
    v_mov_b32 v223, 0
    s_nop 0
    v_mov_b32 v224, 0
    v_mov_b32 v225, 0
    v_mov_b32 v226, 0
    v_mov_b32 v227, 0
    s_nop 0
    v_mov_b32 v228, 0
    v_mov_b32 v229, 0
    v_mov_b32 v230, 0
    v_mov_b32 v231, 0
    s_nop 0
    v_cvt_pk_bf16_f32 v212, v240, v241
    v_cvt_pk_bf16_f32 v213, v242, v243
    v_cvt_pk_bf16_f32 v214, v244, v245
    v_cvt_pk_bf16_f32 v215, v246, v247
    s_branch L_sp5
L_sp4:
    s_sub_u32 s35, s35, 1
    s_cbranch_scc0 L_sp6
    s_endpgm
L_sp6:
    buffer_load_dword v24, v23, s[4:7], 0 offen sc1
L_sp5:
    s_waitcnt vmcnt(0)
    v_readlane_b32 s51, v24, 0
    v_readlane_b32 s50, v24, 1
    s_add_u32 s49, s36, 2
    s_min_u32 s49, s49, 64
    s_min_i32 s50, s50, s51
    s_max_i32 s56, s56, s50
    s_cmp_lt_i32 s56, s49
    s_cbranch_scc1 L_sp4
    buffer_load_dword v252, v253, s[4:7], s55 offen sc1
    s_branch L_spr
L_sp2:
    s_sleep 1
    s_sub_u32 s35, s35, 1
    s_cbranch_scc0 L_sp1
    s_endpgm
    .p2align 6
L_hk64:
    s_branch L_hkret2
L_kvw:
    buffer_load_dword v24, v23, s[4:7], 0 offen sc1
    s_waitcnt vmcnt(0)
    v_readlane_b32 s51, v24, 0
    v_readlane_b32 s50, v24, 1
    s_add_u32 s49, s36, 2
    s_min_u32 s49, s49, 64
    s_min_i32 s50, s50, s51
    s_max_i32 s56, s56, s50
    s_cmp_lt_i32 s56, s49
    s_cbranch_scc1 L_kvw2
    s_branch L_loop
L_kvw2:
    s_sub_u32 s35, s35, 1
    s_cbranch_scc0 L_kvw
    s_endpgm
    .p2align 6
L_hk65:
    s_branch L_hkret2
L_r2:
    buffer_load_dwordx4 v[68:71], v1, s[4:7], s40 offen offset:0 sc1
    buffer_load_dwordx4 v[76:79], v1, s[4:7], s40 offen offset:1024 sc1
    buffer_store_dword v21, v4, s[4:7], s39 offen
    buffer_load_dwordx4 v[84:87], v1, s[4:7], s40 offen offset:2048 sc1
    buffer_load_dwordx4 v[88:91], v1, s[4:7], s40 offen offset:3072 sc1
    s_sub_u32 s35, s35, 1
    s_cbranch_scc0 L_h2
    s_endpgm
    .p2align 6
L_hk66:
    s_branch L_hkret2
L_r2k:
    buffer_load_dwordx4 v[84:87], v1, s[4:7], s40 offen offset:2048 sc1
    buffer_load_dwordx4 v[88:91], v1, s[4:7], s40 offen offset:3072 sc1
    v_mov_b32 v172, 0
    v_mov_b32 v173, 0
    v_mov_b32 v174, 0
    v_mov_b32 v175, 0
    s_sub_u32 s35, s35, 1
    s_cbranch_scc0 L_h2k
    s_endpgm
L_hk67:
    s_branch L_hkret2
    .p2align 6
L_hk68:
    s_branch L_hkret3
L_r2v:
    buffer_load_dwordx4 v[92:95], v1, s[4:7], s41 offen offset:0 sc1
    buffer_load_dwordx4 v[96:99], v1, s[4:7], s41 offen offset:1024 sc1
    s_waitcnt vmcnt(0)
    v_max3_u32 v19, v92, v93, v94
    v_max_u32 v19, v19, v95
    v_max3_u32 v19, v19, v96, v97
    v_max3_u32 v19, v19, v98, v99
    v_cmp_eq_u32 vcc, -1, v19
    s_cbranch_vccz L_h2v
    s_sub_u32 s35, s35, 1
    s_cbranch_scc0 L_r2v
    s_endpgm
L_hk69:
    s_branch L_hkret3
    .p2align 6
L_hk70:
    s_branch L_hkret3
L_r3:
    buffer_load_dwordx2 v[166:167], v195, s[4:7], s46 offen sc1
    buffer_load_dwordx2 v[170:171], v195, s[4:7], s57 offen sc1
    s_waitcnt vmcnt(0)
    s_sub_u32 s35, s35, 1
    s_cbranch_scc0 L_h3
    s_endpgm
    s_waitcnt vmcnt(0)
    v_max3_u32 v16, v164, v165, v166
    v_max_u32 v16, v16, v167
    v_max3_u32 v16, v16, v168, v169
    v_max3_u32 v16, v16, v170, v171
    v_cmp_eq_u32 vcc, -1, v16
    v_mfma_f32_16x16x16_bf16 v[176:179], v[192:193], v[166:167], 0
    v_mfma_f32_16x16x16_bf16 v[176:179], v[192:193], v[170:171], v[176:179]
    s_nop 6
    s_cbranch_vccz L_h3ok
    s_sub_u32 s35, s35, 1
    s_cbranch_scc0 L_r3
    s_endpgm
L_hk71:
    s_branch L_hkret3
L_loop_end:
    .p2align 6
L_loop_i:
    s_waitcnt vmcnt(3)
    v_cmp_eq_u32 vcc, -1, v31
    v_smfmac_f32_16x16x64_bf16 v[44:47], v[28:31], a[0:7], v6
    v_smfmac_f32_16x16x64_bf16 v[48:51], v[28:31], a[8:15], v6
    s_cbranch_vccnz L_Z_i
    s_waitcnt vmcnt(2)
    v_cmp_eq_u32 vcc, -1, v35
    v_smfmac_f32_16x16x64_bf16 v[52:55], v[28:31], a[16:23], v6
    v_smfmac_f32_16x16x64_bf16 v[56:59], v[28:31], a[24:31], v6
    s_cbranch_vccnz L_G14_1_i
    v_smfmac_f32_16x16x64_bf16 v[44:47], v[32:35], a[48:55], v6
    v_smfmac_f32_16x16x64_bf16 v[48:51], v[32:35], a[56:63], v6
    s_waitcnt vmcnt(1)
    v_cmp_eq_u32 vcc, -1, v39
    v_smfmac_f32_16x16x64_bf16 v[52:55], v[32:35], a[64:71], v6
    v_smfmac_f32_16x16x64_bf16 v[56:59], v[32:35], a[72:79], v6
    s_cbranch_vccnz L_G12_2_i
    v_smfmac_f32_16x16x64_bf16 v[44:47], v[36:39], a[96:103], v6
    v_smfmac_f32_16x16x64_bf16 v[48:51], v[36:39], a[104:111], v6
    s_waitcnt vmcnt(0)
    v_cmp_eq_u32 vcc, -1, v43
    v_smfmac_f32_16x16x64_bf16 v[52:55], v[36:39], a[112:119], v6
    v_smfmac_f32_16x16x64_bf16 v[56:59], v[36:39], a[120:127], v6
    s_cbranch_vccnz L_F8_3_i
    v_smfmac_f32_16x16x64_bf16 v[44:47], v[40:43], a[144:151], v6
    v_smfmac_f32_16x16x64_bf16 v[48:51], v[40:43], a[152:159], v6
    v_smfmac_f32_16x16x64_bf16 v[52:55], v[40:43], a[160:167], v6
    v_smfmac_f32_16x16x64_bf16 v[56:59], v[40:43], a[168:175], v6
L_T1_i:
    v_permlane32_swap_b32 v44, v46
    v_permlane32_swap_b32 v45, v47
    v_permlane32_swap_b32 v48, v50
    v_permlane32_swap_b32 v49, v51
    v_pk_add_f32 v[232:233], v[44:45], v[46:47]
    v_pk_add_f32 v[234:235], v[48:49], v[50:51]
    ds_write2st64_b64 v8, v[232:233], v[234:235] offset0:0 offset1:1
    v_permlane32_swap_b32 v52, v54
    v_permlane32_swap_b32 v53, v55
    v_permlane32_swap_b32 v56, v58
    v_permlane32_swap_b32 v57, v59
    v_pk_add_f32 v[236:237], v[52:53], v[54:55]
    v_pk_add_f32 v[238:239], v[56:57], v[58:59]
    ds_write2st64_b64 v8, v[236:237], v[238:239] offset0:2 offset1:3
    v_smfmac_f32_16x16x64_bf16 v[60:63], v[28:31], a[32:39], v6
    buffer_load_dwordx4 v[120:123], v1, s[4:7], s43 offen offset:1024 sc1
    v_smfmac_f32_16x16x64_bf16 v[64:67], v[28:31], a[40:47], v6
    v_smfmac_f32_16x16x64_bf16 v[60:63], v[32:35], a[80:87], v6
    buffer_load_dwordx4 v[124:127], v1, s[4:7], s43 offen offset:2048 sc1
    v_smfmac_f32_16x16x64_bf16 v[64:67], v[32:35], a[88:95], v6
    s_waitcnt lgkmcnt(0)
    s_barrier
    ds_read2st64_b32 v[92:93], v10 offset0:0 offset1:2
    ds_read2st64_b32 v[94:95], v10 offset0:12 offset1:14
    ds_read2st64_b32 v[96:97], v10 offset0:24 offset1:26
    ds_read2st64_b32 v[98:99], v10 offset0:36 offset1:38
    v_smfmac_f32_16x16x64_bf16 v[60:63], v[36:39], a[128:135], v6
    buffer_load_dwordx4 v[128:131], v1, s[4:7], s43 offen offset:3072 sc1
    v_smfmac_f32_16x16x64_bf16 v[64:67], v[36:39], a[136:143], v6
    v_smfmac_f32_16x16x64_bf16 v[60:63], v[40:43], a[176:183], v6
    v_smfmac_f32_16x16x64_bf16 v[64:67], v[40:43], a[184:191], v6
    s_waitcnt lgkmcnt(2)
    v_pk_add_f32 v[92:93], v[92:93], v[94:95]
    s_waitcnt lgkmcnt(0)
    v_pk_add_f32 v[96:97], v[96:97], v[98:99]
    v_pk_add_f32 v[92:93], v[92:93], v[96:97]
    v_cvt_pk_bf16_f32 v20, v92, v93
    buffer_store_dword v20, v3, s[4:7], s39 offen sc1
    v_permlane32_swap_b32 v60, v62
    v_permlane32_swap_b32 v61, v63
    v_permlane32_swap_b32 v64, v66
    v_permlane32_swap_b32 v65, v67
    v_pk_add_f32 v[240:241], v[60:61], v[62:63]
    v_pk_add_f32 v[242:243], v[64:65], v[66:67]
    ds_write2st64_b64 v9, v[240:241], v[242:243] offset0:4 offset1:5
    s_add_u32 s42, s42, 0x4000
    s_add_u32 s43, s43, 0x4000
    s_cmp_eq_u32 s36, s52
    s_cbranch_scc1 L_sp_i
L_spr_i:
    s_waitcnt lgkmcnt(0)
    s_barrier
    ds_read2st64_b32 v[92:93], v11 offset0:0 offset1:2
    ds_read2st64_b32 v[94:95], v11 offset0:12 offset1:14
    ds_read2st64_b32 v[96:97], v11 offset0:24 offset1:26
    ds_read2st64_b32 v[98:99], v11 offset0:36 offset1:38
    buffer_load_dwordx4 v[68:71], v1, s[4:7], s40 offen offset:0 sc1
    buffer_load_dwordx4 v[76:79], v1, s[4:7], s40 offen offset:1024 sc1
    s_waitcnt lgkmcnt(2)
    v_pk_add_f32 v[92:93], v[92:93], v[94:95]
    s_waitcnt lgkmcnt(0)
    v_pk_add_f32 v[96:97], v[96:97], v[98:99]
    v_pk_add_f32 v[92:93], v[92:93], v[96:97]
    v_cvt_pk_bf16_f32 v21, v92, v93
    buffer_store_dword v21, v4, s[4:7], s39 offen sc1
    buffer_load_dwordx4 v[84:87], v1, s[4:7], s40 offen offset:2048 sc1
    buffer_load_dwordx4 v[88:91], v1, s[4:7], s40 offen offset:3072 sc1
L_h2_i:
    s_waitcnt vmcnt(4)
    v_mfma_f32_16x16x32_bf16 v[164:167], v[100:103], v[68:71], 0
    v_mov_b32_dpp v72, v68 row_ror:8 row_mask:0xf bank_mask:0xf
    v_mov_b32_dpp v73, v69 row_ror:8 row_mask:0xf bank_mask:0xf
    v_mfma_f32_16x16x32_bf16 v[168:171], v[116:119], v[68:71], 0
    v_mov_b32_dpp v74, v70 row_ror:8 row_mask:0xf bank_mask:0xf
    v_mov_b32_dpp v75, v71 row_ror:8 row_mask:0xf bank_mask:0xf
    s_waitcnt vmcnt(3)
    v_mfma_f32_16x16x32_bf16 v[164:167], v[108:111], v[76:79], v[164:167]
    v_max_u32 v19, v71, v79
    v_cmp_eq_u32 vcc, -1, v19
    v_mfma_f32_16x16x32_bf16 v[168:171], v[124:127], v[76:79], v[168:171]
    v_mov_b32_dpp v80, v76 row_ror:8 row_mask:0xf bank_mask:0xf
    v_mov_b32_dpp v81, v77 row_ror:8 row_mask:0xf bank_mask:0xf
    v_mfma_f32_16x16x32_bf16 v[164:167], v[104:107], v[72:75], v[164:167]
    v_mov_b32_dpp v82, v78 row_ror:8 row_mask:0xf bank_mask:0xf
    v_mov_b32_dpp v83, v79 row_ror:8 row_mask:0xf bank_mask:0xf
    v_mfma_f32_16x16x32_bf16 v[168:171], v[120:123], v[72:75], v[168:171]
    s_cbranch_vccnz L_r2_i
    v_mfma_f32_16x16x32_bf16 v[164:167], v[112:115], v[80:83], v[164:167]
    v_mfma_f32_16x16x32_bf16 v[168:171], v[128:131], v[80:83], v[168:171]
L_h2k_i:
    s_waitcnt vmcnt(1)
    v_smfmac_f32_16x16x64_bf16 v[172:175], v[84:87], v[68:75], v6
    s_waitcnt vmcnt(0)
    v_smfmac_f32_16x16x64_bf16 v[172:175], v[88:91], v[76:83], v6
    buffer_load_dwordx4 v[92:95], v1, s[4:7], s41 offen offset:0 sc1
    buffer_load_dwordx4 v[96:99], v1, s[4:7], s41 offen offset:1024 sc1
    v_max_u32 v19, v87, v91
    v_cmp_eq_u32 vcc, -1, v19
    v_max3_f32 v16, v22, v164, v165
    v_max3_f32 v16, v16, v166, v167
    v_max3_f32 v16, v16, v168, v169
    v_max3_f32 v16, v16, v170, v171
    v_permlane32_swap_b32 v172, v174
    v_permlane32_swap_b32 v173, v175
    v_pk_add_f32 v[172:173], v[172:173], v[174:175]
    v_max3_f32 v16, v16, v172, v173
    v_mov_b32 v17, v16
    s_cbranch_vccnz L_r2k_i
L_sj_i:
    buffer_load_dwordx4 v[132:135], v1, s[4:7], s44 offen offset:0 sc1
    v_permlane32_swap_b32 v16, v17
    v_max_f32 v16, v16, v17
    v_mov_b32 v17, v16
    buffer_load_dwordx4 v[136:139], v1, s[4:7], s44 offen offset:1024 sc1
    s_nop 0
    v_permlane16_swap_b32 v16, v17
    v_max_f32 v16, v16, v17
    v_mul_f32 v16, s53, v16
    v_fma_f32 v172, v172, s53, -v16
    v_fma_f32 v173, v173, s53, -v16
    v_fma_f32 v164, v164, s53, -v16
    v_fma_f32 v165, v165, s53, -v16
    v_fma_f32 v166, v166, s53, -v16
    v_fma_f32 v167, v167, s53, -v16
    v_fma_f32 v168, v168, s53, -v16
    v_fma_f32 v169, v169, s53, -v16
    v_fma_f32 v170, v170, s53, -v16
    v_fma_f32 v171, v171, s53, -v16
    v_exp_f32 v172, v172
    v_exp_f32 v173, v173
    v_exp_f32 v164, v164
    v_exp_f32 v165, v165
    v_exp_f32 v166, v166
    v_exp_f32 v167, v167
    v_exp_f32 v168, v168
    v_exp_f32 v169, v169
    v_exp_f32 v170, v170
    v_exp_f32 v171, v171
    v_cvt_pk_bf16_f32 v176, v164, v165
    v_cvt_pk_bf16_f32 v177, v166, v167
    v_cvt_pk_bf16_f32 v178, v168, v169
    v_cvt_pk_bf16_f32 v179, v170, v171
    v_cvt_pk_bf16_f32 v184, v172, v173
    v_cvt_pk_bf16_f32 v185, v172, v173
    v_mfma_f32_16x16x32_bf16 v[52:55], v[188:191], v[176:179], 0
    buffer_load_dwordx4 v[140:143], v1, s[4:7], s44 offen offset:2048 sc1
    v_mov_b32_dpp v180, v176 row_shr:8 row_mask:0xf bank_mask:0xc
    v_mov_b32_dpp v181, v177 row_shr:8 row_mask:0xf bank_mask:0xc
    v_mfma_f32_16x16x32_bf16 v[44:47], v[200:203], v[176:179], 0
    v_mov_b32_dpp v182, v178 row_shr:8 row_mask:0xf bank_mask:0xc
    v_mov_b32_dpp v183, v179 row_shr:8 row_mask:0xf bank_mask:0xc
    v_mfma_f32_16x16x32_bf16 v[48:51], v[208:211], v[176:179], 0
    buffer_load_dwordx4 v[144:147], v1, s[4:7], s44 offen offset:3072 sc1
    v_permlane32_swap_b32 v184, v185
    v_mfma_f32_16x16x32_bf16 v[44:47], v[204:207], v[180:183], v[44:47]
    s_waitcnt vmcnt(4)
    v_max_u32 v19, v95, v99
    v_cmp_eq_u32 vcc, -1, v19
    v_mfma_f32_16x16x32_bf16 v[48:51], v[212:215], v[180:183], v[48:51]
    v_mov_b32_dpp v186, v184 row_shr:8 row_mask:0xf bank_mask:0xc
    v_mov_b32_dpp v187, v185 row_shr:8 row_mask:0xf bank_mask:0xc
    v_mfma_f32_16x16x16_bf16 v[52:55], v[196:197], v[184:185], v[52:55]
    s_cbranch_vccnz L_r2v_i
L_h2v_i:
    v_smfmac_f32_16x16x64_bf16 v[216:219], v[92:95], a[192:199], v6
    buffer_load_dwordx4 v[148:151], v1, s[4:7], s45 offen offset:0 sc1
    v_smfmac_f32_16x16x64_bf16 v[216:219], v[96:99], a[200:207], v6
    buffer_load_dwordx4 v[152:155], v1, s[4:7], s45 offen offset:1024 sc1
    v_smfmac_f32_16x16x64_bf16 v[220:223], v[92:95], a[208:215], v6
    buffer_load_dwordx4 v[156:159], v1, s[4:7], s45 offen offset:2048 sc1
    v_rcp_f32 v17, v52
    v_smfmac_f32_16x16x64_bf16 v[220:223], v[96:99], a[216:223], v6
    buffer_load_dwordx4 v[160:163], v1, s[4:7], s45 offen offset:3072 sc1
    v_cvt_pk_bf16_f32 v232, v216, v217
    v_smfmac_f32_16x16x64_bf16 v[224:227], v[92:95], a[224:231], v6
    v_cvt_pk_bf16_f32 v233, v218, v219
    v_smfmac_f32_16x16x64_bf16 v[224:227], v[96:99], a[232:239], v6
    v_cvt_pk_bf16_f32 v234, v220, v221
    v_smfmac_f32_16x16x64_bf16 v[228:231], v[92:95], a[240:247], v6
    ds_write_b32 v14, v17
    v_cvt_pk_bf16_f32 v235, v222, v223
    v_smfmac_f32_16x16x64_bf16 v[228:231], v[96:99], a[248:255], v6
    v_cvt_pk_bf16_f32 v236, v224, v225
    v_mfma_f32_16x16x32_bf16 v[44:47], v[232:235], v[184:187], v[44:47]
    v_cvt_pk_bf16_f32 v237, v226, v227
    s_nop 1
    v_cvt_pk_bf16_f32 v238, v228, v229
    v_cvt_pk_bf16_f32 v239, v230, v231
    s_nop 1
    v_mfma_f32_16x16x32_bf16 v[48:51], v[236:239], v[184:187], v[48:51]
    ds_write_b128 v12, v[44:47]
    s_nop 4
    ds_write_b128 v12, v[48:51] offset:1024
    s_add_u32 s55, s55, 0x4000
    buffer_store_dword v20, v5, s[4:7], s48 offen sc1
    buffer_store_dword v21, v4, s[4:7], s48 offen sc1
    s_waitcnt lgkmcnt(0)
    s_barrier
    ds_read_b128 v[64:67], v15
    ds_read_b64 v[56:57], v13 offset:0
    ds_read_b64 v[58:59], v13 offset:2048
    ds_read_b64 v[60:61], v13 offset:4096
    ds_read_b64 v[62:63], v13 offset:6144
    buffer_load_dword v252, v253, s[4:7], s55 offen sc1
    s_waitcnt lgkmcnt(3)
    v_pk_mul_f32 v[56:57], v[56:57], v[64:65] op_sel:[0,0] op_sel_hi:[1,0]
    s_waitcnt lgkmcnt(2)
    v_pk_fma_f32 v[56:57], v[58:59], v[64:65], v[56:57] op_sel:[0,1,0] op_sel_hi:[1,1,1]
    s_waitcnt lgkmcnt(1)
    v_pk_fma_f32 v[56:57], v[60:61], v[66:67], v[56:57] op_sel:[0,0,0] op_sel_hi:[1,0,1]
    s_waitcnt lgkmcnt(0)
    v_pk_fma_f32 v[56:57], v[62:63], v[66:67], v[56:57] op_sel:[0,1,0] op_sel_hi:[1,1,1]
    v_cvt_pk_bf16_f32 v16, v56, v57
    buffer_store_dword v16, v2, s[4:7], s47 offen sc1
    s_waitcnt vmcnt(4)
    v_mfma_f32_16x16x32_bf16 v[216:219], v[132:135], a[192:195], 0
    buffer_load_dword v24, v23, s[4:7], s54 offen sc1
    v_mfma_f32_16x16x32_bf16 v[220:223], v[148:151], a[192:195], 0
    buffer_load_dwordx4 v[100:103], v1, s[4:7], s42 offen offset:0 sc1
    v_mfma_f32_16x16x32_bf16 v[216:219], v[136:139], a[196:199], v[216:219]
    buffer_load_dwordx4 v[104:107], v1, s[4:7], s42 offen offset:1024 sc1
    v_mfma_f32_16x16x32_bf16 v[220:223], v[152:155], a[196:199], v[220:223]
    buffer_load_dwordx4 v[108:111], v1, s[4:7], s42 offen offset:2048 sc1
    v_mfma_f32_16x16x32_bf16 v[216:219], v[140:143], a[200:203], v[216:219]
    buffer_load_dwordx4 v[112:115], v1, s[4:7], s42 offen offset:3072 sc1
    v_mfma_f32_16x16x32_bf16 v[220:223], v[156:159], a[200:203], v[220:223]
    s_bitcmp1_b32 s38, 14
    v_mfma_f32_16x16x32_bf16 v[216:219], v[144:147], a[204:207], v[216:219]
    s_cselect_b32 s49, 3, 1
    v_mfma_f32_16x16x32_bf16 v[220:223], v[160:163], a[204:207], v[220:223]
    s_lshl_b32 s49, s49, 14
    v_mfma_f32_16x16x32_bf16 v[224:227], v[132:135], a[208:211], 0
    s_xor_b32 s38, s38, s49
    v_mfma_f32_16x16x32_bf16 v[228:231], v[148:151], a[208:211], 0
    s_xor_b32 s37, s37, s49
    v_mfma_f32_16x16x32_bf16 v[224:227], v[136:139], a[212:215], v[224:227]
    s_xor_b32 s49, s38, 0x8000
    v_cvt_pk_bf16_f32 v200, v216, v217
    v_mfma_f32_16x16x32_bf16 v[228:231], v[152:155], a[212:215], v[228:231]
    buffer_store_dword v7, v194, s[4:7], s49 offen sc1
    v_cvt_pk_bf16_f32 v201, v218, v219
    v_mfma_f32_16x16x32_bf16 v[224:227], v[140:143], a[216:219], v[224:227]
    s_xor_b32 s39, s39, 0x8000
    v_cvt_pk_bf16_f32 v202, v220, v221
    v_mfma_f32_16x16x32_bf16 v[228:231], v[156:159], a[216:219], v[228:231]
    buffer_store_dword v7, v3, s[4:7], s39 offen sc1
    v_cvt_pk_bf16_f32 v203, v222, v223
    v_mfma_f32_16x16x32_bf16 v[224:227], v[144:147], a[220:223], v[224:227]
    buffer_store_dword v7, v4, s[4:7], s39 offen sc1
    v_mfma_f32_16x16x32_bf16 v[228:231], v[160:163], a[220:223], v[228:231]
    s_xor_b32 s40, s40, 0x8000
    v_mfma_f32_16x16x32_bf16 v[232:235], v[132:135], a[224:227], 0
    s_xor_b32 s41, s41, 0x8000
    v_mfma_f32_16x16x32_bf16 v[236:239], v[148:151], a[224:227], 0
    s_add_u32 s48, s48, 0x4000
    v_mfma_f32_16x16x32_bf16 v[232:235], v[136:139], a[228:231], v[232:235]
    s_add_u32 s47, s47, 0x4000
    v_cvt_pk_bf16_f32 v204, v224, v225
    v_mfma_f32_16x16x32_bf16 v[236:239], v[152:155], a[228:231], v[236:239]
    s_add_u32 s44, s44, 0x4000
    v_cvt_pk_bf16_f32 v205, v226, v227
    v_mfma_f32_16x16x32_bf16 v[232:235], v[140:143], a[232:235], v[232:235]
    s_add_u32 s45, s45, 0x4000
    v_cvt_pk_bf16_f32 v206, v228, v229
    v_mfma_f32_16x16x32_bf16 v[236:239], v[156:159], a[232:235], v[236:239]
    v_cvt_pk_bf16_f32 v207, v230, v231
    v_mfma_f32_16x16x32_bf16 v[232:235], v[144:147], a[236:239], v[232:235]
    v_mfma_f32_16x16x32_bf16 v[236:239], v[160:163], a[236:239], v[236:239]
    v_mfma_f32_16x16x32_bf16 v[240:243], v[132:135], a[240:243], 0
    buffer_load_dwordx2 v[166:167], v195, s[4:7], s46 offen sc1
    buffer_load_dwordx2 v[170:171], v195, s[4:7], s57 offen sc1
    v_mfma_f32_16x16x32_bf16 v[244:247], v[148:151], a[240:243], 0
    v_mfma_f32_16x16x32_bf16 v[240:243], v[136:139], a[244:247], v[240:243]
    v_cvt_pk_bf16_f32 v208, v232, v233
    v_mfma_f32_16x16x32_bf16 v[244:247], v[152:155], a[244:247], v[244:247]
    v_cvt_pk_bf16_f32 v209, v234, v235
    v_mfma_f32_16x16x32_bf16 v[240:243], v[140:143], a[248:251], v[240:243]
    v_cvt_pk_bf16_f32 v210, v236, v237
    v_mfma_f32_16x16x32_bf16 v[244:247], v[156:159], a[248:251], v[244:247]
    v_cvt_pk_bf16_f32 v211, v238, v239
    v_mfma_f32_16x16x32_bf16 v[240:243], v[144:147], a[252:255], v[240:243]
    v_mfma_f32_16x16x32_bf16 v[244:247], v[160:163], a[252:255], v[244:247]
    s_nop 3
    s_nop 0
    s_nop 3
    buffer_load_dwordx4 v[116:119], v1, s[4:7], s43 offen offset:0 sc1
    s_nop 0
    s_nop 0
    v_cvt_pk_bf16_f32 v212, v240, v241
    v_cvt_pk_bf16_f32 v213, v242, v243
    v_cvt_pk_bf16_f32 v214, v244, v245
    v_cvt_pk_bf16_f32 v215, v246, v247
L_h3_i:
    s_waitcnt vmcnt(2)
    v_mfma_f32_16x16x16_bf16 v[176:179], v[192:193], v[166:167], 0
    s_waitcnt vmcnt(1)
    v_mfma_f32_16x16x16_bf16 v[176:179], v[192:193], v[170:171], v[176:179]
    v_max_u32 v16, v167, v171
    v_cmp_eq_u32 vcc, -1, v16
    s_cbranch_vccnz L_r3_i
L_h3ok_i:
    v_cvt_pk_bf16_f32 v16, v176, v177
    buffer_store_dword v16, v194, s[4:7], s38 offen sc1
    s_add_u32 s36, s36, 1
    s_bitcmp1_b64 s[0:1], s36
    s_cselect_b32 s54, 0, 0x40000000
    s_add_u32 s46, s46, 0x4000
    s_add_u32 s57, s57, 0x4000
    v_mov_b32 v44, 0
    v_mov_b32 v45, 0
    v_mov_b32 v46, 0
    v_mov_b32 v47, 0
    s_nop 0
    v_mov_b32 v48, 0
    v_mov_b32 v49, 0
    v_mov_b32 v50, 0
    v_mov_b32 v51, 0
    s_nop 0
    v_mov_b32 v52, 0
    v_mov_b32 v53, 0
    v_mov_b32 v54, 0
    v_mov_b32 v55, 0
    s_nop 0
    v_mov_b32 v56, 0
    v_mov_b32 v57, 0
    v_mov_b32 v58, 0
    v_mov_b32 v59, 0
    buffer_load_dwordx4 v[28:31], v1, s[4:7], s37 offen offset:0 sc1
    v_mov_b32 v60, 0
    v_mov_b32 v61, 0
    v_mov_b32 v62, 0
    v_mov_b32 v63, 0
    s_nop 0
    v_mov_b32 v64, 0
    v_mov_b32 v65, 0
    v_mov_b32 v66, 0
    v_mov_b32 v67, 0
    s_nop 0
    v_mov_b32 v216, 0
    v_mov_b32 v217, 0
    v_mov_b32 v218, 0
    v_mov_b32 v219, 0
    buffer_load_dwordx4 v[32:35], v1, s[4:7], s37 offen offset:1024 sc1
    v_mov_b32 v220, 0
    v_mov_b32 v221, 0
    v_mov_b32 v222, 0
    v_mov_b32 v223, 0
    s_nop 0
    v_mov_b32 v224, 0
    v_mov_b32 v225, 0
    v_mov_b32 v226, 0
    v_mov_b32 v227, 0
    s_nop 0
    v_mov_b32 v228, 0
    v_mov_b32 v229, 0
    v_mov_b32 v230, 0
    v_mov_b32 v231, 0
    buffer_load_dwordx4 v[36:39], v1, s[4:7], s37 offen offset:2048 sc1
    v_mov_b32 v172, 0
    v_mov_b32 v173, 0
    v_mov_b32 v174, 0
    v_mov_b32 v175, 0
    v_readlane_b32 s51, v24, 0
    v_readlane_b32 s50, v24, 1
    s_add_u32 s49, s36, 2
    s_min_u32 s49, s49, 64
    s_min_i32 s50, s50, s51
    s_max_i32 s56, s56, s50
    s_cmp_lt_i32 s56, s49
    buffer_load_dwordx4 v[40:43], v1, s[4:7], s37 offen offset:3072 sc1
    s_cbranch_scc0 L_loop_i
    s_branch L_kvw_i
    .p2align 6
L_hk0_i:
    s_branch L_hk28_i
L_G15_0_i:
L_Z_i:
    buffer_load_dwordx4 v[28:31], v1, s[4:7], s37 offen offset:0 sc1
    s_nop 1
    v_mov_b64 v[44:45], 0
    v_mov_b64 v[46:47], 0
    s_nop 1
    v_mov_b64 v[48:49], 0
    v_mov_b64 v[50:51], 0
L_dr0_i:
    s_waitcnt vmcnt(3)
    v_cmp_eq_u32 vcc, -1, v35
    s_cbranch_vccnz L_G15_1_i
    v_smfmac_f32_16x16x64_bf16 v[44:47], v[32:35], a[48:55], v6
    v_smfmac_f32_16x16x64_bf16 v[48:51], v[32:35], a[56:63], v6
    s_waitcnt vmcnt(2)
    v_cmp_eq_u32 vcc, -1, v39
    v_smfmac_f32_16x16x64_bf16 v[52:55], v[32:35], a[64:71], v6
    v_smfmac_f32_16x16x64_bf16 v[56:59], v[32:35], a[72:79], v6
    s_cbranch_vccnz L_G13_2_i
    v_smfmac_f32_16x16x64_bf16 v[44:47], v[36:39], a[96:103], v6
    v_smfmac_f32_16x16x64_bf16 v[48:51], v[36:39], a[104:111], v6
    s_waitcnt vmcnt(1)
    v_cmp_eq_u32 vcc, -1, v43
    v_smfmac_f32_16x16x64_bf16 v[52:55], v[36:39], a[112:119], v6
    v_smfmac_f32_16x16x64_bf16 v[56:59], v[36:39], a[120:127], v6
    s_cbranch_vccnz L_G9_3_i
    v_smfmac_f32_16x16x64_bf16 v[44:47], v[40:43], a[144:151], v6
    v_smfmac_f32_16x16x64_bf16 v[48:51], v[40:43], a[152:159], v6
    s_waitcnt vmcnt(0)
    v_cmp_eq_u32 vcc, -1, v31
    v_smfmac_f32_16x16x64_bf16 v[52:55], v[40:43], a[160:167], v6
    v_smfmac_f32_16x16x64_bf16 v[56:59], v[40:43], a[168:175], v6
    s_cbranch_vccnz L_F1_0_i
    v_smfmac_f32_16x16x64_bf16 v[44:47], v[28:31], a[0:7], v6
    v_smfmac_f32_16x16x64_bf16 v[48:51], v[28:31], a[8:15], v6
    v_smfmac_f32_16x16x64_bf16 v[52:55], v[28:31], a[16:23], v6
    v_smfmac_f32_16x16x64_bf16 v[56:59], v[28:31], a[24:31], v6
    s_branch L_T1_i
L_hk1_i:
    s_branch L_hk29_i
    .p2align 6
L_hk2_i:
    s_branch L_hk30_i
L_G15_1_i:
    buffer_load_dwordx4 v[32:35], v1, s[4:7], s37 offen offset:1024 sc1
L_dr1_i:
    s_waitcnt vmcnt(3)
    v_cmp_eq_u32 vcc, -1, v39
    s_cbranch_vccnz L_G15_2_i
    v_smfmac_f32_16x16x64_bf16 v[44:47], v[36:39], a[96:103], v6
    v_smfmac_f32_16x16x64_bf16 v[48:51], v[36:39], a[104:111], v6
    s_waitcnt vmcnt(2)
    v_cmp_eq_u32 vcc, -1, v43
    v_smfmac_f32_16x16x64_bf16 v[52:55], v[36:39], a[112:119], v6
    v_smfmac_f32_16x16x64_bf16 v[56:59], v[36:39], a[120:127], v6
    s_cbranch_vccnz L_G11_3_i
    v_smfmac_f32_16x16x64_bf16 v[44:47], v[40:43], a[144:151], v6
    v_smfmac_f32_16x16x64_bf16 v[48:51], v[40:43], a[152:159], v6
    s_waitcnt vmcnt(1)
    v_cmp_eq_u32 vcc, -1, v31
    v_smfmac_f32_16x16x64_bf16 v[52:55], v[40:43], a[160:167], v6
    v_smfmac_f32_16x16x64_bf16 v[56:59], v[40:43], a[168:175], v6
    s_cbranch_vccnz L_G3_0_i
    v_smfmac_f32_16x16x64_bf16 v[44:47], v[28:31], a[0:7], v6
    v_smfmac_f32_16x16x64_bf16 v[48:51], v[28:31], a[8:15], v6
    s_waitcnt vmcnt(0)
    v_cmp_eq_u32 vcc, -1, v35
    v_smfmac_f32_16x16x64_bf16 v[52:55], v[28:31], a[16:23], v6
    v_smfmac_f32_16x16x64_bf16 v[56:59], v[28:31], a[24:31], v6
    s_cbranch_vccnz L_F2_1_i
    v_smfmac_f32_16x16x64_bf16 v[44:47], v[32:35], a[48:55], v6
    v_smfmac_f32_16x16x64_bf16 v[48:51], v[32:35], a[56:63], v6
    v_smfmac_f32_16x16x64_bf16 v[52:55], v[32:35], a[64:71], v6
    v_smfmac_f32_16x16x64_bf16 v[56:59], v[32:35], a[72:79], v6
    s_branch L_T1_i
L_hk3_i:
    s_branch L_hk31_i
    .p2align 6
L_hk4_i:
    s_branch L_hk32_i
L_G15_2_i:
    buffer_load_dwordx4 v[36:39], v1, s[4:7], s37 offen offset:2048 sc1
L_dr2_i:
    s_waitcnt vmcnt(3)
    v_cmp_eq_u32 vcc, -1, v43
    s_cbranch_vccnz L_G15_3_i
    v_smfmac_f32_16x16x64_bf16 v[44:47], v[40:43], a[144:151], v6
    v_smfmac_f32_16x16x64_bf16 v[48:51], v[40:43], a[152:159], v6
    s_waitcnt vmcnt(2)
    v_cmp_eq_u32 vcc, -1, v31
    v_smfmac_f32_16x16x64_bf16 v[52:55], v[40:43], a[160:167], v6
    v_smfmac_f32_16x16x64_bf16 v[56:59], v[40:43], a[168:175], v6
    s_cbranch_vccnz L_G7_0_i
    v_smfmac_f32_16x16x64_bf16 v[44:47], v[28:31], a[0:7], v6
    v_smfmac_f32_16x16x64_bf16 v[48:51], v[28:31], a[8:15], v6
    s_waitcnt vmcnt(1)
    v_cmp_eq_u32 vcc, -1, v35
    v_smfmac_f32_16x16x64_bf16 v[52:55], v[28:31], a[16:23], v6
    v_smfmac_f32_16x16x64_bf16 v[56:59], v[28:31], a[24:31], v6
    s_cbranch_vccnz L_G6_1_i
    v_smfmac_f32_16x16x64_bf16 v[44:47], v[32:35], a[48:55], v6
    v_smfmac_f32_16x16x64_bf16 v[48:51], v[32:35], a[56:63], v6
    s_waitcnt vmcnt(0)
    v_cmp_eq_u32 vcc, -1, v39
    v_smfmac_f32_16x16x64_bf16 v[52:55], v[32:35], a[64:71], v6
    v_smfmac_f32_16x16x64_bf16 v[56:59], v[32:35], a[72:79], v6
    s_cbranch_vccnz L_F4_2_i
    v_smfmac_f32_16x16x64_bf16 v[44:47], v[36:39], a[96:103], v6
    v_smfmac_f32_16x16x64_bf16 v[48:51], v[36:39], a[104:111], v6
    v_smfmac_f32_16x16x64_bf16 v[52:55], v[36:39], a[112:119], v6
    v_smfmac_f32_16x16x64_bf16 v[56:59], v[36:39], a[120:127], v6
    s_branch L_T1_i
L_hk5_i:
    s_branch L_hk33_i
    .p2align 6
L_hk6_i:
    s_branch L_hk34_i
L_G15_3_i:
    buffer_load_dwordx4 v[40:43], v1, s[4:7], s37 offen offset:3072 sc1
    s_sub_u32 s35, s35, 1
    s_cbranch_scc1 L_end0
L_dr3_i:
    s_waitcnt vmcnt(3)
    v_cmp_eq_u32 vcc, -1, v31
    s_cbranch_vccnz L_G15_0_i
    v_smfmac_f32_16x16x64_bf16 v[44:47], v[28:31], a[0:7], v6
    v_smfmac_f32_16x16x64_bf16 v[48:51], v[28:31], a[8:15], v6
    s_waitcnt vmcnt(2)
    v_cmp_eq_u32 vcc, -1, v35
    v_smfmac_f32_16x16x64_bf16 v[52:55], v[28:31], a[16:23], v6
    v_smfmac_f32_16x16x64_bf16 v[56:59], v[28:31], a[24:31], v6
    s_cbranch_vccnz L_G14_1_i
    v_smfmac_f32_16x16x64_bf16 v[44:47], v[32:35], a[48:55], v6
    v_smfmac_f32_16x16x64_bf16 v[48:51], v[32:35], a[56:63], v6
    s_waitcnt vmcnt(1)
    v_cmp_eq_u32 vcc, -1, v39
    v_smfmac_f32_16x16x64_bf16 v[52:55], v[32:35], a[64:71], v6
    v_smfmac_f32_16x16x64_bf16 v[56:59], v[32:35], a[72:79], v6
    s_cbranch_vccnz L_G12_2_i
    v_smfmac_f32_16x16x64_bf16 v[44:47], v[36:39], a[96:103], v6
    v_smfmac_f32_16x16x64_bf16 v[48:51], v[36:39], a[104:111], v6
    s_waitcnt vmcnt(0)
    v_cmp_eq_u32 vcc, -1, v43
    v_smfmac_f32_16x16x64_bf16 v[52:55], v[36:39], a[112:119], v6
    v_smfmac_f32_16x16x64_bf16 v[56:59], v[36:39], a[120:127], v6
    s_cbranch_vccnz L_F8_3_i
    v_smfmac_f32_16x16x64_bf16 v[44:47], v[40:43], a[144:151], v6
    v_smfmac_f32_16x16x64_bf16 v[48:51], v[40:43], a[152:159], v6
    v_smfmac_f32_16x16x64_bf16 v[52:55], v[40:43], a[160:167], v6
    v_smfmac_f32_16x16x64_bf16 v[56:59], v[40:43], a[168:175], v6
    s_branch L_T1_i
L_hk7_i:
    s_branch L_hk35_i
    .p2align 6
L_hk8_i:
    s_branch L_hk36_i
L_G7_0_i:
    buffer_load_dwordx4 v[28:31], v1, s[4:7], s37 offen offset:0 sc1
L_dr4_i:
    s_waitcnt vmcnt(2)
    v_cmp_eq_u32 vcc, -1, v35
    s_cbranch_vccnz L_G7_1_i
    v_smfmac_f32_16x16x64_bf16 v[44:47], v[32:35], a[48:55], v6
    v_smfmac_f32_16x16x64_bf16 v[48:51], v[32:35], a[56:63], v6
    s_waitcnt vmcnt(1)
    v_cmp_eq_u32 vcc, -1, v39
    v_smfmac_f32_16x16x64_bf16 v[52:55], v[32:35], a[64:71], v6
    v_smfmac_f32_16x16x64_bf16 v[56:59], v[32:35], a[72:79], v6
    s_cbranch_vccnz L_G5_2_i
    v_smfmac_f32_16x16x64_bf16 v[44:47], v[36:39], a[96:103], v6
    v_smfmac_f32_16x16x64_bf16 v[48:51], v[36:39], a[104:111], v6
    v_smfmac_f32_16x16x64_bf16 v[52:55], v[36:39], a[112:119], v6
    v_smfmac_f32_16x16x64_bf16 v[56:59], v[36:39], a[120:127], v6
    s_waitcnt vmcnt(0)
    v_cmp_eq_u32 vcc, -1, v31
    s_cbranch_vccnz L_F1_0_i
    v_smfmac_f32_16x16x64_bf16 v[44:47], v[28:31], a[0:7], v6
    v_smfmac_f32_16x16x64_bf16 v[48:51], v[28:31], a[8:15], v6
    v_smfmac_f32_16x16x64_bf16 v[52:55], v[28:31], a[16:23], v6
    v_smfmac_f32_16x16x64_bf16 v[56:59], v[28:31], a[24:31], v6
    s_branch L_T1_i
L_hk9_i:
    s_branch L_hk37_i
    .p2align 6
L_hk10_i:
    s_branch L_hk38_i
L_G7_1_i:
    buffer_load_dwordx4 v[32:35], v1, s[4:7], s37 offen offset:1024 sc1
L_dr5_i:
    s_waitcnt vmcnt(2)
    v_cmp_eq_u32 vcc, -1, v39
    s_cbranch_vccnz L_G7_2_i
    v_smfmac_f32_16x16x64_bf16 v[44:47], v[36:39], a[96:103], v6
    v_smfmac_f32_16x16x64_bf16 v[48:51], v[36:39], a[104:111], v6
    s_waitcnt vmcnt(1)
    v_cmp_eq_u32 vcc, -1, v31
    v_smfmac_f32_16x16x64_bf16 v[52:55], v[36:39], a[112:119], v6
    v_smfmac_f32_16x16x64_bf16 v[56:59], v[36:39], a[120:127], v6
    s_cbranch_vccnz L_G3_0_i
    v_smfmac_f32_16x16x64_bf16 v[44:47], v[28:31], a[0:7], v6
    v_smfmac_f32_16x16x64_bf16 v[48:51], v[28:31], a[8:15], v6
    v_smfmac_f32_16x16x64_bf16 v[52:55], v[28:31], a[16:23], v6
    v_smfmac_f32_16x16x64_bf16 v[56:59], v[28:31], a[24:31], v6
    s_waitcnt vmcnt(0)
    v_cmp_eq_u32 vcc, -1, v35
    s_cbranch_vccnz L_F2_1_i
    v_smfmac_f32_16x16x64_bf16 v[44:47], v[32:35], a[48:55], v6
    v_smfmac_f32_16x16x64_bf16 v[48:51], v[32:35], a[56:63], v6
    v_smfmac_f32_16x16x64_bf16 v[52:55], v[32:35], a[64:71], v6
    v_smfmac_f32_16x16x64_bf16 v[56:59], v[32:35], a[72:79], v6
    s_branch L_T1_i
L_hk11_i:
    s_branch L_hk39_i
    .p2align 6
L_hk12_i:
    s_branch L_hk40_i
L_G7_2_i:
    buffer_load_dwordx4 v[36:39], v1, s[4:7], s37 offen offset:2048 sc1
    s_sub_u32 s35, s35, 1
    s_cbranch_scc1 L_end0
L_dr6_i:
    s_waitcnt vmcnt(2)
    v_cmp_eq_u32 vcc, -1, v31
    s_cbranch_vccnz L_G7_0_i
    v_smfmac_f32_16x16x64_bf16 v[44:47], v[28:31], a[0:7], v6
    v_smfmac_f32_16x16x64_bf16 v[48:51], v[28:31], a[8:15], v6
    s_waitcnt vmcnt(1)
    v_cmp_eq_u32 vcc, -1, v35
    v_smfmac_f32_16x16x64_bf16 v[52:55], v[28:31], a[16:23], v6
    v_smfmac_f32_16x16x64_bf16 v[56:59], v[28:31], a[24:31], v6
    s_cbranch_vccnz L_G6_1_i
    v_smfmac_f32_16x16x64_bf16 v[44:47], v[32:35], a[48:55], v6
    v_smfmac_f32_16x16x64_bf16 v[48:51], v[32:35], a[56:63], v6
    v_smfmac_f32_16x16x64_bf16 v[52:55], v[32:35], a[64:71], v6
    v_smfmac_f32_16x16x64_bf16 v[56:59], v[32:35], a[72:79], v6
    s_waitcnt vmcnt(0)
    v_cmp_eq_u32 vcc, -1, v39
    s_cbranch_vccnz L_F4_2_i
    v_smfmac_f32_16x16x64_bf16 v[44:47], v[36:39], a[96:103], v6
    v_smfmac_f32_16x16x64_bf16 v[48:51], v[36:39], a[104:111], v6
    v_smfmac_f32_16x16x64_bf16 v[52:55], v[36:39], a[112:119], v6
    v_smfmac_f32_16x16x64_bf16 v[56:59], v[36:39], a[120:127], v6
    s_branch L_T1_i
L_hk13_i:
    s_branch L_hk41_i
    .p2align 6
L_hk14_i:
    s_branch L_hk42_i
L_G11_0_i:
    buffer_load_dwordx4 v[28:31], v1, s[4:7], s37 offen offset:0 sc1
L_dr7_i:
    s_waitcnt vmcnt(2)
    v_cmp_eq_u32 vcc, -1, v35
    s_cbranch_vccnz L_G11_1_i
    v_smfmac_f32_16x16x64_bf16 v[44:47], v[32:35], a[48:55], v6
    v_smfmac_f32_16x16x64_bf16 v[48:51], v[32:35], a[56:63], v6
    s_waitcnt vmcnt(1)
    v_cmp_eq_u32 vcc, -1, v43
    v_smfmac_f32_16x16x64_bf16 v[52:55], v[32:35], a[64:71], v6
    v_smfmac_f32_16x16x64_bf16 v[56:59], v[32:35], a[72:79], v6
    s_cbranch_vccnz L_G9_3_i
    v_smfmac_f32_16x16x64_bf16 v[44:47], v[40:43], a[144:151], v6
    v_smfmac_f32_16x16x64_bf16 v[48:51], v[40:43], a[152:159], v6
    v_smfmac_f32_16x16x64_bf16 v[52:55], v[40:43], a[160:167], v6
    v_smfmac_f32_16x16x64_bf16 v[56:59], v[40:43], a[168:175], v6
    s_waitcnt vmcnt(0)
    v_cmp_eq_u32 vcc, -1, v31
    s_cbranch_vccnz L_F1_0_i
    v_smfmac_f32_16x16x64_bf16 v[44:47], v[28:31], a[0:7], v6
    v_smfmac_f32_16x16x64_bf16 v[48:51], v[28:31], a[8:15], v6
    v_smfmac_f32_16x16x64_bf16 v[52:55], v[28:31], a[16:23], v6
    v_smfmac_f32_16x16x64_bf16 v[56:59], v[28:31], a[24:31], v6
    s_branch L_T1_i
L_hk15_i:
    s_branch L_hk43_i
    .p2align 6
L_hk16_i:
    s_branch L_hk44_i
L_G11_1_i:
    buffer_load_dwordx4 v[32:35], v1, s[4:7], s37 offen offset:1024 sc1
L_dr8_i:
    s_waitcnt vmcnt(2)
    v_cmp_eq_u32 vcc, -1, v43
    s_cbranch_vccnz L_G11_3_i
    v_smfmac_f32_16x16x64_bf16 v[44:47], v[40:43], a[144:151], v6
    v_smfmac_f32_16x16x64_bf16 v[48:51], v[40:43], a[152:159], v6
    s_waitcnt vmcnt(1)
    v_cmp_eq_u32 vcc, -1, v31
    v_smfmac_f32_16x16x64_bf16 v[52:55], v[40:43], a[160:167], v6
    v_smfmac_f32_16x16x64_bf16 v[56:59], v[40:43], a[168:175], v6
    s_cbranch_vccnz L_G3_0_i
    v_smfmac_f32_16x16x64_bf16 v[44:47], v[28:31], a[0:7], v6
    v_smfmac_f32_16x16x64_bf16 v[48:51], v[28:31], a[8:15], v6
    v_smfmac_f32_16x16x64_bf16 v[52:55], v[28:31], a[16:23], v6
    v_smfmac_f32_16x16x64_bf16 v[56:59], v[28:31], a[24:31], v6
    s_waitcnt vmcnt(0)
    v_cmp_eq_u32 vcc, -1, v35
    s_cbranch_vccnz L_F2_1_i
    v_smfmac_f32_16x16x64_bf16 v[44:47], v[32:35], a[48:55], v6
    v_smfmac_f32_16x16x64_bf16 v[48:51], v[32:35], a[56:63], v6
    v_smfmac_f32_16x16x64_bf16 v[52:55], v[32:35], a[64:71], v6
    v_smfmac_f32_16x16x64_bf16 v[56:59], v[32:35], a[72:79], v6
    s_branch L_T1_i
L_hk17_i:
    s_branch L_hk45_i
    .p2align 6
L_hk18_i:
    s_branch L_hk46_i
L_G11_3_i:
    buffer_load_dwordx4 v[40:43], v1, s[4:7], s37 offen offset:3072 sc1
    s_sub_u32 s35, s35, 1
    s_cbranch_scc1 L_end0
L_dr9_i:
    s_waitcnt vmcnt(2)
    v_cmp_eq_u32 vcc, -1, v31
    s_cbranch_vccnz L_G11_0_i
    v_smfmac_f32_16x16x64_bf16 v[44:47], v[28:31], a[0:7], v6
    v_smfmac_f32_16x16x64_bf16 v[48:51], v[28:31], a[8:15], v6
    s_waitcnt vmcnt(1)
    v_cmp_eq_u32 vcc, -1, v35
    v_smfmac_f32_16x16x64_bf16 v[52:55], v[28:31], a[16:23], v6
    v_smfmac_f32_16x16x64_bf16 v[56:59], v[28:31], a[24:31], v6
    s_cbranch_vccnz L_G10_1_i
    v_smfmac_f32_16x16x64_bf16 v[44:47], v[32:35], a[48:55], v6
    v_smfmac_f32_16x16x64_bf16 v[48:51], v[32:35], a[56:63], v6
    v_smfmac_f32_16x16x64_bf16 v[52:55], v[32:35], a[64:71], v6
    v_smfmac_f32_16x16x64_bf16 v[56:59], v[32:35], a[72:79], v6
    s_waitcnt vmcnt(0)
    v_cmp_eq_u32 vcc, -1, v43
    s_cbranch_vccnz L_F8_3_i
    v_smfmac_f32_16x16x64_bf16 v[44:47], v[40:43], a[144:151], v6
    v_smfmac_f32_16x16x64_bf16 v[48:51], v[40:43], a[152:159], v6
    v_smfmac_f32_16x16x64_bf16 v[52:55], v[40:43], a[160:167], v6
    v_smfmac_f32_16x16x64_bf16 v[56:59], v[40:43], a[168:175], v6
    s_branch L_T1_i
L_hk19_i:
    s_branch L_hk47_i
    .p2align 6
L_hk20_i:
    s_branch L_hk48_i
L_G13_0_i:
    buffer_load_dwordx4 v[28:31], v1, s[4:7], s37 offen offset:0 sc1
L_dr10_i:
    s_waitcnt vmcnt(2)
    v_cmp_eq_u32 vcc, -1, v39
    s_cbranch_vccnz L_G13_2_i
    v_smfmac_f32_16x16x64_bf16 v[44:47], v[36:39], a[96:103], v6
    v_smfmac_f32_16x16x64_bf16 v[48:51], v[36:39], a[104:111], v6
    s_waitcnt vmcnt(1)
    v_cmp_eq_u32 vcc, -1, v43
    v_smfmac_f32_16x16x64_bf16 v[52:55], v[36:39], a[112:119], v6
    v_smfmac_f32_16x16x64_bf16 v[56:59], v[36:39], a[120:127], v6
    s_cbranch_vccnz L_G9_3_i
    v_smfmac_f32_16x16x64_bf16 v[44:47], v[40:43], a[144:151], v6
    v_smfmac_f32_16x16x64_bf16 v[48:51], v[40:43], a[152:159], v6
    v_smfmac_f32_16x16x64_bf16 v[52:55], v[40:43], a[160:167], v6
    v_smfmac_f32_16x16x64_bf16 v[56:59], v[40:43], a[168:175], v6
    s_waitcnt vmcnt(0)
    v_cmp_eq_u32 vcc, -1, v31
    s_cbranch_vccnz L_F1_0_i
    v_smfmac_f32_16x16x64_bf16 v[44:47], v[28:31], a[0:7], v6
    v_smfmac_f32_16x16x64_bf16 v[48:51], v[28:31], a[8:15], v6
    v_smfmac_f32_16x16x64_bf16 v[52:55], v[28:31], a[16:23], v6
    v_smfmac_f32_16x16x64_bf16 v[56:59], v[28:31], a[24:31], v6
    s_branch L_T1_i
L_hk21_i:
    s_branch L_hk49_i
    .p2align 6
L_hk22_i:
    s_branch L_hk50_i
L_G13_2_i:
    buffer_load_dwordx4 v[36:39], v1, s[4:7], s37 offen offset:2048 sc1
L_dr11_i:
    s_waitcnt vmcnt(2)
    v_cmp_eq_u32 vcc, -1, v43
    s_cbranch_vccnz L_G13_3_i
    v_smfmac_f32_16x16x64_bf16 v[44:47], v[40:43], a[144:151], v6
    v_smfmac_f32_16x16x64_bf16 v[48:51], v[40:43], a[152:159], v6
    s_waitcnt vmcnt(1)
    v_cmp_eq_u32 vcc, -1, v31
    v_smfmac_f32_16x16x64_bf16 v[52:55], v[40:43], a[160:167], v6
    v_smfmac_f32_16x16x64_bf16 v[56:59], v[40:43], a[168:175], v6
    s_cbranch_vccnz L_G5_0_i
    v_smfmac_f32_16x16x64_bf16 v[44:47], v[28:31], a[0:7], v6
    v_smfmac_f32_16x16x64_bf16 v[48:51], v[28:31], a[8:15], v6
    v_smfmac_f32_16x16x64_bf16 v[52:55], v[28:31], a[16:23], v6
    v_smfmac_f32_16x16x64_bf16 v[56:59], v[28:31], a[24:31], v6
    s_waitcnt vmcnt(0)
    v_cmp_eq_u32 vcc, -1, v39
    s_cbranch_vccnz L_F4_2_i
    v_smfmac_f32_16x16x64_bf16 v[44:47], v[36:39], a[96:103], v6
    v_smfmac_f32_16x16x64_bf16 v[48:51], v[36:39], a[104:111], v6
    v_smfmac_f32_16x16x64_bf16 v[52:55], v[36:39], a[112:119], v6
    v_smfmac_f32_16x16x64_bf16 v[56:59], v[36:39], a[120:127], v6
    s_branch L_T1_i
L_hk23_i:
    s_branch L_hk51_i
    .p2align 6
L_hk24_i:
    s_branch L_hk52_i
L_G13_3_i:
    buffer_load_dwordx4 v[40:43], v1, s[4:7], s37 offen offset:3072 sc1
    s_sub_u32 s35, s35, 1
    s_cbranch_scc1 L_end0
L_dr12_i:
    s_waitcnt vmcnt(2)
    v_cmp_eq_u32 vcc, -1, v31
    s_cbranch_vccnz L_G13_0_i
    v_smfmac_f32_16x16x64_bf16 v[44:47], v[28:31], a[0:7], v6
    v_smfmac_f32_16x16x64_bf16 v[48:51], v[28:31], a[8:15], v6
    s_waitcnt vmcnt(1)
    v_cmp_eq_u32 vcc, -1, v39
    v_smfmac_f32_16x16x64_bf16 v[52:55], v[28:31], a[16:23], v6
    v_smfmac_f32_16x16x64_bf16 v[56:59], v[28:31], a[24:31], v6
    s_cbranch_vccnz L_G12_2_i
    v_smfmac_f32_16x16x64_bf16 v[44:47], v[36:39], a[96:103], v6
    v_smfmac_f32_16x16x64_bf16 v[48:51], v[36:39], a[104:111], v6
    v_smfmac_f32_16x16x64_bf16 v[52:55], v[36:39], a[112:119], v6
    v_smfmac_f32_16x16x64_bf16 v[56:59], v[36:39], a[120:127], v6
    s_waitcnt vmcnt(0)
    v_cmp_eq_u32 vcc, -1, v43
    s_cbranch_vccnz L_F8_3_i
    v_smfmac_f32_16x16x64_bf16 v[44:47], v[40:43], a[144:151], v6
    v_smfmac_f32_16x16x64_bf16 v[48:51], v[40:43], a[152:159], v6
    v_smfmac_f32_16x16x64_bf16 v[52:55], v[40:43], a[160:167], v6
    v_smfmac_f32_16x16x64_bf16 v[56:59], v[40:43], a[168:175], v6
    s_branch L_T1_i
L_hk25_i:
    s_branch L_hk53_i
    .p2align 6
L_hk26_i:
    s_branch L_hk54_i
L_G14_1_i:
    buffer_load_dwordx4 v[32:35], v1, s[4:7], s37 offen offset:1024 sc1
L_dr13_i:
    s_waitcnt vmcnt(2)
    v_cmp_eq_u32 vcc, -1, v39
    s_cbranch_vccnz L_G14_2_i
    v_smfmac_f32_16x16x64_bf16 v[44:47], v[36:39], a[96:103], v6
    v_smfmac_f32_16x16x64_bf16 v[48:51], v[36:39], a[104:111], v6
    s_waitcnt vmcnt(1)
    v_cmp_eq_u32 vcc, -1, v43
    v_smfmac_f32_16x16x64_bf16 v[52:55], v[36:39], a[112:119], v6
    v_smfmac_f32_16x16x64_bf16 v[56:59], v[36:39], a[120:127], v6
    s_cbranch_vccnz L_G10_3_i
    v_smfmac_f32_16x16x64_bf16 v[44:47], v[40:43], a[144:151], v6
    v_smfmac_f32_16x16x64_bf16 v[48:51], v[40:43], a[152:159], v6
    v_smfmac_f32_16x16x64_bf16 v[52:55], v[40:43], a[160:167], v6
    v_smfmac_f32_16x16x64_bf16 v[56:59], v[40:43], a[168:175], v6
    s_waitcnt vmcnt(0)
    v_cmp_eq_u32 vcc, -1, v35
    s_cbranch_vccnz L_F2_1_i
    v_smfmac_f32_16x16x64_bf16 v[44:47], v[32:35], a[48:55], v6
    v_smfmac_f32_16x16x64_bf16 v[48:51], v[32:35], a[56:63], v6
    v_smfmac_f32_16x16x64_bf16 v[52:55], v[32:35], a[64:71], v6
    v_smfmac_f32_16x16x64_bf16 v[56:59], v[32:35], a[72:79], v6
    s_branch L_T1_i
L_hk27_i:
    s_branch L_hk55_i
    .p2align 6
L_hk28_i:
    s_branch L_hk56_i
L_G14_2_i:
    buffer_load_dwordx4 v[36:39], v1, s[4:7], s37 offen offset:2048 sc1
L_dr14_i:
    s_waitcnt vmcnt(2)
    v_cmp_eq_u32 vcc, -1, v43
    s_cbranch_vccnz L_G14_3_i
    v_smfmac_f32_16x16x64_bf16 v[44:47], v[40:43], a[144:151], v6
    v_smfmac_f32_16x16x64_bf16 v[48:51], v[40:43], a[152:159], v6
    s_waitcnt vmcnt(1)
    v_cmp_eq_u32 vcc, -1, v35
    v_smfmac_f32_16x16x64_bf16 v[52:55], v[40:43], a[160:167], v6
    v_smfmac_f32_16x16x64_bf16 v[56:59], v[40:43], a[168:175], v6
    s_cbranch_vccnz L_G6_1_i
    v_smfmac_f32_16x16x64_bf16 v[44:47], v[32:35], a[48:55], v6
    v_smfmac_f32_16x16x64_bf16 v[48:51], v[32:35], a[56:63], v6
    v_smfmac_f32_16x16x64_bf16 v[52:55], v[32:35], a[64:71], v6
    v_smfmac_f32_16x16x64_bf16 v[56:59], v[32:35], a[72:79], v6
    s_waitcnt vmcnt(0)
    v_cmp_eq_u32 vcc, -1, v39
    s_cbranch_vccnz L_F4_2_i
    v_smfmac_f32_16x16x64_bf16 v[44:47], v[36:39], a[96:103], v6
    v_smfmac_f32_16x16x64_bf16 v[48:51], v[36:39], a[104:111], v6
    v_smfmac_f32_16x16x64_bf16 v[52:55], v[36:39], a[112:119], v6
    v_smfmac_f32_16x16x64_bf16 v[56:59], v[36:39], a[120:127], v6
    s_branch L_T1_i
L_hk29_i:
    s_branch L_hk57_i
    .p2align 6
L_hk30_i:
    s_branch L_hk58_i
L_G14_3_i:
    buffer_load_dwordx4 v[40:43], v1, s[4:7], s37 offen offset:3072 sc1
    s_sub_u32 s35, s35, 1
    s_cbranch_scc1 L_end0
L_dr15_i:
    s_waitcnt vmcnt(2)
    v_cmp_eq_u32 vcc, -1, v35
    s_cbranch_vccnz L_G14_1_i
    v_smfmac_f32_16x16x64_bf16 v[44:47], v[32:35], a[48:55], v6
    v_smfmac_f32_16x16x64_bf16 v[48:51], v[32:35], a[56:63], v6
    s_waitcnt vmcnt(1)
    v_cmp_eq_u32 vcc, -1, v39
    v_smfmac_f32_16x16x64_bf16 v[52:55], v[32:35], a[64:71], v6
    v_smfmac_f32_16x16x64_bf16 v[56:59], v[32:35], a[72:79], v6
    s_cbranch_vccnz L_G12_2_i
    v_smfmac_f32_16x16x64_bf16 v[44:47], v[36:39], a[96:103], v6
    v_smfmac_f32_16x16x64_bf16 v[48:51], v[36:39], a[104:111], v6
    v_smfmac_f32_16x16x64_bf16 v[52:55], v[36:39], a[112:119], v6
    v_smfmac_f32_16x16x64_bf16 v[56:59], v[36:39], a[120:127], v6
    s_waitcnt vmcnt(0)
    v_cmp_eq_u32 vcc, -1, v43
    s_cbranch_vccnz L_F8_3_i
    v_smfmac_f32_16x16x64_bf16 v[44:47], v[40:43], a[144:151], v6
    v_smfmac_f32_16x16x64_bf16 v[48:51], v[40:43], a[152:159], v6
    v_smfmac_f32_16x16x64_bf16 v[52:55], v[40:43], a[160:167], v6
    v_smfmac_f32_16x16x64_bf16 v[56:59], v[40:43], a[168:175], v6
    s_branch L_T1_i
L_hk31_i:
    s_branch L_hk59_i
    .p2align 6
L_hk32_i:
    s_branch L_hk60_i
L_G3_0_i:
    buffer_load_dwordx4 v[28:31], v1, s[4:7], s37 offen offset:0 sc1
L_dr16_i:
    s_waitcnt vmcnt(1)
    v_cmp_eq_u32 vcc, -1, v35
    s_cbranch_vccnz L_G3_1_i
    v_smfmac_f32_16x16x64_bf16 v[44:47], v[32:35], a[48:55], v6
    v_smfmac_f32_16x16x64_bf16 v[48:51], v[32:35], a[56:63], v6
    v_smfmac_f32_16x16x64_bf16 v[52:55], v[32:35], a[64:71], v6
    v_smfmac_f32_16x16x64_bf16 v[56:59], v[32:35], a[72:79], v6
    s_waitcnt vmcnt(0)
    v_cmp_eq_u32 vcc, -1, v31
    s_cbranch_vccnz L_F1_0_i
    v_smfmac_f32_16x16x64_bf16 v[44:47], v[28:31], a[0:7], v6
    v_smfmac_f32_16x16x64_bf16 v[48:51], v[28:31], a[8:15], v6
    v_smfmac_f32_16x16x64_bf16 v[52:55], v[28:31], a[16:23], v6
    v_smfmac_f32_16x16x64_bf16 v[56:59], v[28:31], a[24:31], v6
    s_branch L_T1_i
L_hk33_i:
    s_branch L_hk61_i
    .p2align 6
L_hk34_i:
    s_branch L_hk62_i
L_G3_1_i:
    buffer_load_dwordx4 v[32:35], v1, s[4:7], s37 offen offset:1024 sc1
    s_sub_u32 s35, s35, 1
    s_cbranch_scc1 L_end0
L_dr17_i:
    s_waitcnt vmcnt(1)
    v_cmp_eq_u32 vcc, -1, v31
    s_cbranch_vccnz L_G3_0_i
    v_smfmac_f32_16x16x64_bf16 v[44:47], v[28:31], a[0:7], v6
    v_smfmac_f32_16x16x64_bf16 v[48:51], v[28:31], a[8:15], v6
    v_smfmac_f32_16x16x64_bf16 v[52:55], v[28:31], a[16:23], v6
    v_smfmac_f32_16x16x64_bf16 v[56:59], v[28:31], a[24:31], v6
    s_waitcnt vmcnt(0)
    v_cmp_eq_u32 vcc, -1, v35
    s_cbranch_vccnz L_F2_1_i
    v_smfmac_f32_16x16x64_bf16 v[44:47], v[32:35], a[48:55], v6
    v_smfmac_f32_16x16x64_bf16 v[48:51], v[32:35], a[56:63], v6
    v_smfmac_f32_16x16x64_bf16 v[52:55], v[32:35], a[64:71], v6
    v_smfmac_f32_16x16x64_bf16 v[56:59], v[32:35], a[72:79], v6
    s_branch L_T1_i
L_hk35_i:
    s_branch L_hk63_i
    .p2align 6
L_hk36_i:
    s_branch L_hk64_i
L_G5_0_i:
    buffer_load_dwordx4 v[28:31], v1, s[4:7], s37 offen offset:0 sc1
L_dr18_i:
    s_waitcnt vmcnt(1)
    v_cmp_eq_u32 vcc, -1, v39
    s_cbranch_vccnz L_G5_2_i
    v_smfmac_f32_16x16x64_bf16 v[44:47], v[36:39], a[96:103], v6
    v_smfmac_f32_16x16x64_bf16 v[48:51], v[36:39], a[104:111], v6
    v_smfmac_f32_16x16x64_bf16 v[52:55], v[36:39], a[112:119], v6
    v_smfmac_f32_16x16x64_bf16 v[56:59], v[36:39], a[120:127], v6
    s_waitcnt vmcnt(0)
    v_cmp_eq_u32 vcc, -1, v31
    s_cbranch_vccnz L_F1_0_i
    v_smfmac_f32_16x16x64_bf16 v[44:47], v[28:31], a[0:7], v6
    v_smfmac_f32_16x16x64_bf16 v[48:51], v[28:31], a[8:15], v6
    v_smfmac_f32_16x16x64_bf16 v[52:55], v[28:31], a[16:23], v6
    v_smfmac_f32_16x16x64_bf16 v[56:59], v[28:31], a[24:31], v6
    s_branch L_T1_i
L_hk37_i:
    s_branch L_hk65_i
    .p2align 6
L_hk38_i:
    s_branch L_hk66_i
L_G5_2_i:
    buffer_load_dwordx4 v[36:39], v1, s[4:7], s37 offen offset:2048 sc1
    s_sub_u32 s35, s35, 1
    s_cbranch_scc1 L_end0
L_dr19_i:
    s_waitcnt vmcnt(1)
    v_cmp_eq_u32 vcc, -1, v31
    s_cbranch_vccnz L_G5_0_i
    v_smfmac_f32_16x16x64_bf16 v[44:47], v[28:31], a[0:7], v6
    v_smfmac_f32_16x16x64_bf16 v[48:51], v[28:31], a[8:15], v6
    v_smfmac_f32_16x16x64_bf16 v[52:55], v[28:31], a[16:23], v6
    v_smfmac_f32_16x16x64_bf16 v[56:59], v[28:31], a[24:31], v6
    s_waitcnt vmcnt(0)
    v_cmp_eq_u32 vcc, -1, v39
    s_cbranch_vccnz L_F4_2_i
    v_smfmac_f32_16x16x64_bf16 v[44:47], v[36:39], a[96:103], v6
    v_smfmac_f32_16x16x64_bf16 v[48:51], v[36:39], a[104:111], v6
    v_smfmac_f32_16x16x64_bf16 v[52:55], v[36:39], a[112:119], v6
    v_smfmac_f32_16x16x64_bf16 v[56:59], v[36:39], a[120:127], v6
    s_branch L_T1_i
L_hk39_i:
    s_branch L_hk67_i
    .p2align 6
L_hk40_i:
    s_branch L_hk68_i
L_G6_1_i:
    buffer_load_dwordx4 v[32:35], v1, s[4:7], s37 offen offset:1024 sc1
L_dr20_i:
    s_waitcnt vmcnt(1)
    v_cmp_eq_u32 vcc, -1, v39
    s_cbranch_vccnz L_G6_2_i
    v_smfmac_f32_16x16x64_bf16 v[44:47], v[36:39], a[96:103], v6
    v_smfmac_f32_16x16x64_bf16 v[48:51], v[36:39], a[104:111], v6
    v_smfmac_f32_16x16x64_bf16 v[52:55], v[36:39], a[112:119], v6
    v_smfmac_f32_16x16x64_bf16 v[56:59], v[36:39], a[120:127], v6
    s_waitcnt vmcnt(0)
    v_cmp_eq_u32 vcc, -1, v35
    s_cbranch_vccnz L_F2_1_i
    v_smfmac_f32_16x16x64_bf16 v[44:47], v[32:35], a[48:55], v6
    v_smfmac_f32_16x16x64_bf16 v[48:51], v[32:35], a[56:63], v6
    v_smfmac_f32_16x16x64_bf16 v[52:55], v[32:35], a[64:71], v6
    v_smfmac_f32_16x16x64_bf16 v[56:59], v[32:35], a[72:79], v6
    s_branch L_T1_i
L_hk41_i:
    s_branch L_hk69_i
    .p2align 6
L_hk42_i:
    s_branch L_hk70_i
L_G6_2_i:
    buffer_load_dwordx4 v[36:39], v1, s[4:7], s37 offen offset:2048 sc1
    s_sub_u32 s35, s35, 1
    s_cbranch_scc1 L_end0
L_dr21_i:
    s_waitcnt vmcnt(1)
    v_cmp_eq_u32 vcc, -1, v35
    s_cbranch_vccnz L_G6_1_i
    v_smfmac_f32_16x16x64_bf16 v[44:47], v[32:35], a[48:55], v6
    v_smfmac_f32_16x16x64_bf16 v[48:51], v[32:35], a[56:63], v6
    v_smfmac_f32_16x16x64_bf16 v[52:55], v[32:35], a[64:71], v6
    v_smfmac_f32_16x16x64_bf16 v[56:59], v[32:35], a[72:79], v6
    s_waitcnt vmcnt(0)
    v_cmp_eq_u32 vcc, -1, v39
    s_cbranch_vccnz L_F4_2_i
    v_smfmac_f32_16x16x64_bf16 v[44:47], v[36:39], a[96:103], v6
    v_smfmac_f32_16x16x64_bf16 v[48:51], v[36:39], a[104:111], v6
    v_smfmac_f32_16x16x64_bf16 v[52:55], v[36:39], a[112:119], v6
    v_smfmac_f32_16x16x64_bf16 v[56:59], v[36:39], a[120:127], v6
    s_branch L_T1_i
L_hk43_i:
    s_branch L_hk71_i
    .p2align 6
L_hk44_i:
    s_branch L_hkret4
L_G9_0_i:
    buffer_load_dwordx4 v[28:31], v1, s[4:7], s37 offen offset:0 sc1
L_dr22_i:
    s_waitcnt vmcnt(1)
    v_cmp_eq_u32 vcc, -1, v43
    s_cbranch_vccnz L_G9_3_i
    v_smfmac_f32_16x16x64_bf16 v[44:47], v[40:43], a[144:151], v6
    v_smfmac_f32_16x16x64_bf16 v[48:51], v[40:43], a[152:159], v6
    v_smfmac_f32_16x16x64_bf16 v[52:55], v[40:43], a[160:167], v6
    v_smfmac_f32_16x16x64_bf16 v[56:59], v[40:43], a[168:175], v6
    s_waitcnt vmcnt(0)
    v_cmp_eq_u32 vcc, -1, v31
    s_cbranch_vccnz L_F1_0_i
    v_smfmac_f32_16x16x64_bf16 v[44:47], v[28:31], a[0:7], v6
    v_smfmac_f32_16x16x64_bf16 v[48:51], v[28:31], a[8:15], v6
    v_smfmac_f32_16x16x64_bf16 v[52:55], v[28:31], a[16:23], v6
    v_smfmac_f32_16x16x64_bf16 v[56:59], v[28:31], a[24:31], v6
    s_branch L_T1_i
L_hk45_i:
    s_branch L_hkret4
    .p2align 6
L_hk46_i:
    s_branch L_hkret4
L_G9_3_i:
    buffer_load_dwordx4 v[40:43], v1, s[4:7], s37 offen offset:3072 sc1
    s_sub_u32 s35, s35, 1
    s_cbranch_scc1 L_end0
L_dr23_i:
    s_waitcnt vmcnt(1)
    v_cmp_eq_u32 vcc, -1, v31
    s_cbranch_vccnz L_G9_0_i
    v_smfmac_f32_16x16x64_bf16 v[44:47], v[28:31], a[0:7], v6
    v_smfmac_f32_16x16x64_bf16 v[48:51], v[28:31], a[8:15], v6
    v_smfmac_f32_16x16x64_bf16 v[52:55], v[28:31], a[16:23], v6
    v_smfmac_f32_16x16x64_bf16 v[56:59], v[28:31], a[24:31], v6
    s_waitcnt vmcnt(0)
    v_cmp_eq_u32 vcc, -1, v43
    s_cbranch_vccnz L_F8_3_i
    v_smfmac_f32_16x16x64_bf16 v[44:47], v[40:43], a[144:151], v6
    v_smfmac_f32_16x16x64_bf16 v[48:51], v[40:43], a[152:159], v6
    v_smfmac_f32_16x16x64_bf16 v[52:55], v[40:43], a[160:167], v6
    v_smfmac_f32_16x16x64_bf16 v[56:59], v[40:43], a[168:175], v6
    s_branch L_T1_i
L_hk47_i:
    s_branch L_hkret4
    .p2align 6
L_hk48_i:
    s_branch L_hkret5
L_G10_1_i:
    buffer_load_dwordx4 v[32:35], v1, s[4:7], s37 offen offset:1024 sc1
L_dr24_i:
    s_waitcnt vmcnt(1)
    v_cmp_eq_u32 vcc, -1, v43
    s_cbranch_vccnz L_G10_3_i
    v_smfmac_f32_16x16x64_bf16 v[44:47], v[40:43], a[144:151], v6
    v_smfmac_f32_16x16x64_bf16 v[48:51], v[40:43], a[152:159], v6
    v_smfmac_f32_16x16x64_bf16 v[52:55], v[40:43], a[160:167], v6
    v_smfmac_f32_16x16x64_bf16 v[56:59], v[40:43], a[168:175], v6
    s_waitcnt vmcnt(0)
    v_cmp_eq_u32 vcc, -1, v35
    s_cbranch_vccnz L_F2_1_i
    v_smfmac_f32_16x16x64_bf16 v[44:47], v[32:35], a[48:55], v6
    v_smfmac_f32_16x16x64_bf16 v[48:51], v[32:35], a[56:63], v6
    v_smfmac_f32_16x16x64_bf16 v[52:55], v[32:35], a[64:71], v6
    v_smfmac_f32_16x16x64_bf16 v[56:59], v[32:35], a[72:79], v6
    s_branch L_T1_i
L_hk49_i:
    s_branch L_hkret5
    .p2align 6
L_hk50_i:
    s_branch L_hkret5
L_G10_3_i:
    buffer_load_dwordx4 v[40:43], v1, s[4:7], s37 offen offset:3072 sc1
    s_sub_u32 s35, s35, 1
    s_cbranch_scc1 L_end0
L_dr25_i:
    s_waitcnt vmcnt(1)
    v_cmp_eq_u32 vcc, -1, v35
    s_cbranch_vccnz L_G10_1_i
    v_smfmac_f32_16x16x64_bf16 v[44:47], v[32:35], a[48:55], v6
    v_smfmac_f32_16x16x64_bf16 v[48:51], v[32:35], a[56:63], v6
    v_smfmac_f32_16x16x64_bf16 v[52:55], v[32:35], a[64:71], v6
    v_smfmac_f32_16x16x64_bf16 v[56:59], v[32:35], a[72:79], v6
    s_waitcnt vmcnt(0)
    v_cmp_eq_u32 vcc, -1, v43
    s_cbranch_vccnz L_F8_3_i
    v_smfmac_f32_16x16x64_bf16 v[44:47], v[40:43], a[144:151], v6
    v_smfmac_f32_16x16x64_bf16 v[48:51], v[40:43], a[152:159], v6
    v_smfmac_f32_16x16x64_bf16 v[52:55], v[40:43], a[160:167], v6
    v_smfmac_f32_16x16x64_bf16 v[56:59], v[40:43], a[168:175], v6
    s_branch L_T1_i
L_hk51_i:
    s_branch L_hkret5
    .p2align 6
L_hk52_i:
    s_branch L_hkret6
L_G12_2_i:
    buffer_load_dwordx4 v[36:39], v1, s[4:7], s37 offen offset:2048 sc1
L_dr26_i:
    s_waitcnt vmcnt(1)
    v_cmp_eq_u32 vcc, -1, v43
    s_cbranch_vccnz L_G12_3_i
    v_smfmac_f32_16x16x64_bf16 v[44:47], v[40:43], a[144:151], v6
    v_smfmac_f32_16x16x64_bf16 v[48:51], v[40:43], a[152:159], v6
    v_smfmac_f32_16x16x64_bf16 v[52:55], v[40:43], a[160:167], v6
    v_smfmac_f32_16x16x64_bf16 v[56:59], v[40:43], a[168:175], v6
    s_waitcnt vmcnt(0)
    v_cmp_eq_u32 vcc, -1, v39
    s_cbranch_vccnz L_F4_2_i
    v_smfmac_f32_16x16x64_bf16 v[44:47], v[36:39], a[96:103], v6
    v_smfmac_f32_16x16x64_bf16 v[48:51], v[36:39], a[104:111], v6
    v_smfmac_f32_16x16x64_bf16 v[52:55], v[36:39], a[112:119], v6
    v_smfmac_f32_16x16x64_bf16 v[56:59], v[36:39], a[120:127], v6
    s_branch L_T1_i
L_hk53_i:
    s_branch L_hkret6
    .p2align 6
L_hk54_i:
    s_branch L_hkret6
L_G12_3_i:
    buffer_load_dwordx4 v[40:43], v1, s[4:7], s37 offen offset:3072 sc1
    s_sub_u32 s35, s35, 1
    s_cbranch_scc1 L_end0
L_dr27_i:
    s_waitcnt vmcnt(1)
    v_cmp_eq_u32 vcc, -1, v39
    s_cbranch_vccnz L_G12_2_i
    v_smfmac_f32_16x16x64_bf16 v[44:47], v[36:39], a[96:103], v6
    v_smfmac_f32_16x16x64_bf16 v[48:51], v[36:39], a[104:111], v6
    v_smfmac_f32_16x16x64_bf16 v[52:55], v[36:39], a[112:119], v6
    v_smfmac_f32_16x16x64_bf16 v[56:59], v[36:39], a[120:127], v6
    s_waitcnt vmcnt(0)
    v_cmp_eq_u32 vcc, -1, v43
    s_cbranch_vccnz L_F8_3_i
    v_smfmac_f32_16x16x64_bf16 v[44:47], v[40:43], a[144:151], v6
    v_smfmac_f32_16x16x64_bf16 v[48:51], v[40:43], a[152:159], v6
    v_smfmac_f32_16x16x64_bf16 v[52:55], v[40:43], a[160:167], v6
    v_smfmac_f32_16x16x64_bf16 v[56:59], v[40:43], a[168:175], v6
    s_branch L_T1_i
L_hk55_i:
    s_branch L_hkret6
    .p2align 6
L_hk56_i:
    s_branch L_hkret0
L_P1_0_i:
    s_waitcnt vmcnt(3)
    v_max3_u32 v16, v28, v29, v30
    v_max_u32 v16, v16, v31
    v_cmp_eq_u32 vcc, -1, v16
    s_cbranch_vccz L_V1_0_i
L_F1_0_i:
    buffer_load_dwordx4 v[28:31], v1, s[4:7], s37 offen offset:0 sc1
    s_sub_u32 s35, s35, 1
    s_cbranch_scc0 L_P1_0_i
    s_endpgm
    .p2align 6
L_hk57_i:
    s_branch L_hkret0
L_V1_0_i:
    v_smfmac_f32_16x16x64_bf16 v[44:47], v[28:31], a[0:7], v6
    v_smfmac_f32_16x16x64_bf16 v[48:51], v[28:31], a[8:15], v6
    v_smfmac_f32_16x16x64_bf16 v[52:55], v[28:31], a[16:23], v6
    v_smfmac_f32_16x16x64_bf16 v[56:59], v[28:31], a[24:31], v6
    s_branch L_T1_i
    .p2align 6
L_hk58_i:
    s_branch L_hkret0
L_P2_1_i:
    s_waitcnt vmcnt(3)
    v_max3_u32 v16, v32, v33, v34
    v_max_u32 v16, v16, v35
    v_cmp_eq_u32 vcc, -1, v16
    s_cbranch_vccz L_V2_1_i
L_F2_1_i:
    buffer_load_dwordx4 v[32:35], v1, s[4:7], s37 offen offset:1024 sc1
    s_sub_u32 s35, s35, 1
    s_cbranch_scc0 L_P2_1_i
    s_endpgm
    .p2align 6
L_hk59_i:
    s_branch L_hkret0
L_V2_1_i:
    v_smfmac_f32_16x16x64_bf16 v[44:47], v[32:35], a[48:55], v6
    v_smfmac_f32_16x16x64_bf16 v[48:51], v[32:35], a[56:63], v6
    v_smfmac_f32_16x16x64_bf16 v[52:55], v[32:35], a[64:71], v6
    v_smfmac_f32_16x16x64_bf16 v[56:59], v[32:35], a[72:79], v6
    s_branch L_T1_i
    .p2align 6
L_hk60_i:
    s_branch L_hkret1
L_P4_2_i:
    s_waitcnt vmcnt(3)
    v_max3_u32 v16, v36, v37, v38
    v_max_u32 v16, v16, v39
    v_cmp_eq_u32 vcc, -1, v16
    s_cbranch_vccz L_V4_2_i
L_F4_2_i:
    buffer_load_dwordx4 v[36:39], v1, s[4:7], s37 offen offset:2048 sc1
    s_sub_u32 s35, s35, 1
    s_cbranch_scc0 L_P4_2_i
    s_endpgm
    .p2align 6
L_hk61_i:
    s_branch L_hkret1
L_V4_2_i:
    v_smfmac_f32_16x16x64_bf16 v[44:47], v[36:39], a[96:103], v6
    v_smfmac_f32_16x16x64_bf16 v[48:51], v[36:39], a[104:111], v6
    v_smfmac_f32_16x16x64_bf16 v[52:55], v[36:39], a[112:119], v6
    v_smfmac_f32_16x16x64_bf16 v[56:59], v[36:39], a[120:127], v6
    s_branch L_T1_i
    .p2align 6
L_hk62_i:
    s_branch L_hkret1
L_P8_3_i:
    s_waitcnt vmcnt(3)
    v_max3_u32 v16, v40, v41, v42
    v_max_u32 v16, v16, v43
    v_cmp_eq_u32 vcc, -1, v16
    s_cbranch_vccz L_V8_3_i
L_F8_3_i:
    buffer_load_dwordx4 v[40:43], v1, s[4:7], s37 offen offset:3072 sc1
    s_sub_u32 s35, s35, 1
    s_cbranch_scc0 L_P8_3_i
    s_endpgm
    .p2align 6
L_hk63_i:
    s_branch L_hkret1
L_V8_3_i:
    v_smfmac_f32_16x16x64_bf16 v[44:47], v[40:43], a[144:151], v6
    v_smfmac_f32_16x16x64_bf16 v[48:51], v[40:43], a[152:159], v6
    v_smfmac_f32_16x16x64_bf16 v[52:55], v[40:43], a[160:167], v6
    v_smfmac_f32_16x16x64_bf16 v[56:59], v[40:43], a[168:175], v6
    s_branch L_T1_i
L_sp_i:
    s_cmp_eq_u32 s36, 63
    s_cbranch_scc1 L_c_tail
    s_mov_b32 s52, 63
    s_cmp_ge_i32 s56, 1
    s_cbranch_scc1 L_sp3_i
L_sp1_i:
    buffer_load_dword v24, v23, s[4:7], 0 offen sc1
    s_waitcnt vmcnt(0)
    v_readlane_b32 s51, v24, 0
    v_readlane_b32 s50, v24, 1
    s_add_u32 s49, s36, 1
    s_min_u32 s49, s49, 64
    s_min_i32 s50, s50, s51
    s_max_i32 s56, s56, s50
    s_cmp_lt_i32 s56, s49
    s_cbranch_scc1 L_sp2_i
L_sp7_i:
    s_sub_u32 s42, s42, 0x40004000
    s_sub_u32 s43, s43, 0x40004000
    s_sub_u32 s44, s44, 0x40000000
    s_sub_u32 s49, s55, 0x4000
    buffer_load_dword v252, v253, s[4:7], s49 offen sc1
    buffer_load_dwordx4 v[132:135], v1, s[4:7], s44 offen offset:0 sc1
    buffer_load_dwordx4 v[136:139], v1, s[4:7], s44 offen offset:1024 sc1
    buffer_load_dwordx4 v[140:143], v1, s[4:7], s44 offen offset:2048 sc1
    buffer_load_dwordx4 v[144:147], v1, s[4:7], s44 offen offset:3072 sc1
    buffer_load_dwordx4 v[148:151], v1, s[4:7], s45 offen offset:0 sc1
    buffer_load_dwordx4 v[152:155], v1, s[4:7], s45 offen offset:1024 sc1
    buffer_load_dwordx4 v[156:159], v1, s[4:7], s45 offen offset:2048 sc1
    buffer_load_dwordx4 v[160:163], v1, s[4:7], s45 offen offset:3072 sc1
    buffer_load_dwordx4 v[100:103], v1, s[4:7], s42 offen offset:0 sc1
    buffer_load_dwordx4 v[104:107], v1, s[4:7], s42 offen offset:1024 sc1
    buffer_load_dwordx4 v[108:111], v1, s[4:7], s42 offen offset:2048 sc1
    buffer_load_dwordx4 v[112:115], v1, s[4:7], s42 offen offset:3072 sc1
    buffer_load_dwordx4 v[116:119], v1, s[4:7], s43 offen offset:0 sc1
    buffer_load_dwordx4 v[120:123], v1, s[4:7], s43 offen offset:1024 sc1
    buffer_load_dwordx4 v[124:127], v1, s[4:7], s43 offen offset:2048 sc1
    buffer_load_dwordx4 v[128:131], v1, s[4:7], s43 offen offset:3072 sc1
    s_add_u32 s42, s42, 0x4000
    s_add_u32 s43, s43, 0x4000
L_sp3_i:
    s_add_u32 s44, s44, 0x4000
    s_add_u32 s45, s45, 0x4000
    s_waitcnt vmcnt(8) lgkmcnt(0)
    v_mfma_f32_16x16x32_bf16 v[216:219], v[132:135], a[192:195], 0
    v_mfma_f32_16x16x32_bf16 v[220:223], v[148:151], a[192:195], 0
    v_mfma_f32_16x16x32_bf16 v[216:219], v[136:139], a[196:199], v[216:219]
    v_mfma_f32_16x16x32_bf16 v[220:223], v[152:155], a[196:199], v[220:223]
    v_mfma_f32_16x16x32_bf16 v[216:219], v[140:143], a[200:203], v[216:219]
    v_mfma_f32_16x16x32_bf16 v[220:223], v[156:159], a[200:203], v[220:223]
    v_mfma_f32_16x16x32_bf16 v[216:219], v[144:147], a[204:207], v[216:219]
    v_mfma_f32_16x16x32_bf16 v[220:223], v[160:163], a[204:207], v[220:223]
    v_mfma_f32_16x16x32_bf16 v[224:227], v[132:135], a[208:211], 0
    v_mfma_f32_16x16x32_bf16 v[228:231], v[148:151], a[208:211], 0
    v_mfma_f32_16x16x32_bf16 v[224:227], v[136:139], a[212:215], v[224:227]
    v_cvt_pk_bf16_f32 v200, v216, v217
    v_mfma_f32_16x16x32_bf16 v[228:231], v[152:155], a[212:215], v[228:231]
    v_cvt_pk_bf16_f32 v201, v218, v219
    v_mfma_f32_16x16x32_bf16 v[224:227], v[140:143], a[216:219], v[224:227]
    v_cvt_pk_bf16_f32 v202, v220, v221
    v_mfma_f32_16x16x32_bf16 v[228:231], v[156:159], a[216:219], v[228:231]
    v_cvt_pk_bf16_f32 v203, v222, v223
    v_mfma_f32_16x16x32_bf16 v[224:227], v[144:147], a[220:223], v[224:227]
    v_mfma_f32_16x16x32_bf16 v[228:231], v[160:163], a[220:223], v[228:231]
    v_mfma_f32_16x16x32_bf16 v[232:235], v[132:135], a[224:227], 0
    buffer_load_dword v24, v23, s[4:7], 0 offen sc1
    v_mfma_f32_16x16x32_bf16 v[236:239], v[148:151], a[224:227], 0
    v_mfma_f32_16x16x32_bf16 v[232:235], v[136:139], a[228:231], v[232:235]
    v_cvt_pk_bf16_f32 v204, v224, v225
    v_mfma_f32_16x16x32_bf16 v[236:239], v[152:155], a[228:231], v[236:239]
    v_cvt_pk_bf16_f32 v205, v226, v227
    v_mfma_f32_16x16x32_bf16 v[232:235], v[140:143], a[232:235], v[232:235]
    v_cvt_pk_bf16_f32 v206, v228, v229
    v_mfma_f32_16x16x32_bf16 v[236:239], v[156:159], a[232:235], v[236:239]
    v_cvt_pk_bf16_f32 v207, v230, v231
    v_mfma_f32_16x16x32_bf16 v[232:235], v[144:147], a[236:239], v[232:235]
    v_mfma_f32_16x16x32_bf16 v[236:239], v[160:163], a[236:239], v[236:239]
    v_mfma_f32_16x16x32_bf16 v[240:243], v[132:135], a[240:243], 0
    v_mfma_f32_16x16x32_bf16 v[244:247], v[148:151], a[240:243], 0
    v_mfma_f32_16x16x32_bf16 v[240:243], v[136:139], a[244:247], v[240:243]
    v_cvt_pk_bf16_f32 v208, v232, v233
    v_mfma_f32_16x16x32_bf16 v[244:247], v[152:155], a[244:247], v[244:247]
    v_cvt_pk_bf16_f32 v209, v234, v235
    v_mfma_f32_16x16x32_bf16 v[240:243], v[140:143], a[248:251], v[240:243]
    v_cvt_pk_bf16_f32 v210, v236, v237
    v_mfma_f32_16x16x32_bf16 v[244:247], v[156:159], a[248:251], v[244:247]
    v_cvt_pk_bf16_f32 v211, v238, v239
    v_mfma_f32_16x16x32_bf16 v[240:243], v[144:147], a[252:255], v[240:243]
    v_mfma_f32_16x16x32_bf16 v[244:247], v[160:163], a[252:255], v[244:247]
    v_mov_b32 v216, 0
    v_mov_b32 v217, 0
    v_mov_b32 v218, 0
    v_mov_b32 v219, 0
    s_nop 0
    v_mov_b32 v220, 0
    v_mov_b32 v221, 0
    v_mov_b32 v222, 0
    v_mov_b32 v223, 0
    s_nop 0
    v_mov_b32 v224, 0
    v_mov_b32 v225, 0
    v_mov_b32 v226, 0
    v_mov_b32 v227, 0
    s_nop 0
    v_mov_b32 v228, 0
    v_mov_b32 v229, 0
    v_mov_b32 v230, 0
    v_mov_b32 v231, 0
    s_nop 0
    v_cvt_pk_bf16_f32 v212, v240, v241
    v_cvt_pk_bf16_f32 v213, v242, v243
    v_cvt_pk_bf16_f32 v214, v244, v245
    v_cvt_pk_bf16_f32 v215, v246, v247
    s_branch L_sp5_i
L_sp4_i:
    s_sub_u32 s35, s35, 1
    s_cbranch_scc0 L_sp6_i
    s_endpgm
L_sp6_i:
    buffer_load_dword v24, v23, s[4:7], 0 offen sc1
L_sp5_i:
    s_waitcnt vmcnt(0)
    v_readlane_b32 s51, v24, 0
    v_readlane_b32 s50, v24, 1
    s_add_u32 s49, s36, 2
    s_min_u32 s49, s49, 64
    s_min_i32 s50, s50, s51
    s_max_i32 s56, s56, s50
    s_cmp_lt_i32 s56, s49
    s_cbranch_scc1 L_sp4_i
    buffer_load_dword v252, v253, s[4:7], s55 offen sc1
    s_branch L_spr_i
L_sp2_i:
    s_sleep 1
    s_sub_u32 s35, s35, 1
    s_cbranch_scc0 L_sp1_i
    s_endpgm
    .p2align 6
L_hk64_i:
    s_branch L_hkret2
L_kvw_i:
    buffer_load_dword v24, v23, s[4:7], 0 offen sc1
    s_waitcnt vmcnt(0)
    v_readlane_b32 s51, v24, 0
    v_readlane_b32 s50, v24, 1
    s_add_u32 s49, s36, 2
    s_min_u32 s49, s49, 64
    s_min_i32 s50, s50, s51
    s_max_i32 s56, s56, s50
    s_cmp_lt_i32 s56, s49
    s_cbranch_scc1 L_kvw2_i
    s_branch L_loop_i
L_kvw2_i:
    s_sub_u32 s35, s35, 1
    s_cbranch_scc0 L_kvw_i
    s_endpgm
    .p2align 6
L_hk65_i:
    s_branch L_hkret2
L_r2_i:
    buffer_load_dwordx4 v[68:71], v1, s[4:7], s40 offen offset:0 sc1
    buffer_load_dwordx4 v[76:79], v1, s[4:7], s40 offen offset:1024 sc1
    buffer_store_dword v21, v4, s[4:7], s39 offen sc1
    buffer_load_dwordx4 v[84:87], v1, s[4:7], s40 offen offset:2048 sc1
    buffer_load_dwordx4 v[88:91], v1, s[4:7], s40 offen offset:3072 sc1
    s_sub_u32 s35, s35, 1
    s_cbranch_scc0 L_h2_i
    s_endpgm
    .p2align 6
L_hk66_i:
    s_branch L_hkret2
L_r2k_i:
    buffer_load_dwordx4 v[84:87], v1, s[4:7], s40 offen offset:2048 sc1
    buffer_load_dwordx4 v[88:91], v1, s[4:7], s40 offen offset:3072 sc1
    v_mov_b32 v172, 0
    v_mov_b32 v173, 0
    v_mov_b32 v174, 0
    v_mov_b32 v175, 0
    s_sub_u32 s35, s35, 1
    s_cbranch_scc0 L_h2k_i
    s_endpgm
L_hk67_i:
    s_branch L_hkret2
    .p2align 6
L_hk68_i:
    s_branch L_hkret3
L_r2v_i:
    buffer_load_dwordx4 v[92:95], v1, s[4:7], s41 offen offset:0 sc1
    buffer_load_dwordx4 v[96:99], v1, s[4:7], s41 offen offset:1024 sc1
    s_waitcnt vmcnt(0)
    v_max3_u32 v19, v92, v93, v94
    v_max_u32 v19, v19, v95
    v_max3_u32 v19, v19, v96, v97
    v_max3_u32 v19, v19, v98, v99
    v_cmp_eq_u32 vcc, -1, v19
    s_cbranch_vccz L_h2v_i
    s_sub_u32 s35, s35, 1
    s_cbranch_scc0 L_r2v_i
    s_endpgm
L_hk69_i:
    s_branch L_hkret3
    .p2align 6
L_hk70_i:
    s_branch L_hkret3
L_r3_i:
    buffer_load_dwordx2 v[166:167], v195, s[4:7], s46 offen sc1
    buffer_load_dwordx2 v[170:171], v195, s[4:7], s57 offen sc1
    s_waitcnt vmcnt(0)
    s_sub_u32 s35, s35, 1
    s_cbranch_scc0 L_h3_i
    s_endpgm
    s_waitcnt vmcnt(0)
    v_max3_u32 v16, v164, v165, v166
    v_max_u32 v16, v16, v167
    v_max3_u32 v16, v16, v168, v169
    v_max3_u32 v16, v16, v170, v171
    v_cmp_eq_u32 vcc, -1, v16
    v_mfma_f32_16x16x16_bf16 v[176:179], v[192:193], v[166:167], 0
    v_mfma_f32_16x16x16_bf16 v[176:179], v[192:193], v[170:171], v[176:179]
    s_nop 6
    s_cbranch_vccz L_h3ok_i
    s_sub_u32 s35, s35, 1
    s_cbranch_scc0 L_r3_i
    s_endpgm
L_hk71_i:
    s_branch L_hkret3
L_loop_end_i:
L_c_tail:
    s_add_u32 s48, s48, 2048
    s_xor_b32 s48, s48, 0x2000
    s_sub_u32 s48, s48, 2048
    buffer_store_dword v20, v5, s[4:7], s48 offen sc1
    s_waitcnt lgkmcnt(0)
    s_barrier
    ds_read2st64_b32 v[92:93], v11 offset0:0 offset1:2
    ds_read2st64_b32 v[94:95], v11 offset0:12 offset1:14
    ds_read2st64_b32 v[96:97], v11 offset0:24 offset1:26
    ds_read2st64_b32 v[98:99], v11 offset0:36 offset1:38
    s_waitcnt lgkmcnt(2)
    v_pk_add_f32 v[92:93], v[92:93], v[94:95]
    s_waitcnt lgkmcnt(0)
    v_pk_add_f32 v[96:97], v[96:97], v[98:99]
    v_pk_add_f32 v[92:93], v[92:93], v[96:97]
    v_cvt_pk_bf16_f32 v21, v92, v93
    buffer_store_dword v21, v4, s[4:7], s48 offen sc1
    s_waitcnt vmcnt(0)
    s_endpgm
L_k:
    s_mov_b32 s12, s70
    s_and_b32 s13, s71, 0xffff
    s_mov_b32 s14, 0x800000
    s_mov_b32 s15, 0x20000
    s_mov_b32 s16, s64
    s_and_b32 s17, s65, 0xffff
    s_mov_b32 s18, 0x400000
    s_mov_b32 s19, 0x20000
    v_lshlrev_b32 v1, 4, v0
    s_lshl_b32 s45, s36, 7
    s_lshl_b32 s45, s45, 1
    s_add_u32 s45, s45, 0xe430000
    s_cmp_eq_u32 s32, 0
    s_cselect_b32 s46, 2, 0
    v_bfe_u32 v6, v0, 0, 1
    v_lshlrev_b32 v4, 13, v6
    v_add_u32 v4, s45, v4
    v_mov_b32 v6, 0x40000000
    v_cmp_gt_u32 vcc, s46, v0
    s_nop 1
    v_cndmask_b32 v4, v6, v4, vcc
    v_and_b32 v6, 15, v0
    v_mul_u32_u24 v2, 2064, v6
    v_lshrrev_b32 v6, 4, v0
    v_lshl_add_u32 v2, v6, 8, v2
    v_lshlrev_b32 v3, 1, v2
    v_add_u32 v3, 66048, v3
    s_mul_i32 s39, s32, 16512
    s_lshl_b32 s40, s39, 1
    s_add_u32 s40, s40, 66048
    s_lshl_b32 s38, s32, 14
    s_and_b32 s45, s32, 1
    s_lshl_b32 s45, s45, 3
    v_bfe_u32 v6, v0, 4, 2
    v_lshlrev_b32 v7, 1, v6
    v_add_u32 v7, s45, v7
    v_and_b32 v6, 15, v0
    v_xor_b32 v7, v7, v6
    v_bfe_u32 v6, v0, 4, 2
    v_lshlrev_b32 v12, 13, v6
    v_lshl_add_u32 v12, v7, 4, v12
    s_lshl_b32 s45, s32, 11
    s_add_u32 s45, s45, 132096
    v_add_u32 v13, s45, v1
    s_lshl_b32 s45, s32, 1
    v_bfe_u32 v7, v0, 2, 3
    v_xor_b32 v7, s45, v7
    v_bfe_u32 v6, v0, 4, 2
    v_lshlrev_b32 v14, 11, v6
    v_bfe_u32 v6, v0, 2, 2
    v_lshl_add_u32 v14, v6, 8, v14
    v_bfe_u32 v6, v0, 0, 2
    v_lshl_add_u32 v14, v6, 3, v14
    v_add_u32 v14, 132096, v14
    v_lshl_add_u32 v14, v7, 5, v14
    v_xor_b32 v15, 32, v14
    s_lshl_b32 s47, s36, 8
    s_lshl_b32 s45, s32, 20
    s_add_u32 s47, s47, s45
    s_add_u32 s46, s47, 0x0
    buffer_load_dwordx4 a[0:3], v12, s[12:15], s46 offen nt
    s_add_u32 s46, s47, 0x8000
    buffer_load_dwordx4 a[4:7], v12, s[12:15], s46 offen nt
    s_add_u32 s46, s47, 0x10000
    buffer_load_dwordx4 a[8:11], v12, s[12:15], s46 offen nt
    s_add_u32 s46, s47, 0x18000
    buffer_load_dwordx4 a[12:15], v12, s[12:15], s46 offen nt
    s_add_u32 s46, s47, 0x20000
    buffer_load_dwordx4 a[16:19], v12, s[12:15], s46 offen nt
    s_add_u32 s46, s47, 0x28000
    buffer_load_dwordx4 a[20:23], v12, s[12:15], s46 offen nt
    s_waitcnt vmcnt(6)
    s_barrier
    buffer_atomic_or v254, v255, s[8:11], 0 offen sc0 sc1
    s_add_u32 m0, s39, 0
    s_add_u32 s45, s38, 0
    buffer_load_dwordx4 v1, s[16:19], s45 offen offset:0 lds
    s_add_u32 m0, s39, 66048
    s_add_u32 s45, s38, 65536
    buffer_load_dwordx4 v1, s[16:19], s45 offen offset:0 lds
    s_add_u32 m0, s39, 2064
    s_add_u32 s45, s38, 2048
    buffer_load_dwordx4 v1, s[16:19], s45 offen offset:0 lds
    s_add_u32 m0, s39, 68112
    s_add_u32 s45, s38, 67584
    buffer_load_dwordx4 v1, s[16:19], s45 offen offset:0 lds
    s_add_u32 m0, s39, 4128
    s_add_u32 s45, s38, 4096
    buffer_load_dwordx4 v1, s[16:19], s45 offen offset:0 lds
    s_add_u32 m0, s39, 70176
    s_add_u32 s45, s38, 69632
    buffer_load_dwordx4 v1, s[16:19], s45 offen offset:0 lds
    s_add_u32 m0, s39, 6192
    s_add_u32 s45, s38, 6144
    buffer_load_dwordx4 v1, s[16:19], s45 offen offset:0 lds
    s_add_u32 m0, s39, 72240
    s_add_u32 s45, s38, 71680
    buffer_load_dwordx4 v1, s[16:19], s45 offen offset:0 lds
    s_add_u32 m0, s39, 8256
    s_add_u32 s45, s38, 8192
    buffer_load_dwordx4 v1, s[16:19], s45 offen offset:0 lds
    s_add_u32 m0, s39, 74304
    s_add_u32 s45, s38, 73728
    buffer_load_dwordx4 v1, s[16:19], s45 offen offset:0 lds
    s_add_u32 m0, s39, 10320
    s_add_u32 s45, s38, 10240
    buffer_load_dwordx4 v1, s[16:19], s45 offen offset:0 lds
    s_add_u32 m0, s39, 76368
    s_add_u32 s45, s38, 75776
    buffer_load_dwordx4 v1, s[16:19], s45 offen offset:0 lds
    s_add_u32 m0, s39, 12384
    s_add_u32 s45, s38, 12288
    buffer_load_dwordx4 v1, s[16:19], s45 offen offset:0 lds
    s_add_u32 m0, s39, 78432
    s_add_u32 s45, s38, 77824
    buffer_load_dwordx4 v1, s[16:19], s45 offen offset:0 lds
    s_add_u32 m0, s39, 14448
    s_add_u32 s45, s38, 14336
    buffer_load_dwordx4 v1, s[16:19], s45 offen offset:0 lds
    s_add_u32 m0, s39, 80496
    s_add_u32 s45, s38, 79872
    buffer_load_dwordx4 v1, s[16:19], s45 offen offset:0 lds
    s_add_u32 s46, s47, 0x30000
    buffer_load_dwordx4 a[24:27], v12, s[12:15], s46 offen nt
    s_add_u32 s46, s47, 0x38000
    buffer_load_dwordx4 a[28:31], v12, s[12:15], s46 offen nt
    s_add_u32 s46, s47, 0x40000
    buffer_load_dwordx4 a[32:35], v12, s[12:15], s46 offen nt
    s_add_u32 s46, s47, 0x48000
    buffer_load_dwordx4 a[36:39], v12, s[12:15], s46 offen nt
    s_add_u32 s46, s47, 0x50000
    buffer_load_dwordx4 a[40:43], v12, s[12:15], s46 offen nt
    s_add_u32 s46, s47, 0x58000
    buffer_load_dwordx4 a[44:47], v12, s[12:15], s46 offen nt
    s_mul_i32 s41, s36, 0x208000
    s_lshl_b32 s45, s32, 11
    s_add_u32 s42, s41, s45
    s_add_u32 s42, s42, 0x2000
    s_lshl_b32 s45, s32, 10
    s_add_u32 s41, s41, s45
    s_add_u32 s41, s41, 0x0
    v_bfe_u32 v6, v0, 4, 2
    v_lshlrev_b32 v5, 22, v6
    v_bfe_u32 v6, v0, 4, 2
    v_lshl_add_u32 v5, v6, 16, v5
    v_bfe_u32 v6, v0, 0, 4
    v_lshl_add_u32 v5, v6, 4, v5
    s_lshl_b32 s43, s32, 3
    s_bfe_u32 s45, s36, 0x10001
    s_add_u32 s43, s43, s45
    s_mul_i32 s43, s43, 0x208000
    s_and_b32 s45, s36, 1
    s_lshl_b32 s45, s45, 12
    s_add_u32 s43, s43, s45
    s_lshr_b32 s45, s36, 2
    s_lshl_b32 s45, s45, 8
    s_add_u32 s43, s43, s45
    s_add_u32 s43, s43, 0xa000000
    s_lshr_b32 s48, s36, 1
    s_mul_i32 s48, s48, 0x208000
    s_and_b32 s45, s36, 1
    s_lshl_b32 s45, s45, 2
    s_add_u32 s45, s45, s32
    s_lshl_b32 s45, s45, 10
    s_add_u32 s48, s48, s45
    s_add_u32 s48, s48, 0x8000000
    v_mov_b32 v104, -1
    v_mov_b32 v105, -1
    v_mov_b32 v106, -1
    v_mov_b32 v107, -1
    s_and_b32 s44, s63, 15
    s_lshl_b32 s44, s44, 2
    s_add_u32 s44, s44, s32
    s_lshl_b32 s44, s44, 10
    s_add_u32 s44, s44, 0x20000
    s_mov_b32 s37, 0xe400000
    v_add_u32 v16, 66048, v2
    s_waitcnt vmcnt(6)
    v_mov_b32 v7, 163832
    s_cmp_lg_u32 s32, 0
    s_cbranch_scc1 L_cf_6
    v_readfirstlane_b32 s45, v254
    s_nop 1
    v_mov_b32 v6, s45
    ds_write_b32 v7, v6
    s_waitcnt lgkmcnt(0)
L_cf_6:
    s_barrier
    ds_read_b32 v6, v7
    s_waitcnt lgkmcnt(0)
    v_readfirstlane_b32 s45, v6
    s_nop 0
    s_bitcmp1_b32 s45, s63
    s_cbranch_scc1 L_redo
    ds_write_b128 v13, a[0:3] offset:0
    ds_write_b128 v13, a[4:7] offset:1024
    s_waitcnt lgkmcnt(0)
    s_barrier
    ds_read_b64_tr_b16 a[0:1], v14 offset:0
    ds_read_b64_tr_b16 a[2:3], v14 offset:1024
    ds_read_b64_tr_b16 a[4:5], v15 offset:0
    ds_read_b64_tr_b16 a[6:7], v15 offset:1024
    ds_read_b128 v[28:31], v2 offset:0
    ds_read_b128 v[32:35], v2 offset:33024
    ds_read_b128 v[36:39], v16 offset:0
    ds_read_b128 v[40:43], v16 offset:33024
    s_add_u32 m0, s39, 0
    s_add_u32 s45, s38, 0
    buffer_load_dwordx4 v1, s[16:19], s45 offen offset:1024 lds
    s_add_u32 m0, s39, 66048
    s_add_u32 s45, s38, 65536
    buffer_load_dwordx4 v1, s[16:19], s45 offen offset:1024 lds
    s_add_u32 s46, s47, 0x60000
    buffer_load_dwordx4 a[48:51], v12, s[12:15], s46 offen nt
    s_add_u32 s46, s47, 0x68000
    buffer_load_dwordx4 a[52:55], v12, s[12:15], s46 offen nt
    s_waitcnt vmcnt(12)
    ds_write_b128 v13, a[8:11] offset:8192
    ds_write_b128 v13, a[12:15] offset:9216
    s_waitcnt lgkmcnt(0)
    s_barrier
    ds_read_b64_tr_b16 a[8:9], v14 offset:8192
    ds_read_b64_tr_b16 a[10:11], v14 offset:9216
    ds_read_b64_tr_b16 a[12:13], v15 offset:8192
    ds_read_b64_tr_b16 a[14:15], v15 offset:9216
    ds_read_b128 v[88:91], v2 offset:16
    ds_read_b128 v[92:95], v2 offset:33040
    ds_read_b128 v[96:99], v16 offset:16
    ds_read_b128 v[100:103], v16 offset:33040
    v_mfma_f32_16x16x32_bf16 v[44:47], a[0:3], v[28:31], 0
    s_add_u32 m0, s39, 2064
    s_add_u32 s45, s38, 2048
    buffer_load_dwordx4 v1, s[16:19], s45 offen offset:1024 lds
    v_mfma_f32_16x16x32_bf16 v[52:55], a[4:7], v[28:31], 0
    s_add_u32 m0, s39, 68112
    s_add_u32 s45, s38, 67584
    buffer_load_dwordx4 v1, s[16:19], s45 offen offset:1024 lds
    v_mfma_f32_16x16x32_bf16 v[48:51], a[0:3], v[32:35], 0
    s_add_u32 s46, s47, 0x70000
    buffer_load_dwordx4 a[56:59], v12, s[12:15], s46 offen nt
    v_mfma_f32_16x16x32_bf16 v[56:59], a[4:7], v[32:35], 0
    s_add_u32 s46, s47, 0x78000
    buffer_load_dwordx4 a[60:63], v12, s[12:15], s46 offen nt
    v_mfma_f32_16x16x32_bf16 v[72:75], a[0:3], v[36:39], 0
    s_waitcnt vmcnt(14)
    ds_write_b128 v13, a[16:19] offset:0
    v_mfma_f32_16x16x32_bf16 v[80:83], a[4:7], v[36:39], 0
    ds_write_b128 v13, a[20:23] offset:1024
    v_mfma_f32_16x16x32_bf16 v[76:79], a[0:3], v[40:43], 0
    v_mfma_f32_16x16x32_bf16 v[84:87], a[4:7], v[40:43], 0
    s_waitcnt lgkmcnt(0)
    s_barrier
    ds_read_b64_tr_b16 a[16:17], v14 offset:0
    ds_read_b64_tr_b16 a[18:19], v14 offset:1024
    ds_read_b64_tr_b16 a[20:21], v15 offset:0
    ds_read_b64_tr_b16 a[22:23], v15 offset:1024
    ds_read_b128 v[28:31], v2 offset:32
    ds_read_b128 v[32:35], v2 offset:33056
    ds_read_b128 v[36:39], v16 offset:32
    ds_read_b128 v[40:43], v16 offset:33056
    v_mfma_f32_16x16x32_bf16 v[44:47], a[8:11], v[88:91], v[44:47]
    s_add_u32 m0, s39, 4128
    s_add_u32 s45, s38, 4096
    buffer_load_dwordx4 v1, s[16:19], s45 offen offset:1024 lds
    v_mfma_f32_16x16x32_bf16 v[52:55], a[12:15], v[88:91], v[52:55]
    s_add_u32 m0, s39, 70176
    s_add_u32 s45, s38, 69632
    buffer_load_dwordx4 v1, s[16:19], s45 offen offset:1024 lds
    v_mfma_f32_16x16x32_bf16 v[48:51], a[8:11], v[92:95], v[48:51]
    s_add_u32 s46, s47, 0x80000
    buffer_load_dwordx4 a[64:67], v12, s[12:15], s46 offen nt
    v_mfma_f32_16x16x32_bf16 v[56:59], a[12:15], v[92:95], v[56:59]
    s_add_u32 s46, s47, 0x88000
    buffer_load_dwordx4 a[68:71], v12, s[12:15], s46 offen nt
    v_mfma_f32_16x16x32_bf16 v[72:75], a[8:11], v[96:99], v[72:75]
    s_waitcnt vmcnt(16)
    ds_write_b128 v13, a[24:27] offset:8192
    v_mfma_f32_16x16x32_bf16 v[80:83], a[12:15], v[96:99], v[80:83]
    ds_write_b128 v13, a[28:31] offset:9216
    v_mfma_f32_16x16x32_bf16 v[76:79], a[8:11], v[100:103], v[76:79]
    v_mfma_f32_16x16x32_bf16 v[84:87], a[12:15], v[100:103], v[84:87]
    s_waitcnt lgkmcnt(0)
    s_barrier
    ds_read_b64_tr_b16 a[24:25], v14 offset:8192
    ds_read_b64_tr_b16 a[26:27], v14 offset:9216
    ds_read_b64_tr_b16 a[28:29], v15 offset:8192
    ds_read_b64_tr_b16 a[30:31], v15 offset:9216
    ds_read_b128 v[88:91], v2 offset:48
    ds_read_b128 v[92:95], v2 offset:33072
    ds_read_b128 v[96:99], v16 offset:48
    ds_read_b128 v[100:103], v16 offset:33072
    v_mfma_f32_16x16x32_bf16 v[44:47], a[16:19], v[28:31], v[44:47]
    s_add_u32 m0, s39, 6192
    s_add_u32 s45, s38, 6144
    buffer_load_dwordx4 v1, s[16:19], s45 offen offset:1024 lds
    v_mfma_f32_16x16x32_bf16 v[52:55], a[20:23], v[28:31], v[52:55]
    s_add_u32 m0, s39, 72240
    s_add_u32 s45, s38, 71680
    buffer_load_dwordx4 v1, s[16:19], s45 offen offset:1024 lds
    v_mfma_f32_16x16x32_bf16 v[48:51], a[16:19], v[32:35], v[48:51]
    s_add_u32 s46, s47, 0x90000
    buffer_load_dwordx4 a[72:75], v12, s[12:15], s46 offen nt
    v_mfma_f32_16x16x32_bf16 v[56:59], a[20:23], v[32:35], v[56:59]
    s_add_u32 s46, s47, 0x98000
    buffer_load_dwordx4 a[76:79], v12, s[12:15], s46 offen nt
    v_mfma_f32_16x16x32_bf16 v[72:75], a[16:19], v[36:39], v[72:75]
    s_waitcnt vmcnt(18)
    ds_write_b128 v13, a[32:35] offset:0
    v_mfma_f32_16x16x32_bf16 v[80:83], a[20:23], v[36:39], v[80:83]
    ds_write_b128 v13, a[36:39] offset:1024
    v_mfma_f32_16x16x32_bf16 v[76:79], a[16:19], v[40:43], v[76:79]
    v_mfma_f32_16x16x32_bf16 v[84:87], a[20:23], v[40:43], v[84:87]
    s_waitcnt lgkmcnt(0)
    s_barrier
    ds_read_b64_tr_b16 a[32:33], v14 offset:0
    ds_read_b64_tr_b16 a[34:35], v14 offset:1024
    ds_read_b64_tr_b16 a[36:37], v15 offset:0
    ds_read_b64_tr_b16 a[38:39], v15 offset:1024
    ds_read_b128 v[28:31], v2 offset:64
    ds_read_b128 v[32:35], v2 offset:33088
    ds_read_b128 v[36:39], v16 offset:64
    ds_read_b128 v[40:43], v16 offset:33088
    v_mfma_f32_16x16x32_bf16 v[44:47], a[24:27], v[88:91], v[44:47]
    s_add_u32 m0, s39, 8256
    s_add_u32 s45, s38, 8192
    buffer_load_dwordx4 v1, s[16:19], s45 offen offset:1024 lds
    v_mfma_f32_16x16x32_bf16 v[52:55], a[28:31], v[88:91], v[52:55]
    s_add_u32 m0, s39, 74304
    s_add_u32 s45, s38, 73728
    buffer_load_dwordx4 v1, s[16:19], s45 offen offset:1024 lds
    v_mfma_f32_16x16x32_bf16 v[48:51], a[24:27], v[92:95], v[48:51]
    s_add_u32 s46, s47, 0xa0000
    buffer_load_dwordx4 a[80:83], v12, s[12:15], s46 offen nt
    v_mfma_f32_16x16x32_bf16 v[56:59], a[28:31], v[92:95], v[56:59]
    s_add_u32 s46, s47, 0xa8000
    buffer_load_dwordx4 a[84:87], v12, s[12:15], s46 offen nt
    v_mfma_f32_16x16x32_bf16 v[72:75], a[24:27], v[96:99], v[72:75]
    s_waitcnt vmcnt(20)
    ds_write_b128 v13, a[40:43] offset:8192
    v_mfma_f32_16x16x32_bf16 v[80:83], a[28:31], v[96:99], v[80:83]
    ds_write_b128 v13, a[44:47] offset:9216
    v_mfma_f32_16x16x32_bf16 v[76:79], a[24:27], v[100:103], v[76:79]
    v_mfma_f32_16x16x32_bf16 v[84:87], a[28:31], v[100:103], v[84:87]
    s_waitcnt lgkmcnt(0)
    s_barrier
    ds_read_b64_tr_b16 a[40:41], v14 offset:8192
    ds_read_b64_tr_b16 a[42:43], v14 offset:9216
    ds_read_b64_tr_b16 a[44:45], v15 offset:8192
    ds_read_b64_tr_b16 a[46:47], v15 offset:9216
    ds_read_b128 v[88:91], v2 offset:80
    ds_read_b128 v[92:95], v2 offset:33104
    ds_read_b128 v[96:99], v16 offset:80
    ds_read_b128 v[100:103], v16 offset:33104
    v_mfma_f32_16x16x32_bf16 v[44:47], a[32:35], v[28:31], v[44:47]
    s_add_u32 m0, s39, 10320
    s_add_u32 s45, s38, 10240
    buffer_load_dwordx4 v1, s[16:19], s45 offen offset:1024 lds
    v_mfma_f32_16x16x32_bf16 v[52:55], a[36:39], v[28:31], v[52:55]
    s_add_u32 m0, s39, 76368
    s_add_u32 s45, s38, 75776
    buffer_load_dwordx4 v1, s[16:19], s45 offen offset:1024 lds
    v_mfma_f32_16x16x32_bf16 v[48:51], a[32:35], v[32:35], v[48:51]
    s_add_u32 s46, s47, 0xb0000
    buffer_load_dwordx4 a[88:91], v12, s[12:15], s46 offen nt
    v_mfma_f32_16x16x32_bf16 v[56:59], a[36:39], v[32:35], v[56:59]
    s_add_u32 s46, s47, 0xb8000
    buffer_load_dwordx4 a[92:95], v12, s[12:15], s46 offen nt
    v_mfma_f32_16x16x32_bf16 v[72:75], a[32:35], v[36:39], v[72:75]
    s_waitcnt vmcnt(20)
    ds_write_b128 v13, a[48:51] offset:0
    v_mfma_f32_16x16x32_bf16 v[80:83], a[36:39], v[36:39], v[80:83]
    ds_write_b128 v13, a[52:55] offset:1024
    v_mfma_f32_16x16x32_bf16 v[76:79], a[32:35], v[40:43], v[76:79]
    v_mfma_f32_16x16x32_bf16 v[84:87], a[36:39], v[40:43], v[84:87]
    s_waitcnt lgkmcnt(0)
    s_barrier
    ds_read_b64_tr_b16 a[48:49], v14 offset:0
    ds_read_b64_tr_b16 a[50:51], v14 offset:1024
    ds_read_b64_tr_b16 a[52:53], v15 offset:0
    ds_read_b64_tr_b16 a[54:55], v15 offset:1024
    ds_read_b128 v[28:31], v2 offset:96
    ds_read_b128 v[32:35], v2 offset:33120
    ds_read_b128 v[36:39], v16 offset:96
    ds_read_b128 v[40:43], v16 offset:33120
    v_mfma_f32_16x16x32_bf16 v[44:47], a[40:43], v[88:91], v[44:47]
    s_add_u32 m0, s39, 12384
    s_add_u32 s45, s38, 12288
    buffer_load_dwordx4 v1, s[16:19], s45 offen offset:1024 lds
    v_mfma_f32_16x16x32_bf16 v[52:55], a[44:47], v[88:91], v[52:55]
    s_add_u32 m0, s39, 78432
    s_add_u32 s45, s38, 77824
    buffer_load_dwordx4 v1, s[16:19], s45 offen offset:1024 lds
    v_mfma_f32_16x16x32_bf16 v[48:51], a[40:43], v[92:95], v[48:51]
    s_add_u32 s46, s47, 0xc0000
    buffer_load_dwordx4 a[96:99], v12, s[12:15], s46 offen nt
    v_mfma_f32_16x16x32_bf16 v[56:59], a[44:47], v[92:95], v[56:59]
    s_add_u32 s46, s47, 0xc8000
    buffer_load_dwordx4 a[100:103], v12, s[12:15], s46 offen nt
    v_mfma_f32_16x16x32_bf16 v[72:75], a[40:43], v[96:99], v[72:75]
    s_waitcnt vmcnt(20)
    ds_write_b128 v13, a[56:59] offset:8192
    v_mfma_f32_16x16x32_bf16 v[80:83], a[44:47], v[96:99], v[80:83]
    ds_write_b128 v13, a[60:63] offset:9216
    v_mfma_f32_16x16x32_bf16 v[76:79], a[40:43], v[100:103], v[76:79]
    v_mfma_f32_16x16x32_bf16 v[84:87], a[44:47], v[100:103], v[84:87]
    s_waitcnt lgkmcnt(0)
    s_barrier
    ds_read_b64_tr_b16 a[56:57], v14 offset:8192
    ds_read_b64_tr_b16 a[58:59], v14 offset:9216
    ds_read_b64_tr_b16 a[60:61], v15 offset:8192
    ds_read_b64_tr_b16 a[62:63], v15 offset:9216
    ds_read_b128 v[88:91], v2 offset:112
    ds_read_b128 v[92:95], v2 offset:33136
    ds_read_b128 v[96:99], v16 offset:112
    ds_read_b128 v[100:103], v16 offset:33136
    v_mfma_f32_16x16x32_bf16 v[44:47], a[48:51], v[28:31], v[44:47]
    s_add_u32 m0, s39, 14448
    s_add_u32 s45, s38, 14336
    buffer_load_dwordx4 v1, s[16:19], s45 offen offset:1024 lds
    v_mfma_f32_16x16x32_bf16 v[52:55], a[52:55], v[28:31], v[52:55]
    s_add_u32 s46, s47, 0xd0000
    buffer_load_dwordx4 a[104:107], v12, s[12:15], s46 offen nt
    v_mfma_f32_16x16x32_bf16 v[48:51], a[48:51], v[32:35], v[48:51]
    s_add_u32 s46, s47, 0xd8000
    buffer_load_dwordx4 a[108:111], v12, s[12:15], s46 offen nt
    v_mfma_f32_16x16x32_bf16 v[56:59], a[52:55], v[32:35], v[56:59]
    s_waitcnt vmcnt(19)
    ds_write_b128 v13, a[64:67] offset:0
    v_mfma_f32_16x16x32_bf16 v[72:75], a[48:51], v[36:39], v[72:75]
    ds_write_b128 v13, a[68:71] offset:1024
    v_mfma_f32_16x16x32_bf16 v[80:83], a[52:55], v[36:39], v[80:83]
    v_mfma_f32_16x16x32_bf16 v[76:79], a[48:51], v[40:43], v[76:79]
    v_mfma_f32_16x16x32_bf16 v[84:87], a[52:55], v[40:43], v[84:87]
    s_waitcnt lgkmcnt(0)
    s_barrier
    ds_read_b64_tr_b16 a[64:65], v14 offset:0
    ds_read_b64_tr_b16 a[66:67], v14 offset:1024
    ds_read_b64_tr_b16 a[68:69], v15 offset:0
    ds_read_b64_tr_b16 a[70:71], v15 offset:1024
    ds_read_b128 v[28:31], v2 offset:128
    ds_read_b128 v[32:35], v2 offset:33152
    ds_read_b128 v[36:39], v16 offset:128
    ds_read_b128 v[40:43], v16 offset:33152
    v_mfma_f32_16x16x32_bf16 v[44:47], a[56:59], v[88:91], v[44:47]
    s_add_u32 m0, s39, 80496
    s_add_u32 s45, s38, 79872
    buffer_load_dwordx4 v1, s[16:19], s45 offen offset:1024 lds
    v_mfma_f32_16x16x32_bf16 v[52:55], a[60:63], v[88:91], v[52:55]
    s_add_u32 s46, s47, 0xe0000
    buffer_load_dwordx4 a[112:115], v12, s[12:15], s46 offen nt
    v_mfma_f32_16x16x32_bf16 v[48:51], a[56:59], v[92:95], v[48:51]
    s_add_u32 s46, s47, 0xe8000
    buffer_load_dwordx4 a[116:119], v12, s[12:15], s46 offen nt
    v_mfma_f32_16x16x32_bf16 v[56:59], a[60:63], v[92:95], v[56:59]
    s_waitcnt vmcnt(18)
    ds_write_b128 v13, a[72:75] offset:8192
    v_mfma_f32_16x16x32_bf16 v[72:75], a[56:59], v[96:99], v[72:75]
    ds_write_b128 v13, a[76:79] offset:9216
    v_mfma_f32_16x16x32_bf16 v[80:83], a[60:63], v[96:99], v[80:83]
    v_mfma_f32_16x16x32_bf16 v[76:79], a[56:59], v[100:103], v[76:79]
    v_mfma_f32_16x16x32_bf16 v[84:87], a[60:63], v[100:103], v[84:87]
    s_waitcnt lgkmcnt(0)
    s_barrier
    ds_read_b64_tr_b16 a[72:73], v14 offset:8192
    ds_read_b64_tr_b16 a[74:75], v14 offset:9216
    ds_read_b64_tr_b16 a[76:77], v15 offset:8192
    ds_read_b64_tr_b16 a[78:79], v15 offset:9216
    ds_read_b128 v[88:91], v2 offset:144
    ds_read_b128 v[92:95], v2 offset:33168
    ds_read_b128 v[96:99], v16 offset:144
    ds_read_b128 v[100:103], v16 offset:33168
    v_mfma_f32_16x16x32_bf16 v[44:47], a[64:67], v[28:31], v[44:47]
    s_add_u32 s46, s47, 0xf0000
    buffer_load_dwordx4 a[120:123], v12, s[12:15], s46 offen nt
    v_mfma_f32_16x16x32_bf16 v[52:55], a[68:71], v[28:31], v[52:55]
    s_add_u32 s46, s47, 0xf8000
    buffer_load_dwordx4 a[124:127], v12, s[12:15], s46 offen nt
    v_mfma_f32_16x16x32_bf16 v[48:51], a[64:67], v[32:35], v[48:51]
    s_waitcnt vmcnt(16)
    ds_write_b128 v13, a[80:83] offset:0
    v_mfma_f32_16x16x32_bf16 v[56:59], a[68:71], v[32:35], v[56:59]
    ds_write_b128 v13, a[84:87] offset:1024
    v_mfma_f32_16x16x32_bf16 v[72:75], a[64:67], v[36:39], v[72:75]
    v_mfma_f32_16x16x32_bf16 v[80:83], a[68:71], v[36:39], v[80:83]
    v_mfma_f32_16x16x32_bf16 v[76:79], a[64:67], v[40:43], v[76:79]
    v_mfma_f32_16x16x32_bf16 v[84:87], a[68:71], v[40:43], v[84:87]
    s_waitcnt lgkmcnt(0)
    s_barrier
    ds_read_b64_tr_b16 a[80:81], v14 offset:0
    ds_read_b64_tr_b16 a[82:83], v14 offset:1024
    ds_read_b64_tr_b16 a[84:85], v15 offset:0
    ds_read_b64_tr_b16 a[86:87], v15 offset:1024
    ds_read_b128 v[28:31], v2 offset:160
    ds_read_b128 v[32:35], v2 offset:33184
    ds_read_b128 v[36:39], v16 offset:160
    ds_read_b128 v[40:43], v16 offset:33184
    v_mfma_f32_16x16x32_bf16 v[44:47], a[72:75], v[88:91], v[44:47]
    s_add_u32 s46, s47, 0x400000
    buffer_load_dwordx4 a[128:131], v12, s[12:15], s46 offen nt
    v_mfma_f32_16x16x32_bf16 v[52:55], a[76:79], v[88:91], v[52:55]
    s_add_u32 s46, s47, 0x408000
    buffer_load_dwordx4 a[132:135], v12, s[12:15], s46 offen nt
    v_mfma_f32_16x16x32_bf16 v[48:51], a[72:75], v[92:95], v[48:51]
    s_waitcnt vmcnt(14)
    ds_write_b128 v13, a[88:91] offset:8192
    v_mfma_f32_16x16x32_bf16 v[56:59], a[76:79], v[92:95], v[56:59]
    ds_write_b128 v13, a[92:95] offset:9216
    v_mfma_f32_16x16x32_bf16 v[72:75], a[72:75], v[96:99], v[72:75]
    v_mfma_f32_16x16x32_bf16 v[80:83], a[76:79], v[96:99], v[80:83]
    v_mfma_f32_16x16x32_bf16 v[76:79], a[72:75], v[100:103], v[76:79]
    v_mfma_f32_16x16x32_bf16 v[84:87], a[76:79], v[100:103], v[84:87]
    s_waitcnt lgkmcnt(0)
    s_barrier
    ds_read_b64_tr_b16 a[88:89], v14 offset:8192
    ds_read_b64_tr_b16 a[90:91], v14 offset:9216
    ds_read_b64_tr_b16 a[92:93], v15 offset:8192
    ds_read_b64_tr_b16 a[94:95], v15 offset:9216
    ds_read_b128 v[88:91], v2 offset:176
    ds_read_b128 v[92:95], v2 offset:33200
    ds_read_b128 v[96:99], v16 offset:176
    ds_read_b128 v[100:103], v16 offset:33200
    v_mfma_f32_16x16x32_bf16 v[44:47], a[80:83], v[28:31], v[44:47]
    s_add_u32 s46, s47, 0x410000
    buffer_load_dwordx4 a[136:139], v12, s[12:15], s46 offen nt
    v_mfma_f32_16x16x32_bf16 v[52:55], a[84:87], v[28:31], v[52:55]
    s_add_u32 s46, s47, 0x418000
    buffer_load_dwordx4 a[140:143], v12, s[12:15], s46 offen nt
    v_mfma_f32_16x16x32_bf16 v[48:51], a[80:83], v[32:35], v[48:51]
    s_waitcnt vmcnt(12)
    ds_write_b128 v13, a[96:99] offset:0
    v_mfma_f32_16x16x32_bf16 v[56:59], a[84:87], v[32:35], v[56:59]
    ds_write_b128 v13, a[100:103] offset:1024
    v_mfma_f32_16x16x32_bf16 v[72:75], a[80:83], v[36:39], v[72:75]
    v_mfma_f32_16x16x32_bf16 v[80:83], a[84:87], v[36:39], v[80:83]
    v_mfma_f32_16x16x32_bf16 v[76:79], a[80:83], v[40:43], v[76:79]
    v_mfma_f32_16x16x32_bf16 v[84:87], a[84:87], v[40:43], v[84:87]
    s_waitcnt lgkmcnt(0)
    s_barrier
    ds_read_b64_tr_b16 a[96:97], v14 offset:0
    ds_read_b64_tr_b16 a[98:99], v14 offset:1024
    ds_read_b64_tr_b16 a[100:101], v15 offset:0
    ds_read_b64_tr_b16 a[102:103], v15 offset:1024
    ds_read_b128 v[28:31], v2 offset:192
    ds_read_b128 v[32:35], v2 offset:33216
    ds_read_b128 v[36:39], v16 offset:192
    ds_read_b128 v[40:43], v16 offset:33216
    v_mfma_f32_16x16x32_bf16 v[44:47], a[88:91], v[88:91], v[44:47]
    s_add_u32 s46, s47, 0x420000
    buffer_load_dwordx4 a[144:147], v12, s[12:15], s46 offen nt
    v_mfma_f32_16x16x32_bf16 v[52:55], a[92:95], v[88:91], v[52:55]
    s_add_u32 s46, s47, 0x428000
    buffer_load_dwordx4 a[148:151], v12, s[12:15], s46 offen nt
    v_mfma_f32_16x16x32_bf16 v[48:51], a[88:91], v[92:95], v[48:51]
    s_waitcnt vmcnt(11)
    ds_write_b128 v13, a[104:107] offset:8192
    v_mfma_f32_16x16x32_bf16 v[56:59], a[92:95], v[92:95], v[56:59]
    ds_write_b128 v13, a[108:111] offset:9216
    v_mfma_f32_16x16x32_bf16 v[72:75], a[88:91], v[96:99], v[72:75]
    v_mfma_f32_16x16x32_bf16 v[80:83], a[92:95], v[96:99], v[80:83]
    v_mfma_f32_16x16x32_bf16 v[76:79], a[88:91], v[100:103], v[76:79]
    v_mfma_f32_16x16x32_bf16 v[84:87], a[92:95], v[100:103], v[84:87]
    s_waitcnt lgkmcnt(0)
    s_barrier
    ds_read_b64_tr_b16 a[104:105], v14 offset:8192
    ds_read_b64_tr_b16 a[106:107], v14 offset:9216
    ds_read_b64_tr_b16 a[108:109], v15 offset:8192
    ds_read_b64_tr_b16 a[110:111], v15 offset:9216
    ds_read_b128 v[88:91], v2 offset:208
    ds_read_b128 v[92:95], v2 offset:33232
    ds_read_b128 v[96:99], v16 offset:208
    ds_read_b128 v[100:103], v16 offset:33232
    v_mfma_f32_16x16x32_bf16 v[44:47], a[96:99], v[28:31], v[44:47]
    s_add_u32 s46, s47, 0x430000
    buffer_load_dwordx4 a[152:155], v12, s[12:15], s46 offen nt
    v_mfma_f32_16x16x32_bf16 v[52:55], a[100:103], v[28:31], v[52:55]
    s_add_u32 s46, s47, 0x438000
    buffer_load_dwordx4 a[156:159], v12, s[12:15], s46 offen nt
    v_mfma_f32_16x16x32_bf16 v[48:51], a[96:99], v[32:35], v[48:51]
    s_waitcnt vmcnt(10)
    ds_write_b128 v13, a[112:115] offset:0
    v_mfma_f32_16x16x32_bf16 v[56:59], a[100:103], v[32:35], v[56:59]
    ds_write_b128 v13, a[116:119] offset:1024
    v_mfma_f32_16x16x32_bf16 v[72:75], a[96:99], v[36:39], v[72:75]
    v_mfma_f32_16x16x32_bf16 v[80:83], a[100:103], v[36:39], v[80:83]
    v_mfma_f32_16x16x32_bf16 v[76:79], a[96:99], v[40:43], v[76:79]
    v_mfma_f32_16x16x32_bf16 v[84:87], a[100:103], v[40:43], v[84:87]
    s_waitcnt lgkmcnt(0)
    s_barrier
    ds_read_b64_tr_b16 a[112:113], v14 offset:0
    ds_read_b64_tr_b16 a[114:115], v14 offset:1024
    ds_read_b64_tr_b16 a[116:117], v15 offset:0
    ds_read_b64_tr_b16 a[118:119], v15 offset:1024
    ds_read_b128 v[28:31], v2 offset:224
    ds_read_b128 v[32:35], v2 offset:33248
    ds_read_b128 v[36:39], v16 offset:224
    ds_read_b128 v[40:43], v16 offset:33248
    v_mfma_f32_16x16x32_bf16 v[44:47], a[104:107], v[88:91], v[44:47]
    s_waitcnt vmcnt(8)
    ds_write_b128 v13, a[120:123] offset:8192
    v_mfma_f32_16x16x32_bf16 v[52:55], a[108:111], v[88:91], v[52:55]
    ds_write_b128 v13, a[124:127] offset:9216
    v_mfma_f32_16x16x32_bf16 v[48:51], a[104:107], v[92:95], v[48:51]
    s_add_u32 s46, s47, 0x440000
    buffer_load_dwordx4 a[160:163], v12, s[12:15], s46 offen nt
    v_mfma_f32_16x16x32_bf16 v[56:59], a[108:111], v[92:95], v[56:59]
    s_add_u32 s46, s47, 0x448000
    buffer_load_dwordx4 a[164:167], v12, s[12:15], s46 offen nt
    v_mfma_f32_16x16x32_bf16 v[72:75], a[104:107], v[96:99], v[72:75]
    v_mfma_f32_16x16x32_bf16 v[80:83], a[108:111], v[96:99], v[80:83]
    v_mfma_f32_16x16x32_bf16 v[76:79], a[104:107], v[100:103], v[76:79]
    v_mfma_f32_16x16x32_bf16 v[84:87], a[108:111], v[100:103], v[84:87]
    s_waitcnt lgkmcnt(0)
    s_barrier
    ds_read_b64_tr_b16 a[120:121], v14 offset:8192
    ds_read_b64_tr_b16 a[122:123], v14 offset:9216
    ds_read_b64_tr_b16 a[124:125], v15 offset:8192
    ds_read_b64_tr_b16 a[126:127], v15 offset:9216
    ds_read_b128 v[88:91], v2 offset:240
    ds_read_b128 v[92:95], v2 offset:33264
    ds_read_b128 v[96:99], v16 offset:240
    ds_read_b128 v[100:103], v16 offset:33264
    v_mfma_f32_16x16x32_bf16 v[44:47], a[112:115], v[28:31], v[44:47]
    s_waitcnt vmcnt(8)
    ds_write_b128 v13, a[128:131] offset:0
    v_mfma_f32_16x16x32_bf16 v[52:55], a[116:119], v[28:31], v[52:55]
    ds_write_b128 v13, a[132:135] offset:1024
    v_mfma_f32_16x16x32_bf16 v[48:51], a[112:115], v[32:35], v[48:51]
    s_add_u32 s46, s47, 0x450000
    buffer_load_dwordx4 a[168:171], v12, s[12:15], s46 offen nt
    v_mfma_f32_16x16x32_bf16 v[56:59], a[116:119], v[32:35], v[56:59]
    s_add_u32 s46, s47, 0x458000
    buffer_load_dwordx4 a[172:175], v12, s[12:15], s46 offen nt
    v_mfma_f32_16x16x32_bf16 v[72:75], a[112:115], v[36:39], v[72:75]
    v_mfma_f32_16x16x32_bf16 v[80:83], a[116:119], v[36:39], v[80:83]
    v_mfma_f32_16x16x32_bf16 v[76:79], a[112:115], v[40:43], v[76:79]
    v_mfma_f32_16x16x32_bf16 v[84:87], a[116:119], v[40:43], v[84:87]
    s_waitcnt lgkmcnt(0)
    s_barrier
    ds_read_b64_tr_b16 a[128:129], v14 offset:0
    ds_read_b64_tr_b16 a[130:131], v14 offset:1024
    ds_read_b64_tr_b16 a[132:133], v15 offset:0
    ds_read_b64_tr_b16 a[134:135], v15 offset:1024
    ds_read_b128 v[28:31], v2 offset:1024
    ds_read_b128 v[32:35], v2 offset:34048
    ds_read_b128 v[36:39], v16 offset:1024
    ds_read_b128 v[40:43], v16 offset:34048
    v_mfma_f32_16x16x32_bf16 v[44:47], a[120:123], v[88:91], v[44:47]
    s_waitcnt vmcnt(8)
    ds_write_b128 v13, a[136:139] offset:8192
    v_mfma_f32_16x16x32_bf16 v[52:55], a[124:127], v[88:91], v[52:55]
    ds_write_b128 v13, a[140:143] offset:9216
    v_mfma_f32_16x16x32_bf16 v[48:51], a[120:123], v[92:95], v[48:51]
    s_add_u32 s46, s47, 0x460000
    buffer_load_dwordx4 a[176:179], v12, s[12:15], s46 offen nt
    v_mfma_f32_16x16x32_bf16 v[56:59], a[124:127], v[92:95], v[56:59]
    s_add_u32 s46, s47, 0x468000
    buffer_load_dwordx4 a[180:183], v12, s[12:15], s46 offen nt
    v_mfma_f32_16x16x32_bf16 v[72:75], a[120:123], v[96:99], v[72:75]
    v_mfma_f32_16x16x32_bf16 v[80:83], a[124:127], v[96:99], v[80:83]
    v_mfma_f32_16x16x32_bf16 v[76:79], a[120:123], v[100:103], v[76:79]
    v_mfma_f32_16x16x32_bf16 v[84:87], a[124:127], v[100:103], v[84:87]
    s_waitcnt lgkmcnt(0)
    s_barrier
    ds_read_b64_tr_b16 a[136:137], v14 offset:8192
    ds_read_b64_tr_b16 a[138:139], v14 offset:9216
    ds_read_b64_tr_b16 a[140:141], v15 offset:8192
    ds_read_b64_tr_b16 a[142:143], v15 offset:9216
    ds_read_b128 v[88:91], v2 offset:1040
    ds_read_b128 v[92:95], v2 offset:34064
    ds_read_b128 v[96:99], v16 offset:1040
    ds_read_b128 v[100:103], v16 offset:34064
    v_mfma_f32_16x16x32_bf16 v[44:47], a[128:131], v[28:31], v[44:47]
    s_waitcnt vmcnt(8)
    ds_write_b128 v13, a[144:147] offset:0
    v_mfma_f32_16x16x32_bf16 v[52:55], a[132:135], v[28:31], v[52:55]
    ds_write_b128 v13, a[148:151] offset:1024
    v_mfma_f32_16x16x32_bf16 v[48:51], a[128:131], v[32:35], v[48:51]
    s_add_u32 s46, s47, 0x470000
    buffer_load_dwordx4 a[184:187], v12, s[12:15], s46 offen nt
    v_mfma_f32_16x16x32_bf16 v[56:59], a[132:135], v[32:35], v[56:59]
    s_add_u32 s46, s47, 0x478000
    buffer_load_dwordx4 a[188:191], v12, s[12:15], s46 offen nt
    v_mfma_f32_16x16x32_bf16 v[72:75], a[128:131], v[36:39], v[72:75]
    v_mfma_f32_16x16x32_bf16 v[80:83], a[132:135], v[36:39], v[80:83]
    v_mfma_f32_16x16x32_bf16 v[76:79], a[128:131], v[40:43], v[76:79]
    v_mfma_f32_16x16x32_bf16 v[84:87], a[132:135], v[40:43], v[84:87]
    s_waitcnt lgkmcnt(0)
    s_barrier
    ds_read_b64_tr_b16 a[144:145], v14 offset:0
    ds_read_b64_tr_b16 a[146:147], v14 offset:1024
    ds_read_b64_tr_b16 a[148:149], v15 offset:0
    ds_read_b64_tr_b16 a[150:151], v15 offset:1024
    ds_read_b128 v[28:31], v2 offset:1056
    ds_read_b128 v[32:35], v2 offset:34080
    ds_read_b128 v[36:39], v16 offset:1056
    ds_read_b128 v[40:43], v16 offset:34080
    v_mfma_f32_16x16x32_bf16 v[44:47], a[136:139], v[88:91], v[44:47]
    s_waitcnt vmcnt(8)
    ds_write_b128 v13, a[152:155] offset:8192
    v_mfma_f32_16x16x32_bf16 v[52:55], a[140:143], v[88:91], v[52:55]
    ds_write_b128 v13, a[156:159] offset:9216
    v_mfma_f32_16x16x32_bf16 v[48:51], a[136:139], v[92:95], v[48:51]
    s_add_u32 m0, s39, 0
    s_add_u32 s45, s38, 131072
    buffer_load_dwordx4 v1, s[16:19], s45 offen offset:0 lds
    v_mfma_f32_16x16x32_bf16 v[56:59], a[140:143], v[92:95], v[56:59]
    s_add_u32 s46, s47, 0x480000
    buffer_load_dwordx4 a[192:195], v12, s[12:15], s46 offen nt
    v_mfma_f32_16x16x32_bf16 v[72:75], a[136:139], v[96:99], v[72:75]
    s_add_u32 s46, s47, 0x488000
    buffer_load_dwordx4 a[196:199], v12, s[12:15], s46 offen nt
    v_mfma_f32_16x16x32_bf16 v[80:83], a[140:143], v[96:99], v[80:83]
    v_mfma_f32_16x16x32_bf16 v[76:79], a[136:139], v[100:103], v[76:79]
    v_mfma_f32_16x16x32_bf16 v[84:87], a[140:143], v[100:103], v[84:87]
    s_waitcnt lgkmcnt(0)
    s_barrier
    ds_read_b64_tr_b16 a[152:153], v14 offset:8192
    ds_read_b64_tr_b16 a[154:155], v14 offset:9216
    ds_read_b64_tr_b16 a[156:157], v15 offset:8192
    ds_read_b64_tr_b16 a[158:159], v15 offset:9216
    ds_read_b128 v[88:91], v2 offset:1072
    ds_read_b128 v[92:95], v2 offset:34096
    ds_read_b128 v[96:99], v16 offset:1072
    ds_read_b128 v[100:103], v16 offset:34096
    v_mfma_f32_16x16x32_bf16 v[44:47], a[144:147], v[28:31], v[44:47]
    s_waitcnt vmcnt(9)
    ds_write_b128 v13, a[160:163] offset:0
    v_mfma_f32_16x16x32_bf16 v[52:55], a[148:151], v[28:31], v[52:55]
    ds_write_b128 v13, a[164:167] offset:1024
    v_mfma_f32_16x16x32_bf16 v[48:51], a[144:147], v[32:35], v[48:51]
    s_add_u32 m0, s39, 2064
    s_add_u32 s45, s38, 133120
    buffer_load_dwordx4 v1, s[16:19], s45 offen offset:0 lds
    v_mfma_f32_16x16x32_bf16 v[56:59], a[148:151], v[32:35], v[56:59]
    s_add_u32 s46, s47, 0x490000
    buffer_load_dwordx4 a[200:203], v12, s[12:15], s46 offen nt
    v_mfma_f32_16x16x32_bf16 v[72:75], a[144:147], v[36:39], v[72:75]
    s_add_u32 s46, s47, 0x498000
    buffer_load_dwordx4 a[204:207], v12, s[12:15], s46 offen nt
    v_mfma_f32_16x16x32_bf16 v[80:83], a[148:151], v[36:39], v[80:83]
    v_mfma_f32_16x16x32_bf16 v[76:79], a[144:147], v[40:43], v[76:79]
    v_mfma_f32_16x16x32_bf16 v[84:87], a[148:151], v[40:43], v[84:87]
    s_waitcnt lgkmcnt(0)
    s_barrier
    ds_read_b64_tr_b16 a[160:161], v14 offset:0
    ds_read_b64_tr_b16 a[162:163], v14 offset:1024
    ds_read_b64_tr_b16 a[164:165], v15 offset:0
    ds_read_b64_tr_b16 a[166:167], v15 offset:1024
    ds_read_b128 v[28:31], v2 offset:1088
    ds_read_b128 v[32:35], v2 offset:34112
    ds_read_b128 v[36:39], v16 offset:1088
    ds_read_b128 v[40:43], v16 offset:34112
    v_mfma_f32_16x16x32_bf16 v[44:47], a[152:155], v[88:91], v[44:47]
    s_waitcnt vmcnt(10)
    ds_write_b128 v13, a[168:171] offset:8192
    v_mfma_f32_16x16x32_bf16 v[52:55], a[156:159], v[88:91], v[52:55]
    ds_write_b128 v13, a[172:175] offset:9216
    v_mfma_f32_16x16x32_bf16 v[48:51], a[152:155], v[92:95], v[48:51]
    s_add_u32 m0, s39, 4128
    s_add_u32 s45, s38, 135168
    buffer_load_dwordx4 v1, s[16:19], s45 offen offset:0 lds
    v_mfma_f32_16x16x32_bf16 v[56:59], a[156:159], v[92:95], v[56:59]
    s_add_u32 s46, s47, 0x4a0000
    buffer_load_dwordx4 a[208:211], v12, s[12:15], s46 offen nt
    v_mfma_f32_16x16x32_bf16 v[72:75], a[152:155], v[96:99], v[72:75]
    s_add_u32 s46, s47, 0x4a8000
    buffer_load_dwordx4 a[212:215], v12, s[12:15], s46 offen nt
    v_mfma_f32_16x16x32_bf16 v[80:83], a[156:159], v[96:99], v[80:83]
    v_mfma_f32_16x16x32_bf16 v[76:79], a[152:155], v[100:103], v[76:79]
    v_mfma_f32_16x16x32_bf16 v[84:87], a[156:159], v[100:103], v[84:87]
    s_waitcnt lgkmcnt(0)
    s_barrier
    ds_read_b64_tr_b16 a[168:169], v14 offset:8192
    ds_read_b64_tr_b16 a[170:171], v14 offset:9216
    ds_read_b64_tr_b16 a[172:173], v15 offset:8192
    ds_read_b64_tr_b16 a[174:175], v15 offset:9216
    ds_read_b128 v[88:91], v2 offset:1104
    ds_read_b128 v[92:95], v2 offset:34128
    ds_read_b128 v[96:99], v16 offset:1104
    ds_read_b128 v[100:103], v16 offset:34128
    v_mfma_f32_16x16x32_bf16 v[44:47], a[160:163], v[28:31], v[44:47]
    s_waitcnt vmcnt(11)
    ds_write_b128 v13, a[176:179] offset:0
    v_mfma_f32_16x16x32_bf16 v[52:55], a[164:167], v[28:31], v[52:55]
    ds_write_b128 v13, a[180:183] offset:1024
    v_mfma_f32_16x16x32_bf16 v[48:51], a[160:163], v[32:35], v[48:51]
    s_add_u32 m0, s39, 6192
    s_add_u32 s45, s38, 137216
    buffer_load_dwordx4 v1, s[16:19], s45 offen offset:0 lds
    v_mfma_f32_16x16x32_bf16 v[56:59], a[164:167], v[32:35], v[56:59]
    s_add_u32 s46, s47, 0x4b0000
    buffer_load_dwordx4 a[216:219], v12, s[12:15], s46 offen nt
    v_mfma_f32_16x16x32_bf16 v[72:75], a[160:163], v[36:39], v[72:75]
    s_add_u32 s46, s47, 0x4b8000
    buffer_load_dwordx4 a[220:223], v12, s[12:15], s46 offen nt
    v_mfma_f32_16x16x32_bf16 v[80:83], a[164:167], v[36:39], v[80:83]
    v_mfma_f32_16x16x32_bf16 v[76:79], a[160:163], v[40:43], v[76:79]
    v_mfma_f32_16x16x32_bf16 v[84:87], a[164:167], v[40:43], v[84:87]
    s_waitcnt lgkmcnt(0)
    s_barrier
    ds_read_b64_tr_b16 a[176:177], v14 offset:0
    ds_read_b64_tr_b16 a[178:179], v14 offset:1024
    ds_read_b64_tr_b16 a[180:181], v15 offset:0
    ds_read_b64_tr_b16 a[182:183], v15 offset:1024
    ds_read_b128 v[28:31], v2 offset:1120
    ds_read_b128 v[32:35], v2 offset:34144
    ds_read_b128 v[36:39], v16 offset:1120
    ds_read_b128 v[40:43], v16 offset:34144
    v_mfma_f32_16x16x32_bf16 v[44:47], a[168:171], v[88:91], v[44:47]
    s_waitcnt vmcnt(12)
    ds_write_b128 v13, a[184:187] offset:8192
    v_mfma_f32_16x16x32_bf16 v[52:55], a[172:175], v[88:91], v[52:55]
    ds_write_b128 v13, a[188:191] offset:9216
    v_mfma_f32_16x16x32_bf16 v[48:51], a[168:171], v[92:95], v[48:51]
    s_add_u32 m0, s39, 8256
    s_add_u32 s45, s38, 139264
    buffer_load_dwordx4 v1, s[16:19], s45 offen offset:0 lds
    v_mfma_f32_16x16x32_bf16 v[56:59], a[172:175], v[92:95], v[56:59]
    s_add_u32 s46, s47, 0x4c0000
    buffer_load_dwordx4 a[224:227], v12, s[12:15], s46 offen nt
    v_mfma_f32_16x16x32_bf16 v[72:75], a[168:171], v[96:99], v[72:75]
    s_add_u32 s46, s47, 0x4c8000
    buffer_load_dwordx4 a[228:231], v12, s[12:15], s46 offen nt
    v_mfma_f32_16x16x32_bf16 v[80:83], a[172:175], v[96:99], v[80:83]
    v_mfma_f32_16x16x32_bf16 v[76:79], a[168:171], v[100:103], v[76:79]
    v_mfma_f32_16x16x32_bf16 v[84:87], a[172:175], v[100:103], v[84:87]
    s_waitcnt lgkmcnt(0)
    s_barrier
    ds_read_b64_tr_b16 a[184:185], v14 offset:8192
    ds_read_b64_tr_b16 a[186:187], v14 offset:9216
    ds_read_b64_tr_b16 a[188:189], v15 offset:8192
    ds_read_b64_tr_b16 a[190:191], v15 offset:9216
    ds_read_b128 v[88:91], v2 offset:1136
    ds_read_b128 v[92:95], v2 offset:34160
    ds_read_b128 v[96:99], v16 offset:1136
    ds_read_b128 v[100:103], v16 offset:34160
    v_mfma_f32_16x16x32_bf16 v[44:47], a[176:179], v[28:31], v[44:47]
    s_waitcnt vmcnt(12)
    ds_write_b128 v13, a[192:195] offset:0
    v_mfma_f32_16x16x32_bf16 v[52:55], a[180:183], v[28:31], v[52:55]
    ds_write_b128 v13, a[196:199] offset:1024
    v_mfma_f32_16x16x32_bf16 v[48:51], a[176:179], v[32:35], v[48:51]
    s_add_u32 m0, s39, 10320
    s_add_u32 s45, s38, 141312
    buffer_load_dwordx4 v1, s[16:19], s45 offen offset:0 lds
    v_mfma_f32_16x16x32_bf16 v[56:59], a[180:183], v[32:35], v[56:59]
    s_add_u32 s46, s47, 0x4d0000
    buffer_load_dwordx4 a[232:235], v12, s[12:15], s46 offen nt
    v_mfma_f32_16x16x32_bf16 v[72:75], a[176:179], v[36:39], v[72:75]
    s_add_u32 s46, s47, 0x4d8000
    buffer_load_dwordx4 a[236:239], v12, s[12:15], s46 offen nt
    v_mfma_f32_16x16x32_bf16 v[80:83], a[180:183], v[36:39], v[80:83]
    v_lshlrev_b32 v7, 5, v0
    v_min_u32 v7, 0xe4, v7
    v_cmp_eq_u32 vcc, 9, v0
    s_nop 1
    v_cndmask_b32 v6, 0, 4, vcc
    v_add_u32 v7, v7, v6
    buffer_load_dword v6, v7, s[8:11], 0 offen sc1
    v_mfma_f32_16x16x32_bf16 v[76:79], a[176:179], v[40:43], v[76:79]
    v_mfma_f32_16x16x32_bf16 v[84:87], a[180:183], v[40:43], v[84:87]
    s_waitcnt lgkmcnt(0)
    s_barrier
    ds_read_b64_tr_b16 a[192:193], v14 offset:0
    ds_read_b64_tr_b16 a[194:195], v14 offset:1024
    ds_read_b64_tr_b16 a[196:197], v15 offset:0
    ds_read_b64_tr_b16 a[198:199], v15 offset:1024
    ds_read_b128 v[28:31], v2 offset:1152
    ds_read_b128 v[32:35], v2 offset:34176
    ds_read_b128 v[36:39], v16 offset:1152
    ds_read_b128 v[40:43], v16 offset:34176
    v_mfma_f32_16x16x32_bf16 v[44:47], a[184:187], v[88:91], v[44:47]
    s_waitcnt vmcnt(13)
    ds_write_b128 v13, a[200:203] offset:8192
    v_mfma_f32_16x16x32_bf16 v[52:55], a[188:191], v[88:91], v[52:55]
    ds_write_b128 v13, a[204:207] offset:9216
    v_mfma_f32_16x16x32_bf16 v[48:51], a[184:187], v[92:95], v[48:51]
    s_add_u32 m0, s39, 12384
    s_add_u32 s45, s38, 143360
    buffer_load_dwordx4 v1, s[16:19], s45 offen offset:0 lds
    v_mfma_f32_16x16x32_bf16 v[56:59], a[188:191], v[92:95], v[56:59]
    s_add_u32 s46, s47, 0x4e0000
    buffer_load_dwordx4 a[240:243], v12, s[12:15], s46 offen nt
    v_mfma_f32_16x16x32_bf16 v[72:75], a[184:187], v[96:99], v[72:75]
    s_add_u32 s46, s47, 0x4e8000
    buffer_load_dwordx4 a[244:247], v12, s[12:15], s46 offen nt
    v_mfma_f32_16x16x32_bf16 v[80:83], a[188:191], v[96:99], v[80:83]
    v_mfma_f32_16x16x32_bf16 v[76:79], a[184:187], v[100:103], v[76:79]
    v_mfma_f32_16x16x32_bf16 v[84:87], a[188:191], v[100:103], v[84:87]
    s_waitcnt lgkmcnt(0)
    s_barrier
    ds_read_b64_tr_b16 a[200:201], v14 offset:8192
    ds_read_b64_tr_b16 a[202:203], v14 offset:9216
    ds_read_b64_tr_b16 a[204:205], v15 offset:8192
    ds_read_b64_tr_b16 a[206:207], v15 offset:9216
    ds_read_b128 v[88:91], v2 offset:1168
    ds_read_b128 v[92:95], v2 offset:34192
    ds_read_b128 v[96:99], v16 offset:1168
    ds_read_b128 v[100:103], v16 offset:34192
    v_mfma_f32_16x16x32_bf16 v[44:47], a[192:195], v[28:31], v[44:47]
    s_waitcnt vmcnt(13)
    ds_write_b128 v13, a[208:211] offset:0
    v_mfma_f32_16x16x32_bf16 v[52:55], a[196:199], v[28:31], v[52:55]
    ds_write_b128 v13, a[212:215] offset:1024
    v_mfma_f32_16x16x32_bf16 v[48:51], a[192:195], v[32:35], v[48:51]
    s_add_u32 m0, s39, 14448
    s_add_u32 s45, s38, 145408
    buffer_load_dwordx4 v1, s[16:19], s45 offen offset:0 lds
    v_mfma_f32_16x16x32_bf16 v[56:59], a[196:199], v[32:35], v[56:59]
    s_add_u32 s46, s47, 0x4f0000
    buffer_load_dwordx4 a[248:251], v12, s[12:15], s46 offen nt
    v_mfma_f32_16x16x32_bf16 v[72:75], a[192:195], v[36:39], v[72:75]
    s_add_u32 s46, s47, 0x4f8000
    buffer_load_dwordx4 a[252:255], v12, s[12:15], s46 offen nt
    v_mfma_f32_16x16x32_bf16 v[80:83], a[196:199], v[36:39], v[80:83]
    v_mfma_f32_16x16x32_bf16 v[76:79], a[192:195], v[40:43], v[76:79]
    v_mfma_f32_16x16x32_bf16 v[84:87], a[196:199], v[40:43], v[84:87]
    s_waitcnt lgkmcnt(0)
    s_barrier
    ds_read_b64_tr_b16 a[208:209], v14 offset:0
    ds_read_b64_tr_b16 a[210:211], v14 offset:1024
    ds_read_b64_tr_b16 a[212:213], v15 offset:0
    ds_read_b64_tr_b16 a[214:215], v15 offset:1024
    ds_read_b128 v[28:31], v2 offset:1184
    ds_read_b128 v[32:35], v2 offset:34208
    ds_read_b128 v[36:39], v16 offset:1184
    ds_read_b128 v[40:43], v16 offset:34208
    v_mfma_f32_16x16x32_bf16 v[44:47], a[200:203], v[88:91], v[44:47]
    s_waitcnt vmcnt(13)
    ds_write_b128 v13, a[216:219] offset:8192
    v_mfma_f32_16x16x32_bf16 v[52:55], a[204:207], v[88:91], v[52:55]
    ds_write_b128 v13, a[220:223] offset:9216
    v_mfma_f32_16x16x32_bf16 v[48:51], a[200:203], v[92:95], v[48:51]
    v_mfma_f32_16x16x32_bf16 v[56:59], a[204:207], v[92:95], v[56:59]
    v_mfma_f32_16x16x32_bf16 v[72:75], a[200:203], v[96:99], v[72:75]
    v_mfma_f32_16x16x32_bf16 v[80:83], a[204:207], v[96:99], v[80:83]
    v_mfma_f32_16x16x32_bf16 v[76:79], a[200:203], v[100:103], v[76:79]
    v_mfma_f32_16x16x32_bf16 v[84:87], a[204:207], v[100:103], v[84:87]
    s_waitcnt lgkmcnt(0)
    s_barrier
    ds_read_b64_tr_b16 a[216:217], v14 offset:8192
    ds_read_b64_tr_b16 a[218:219], v14 offset:9216
    ds_read_b64_tr_b16 a[220:221], v15 offset:8192
    ds_read_b64_tr_b16 a[222:223], v15 offset:9216
    ds_read_b128 v[88:91], v2 offset:1200
    ds_read_b128 v[92:95], v2 offset:34224
    ds_read_b128 v[96:99], v16 offset:1200
    ds_read_b128 v[100:103], v16 offset:34224
    v_mfma_f32_16x16x32_bf16 v[44:47], a[208:211], v[28:31], v[44:47]
    s_waitcnt vmcnt(10)
    ds_write_b128 v13, a[224:227] offset:0
    v_mfma_f32_16x16x32_bf16 v[52:55], a[212:215], v[28:31], v[52:55]
    ds_write_b128 v13, a[228:231] offset:1024
    v_mfma_f32_16x16x32_bf16 v[48:51], a[208:211], v[32:35], v[48:51]
    v_mfma_f32_16x16x32_bf16 v[56:59], a[212:215], v[32:35], v[56:59]
    v_mfma_f32_16x16x32_bf16 v[72:75], a[208:211], v[36:39], v[72:75]
    v_mfma_f32_16x16x32_bf16 v[80:83], a[212:215], v[36:39], v[80:83]
    v_mfma_f32_16x16x32_bf16 v[76:79], a[208:211], v[40:43], v[76:79]
    v_mfma_f32_16x16x32_bf16 v[84:87], a[212:215], v[40:43], v[84:87]
    s_waitcnt lgkmcnt(0)
    s_barrier
    ds_read_b64_tr_b16 a[224:225], v14 offset:0
    ds_read_b64_tr_b16 a[226:227], v14 offset:1024
    ds_read_b64_tr_b16 a[228:229], v15 offset:0
    ds_read_b64_tr_b16 a[230:231], v15 offset:1024
    ds_read_b128 v[28:31], v2 offset:1216
    ds_read_b128 v[32:35], v2 offset:34240
    ds_read_b128 v[36:39], v16 offset:1216
    ds_read_b128 v[40:43], v16 offset:34240
    v_mfma_f32_16x16x32_bf16 v[44:47], a[216:219], v[88:91], v[44:47]
    s_waitcnt vmcnt(7)
    ds_write_b128 v13, a[232:235] offset:8192
    v_mfma_f32_16x16x32_bf16 v[52:55], a[220:223], v[88:91], v[52:55]
    ds_write_b128 v13, a[236:239] offset:9216
    v_mfma_f32_16x16x32_bf16 v[48:51], a[216:219], v[92:95], v[48:51]
    v_mfma_f32_16x16x32_bf16 v[56:59], a[220:223], v[92:95], v[56:59]
    v_mfma_f32_16x16x32_bf16 v[72:75], a[216:219], v[96:99], v[72:75]
    v_mfma_f32_16x16x32_bf16 v[80:83], a[220:223], v[96:99], v[80:83]
    v_mfma_f32_16x16x32_bf16 v[76:79], a[216:219], v[100:103], v[76:79]
    v_mfma_f32_16x16x32_bf16 v[84:87], a[220:223], v[100:103], v[84:87]
    s_waitcnt lgkmcnt(0)
    s_barrier
    ds_read_b64_tr_b16 a[232:233], v14 offset:8192
    ds_read_b64_tr_b16 a[234:235], v14 offset:9216
    ds_read_b64_tr_b16 a[236:237], v15 offset:8192
    ds_read_b64_tr_b16 a[238:239], v15 offset:9216
    ds_read_b128 v[88:91], v2 offset:1232
    ds_read_b128 v[92:95], v2 offset:34256
    ds_read_b128 v[96:99], v16 offset:1232
    ds_read_b128 v[100:103], v16 offset:34256
    v_mfma_f32_16x16x32_bf16 v[44:47], a[224:227], v[28:31], v[44:47]
    s_waitcnt vmcnt(3)
    ds_write_b128 v13, a[240:243] offset:0
    v_mfma_f32_16x16x32_bf16 v[52:55], a[228:231], v[28:31], v[52:55]
    ds_write_b128 v13, a[244:247] offset:1024
    v_mfma_f32_16x16x32_bf16 v[48:51], a[224:227], v[32:35], v[48:51]
    v_mfma_f32_16x16x32_bf16 v[56:59], a[228:231], v[32:35], v[56:59]
    v_mfma_f32_16x16x32_bf16 v[72:75], a[224:227], v[36:39], v[72:75]
    v_mfma_f32_16x16x32_bf16 v[80:83], a[228:231], v[36:39], v[80:83]
    v_mfma_f32_16x16x32_bf16 v[76:79], a[224:227], v[40:43], v[76:79]
    v_mfma_f32_16x16x32_bf16 v[84:87], a[228:231], v[40:43], v[84:87]
    s_branch L_wi_9
L_wi_7:
    v_lshlrev_b32 v7, 5, v0
    v_min_u32 v7, 0xe4, v7
    v_cmp_eq_u32 vcc, 9, v0
    s_nop 1
    v_cndmask_b32 v6, 0, 4, vcc
    v_add_u32 v7, v7, v6
    buffer_load_dword v6, v7, s[8:11], 0 offen sc1
    s_waitcnt vmcnt(0)
L_wi_9:
    v_bcnt_u32_b32 v7, v6, 0
    s_nop 0
    v_readlane_b32 s45, v7, 0
    v_readlane_b32 s46, v7, 1
    s_nop 0
    s_add_u32 s45, s45, s46
    v_readlane_b32 s46, v7, 2
    s_nop 0
    s_add_u32 s45, s45, s46
    v_readlane_b32 s46, v7, 3
    s_nop 0
    s_add_u32 s45, s45, s46
    v_readlane_b32 s46, v7, 4
    s_nop 0
    s_add_u32 s45, s45, s46
    v_readlane_b32 s46, v7, 5
    s_nop 0
    s_add_u32 s45, s45, s46
    v_readlane_b32 s46, v7, 6
    s_nop 0
    s_add_u32 s45, s45, s46
    v_readlane_b32 s46, v7, 7
    s_nop 0
    s_add_u32 s45, s45, s46
    v_readlane_b32 s46, v6, 9
    s_nop 0
    s_add_u32 s45, s45, s46
    v_readlane_b32 s62, v6, 8
    s_nop 0
    s_lshr_b32 s46, s62, 16
    s_add_u32 s45, s45, s46
    s_cmp_ge_u32 s45, 272
    s_cbranch_scc1 L_wiok_8
    s_sleep 8
    s_sub_u32 s35, s35, 1
    s_cbranch_scc0 L_wi_7
    s_endpgm
L_wiok_8:
    s_and_b32 s62, s62, 0xffff
    s_cmp_gt_u32 s62, 8
    s_cselect_b32 s62, 0x2000, 0
    s_lshr_b32 s45, s63, 5
    v_readlane_b32 s101, v7, s45
    s_lshr_b32 s45, s41, 8
    s_xor_b32 s45, s45, s62
    s_and_b32 s45, s45, 0x2000
    s_xor_b32 s41, s41, s45
    s_lshr_b32 s45, s42, 8
    s_xor_b32 s45, s45, s62
    s_and_b32 s45, s45, 0x2000
    s_xor_b32 s42, s42, s45
    s_lshr_b32 s45, s48, 8
    s_xor_b32 s45, s45, s62
    s_and_b32 s45, s45, 0x2000
    s_xor_b32 s48, s48, s45
    s_lshr_b32 s45, s43, 8
    s_xor_b32 s45, s45, s62
    s_and_b32 s45, s45, 0x2000
    s_xor_b32 s43, s43, s45
    s_waitcnt lgkmcnt(0)
    s_barrier
    ds_read_b64_tr_b16 a[240:241], v14 offset:0
    ds_read_b64_tr_b16 a[242:243], v14 offset:1024
    ds_read_b64_tr_b16 a[244:245], v15 offset:0
    ds_read_b64_tr_b16 a[246:247], v15 offset:1024
    ds_read_b128 v[28:31], v2 offset:1248
    ds_read_b128 v[32:35], v2 offset:34272
    ds_read_b128 v[36:39], v16 offset:1248
    ds_read_b128 v[40:43], v16 offset:34272
    v_mfma_f32_16x16x32_bf16 v[44:47], a[232:235], v[88:91], v[44:47]
    s_waitcnt vmcnt(0)
    ds_write_b128 v13, a[248:251] offset:8192
    v_mfma_f32_16x16x32_bf16 v[52:55], a[236:239], v[88:91], v[52:55]
    ds_write_b128 v13, a[252:255] offset:9216
    v_mfma_f32_16x16x32_bf16 v[48:51], a[232:235], v[92:95], v[48:51]
    v_mfma_f32_16x16x32_bf16 v[56:59], a[236:239], v[92:95], v[56:59]
    v_mfma_f32_16x16x32_bf16 v[72:75], a[232:235], v[96:99], v[72:75]
    v_mfma_f32_16x16x32_bf16 v[80:83], a[236:239], v[96:99], v[80:83]
    v_mfma_f32_16x16x32_bf16 v[76:79], a[232:235], v[100:103], v[76:79]
    v_mfma_f32_16x16x32_bf16 v[84:87], a[236:239], v[100:103], v[84:87]
    s_waitcnt lgkmcnt(0)
    s_barrier
    ds_read_b64_tr_b16 a[248:249], v14 offset:8192
    ds_read_b64_tr_b16 a[250:251], v14 offset:9216
    ds_read_b64_tr_b16 a[252:253], v15 offset:8192
    ds_read_b64_tr_b16 a[254:255], v15 offset:9216
    ds_read_b128 v[88:91], v2 offset:1264
    ds_read_b128 v[92:95], v2 offset:34288
    ds_read_b128 v[96:99], v16 offset:1264
    ds_read_b128 v[100:103], v16 offset:34288
    v_mfma_f32_16x16x32_bf16 v[44:47], a[240:243], v[28:31], v[44:47]
    v_mfma_f32_16x16x32_bf16 v[52:55], a[244:247], v[28:31], v[52:55]
    v_mfma_f32_16x16x32_bf16 v[48:51], a[240:243], v[32:35], v[48:51]
    v_mfma_f32_16x16x32_bf16 v[56:59], a[244:247], v[32:35], v[56:59]
    v_mfma_f32_16x16x32_bf16 v[72:75], a[240:243], v[36:39], v[72:75]
    v_mfma_f32_16x16x32_bf16 v[80:83], a[244:247], v[36:39], v[80:83]
    v_mfma_f32_16x16x32_bf16 v[76:79], a[240:243], v[40:43], v[76:79]
    v_mfma_f32_16x16x32_bf16 v[84:87], a[244:247], v[40:43], v[84:87]
    s_waitcnt lgkmcnt(0)
    v_mfma_f32_16x16x32_bf16 v[44:47], a[248:251], v[88:91], v[44:47]
    v_mfma_f32_16x16x32_bf16 v[52:55], a[252:255], v[88:91], v[52:55]
    v_mfma_f32_16x16x32_bf16 v[48:51], a[248:251], v[92:95], v[48:51]
    v_mfma_f32_16x16x32_bf16 v[56:59], a[252:255], v[92:95], v[56:59]
    v_mfma_f32_16x16x32_bf16 v[72:75], a[248:251], v[96:99], v[72:75]
    v_mfma_f32_16x16x32_bf16 v[80:83], a[252:255], v[96:99], v[80:83]
    v_mfma_f32_16x16x32_bf16 v[76:79], a[248:251], v[100:103], v[76:79]
    v_mfma_f32_16x16x32_bf16 v[84:87], a[252:255], v[100:103], v[84:87]
    s_add_u32 s38, s38, 0x20000
    s_mov_b32 s37, 0
    s_barrier
    s_add_u32 s44, s44, 0x20000
    v_cvt_pk_bf16_f32 v60, v44, v52
    v_cvt_pk_bf16_f32 v61, v45, v53
    v_cvt_pk_bf16_f32 v62, v46, v54
    v_cvt_pk_bf16_f32 v63, v47, v55
    v_cvt_pk_bf16_f32 v64, v48, v56
    v_cvt_pk_bf16_f32 v65, v49, v57
    v_cvt_pk_bf16_f32 v66, v50, v58
    v_cvt_pk_bf16_f32 v67, v51, v59
    s_add_u32 s46, s41, 4096
    buffer_store_dwordx4 v[60:63], v1, s[4:7], s41 offen offset:0 sc1
    buffer_store_dwordx4 v[64:67], v1, s[4:7], s46 offen offset:0 sc1
    s_add_u32 s41, s41, 0x4000
    buffer_store_dwordx4 v[104:107], v5, s[4:7], s43 offen sc1
    buffer_store_dwordx4 v[104:107], v1, s[4:7], s48 offen offset:0 sc1
    s_add_u32 s43, s43, 0x4000
    s_add_u32 s48, s48, 0x4000
    v_cvt_pk_bf16_f32 v60, v72, v80
    v_cvt_pk_bf16_f32 v61, v73, v81
    v_cvt_pk_bf16_f32 v62, v74, v82
    v_cvt_pk_bf16_f32 v63, v75, v83
    v_cvt_pk_bf16_f32 v64, v76, v84
    v_cvt_pk_bf16_f32 v65, v77, v85
    v_cvt_pk_bf16_f32 v66, v78, v86
    v_cvt_pk_bf16_f32 v67, v79, v87
    s_add_u32 s46, s41, 4096
    buffer_store_dwordx4 v[60:63], v1, s[4:7], s41 offen offset:0 sc1
    buffer_store_dwordx4 v[64:67], v1, s[4:7], s46 offen offset:0 sc1
    s_add_u32 s41, s41, 0x4000
    buffer_store_dwordx4 v[104:107], v5, s[4:7], s43 offen sc1
    buffer_store_dwordx4 v[104:107], v1, s[4:7], s48 offen offset:0 sc1
    s_add_u32 s43, s43, 0x4000
    s_add_u32 s48, s48, 0x4000
    v_mov_b32 v9, 1
    ds_read_b128 v[12:15], v2 offset:0
    ds_read_b128 v[16:19], v2 offset:33024
    ds_read_b128 v[20:23], v2 offset:16
    ds_read_b128 v[24:27], v2 offset:33040
    ds_read_b128 v[28:31], v2 offset:32
    ds_read_b128 v[32:35], v2 offset:33056
    s_waitcnt lgkmcnt(4)
    v_mfma_f32_16x16x32_bf16 v[44:47], a[0:3], v[12:15], 0
    ds_read_b128 v[36:39], v2 offset:48
    s_add_u32 m0, s39, 0
    s_add_u32 s45, s38, 0
    v_mfma_f32_16x16x32_bf16 v[52:55], a[4:7], v[12:15], 0
    buffer_load_dwordx4 v1, s[16:19], s45 offen offset:1024 lds
    v_mfma_f32_16x16x32_bf16 v[48:51], a[0:3], v[16:19], 0
    ds_read_b128 v[40:43], v2 offset:33072
    v_mfma_f32_16x16x32_bf16 v[56:59], a[4:7], v[16:19], 0
    s_waitcnt lgkmcnt(4)
    v_mfma_f32_16x16x32_bf16 v[44:47], a[8:11], v[20:23], v[44:47]
    ds_read_b128 v[12:15], v2 offset:64
    s_add_u32 m0, s39, 2064
    s_add_u32 s45, s38, 2048
    v_mfma_f32_16x16x32_bf16 v[52:55], a[12:15], v[20:23], v[52:55]
    buffer_load_dwordx4 v1, s[16:19], s45 offen offset:1024 lds
    v_mfma_f32_16x16x32_bf16 v[48:51], a[8:11], v[24:27], v[48:51]
    ds_read_b128 v[16:19], v2 offset:33088
    v_mfma_f32_16x16x32_bf16 v[56:59], a[12:15], v[24:27], v[56:59]
    s_waitcnt lgkmcnt(4)
    v_mfma_f32_16x16x32_bf16 v[44:47], a[16:19], v[28:31], v[44:47]
    ds_read_b128 v[20:23], v2 offset:80
    s_add_u32 m0, s39, 4128
    s_add_u32 s45, s38, 4096
    v_mfma_f32_16x16x32_bf16 v[52:55], a[20:23], v[28:31], v[52:55]
    buffer_load_dwordx4 v1, s[16:19], s45 offen offset:1024 lds
    v_mfma_f32_16x16x32_bf16 v[48:51], a[16:19], v[32:35], v[48:51]
    ds_read_b128 v[24:27], v2 offset:33104
    v_mfma_f32_16x16x32_bf16 v[56:59], a[20:23], v[32:35], v[56:59]
    s_waitcnt lgkmcnt(4)
    v_mfma_f32_16x16x32_bf16 v[44:47], a[24:27], v[36:39], v[44:47]
    ds_read_b128 v[28:31], v2 offset:96
    s_add_u32 m0, s39, 6192
    s_add_u32 s45, s38, 6144
    v_mfma_f32_16x16x32_bf16 v[52:55], a[28:31], v[36:39], v[52:55]
    buffer_load_dwordx4 v1, s[16:19], s45 offen offset:1024 lds
    v_mfma_f32_16x16x32_bf16 v[48:51], a[24:27], v[40:43], v[48:51]
    ds_read_b128 v[32:35], v2 offset:33120
    v_mfma_f32_16x16x32_bf16 v[56:59], a[28:31], v[40:43], v[56:59]
    s_waitcnt lgkmcnt(4)
    v_mfma_f32_16x16x32_bf16 v[44:47], a[32:35], v[12:15], v[44:47]
    ds_read_b128 v[36:39], v2 offset:112
    s_add_u32 m0, s39, 8256
    s_add_u32 s45, s38, 8192
    v_mfma_f32_16x16x32_bf16 v[52:55], a[36:39], v[12:15], v[52:55]
    buffer_load_dwordx4 v1, s[16:19], s45 offen offset:1024 lds
    v_mfma_f32_16x16x32_bf16 v[48:51], a[32:35], v[16:19], v[48:51]
    ds_read_b128 v[40:43], v2 offset:33136
    v_mfma_f32_16x16x32_bf16 v[56:59], a[36:39], v[16:19], v[56:59]
    s_waitcnt lgkmcnt(4)
    s_waitcnt vmcnt(11)
    s_barrier
    buffer_store_dword v9, v4, s[4:7], 0 offen sc1
    v_mfma_f32_16x16x32_bf16 v[44:47], a[40:43], v[20:23], v[44:47]
    ds_read_b128 v[12:15], v2 offset:128
    s_add_u32 m0, s39, 10320
    s_add_u32 s45, s38, 10240
    v_mfma_f32_16x16x32_bf16 v[52:55], a[44:47], v[20:23], v[52:55]
    buffer_load_dwordx4 v1, s[16:19], s45 offen offset:1024 lds
    v_mfma_f32_16x16x32_bf16 v[48:51], a[40:43], v[24:27], v[48:51]
    ds_read_b128 v[16:19], v2 offset:33152
    v_mfma_f32_16x16x32_bf16 v[56:59], a[44:47], v[24:27], v[56:59]
    s_waitcnt lgkmcnt(4)
    v_mfma_f32_16x16x32_bf16 v[44:47], a[48:51], v[28:31], v[44:47]
    ds_read_b128 v[20:23], v2 offset:144
    s_add_u32 m0, s39, 12384
    s_add_u32 s45, s38, 12288
    v_mfma_f32_16x16x32_bf16 v[52:55], a[52:55], v[28:31], v[52:55]
    buffer_load_dwordx4 v1, s[16:19], s45 offen offset:1024 lds
    v_mfma_f32_16x16x32_bf16 v[48:51], a[48:51], v[32:35], v[48:51]
    ds_read_b128 v[24:27], v2 offset:33168
    v_mfma_f32_16x16x32_bf16 v[56:59], a[52:55], v[32:35], v[56:59]
    s_waitcnt lgkmcnt(4)
    v_mfma_f32_16x16x32_bf16 v[44:47], a[56:59], v[36:39], v[44:47]
    ds_read_b128 v[28:31], v2 offset:160
    s_add_u32 m0, s39, 14448
    s_add_u32 s45, s38, 14336
    v_mfma_f32_16x16x32_bf16 v[52:55], a[60:63], v[36:39], v[52:55]
    buffer_load_dwordx4 v1, s[16:19], s45 offen offset:1024 lds
    v_mfma_f32_16x16x32_bf16 v[48:51], a[56:59], v[40:43], v[48:51]
    ds_read_b128 v[32:35], v2 offset:33184
    v_mfma_f32_16x16x32_bf16 v[56:59], a[60:63], v[40:43], v[56:59]
    s_waitcnt lgkmcnt(4)
    v_mfma_f32_16x16x32_bf16 v[44:47], a[64:67], v[12:15], v[44:47]
    ds_read_b128 v[36:39], v2 offset:176
    v_mfma_f32_16x16x32_bf16 v[52:55], a[68:71], v[12:15], v[52:55]
    s_sub_u32 s39, s40, s39
    s_add_u32 s38, s38, 0x10000
    v_mov_b32 v9, 2
    v_mfma_f32_16x16x32_bf16 v[48:51], a[64:67], v[16:19], v[48:51]
    ds_read_b128 v[40:43], v2 offset:33200
    v_mfma_f32_16x16x32_bf16 v[56:59], a[68:71], v[16:19], v[56:59]
    s_waitcnt lgkmcnt(4)
    v_mfma_f32_16x16x32_bf16 v[44:47], a[72:75], v[20:23], v[44:47]
    ds_read_b128 v[12:15], v2 offset:192
    v_mfma_f32_16x16x32_bf16 v[52:55], a[76:79], v[20:23], v[52:55]
    v_mfma_f32_16x16x32_bf16 v[48:51], a[72:75], v[24:27], v[48:51]
    ds_read_b128 v[16:19], v2 offset:33216
    v_mfma_f32_16x16x32_bf16 v[56:59], a[76:79], v[24:27], v[56:59]
    s_waitcnt lgkmcnt(4)
    v_mfma_f32_16x16x32_bf16 v[44:47], a[80:83], v[28:31], v[44:47]
    ds_read_b128 v[20:23], v2 offset:208
    v_mfma_f32_16x16x32_bf16 v[52:55], a[84:87], v[28:31], v[52:55]
    v_mfma_f32_16x16x32_bf16 v[48:51], a[80:83], v[32:35], v[48:51]
    ds_read_b128 v[24:27], v2 offset:33232
    v_mfma_f32_16x16x32_bf16 v[56:59], a[84:87], v[32:35], v[56:59]
    s_waitcnt lgkmcnt(4)
    v_mfma_f32_16x16x32_bf16 v[44:47], a[88:91], v[36:39], v[44:47]
    ds_read_b128 v[28:31], v2 offset:224
    v_mfma_f32_16x16x32_bf16 v[52:55], a[92:95], v[36:39], v[52:55]
    v_mfma_f32_16x16x32_bf16 v[48:51], a[88:91], v[40:43], v[48:51]
    ds_read_b128 v[32:35], v2 offset:33248
    v_mfma_f32_16x16x32_bf16 v[56:59], a[92:95], v[40:43], v[56:59]
    s_waitcnt lgkmcnt(4)
    v_mfma_f32_16x16x32_bf16 v[44:47], a[96:99], v[12:15], v[44:47]
    ds_read_b128 v[36:39], v2 offset:240
    v_mfma_f32_16x16x32_bf16 v[52:55], a[100:103], v[12:15], v[52:55]
    v_mfma_f32_16x16x32_bf16 v[48:51], a[96:99], v[16:19], v[48:51]
    ds_read_b128 v[40:43], v2 offset:33264
    v_mfma_f32_16x16x32_bf16 v[56:59], a[100:103], v[16:19], v[56:59]
    s_waitcnt lgkmcnt(4)
    s_waitcnt vmcnt(0)
    s_barrier
    buffer_store_dword v9, v4, s[4:7], 0 offen sc1
    v_mfma_f32_16x16x32_bf16 v[44:47], a[104:107], v[20:23], v[44:47]
    ds_read_b128 v[12:15], v2 offset:1024
    s_add_u32 m0, s39, 0
    s_add_u32 s45, s38, 0
    v_mfma_f32_16x16x32_bf16 v[52:55], a[108:111], v[20:23], v[52:55]
    buffer_load_dwordx4 v1, s[16:19], s45 offen lds
    v_mfma_f32_16x16x32_bf16 v[48:51], a[104:107], v[24:27], v[48:51]
    ds_read_b128 v[16:19], v2 offset:34048
    v_mfma_f32_16x16x32_bf16 v[56:59], a[108:111], v[24:27], v[56:59]
    s_waitcnt lgkmcnt(4)
    v_mfma_f32_16x16x32_bf16 v[44:47], a[112:115], v[28:31], v[44:47]
    ds_read_b128 v[20:23], v2 offset:1040
    v_mfma_f32_16x16x32_bf16 v[52:55], a[116:119], v[28:31], v[52:55]
    buffer_load_dwordx4 v1, s[16:19], s45 offen offset:1024 lds
    v_mfma_f32_16x16x32_bf16 v[48:51], a[112:115], v[32:35], v[48:51]
    ds_read_b128 v[24:27], v2 offset:34064
    v_mfma_f32_16x16x32_bf16 v[56:59], a[116:119], v[32:35], v[56:59]
    s_waitcnt lgkmcnt(4)
    v_mfma_f32_16x16x32_bf16 v[44:47], a[120:123], v[36:39], v[44:47]
    ds_read_b128 v[28:31], v2 offset:1056
    s_add_u32 m0, s39, 2064
    s_add_u32 s45, s38, 2048
    v_mfma_f32_16x16x32_bf16 v[52:55], a[124:127], v[36:39], v[52:55]
    buffer_load_dwordx4 v1, s[16:19], s45 offen lds
    v_mfma_f32_16x16x32_bf16 v[48:51], a[120:123], v[40:43], v[48:51]
    ds_read_b128 v[32:35], v2 offset:34080
    v_mfma_f32_16x16x32_bf16 v[56:59], a[124:127], v[40:43], v[56:59]
    s_waitcnt lgkmcnt(4)
    v_mfma_f32_16x16x32_bf16 v[44:47], a[128:131], v[12:15], v[44:47]
    ds_read_b128 v[36:39], v2 offset:1072
    v_mfma_f32_16x16x32_bf16 v[52:55], a[132:135], v[12:15], v[52:55]
    buffer_load_dwordx4 v1, s[16:19], s45 offen offset:1024 lds
    v_mfma_f32_16x16x32_bf16 v[48:51], a[128:131], v[16:19], v[48:51]
    ds_read_b128 v[40:43], v2 offset:34096
    v_mfma_f32_16x16x32_bf16 v[56:59], a[132:135], v[16:19], v[56:59]
    s_waitcnt lgkmcnt(4)
    v_mfma_f32_16x16x32_bf16 v[44:47], a[136:139], v[20:23], v[44:47]
    ds_read_b128 v[12:15], v2 offset:1088
    s_add_u32 m0, s39, 4128
    s_add_u32 s45, s38, 4096
    v_mfma_f32_16x16x32_bf16 v[52:55], a[140:143], v[20:23], v[52:55]
    buffer_load_dwordx4 v1, s[16:19], s45 offen lds
    v_mfma_f32_16x16x32_bf16 v[48:51], a[136:139], v[24:27], v[48:51]
    ds_read_b128 v[16:19], v2 offset:34112
    v_mfma_f32_16x16x32_bf16 v[56:59], a[140:143], v[24:27], v[56:59]
    s_waitcnt lgkmcnt(4)
    v_mfma_f32_16x16x32_bf16 v[44:47], a[144:147], v[28:31], v[44:47]
    ds_read_b128 v[20:23], v2 offset:1104
    v_mfma_f32_16x16x32_bf16 v[52:55], a[148:151], v[28:31], v[52:55]
    buffer_load_dwordx4 v1, s[16:19], s45 offen offset:1024 lds
    v_mfma_f32_16x16x32_bf16 v[48:51], a[144:147], v[32:35], v[48:51]
    ds_read_b128 v[24:27], v2 offset:34128
    v_mfma_f32_16x16x32_bf16 v[56:59], a[148:151], v[32:35], v[56:59]
    s_waitcnt lgkmcnt(4)
    v_mfma_f32_16x16x32_bf16 v[44:47], a[152:155], v[36:39], v[44:47]
    ds_read_b128 v[28:31], v2 offset:1120
    s_add_u32 m0, s39, 6192
    s_add_u32 s45, s38, 6144
    v_mfma_f32_16x16x32_bf16 v[52:55], a[156:159], v[36:39], v[52:55]
    buffer_load_dwordx4 v1, s[16:19], s45 offen lds
    v_mfma_f32_16x16x32_bf16 v[48:51], a[152:155], v[40:43], v[48:51]
    ds_read_b128 v[32:35], v2 offset:34144
    v_mfma_f32_16x16x32_bf16 v[56:59], a[156:159], v[40:43], v[56:59]
    s_waitcnt lgkmcnt(4)
    v_mfma_f32_16x16x32_bf16 v[44:47], a[160:163], v[12:15], v[44:47]
    ds_read_b128 v[36:39], v2 offset:1136
    v_mfma_f32_16x16x32_bf16 v[52:55], a[164:167], v[12:15], v[52:55]
    buffer_load_dwordx4 v1, s[16:19], s45 offen offset:1024 lds
    v_mfma_f32_16x16x32_bf16 v[48:51], a[160:163], v[16:19], v[48:51]
    ds_read_b128 v[40:43], v2 offset:34160
    v_mfma_f32_16x16x32_bf16 v[56:59], a[164:167], v[16:19], v[56:59]
    s_waitcnt lgkmcnt(4)
    v_mfma_f32_16x16x32_bf16 v[44:47], a[168:171], v[20:23], v[44:47]
    ds_read_b128 v[12:15], v2 offset:1152
    s_add_u32 m0, s39, 8256
    s_add_u32 s45, s38, 8192
    v_mfma_f32_16x16x32_bf16 v[52:55], a[172:175], v[20:23], v[52:55]
    buffer_load_dwordx4 v1, s[16:19], s45 offen lds
    v_mfma_f32_16x16x32_bf16 v[48:51], a[168:171], v[24:27], v[48:51]
    ds_read_b128 v[16:19], v2 offset:34176
    v_mfma_f32_16x16x32_bf16 v[56:59], a[172:175], v[24:27], v[56:59]
    s_waitcnt lgkmcnt(4)
    v_mfma_f32_16x16x32_bf16 v[44:47], a[176:179], v[28:31], v[44:47]
    ds_read_b128 v[20:23], v2 offset:1168
    v_mfma_f32_16x16x32_bf16 v[52:55], a[180:183], v[28:31], v[52:55]
    buffer_load_dwordx4 v1, s[16:19], s45 offen offset:1024 lds
    v_mfma_f32_16x16x32_bf16 v[48:51], a[176:179], v[32:35], v[48:51]
    ds_read_b128 v[24:27], v2 offset:34192
    v_mfma_f32_16x16x32_bf16 v[56:59], a[180:183], v[32:35], v[56:59]
    s_waitcnt lgkmcnt(4)
    v_mfma_f32_16x16x32_bf16 v[44:47], a[184:187], v[36:39], v[44:47]
    ds_read_b128 v[28:31], v2 offset:1184
    s_add_u32 m0, s39, 10320
    s_add_u32 s45, s38, 10240
    v_mfma_f32_16x16x32_bf16 v[52:55], a[188:191], v[36:39], v[52:55]
    buffer_load_dwordx4 v1, s[16:19], s45 offen lds
    v_mfma_f32_16x16x32_bf16 v[48:51], a[184:187], v[40:43], v[48:51]
    ds_read_b128 v[32:35], v2 offset:34208
    v_mfma_f32_16x16x32_bf16 v[56:59], a[188:191], v[40:43], v[56:59]
    s_waitcnt lgkmcnt(4)
    v_mfma_f32_16x16x32_bf16 v[44:47], a[192:195], v[12:15], v[44:47]
    ds_read_b128 v[36:39], v2 offset:1200
    v_mfma_f32_16x16x32_bf16 v[52:55], a[196:199], v[12:15], v[52:55]
    buffer_load_dwordx4 v1, s[16:19], s45 offen offset:1024 lds
    v_mfma_f32_16x16x32_bf16 v[48:51], a[192:195], v[16:19], v[48:51]
    ds_read_b128 v[40:43], v2 offset:34224
    v_mfma_f32_16x16x32_bf16 v[56:59], a[196:199], v[16:19], v[56:59]
    s_waitcnt lgkmcnt(4)
    v_mfma_f32_16x16x32_bf16 v[44:47], a[200:203], v[20:23], v[44:47]
    ds_read_b128 v[12:15], v2 offset:1216
    s_add_u32 m0, s39, 12384
    s_add_u32 s45, s38, 12288
    v_mfma_f32_16x16x32_bf16 v[52:55], a[204:207], v[20:23], v[52:55]
    buffer_load_dwordx4 v1, s[16:19], s45 offen lds
    v_mfma_f32_16x16x32_bf16 v[48:51], a[200:203], v[24:27], v[48:51]
    ds_read_b128 v[16:19], v2 offset:34240
    v_mfma_f32_16x16x32_bf16 v[56:59], a[204:207], v[24:27], v[56:59]
    s_waitcnt lgkmcnt(4)
    v_mfma_f32_16x16x32_bf16 v[44:47], a[208:211], v[28:31], v[44:47]
    ds_read_b128 v[20:23], v2 offset:1232
    v_mfma_f32_16x16x32_bf16 v[52:55], a[212:215], v[28:31], v[52:55]
    buffer_load_dwordx4 v1, s[16:19], s45 offen offset:1024 lds
    v_mfma_f32_16x16x32_bf16 v[48:51], a[208:211], v[32:35], v[48:51]
    ds_read_b128 v[24:27], v2 offset:34256
    v_mfma_f32_16x16x32_bf16 v[56:59], a[212:215], v[32:35], v[56:59]
    s_waitcnt lgkmcnt(4)
    v_mfma_f32_16x16x32_bf16 v[44:47], a[216:219], v[36:39], v[44:47]
    ds_read_b128 v[28:31], v2 offset:1248
    s_add_u32 m0, s39, 14448
    s_add_u32 s45, s38, 14336
    v_mfma_f32_16x16x32_bf16 v[52:55], a[220:223], v[36:39], v[52:55]
    buffer_load_dwordx4 v1, s[16:19], s45 offen lds
    v_mfma_f32_16x16x32_bf16 v[48:51], a[216:219], v[40:43], v[48:51]
    ds_read_b128 v[32:35], v2 offset:34272
    v_mfma_f32_16x16x32_bf16 v[56:59], a[220:223], v[40:43], v[56:59]
    s_waitcnt lgkmcnt(4)
    v_mfma_f32_16x16x32_bf16 v[44:47], a[224:227], v[12:15], v[44:47]
    ds_read_b128 v[36:39], v2 offset:1264
    v_mfma_f32_16x16x32_bf16 v[52:55], a[228:231], v[12:15], v[52:55]
    buffer_load_dwordx4 v1, s[16:19], s45 offen offset:1024 lds
    v_mfma_f32_16x16x32_bf16 v[48:51], a[224:227], v[16:19], v[48:51]
    ds_read_b128 v[40:43], v2 offset:34288
    s_sub_u32 s39, s40, s39
    s_add_u32 s38, s38, 0x10000
    v_mfma_f32_16x16x32_bf16 v[56:59], a[228:231], v[16:19], v[56:59]
    s_waitcnt lgkmcnt(4)
    v_mfma_f32_16x16x32_bf16 v[44:47], a[232:235], v[20:23], v[44:47]
    buffer_load_dwordx4 v[68:71], v1, s[16:19], s44 offen
    v_mfma_f32_16x16x32_bf16 v[52:55], a[236:239], v[20:23], v[52:55]
    s_add_u32 s44, s44, 0x10000
    v_mfma_f32_16x16x32_bf16 v[48:51], a[232:235], v[24:27], v[48:51]
    v_mfma_f32_16x16x32_bf16 v[56:59], a[236:239], v[24:27], v[56:59]
    s_waitcnt lgkmcnt(2)
    v_mfma_f32_16x16x32_bf16 v[44:47], a[240:243], v[28:31], v[44:47]
    v_mfma_f32_16x16x32_bf16 v[52:55], a[244:247], v[28:31], v[52:55]
    v_mfma_f32_16x16x32_bf16 v[48:51], a[240:243], v[32:35], v[48:51]
    v_mfma_f32_16x16x32_bf16 v[56:59], a[244:247], v[32:35], v[56:59]
    s_waitcnt lgkmcnt(0)
    v_mfma_f32_16x16x32_bf16 v[44:47], a[248:251], v[36:39], v[44:47]
    v_mfma_f32_16x16x32_bf16 v[52:55], a[252:255], v[36:39], v[52:55]
    v_mfma_f32_16x16x32_bf16 v[48:51], a[248:251], v[40:43], v[48:51]
    v_mfma_f32_16x16x32_bf16 v[56:59], a[252:255], v[40:43], v[56:59]
    v_sub_u32 v2, v3, v2
    v_cvt_pk_bf16_f32 v60, v44, v52
    v_cvt_pk_bf16_f32 v61, v45, v53
    v_cvt_pk_bf16_f32 v62, v46, v54
    v_cvt_pk_bf16_f32 v63, v47, v55
    s_nop 1
    v_cvt_pk_bf16_f32 v64, v48, v56
    v_cvt_pk_bf16_f32 v65, v49, v57
    v_cvt_pk_bf16_f32 v66, v50, v58
    v_cvt_pk_bf16_f32 v67, v51, v59
    s_mov_b32 s37, 3
    s_waitcnt vmcnt(1)
    s_barrier
L_k_loope:
    ds_read_b128 v[12:15], v2 offset:0
    ds_read_b128 v[16:19], v2 offset:33024
    ds_read_b128 v[20:23], v2 offset:16
    ds_read_b128 v[24:27], v2 offset:33040
    ds_read_b128 v[28:31], v2 offset:32
    ds_read_b128 v[32:35], v2 offset:33056
    s_waitcnt lgkmcnt(4)
    v_mfma_f32_16x16x32_bf16 v[44:47], a[0:3], v[12:15], 0
    ds_read_b128 v[36:39], v2 offset:48
    s_add_u32 s46, s41, 4096
    v_mfma_f32_16x16x32_bf16 v[52:55], a[4:7], v[12:15], 0
    buffer_store_dwordx4 v[60:63], v1, s[4:7], s41 offen offset:0 sc1
    v_mfma_f32_16x16x32_bf16 v[48:51], a[0:3], v[16:19], 0
    ds_read_b128 v[40:43], v2 offset:33072
    v_mfma_f32_16x16x32_bf16 v[56:59], a[4:7], v[16:19], 0
    s_waitcnt lgkmcnt(4)
    v_mfma_f32_16x16x32_bf16 v[44:47], a[8:11], v[20:23], v[44:47]
    ds_read_b128 v[12:15], v2 offset:64
    v_mfma_f32_16x16x32_bf16 v[52:55], a[12:15], v[20:23], v[52:55]
    buffer_store_dwordx4 v[64:67], v1, s[4:7], s46 offen offset:0 sc1
    v_mfma_f32_16x16x32_bf16 v[48:51], a[8:11], v[24:27], v[48:51]
    ds_read_b128 v[16:19], v2 offset:33088
    s_add_u32 s41, s41, 0x4000
    v_mfma_f32_16x16x32_bf16 v[56:59], a[12:15], v[24:27], v[56:59]
    s_waitcnt lgkmcnt(4)
    v_mfma_f32_16x16x32_bf16 v[44:47], a[16:19], v[28:31], v[44:47]
    ds_read_b128 v[20:23], v2 offset:80
    v_mfma_f32_16x16x32_bf16 v[52:55], a[20:23], v[28:31], v[52:55]
    buffer_store_dwordx4 v[104:107], v5, s[4:7], s43 offen sc1
    v_mfma_f32_16x16x32_bf16 v[48:51], a[16:19], v[32:35], v[48:51]
    ds_read_b128 v[24:27], v2 offset:33104
    v_mfma_f32_16x16x32_bf16 v[56:59], a[20:23], v[32:35], v[56:59]
    s_waitcnt lgkmcnt(4)
    v_mfma_f32_16x16x32_bf16 v[44:47], a[24:27], v[36:39], v[44:47]
    ds_read_b128 v[28:31], v2 offset:96
    v_mfma_f32_16x16x32_bf16 v[52:55], a[28:31], v[36:39], v[52:55]
    buffer_store_dwordx4 v[104:107], v1, s[4:7], s48 offen offset:0 sc1
    v_mfma_f32_16x16x32_bf16 v[48:51], a[24:27], v[40:43], v[48:51]
    ds_read_b128 v[32:35], v2 offset:33120
    s_add_u32 s43, s43, 0x4000
    s_add_u32 s48, s48, 0x4000
    v_mfma_f32_16x16x32_bf16 v[56:59], a[28:31], v[40:43], v[56:59]
    s_waitcnt lgkmcnt(4)
    v_mov_b32 v9, s37
    v_mfma_f32_16x16x32_bf16 v[44:47], a[32:35], v[12:15], v[44:47]
    ds_read_b128 v[36:39], v2 offset:112
    s_add_u32 m0, s39, 0
    s_add_u32 s45, s38, 0
    v_mfma_f32_16x16x32_bf16 v[52:55], a[36:39], v[12:15], v[52:55]
    buffer_load_dwordx4 v1, s[16:19], s45 offen lds
    v_mfma_f32_16x16x32_bf16 v[48:51], a[32:35], v[16:19], v[48:51]
    ds_read_b128 v[40:43], v2 offset:33136
    v_mfma_f32_16x16x32_bf16 v[56:59], a[36:39], v[16:19], v[56:59]
    s_waitcnt lgkmcnt(4)
    v_mfma_f32_16x16x32_bf16 v[44:47], a[40:43], v[20:23], v[44:47]
    ds_read_b128 v[12:15], v2 offset:128
    v_mfma_f32_16x16x32_bf16 v[52:55], a[44:47], v[20:23], v[52:55]
    buffer_load_dwordx4 v1, s[16:19], s45 offen offset:1024 lds
    v_mfma_f32_16x16x32_bf16 v[48:51], a[40:43], v[24:27], v[48:51]
    ds_read_b128 v[16:19], v2 offset:33152
    v_mfma_f32_16x16x32_bf16 v[56:59], a[44:47], v[24:27], v[56:59]
    s_waitcnt lgkmcnt(4)
    v_mfma_f32_16x16x32_bf16 v[44:47], a[48:51], v[28:31], v[44:47]
    ds_read_b128 v[20:23], v2 offset:144
    s_add_u32 m0, s39, 2064
    s_add_u32 s45, s38, 2048
    v_mfma_f32_16x16x32_bf16 v[52:55], a[52:55], v[28:31], v[52:55]
    buffer_load_dwordx4 v1, s[16:19], s45 offen lds
    v_mfma_f32_16x16x32_bf16 v[48:51], a[48:51], v[32:35], v[48:51]
    ds_read_b128 v[24:27], v2 offset:33168
    v_mfma_f32_16x16x32_bf16 v[56:59], a[52:55], v[32:35], v[56:59]
    s_waitcnt lgkmcnt(4)
    v_mfma_f32_16x16x32_bf16 v[44:47], a[56:59], v[36:39], v[44:47]
    ds_read_b128 v[28:31], v2 offset:160
    v_mfma_f32_16x16x32_bf16 v[52:55], a[60:63], v[36:39], v[52:55]
    buffer_load_dwordx4 v1, s[16:19], s45 offen offset:1024 lds
    v_mfma_f32_16x16x32_bf16 v[48:51], a[56:59], v[40:43], v[48:51]
    ds_read_b128 v[32:35], v2 offset:33184
    v_mfma_f32_16x16x32_bf16 v[56:59], a[60:63], v[40:43], v[56:59]
    s_waitcnt lgkmcnt(4)
    v_mfma_f32_16x16x32_bf16 v[44:47], a[64:67], v[12:15], v[44:47]
    ds_read_b128 v[36:39], v2 offset:176
    s_add_u32 m0, s39, 4128
    s_add_u32 s45, s38, 4096
    v_mfma_f32_16x16x32_bf16 v[52:55], a[68:71], v[12:15], v[52:55]
    buffer_load_dwordx4 v1, s[16:19], s45 offen lds
    v_mfma_f32_16x16x32_bf16 v[48:51], a[64:67], v[16:19], v[48:51]
    ds_read_b128 v[40:43], v2 offset:33200
    v_mfma_f32_16x16x32_bf16 v[56:59], a[68:71], v[16:19], v[56:59]
    s_waitcnt lgkmcnt(4)
    v_mfma_f32_16x16x32_bf16 v[44:47], a[72:75], v[20:23], v[44:47]
    ds_read_b128 v[12:15], v2 offset:192
    v_mfma_f32_16x16x32_bf16 v[52:55], a[76:79], v[20:23], v[52:55]
    buffer_load_dwordx4 v1, s[16:19], s45 offen offset:1024 lds
    v_mfma_f32_16x16x32_bf16 v[48:51], a[72:75], v[24:27], v[48:51]
    ds_read_b128 v[16:19], v2 offset:33216
    v_mfma_f32_16x16x32_bf16 v[56:59], a[76:79], v[24:27], v[56:59]
    s_waitcnt lgkmcnt(4)
    v_mfma_f32_16x16x32_bf16 v[44:47], a[80:83], v[28:31], v[44:47]
    ds_read_b128 v[20:23], v2 offset:208
    s_add_u32 m0, s39, 6192
    s_add_u32 s45, s38, 6144
    v_mfma_f32_16x16x32_bf16 v[52:55], a[84:87], v[28:31], v[52:55]
    buffer_load_dwordx4 v1, s[16:19], s45 offen lds
    v_mfma_f32_16x16x32_bf16 v[48:51], a[80:83], v[32:35], v[48:51]
    ds_read_b128 v[24:27], v2 offset:33232
    v_mfma_f32_16x16x32_bf16 v[56:59], a[84:87], v[32:35], v[56:59]
    s_waitcnt lgkmcnt(4)
    v_mfma_f32_16x16x32_bf16 v[44:47], a[88:91], v[36:39], v[44:47]
    ds_read_b128 v[28:31], v2 offset:224
    v_mfma_f32_16x16x32_bf16 v[52:55], a[92:95], v[36:39], v[52:55]
    buffer_load_dwordx4 v1, s[16:19], s45 offen offset:1024 lds
    v_mfma_f32_16x16x32_bf16 v[48:51], a[88:91], v[40:43], v[48:51]
    ds_read_b128 v[32:35], v2 offset:33248
    v_mfma_f32_16x16x32_bf16 v[56:59], a[92:95], v[40:43], v[56:59]
    s_waitcnt lgkmcnt(4)
    v_mfma_f32_16x16x32_bf16 v[44:47], a[96:99], v[12:15], v[44:47]
    ds_read_b128 v[36:39], v2 offset:240
    s_add_u32 m0, s39, 8256
    s_add_u32 s45, s38, 8192
    v_mfma_f32_16x16x32_bf16 v[52:55], a[100:103], v[12:15], v[52:55]
    buffer_load_dwordx4 v1, s[16:19], s45 offen lds
    v_mfma_f32_16x16x32_bf16 v[48:51], a[96:99], v[16:19], v[48:51]
    ds_read_b128 v[40:43], v2 offset:33264
    v_mfma_f32_16x16x32_bf16 v[56:59], a[100:103], v[16:19], v[56:59]
    s_waitcnt lgkmcnt(4)
    v_mfma_f32_16x16x32_bf16 v[44:47], a[104:107], v[20:23], v[44:47]
    ds_read_b128 v[12:15], v2 offset:1024
    v_mfma_f32_16x16x32_bf16 v[52:55], a[108:111], v[20:23], v[52:55]
    buffer_load_dwordx4 v1, s[16:19], s45 offen offset:1024 lds
    v_mfma_f32_16x16x32_bf16 v[48:51], a[104:107], v[24:27], v[48:51]
    ds_read_b128 v[16:19], v2 offset:34048
    v_mfma_f32_16x16x32_bf16 v[56:59], a[108:111], v[24:27], v[56:59]
    s_waitcnt lgkmcnt(4)
    v_mfma_f32_16x16x32_bf16 v[44:47], a[112:115], v[28:31], v[44:47]
    ds_read_b128 v[20:23], v2 offset:1040
    s_add_u32 m0, s39, 10320
    s_add_u32 s45, s38, 10240
    v_mfma_f32_16x16x32_bf16 v[52:55], a[116:119], v[28:31], v[52:55]
    buffer_load_dwordx4 v1, s[16:19], s45 offen lds
    v_mfma_f32_16x16x32_bf16 v[48:51], a[112:115], v[32:35], v[48:51]
    ds_read_b128 v[24:27], v2 offset:34064
    v_mfma_f32_16x16x32_bf16 v[56:59], a[116:119], v[32:35], v[56:59]
    s_waitcnt lgkmcnt(4)
    v_mfma_f32_16x16x32_bf16 v[44:47], a[120:123], v[36:39], v[44:47]
    ds_read_b128 v[28:31], v2 offset:1056
    v_mfma_f32_16x16x32_bf16 v[52:55], a[124:127], v[36:39], v[52:55]
    buffer_load_dwordx4 v1, s[16:19], s45 offen offset:1024 lds
    v_mfma_f32_16x16x32_bf16 v[48:51], a[120:123], v[40:43], v[48:51]
    ds_read_b128 v[32:35], v2 offset:34080
    v_mfma_f32_16x16x32_bf16 v[56:59], a[124:127], v[40:43], v[56:59]
    s_waitcnt lgkmcnt(4)
    v_mfma_f32_16x16x32_bf16 v[44:47], a[128:131], v[12:15], v[44:47]
    ds_read_b128 v[36:39], v2 offset:1072
    s_add_u32 m0, s39, 12384
    s_add_u32 s45, s38, 12288
    v_mfma_f32_16x16x32_bf16 v[52:55], a[132:135], v[12:15], v[52:55]
    buffer_load_dwordx4 v1, s[16:19], s45 offen lds
    v_mfma_f32_16x16x32_bf16 v[48:51], a[128:131], v[16:19], v[48:51]
    ds_read_b128 v[40:43], v2 offset:34096
    v_mfma_f32_16x16x32_bf16 v[56:59], a[132:135], v[16:19], v[56:59]
    s_waitcnt lgkmcnt(4)
    v_mfma_f32_16x16x32_bf16 v[44:47], a[136:139], v[20:23], v[44:47]
    ds_read_b128 v[12:15], v2 offset:1088
    v_mfma_f32_16x16x32_bf16 v[52:55], a[140:143], v[20:23], v[52:55]
    buffer_load_dwordx4 v1, s[16:19], s45 offen offset:1024 lds
    v_mfma_f32_16x16x32_bf16 v[48:51], a[136:139], v[24:27], v[48:51]
    ds_read_b128 v[16:19], v2 offset:34112
    v_mfma_f32_16x16x32_bf16 v[56:59], a[140:143], v[24:27], v[56:59]
    s_waitcnt lgkmcnt(4)
    v_mfma_f32_16x16x32_bf16 v[44:47], a[144:147], v[28:31], v[44:47]
    ds_read_b128 v[20:23], v2 offset:1104
    s_add_u32 m0, s39, 14448
    s_add_u32 s45, s38, 14336
    v_mfma_f32_16x16x32_bf16 v[52:55], a[148:151], v[28:31], v[52:55]
    buffer_load_dwordx4 v1, s[16:19], s45 offen lds
    v_mfma_f32_16x16x32_bf16 v[48:51], a[144:147], v[32:35], v[48:51]
    ds_read_b128 v[24:27], v2 offset:34128
    v_mfma_f32_16x16x32_bf16 v[56:59], a[148:151], v[32:35], v[56:59]
    s_waitcnt lgkmcnt(4)
    v_mfma_f32_16x16x32_bf16 v[44:47], a[152:155], v[36:39], v[44:47]
    ds_read_b128 v[28:31], v2 offset:1120
    v_mfma_f32_16x16x32_bf16 v[52:55], a[156:159], v[36:39], v[52:55]
    buffer_load_dwordx4 v1, s[16:19], s45 offen offset:1024 lds
    v_mfma_f32_16x16x32_bf16 v[48:51], a[152:155], v[40:43], v[48:51]
    ds_read_b128 v[32:35], v2 offset:34144
    s_sub_u32 s39, s40, s39
    s_add_u32 s38, s38, 0x10000
    v_mfma_f32_16x16x32_bf16 v[56:59], a[156:159], v[40:43], v[56:59]
    s_waitcnt lgkmcnt(4)
    v_mfma_f32_16x16x32_bf16 v[44:47], a[160:163], v[12:15], v[44:47]
    ds_read_b128 v[36:39], v2 offset:1136
    v_mfma_f32_16x16x32_bf16 v[52:55], a[164:167], v[12:15], v[52:55]
    buffer_load_dwordx4 v[68:71], v1, s[16:19], s44 offen
    s_add_u32 s44, s44, 0x10000
    v_mfma_f32_16x16x32_bf16 v[48:51], a[160:163], v[16:19], v[48:51]
    ds_read_b128 v[40:43], v2 offset:34160
    v_mfma_f32_16x16x32_bf16 v[56:59], a[164:167], v[16:19], v[56:59]
    s_waitcnt lgkmcnt(4)
    s_waitcnt vmcnt(17)
    s_barrier
    buffer_store_dword v9, v4, s[4:7], 0 offen sc1
    v_mfma_f32_16x16x32_bf16 v[44:47], a[168:171], v[20:23], v[44:47]
    ds_read_b128 v[12:15], v2 offset:1152
    v_mfma_f32_16x16x32_bf16 v[52:55], a[172:175], v[20:23], v[52:55]
    v_mfma_f32_16x16x32_bf16 v[48:51], a[168:171], v[24:27], v[48:51]
    ds_read_b128 v[16:19], v2 offset:34176
    v_mfma_f32_16x16x32_bf16 v[56:59], a[172:175], v[24:27], v[56:59]
    s_waitcnt lgkmcnt(4)
    v_mfma_f32_16x16x32_bf16 v[44:47], a[176:179], v[28:31], v[44:47]
    ds_read_b128 v[20:23], v2 offset:1168
    v_mfma_f32_16x16x32_bf16 v[52:55], a[180:183], v[28:31], v[52:55]
    v_mfma_f32_16x16x32_bf16 v[48:51], a[176:179], v[32:35], v[48:51]
    ds_read_b128 v[24:27], v2 offset:34192
    v_mfma_f32_16x16x32_bf16 v[56:59], a[180:183], v[32:35], v[56:59]
    s_waitcnt lgkmcnt(4)
    v_mfma_f32_16x16x32_bf16 v[44:47], a[184:187], v[36:39], v[44:47]
    ds_read_b128 v[28:31], v2 offset:1184
    v_mfma_f32_16x16x32_bf16 v[52:55], a[188:191], v[36:39], v[52:55]
    v_mfma_f32_16x16x32_bf16 v[48:51], a[184:187], v[40:43], v[48:51]
    ds_read_b128 v[32:35], v2 offset:34208
    v_mfma_f32_16x16x32_bf16 v[56:59], a[188:191], v[40:43], v[56:59]
    s_waitcnt lgkmcnt(4)
    v_mfma_f32_16x16x32_bf16 v[44:47], a[192:195], v[12:15], v[44:47]
    ds_read_b128 v[36:39], v2 offset:1200
    v_mfma_f32_16x16x32_bf16 v[52:55], a[196:199], v[12:15], v[52:55]
    v_mfma_f32_16x16x32_bf16 v[48:51], a[192:195], v[16:19], v[48:51]
    ds_read_b128 v[40:43], v2 offset:34224
    v_mfma_f32_16x16x32_bf16 v[56:59], a[196:199], v[16:19], v[56:59]
    s_waitcnt lgkmcnt(4)
    v_mfma_f32_16x16x32_bf16 v[44:47], a[200:203], v[20:23], v[44:47]
    ds_read_b128 v[12:15], v2 offset:1216
    v_mfma_f32_16x16x32_bf16 v[52:55], a[204:207], v[20:23], v[52:55]
    v_mfma_f32_16x16x32_bf16 v[48:51], a[200:203], v[24:27], v[48:51]
    ds_read_b128 v[16:19], v2 offset:34240
    v_mfma_f32_16x16x32_bf16 v[56:59], a[204:207], v[24:27], v[56:59]
    s_waitcnt lgkmcnt(4)
    v_mfma_f32_16x16x32_bf16 v[44:47], a[208:211], v[28:31], v[44:47]
    ds_read_b128 v[20:23], v2 offset:1232
    v_mfma_f32_16x16x32_bf16 v[52:55], a[212:215], v[28:31], v[52:55]
    v_mfma_f32_16x16x32_bf16 v[48:51], a[208:211], v[32:35], v[48:51]
    ds_read_b128 v[24:27], v2 offset:34256
    v_mfma_f32_16x16x32_bf16 v[56:59], a[212:215], v[32:35], v[56:59]
    s_waitcnt lgkmcnt(4)
    v_mfma_f32_16x16x32_bf16 v[44:47], a[216:219], v[36:39], v[44:47]
    ds_read_b128 v[28:31], v2 offset:1248
    v_mfma_f32_16x16x32_bf16 v[52:55], a[220:223], v[36:39], v[52:55]
    v_mfma_f32_16x16x32_bf16 v[48:51], a[216:219], v[40:43], v[48:51]
    ds_read_b128 v[32:35], v2 offset:34272
    v_mfma_f32_16x16x32_bf16 v[56:59], a[220:223], v[40:43], v[56:59]
    s_waitcnt lgkmcnt(4)
    v_mfma_f32_16x16x32_bf16 v[44:47], a[224:227], v[12:15], v[44:47]
    ds_read_b128 v[36:39], v2 offset:1264
    v_mfma_f32_16x16x32_bf16 v[52:55], a[228:231], v[12:15], v[52:55]
    v_mfma_f32_16x16x32_bf16 v[48:51], a[224:227], v[16:19], v[48:51]
    ds_read_b128 v[40:43], v2 offset:34288
    v_mfma_f32_16x16x32_bf16 v[56:59], a[228:231], v[16:19], v[56:59]
    s_waitcnt lgkmcnt(4)
    v_mfma_f32_16x16x32_bf16 v[44:47], a[232:235], v[20:23], v[44:47]
    v_mfma_f32_16x16x32_bf16 v[52:55], a[236:239], v[20:23], v[52:55]
    v_mfma_f32_16x16x32_bf16 v[48:51], a[232:235], v[24:27], v[48:51]
    v_mfma_f32_16x16x32_bf16 v[56:59], a[236:239], v[24:27], v[56:59]
    s_waitcnt lgkmcnt(2)
    v_mfma_f32_16x16x32_bf16 v[44:47], a[240:243], v[28:31], v[44:47]
    v_mfma_f32_16x16x32_bf16 v[52:55], a[244:247], v[28:31], v[52:55]
    v_mfma_f32_16x16x32_bf16 v[48:51], a[240:243], v[32:35], v[48:51]
    v_mfma_f32_16x16x32_bf16 v[56:59], a[244:247], v[32:35], v[56:59]
    s_waitcnt lgkmcnt(0)
    v_mfma_f32_16x16x32_bf16 v[44:47], a[248:251], v[36:39], v[44:47]
    v_mfma_f32_16x16x32_bf16 v[52:55], a[252:255], v[36:39], v[52:55]
    v_mfma_f32_16x16x32_bf16 v[48:51], a[248:251], v[40:43], v[48:51]
    v_mfma_f32_16x16x32_bf16 v[56:59], a[252:255], v[40:43], v[56:59]
    v_sub_u32 v2, v3, v2
    v_cvt_pk_bf16_f32 v60, v44, v52
    v_cvt_pk_bf16_f32 v61, v45, v53
    v_cvt_pk_bf16_f32 v62, v46, v54
    v_cvt_pk_bf16_f32 v63, v47, v55
    s_nop 1
    v_cvt_pk_bf16_f32 v64, v48, v56
    v_cvt_pk_bf16_f32 v65, v49, v57
    v_cvt_pk_bf16_f32 v66, v50, v58
    v_cvt_pk_bf16_f32 v67, v51, v59
    s_add_u32 s37, s37, 1
    s_cmp_le_u32 s37, 14
    s_waitcnt vmcnt(2)
    s_barrier
    s_cbranch_scc1 L_k_loope
    .p2align 6
L_k_loop:
    ds_read_b128 v[12:15], v2 offset:0
    ds_read_b128 v[16:19], v2 offset:33024
    ds_read_b128 v[20:23], v2 offset:16
    ds_read_b128 v[24:27], v2 offset:33040
    ds_read_b128 v[28:31], v2 offset:32
    ds_read_b128 v[32:35], v2 offset:33056
    s_waitcnt lgkmcnt(4)
    v_mfma_f32_16x16x32_bf16 v[44:47], a[0:3], v[12:15], 0
    ds_read_b128 v[36:39], v2 offset:48
    s_add_u32 m0, s39, 0
    s_add_u32 s45, s38, 0
    v_mfma_f32_16x16x32_bf16 v[52:55], a[4:7], v[12:15], 0
    buffer_load_dwordx4 v1, s[16:19], s45 offen lds
    v_mfma_f32_16x16x32_bf16 v[48:51], a[0:3], v[16:19], 0
    ds_read_b128 v[40:43], v2 offset:33072
    v_mfma_f32_16x16x32_bf16 v[56:59], a[4:7], v[16:19], 0
    s_waitcnt lgkmcnt(4)
    v_mfma_f32_16x16x32_bf16 v[44:47], a[8:11], v[20:23], v[44:47]
    ds_read_b128 v[12:15], v2 offset:64
    v_mfma_f32_16x16x32_bf16 v[52:55], a[12:15], v[20:23], v[52:55]
    buffer_load_dwordx4 v1, s[16:19], s45 offen offset:1024 lds
    v_mfma_f32_16x16x32_bf16 v[48:51], a[8:11], v[24:27], v[48:51]
    ds_read_b128 v[16:19], v2 offset:33088
    v_mfma_f32_16x16x32_bf16 v[56:59], a[12:15], v[24:27], v[56:59]
    s_waitcnt lgkmcnt(4)
    v_mfma_f32_16x16x32_bf16 v[44:47], a[16:19], v[28:31], v[44:47]
    ds_read_b128 v[20:23], v2 offset:80
    s_add_u32 m0, s39, 2064
    s_add_u32 s45, s38, 2048
    v_mfma_f32_16x16x32_bf16 v[52:55], a[20:23], v[28:31], v[52:55]
    buffer_load_dwordx4 v1, s[16:19], s45 offen lds
    v_mfma_f32_16x16x32_bf16 v[48:51], a[16:19], v[32:35], v[48:51]
    ds_read_b128 v[24:27], v2 offset:33104
    v_mfma_f32_16x16x32_bf16 v[56:59], a[20:23], v[32:35], v[56:59]
    s_waitcnt lgkmcnt(4)
    v_mfma_f32_16x16x32_bf16 v[44:47], a[24:27], v[36:39], v[44:47]
    ds_read_b128 v[28:31], v2 offset:96
    v_mfma_f32_16x16x32_bf16 v[52:55], a[28:31], v[36:39], v[52:55]
    buffer_load_dwordx4 v1, s[16:19], s45 offen offset:1024 lds
    v_mfma_f32_16x16x32_bf16 v[48:51], a[24:27], v[40:43], v[48:51]
    ds_read_b128 v[32:35], v2 offset:33120
    v_mfma_f32_16x16x32_bf16 v[56:59], a[28:31], v[40:43], v[56:59]
    s_waitcnt lgkmcnt(4)
    v_mfma_f32_16x16x32_bf16 v[44:47], a[32:35], v[12:15], v[44:47]
    ds_read_b128 v[36:39], v2 offset:112
    s_add_u32 m0, s39, 4128
    s_add_u32 s45, s38, 4096
    v_mfma_f32_16x16x32_bf16 v[52:55], a[36:39], v[12:15], v[52:55]
    buffer_load_dwordx4 v1, s[16:19], s45 offen lds
    v_mfma_f32_16x16x32_bf16 v[48:51], a[32:35], v[16:19], v[48:51]
    ds_read_b128 v[40:43], v2 offset:33136
    v_mfma_f32_16x16x32_bf16 v[56:59], a[36:39], v[16:19], v[56:59]
    s_waitcnt lgkmcnt(4)
    v_mfma_f32_16x16x32_bf16 v[44:47], a[40:43], v[20:23], v[44:47]
    ds_read_b128 v[12:15], v2 offset:128
    v_mfma_f32_16x16x32_bf16 v[52:55], a[44:47], v[20:23], v[52:55]
    buffer_load_dwordx4 v1, s[16:19], s45 offen offset:1024 lds
    v_mfma_f32_16x16x32_bf16 v[48:51], a[40:43], v[24:27], v[48:51]
    ds_read_b128 v[16:19], v2 offset:33152
    v_mfma_f32_16x16x32_bf16 v[56:59], a[44:47], v[24:27], v[56:59]
    s_waitcnt lgkmcnt(4)
    v_mfma_f32_16x16x32_bf16 v[44:47], a[48:51], v[28:31], v[44:47]
    ds_read_b128 v[20:23], v2 offset:144
    s_add_u32 m0, s39, 6192
    s_add_u32 s45, s38, 6144
    v_mfma_f32_16x16x32_bf16 v[52:55], a[52:55], v[28:31], v[52:55]
    buffer_load_dwordx4 v1, s[16:19], s45 offen lds
    v_mfma_f32_16x16x32_bf16 v[48:51], a[48:51], v[32:35], v[48:51]
    ds_read_b128 v[24:27], v2 offset:33168
    v_mfma_f32_16x16x32_bf16 v[56:59], a[52:55], v[32:35], v[56:59]
    s_waitcnt lgkmcnt(4)
    v_mfma_f32_16x16x32_bf16 v[44:47], a[56:59], v[36:39], v[44:47]
    ds_read_b128 v[28:31], v2 offset:160
    v_mfma_f32_16x16x32_bf16 v[52:55], a[60:63], v[36:39], v[52:55]
    buffer_load_dwordx4 v1, s[16:19], s45 offen offset:1024 lds
    v_mfma_f32_16x16x32_bf16 v[48:51], a[56:59], v[40:43], v[48:51]
    ds_read_b128 v[32:35], v2 offset:33184
    v_mfma_f32_16x16x32_bf16 v[56:59], a[60:63], v[40:43], v[56:59]
    s_waitcnt lgkmcnt(4)
    v_mfma_f32_16x16x32_bf16 v[44:47], a[64:67], v[12:15], v[44:47]
    ds_read_b128 v[36:39], v2 offset:176
    s_add_u32 m0, s39, 8256
    s_add_u32 s45, s38, 8192
    v_mfma_f32_16x16x32_bf16 v[52:55], a[68:71], v[12:15], v[52:55]
    buffer_load_dwordx4 v1, s[16:19], s45 offen lds
    v_mfma_f32_16x16x32_bf16 v[48:51], a[64:67], v[16:19], v[48:51]
    ds_read_b128 v[40:43], v2 offset:33200
    v_mfma_f32_16x16x32_bf16 v[56:59], a[68:71], v[16:19], v[56:59]
    s_waitcnt lgkmcnt(4)
    v_mfma_f32_16x16x32_bf16 v[44:47], a[72:75], v[20:23], v[44:47]
    ds_read_b128 v[12:15], v2 offset:192
    v_mfma_f32_16x16x32_bf16 v[52:55], a[76:79], v[20:23], v[52:55]
    buffer_load_dwordx4 v1, s[16:19], s45 offen offset:1024 lds
    v_mfma_f32_16x16x32_bf16 v[48:51], a[72:75], v[24:27], v[48:51]
    ds_read_b128 v[16:19], v2 offset:33216
    v_mfma_f32_16x16x32_bf16 v[56:59], a[76:79], v[24:27], v[56:59]
    s_waitcnt lgkmcnt(4)
    v_mfma_f32_16x16x32_bf16 v[44:47], a[80:83], v[28:31], v[44:47]
    ds_read_b128 v[20:23], v2 offset:208
    s_add_u32 m0, s39, 10320
    s_add_u32 s45, s38, 10240
    v_mfma_f32_16x16x32_bf16 v[52:55], a[84:87], v[28:31], v[52:55]
    buffer_load_dwordx4 v1, s[16:19], s45 offen lds
    v_mfma_f32_16x16x32_bf16 v[48:51], a[80:83], v[32:35], v[48:51]
    ds_read_b128 v[24:27], v2 offset:33232
    v_mfma_f32_16x16x32_bf16 v[56:59], a[84:87], v[32:35], v[56:59]
    s_waitcnt lgkmcnt(4)
    v_mfma_f32_16x16x32_bf16 v[44:47], a[88:91], v[36:39], v[44:47]
    ds_read_b128 v[28:31], v2 offset:224
    v_mfma_f32_16x16x32_bf16 v[52:55], a[92:95], v[36:39], v[52:55]
    buffer_load_dwordx4 v1, s[16:19], s45 offen offset:1024 lds
    v_mfma_f32_16x16x32_bf16 v[48:51], a[88:91], v[40:43], v[48:51]
    ds_read_b128 v[32:35], v2 offset:33248
    v_mfma_f32_16x16x32_bf16 v[56:59], a[92:95], v[40:43], v[56:59]
    s_waitcnt lgkmcnt(4)
    v_mfma_f32_16x16x32_bf16 v[44:47], a[96:99], v[12:15], v[44:47]
    ds_read_b128 v[36:39], v2 offset:240
    s_add_u32 m0, s39, 12384
    s_add_u32 s45, s38, 12288
    v_mfma_f32_16x16x32_bf16 v[52:55], a[100:103], v[12:15], v[52:55]
    buffer_load_dwordx4 v1, s[16:19], s45 offen lds
    v_mfma_f32_16x16x32_bf16 v[48:51], a[96:99], v[16:19], v[48:51]
    ds_read_b128 v[40:43], v2 offset:33264
    v_mfma_f32_16x16x32_bf16 v[56:59], a[100:103], v[16:19], v[56:59]
    s_waitcnt lgkmcnt(4)
    v_mfma_f32_16x16x32_bf16 v[44:47], a[104:107], v[20:23], v[44:47]
    ds_read_b128 v[12:15], v2 offset:1024
    v_mfma_f32_16x16x32_bf16 v[52:55], a[108:111], v[20:23], v[52:55]
    buffer_load_dwordx4 v1, s[16:19], s45 offen offset:1024 lds
    v_mfma_f32_16x16x32_bf16 v[48:51], a[104:107], v[24:27], v[48:51]
    ds_read_b128 v[16:19], v2 offset:34048
    v_mfma_f32_16x16x32_bf16 v[56:59], a[108:111], v[24:27], v[56:59]
    s_waitcnt lgkmcnt(4)
    v_mfma_f32_16x16x32_bf16 v[44:47], a[112:115], v[28:31], v[44:47]
    ds_read_b128 v[20:23], v2 offset:1040
    s_add_u32 m0, s39, 14448
    s_add_u32 s45, s38, 14336
    v_mfma_f32_16x16x32_bf16 v[52:55], a[116:119], v[28:31], v[52:55]
    buffer_load_dwordx4 v1, s[16:19], s45 offen lds
    v_mfma_f32_16x16x32_bf16 v[48:51], a[112:115], v[32:35], v[48:51]
    ds_read_b128 v[24:27], v2 offset:34064
    v_mfma_f32_16x16x32_bf16 v[56:59], a[116:119], v[32:35], v[56:59]
    s_waitcnt lgkmcnt(4)
    v_mfma_f32_16x16x32_bf16 v[44:47], a[120:123], v[36:39], v[44:47]
    ds_read_b128 v[28:31], v2 offset:1056
    v_mfma_f32_16x16x32_bf16 v[52:55], a[124:127], v[36:39], v[52:55]
    buffer_load_dwordx4 v1, s[16:19], s45 offen offset:1024 lds
    v_mfma_f32_16x16x32_bf16 v[48:51], a[120:123], v[40:43], v[48:51]
    ds_read_b128 v[32:35], v2 offset:34080
    s_sub_u32 s39, s40, s39
    s_add_u32 s38, s38, 0x10000
    v_mfma_f32_16x16x32_bf16 v[56:59], a[124:127], v[40:43], v[56:59]
    s_waitcnt lgkmcnt(4)
    v_mfma_f32_16x16x32_bf16 v[44:47], a[128:131], v[12:15], v[44:47]
    ds_read_b128 v[36:39], v2 offset:1072
    s_sub_u32 s46, s37, 2
    s_max_u32 s46, s46, 14
    v_mfma_f32_16x16x32_bf16 v[52:55], a[132:135], v[12:15], v[52:55]
    v_mov_b32 v9, s46
    v_mfma_f32_16x16x32_bf16 v[48:51], a[128:131], v[16:19], v[48:51]
    ds_read_b128 v[40:43], v2 offset:34096
    v_mfma_f32_16x16x32_bf16 v[56:59], a[132:135], v[16:19], v[56:59]
    s_waitcnt lgkmcnt(4)
    v_mfma_f32_16x16x32_bf16 v[44:47], a[136:139], v[20:23], v[44:47]
    ds_read_b128 v[12:15], v2 offset:1088
    v_mfma_f32_16x16x32_bf16 v[52:55], a[140:143], v[20:23], v[52:55]
    buffer_store_dword v9, v4, s[4:7], 0 offen sc1
    v_mfma_f32_16x16x32_bf16 v[48:51], a[136:139], v[24:27], v[48:51]
    ds_read_b128 v[16:19], v2 offset:34112
    s_add_u32 s46, s41, 4096
    v_mfma_f32_16x16x32_bf16 v[56:59], a[140:143], v[24:27], v[56:59]
    s_waitcnt lgkmcnt(4)
    v_mfma_f32_16x16x32_bf16 v[44:47], a[144:147], v[28:31], v[44:47]
    ds_read_b128 v[20:23], v2 offset:1104
    v_mfma_f32_16x16x32_bf16 v[52:55], a[148:151], v[28:31], v[52:55]
    buffer_store_dwordx4 v[60:63], v1, s[4:7], s41 offen offset:0 sc1
    v_mfma_f32_16x16x32_bf16 v[48:51], a[144:147], v[32:35], v[48:51]
    ds_read_b128 v[24:27], v2 offset:34128
    v_mfma_f32_16x16x32_bf16 v[56:59], a[148:151], v[32:35], v[56:59]
    s_waitcnt lgkmcnt(4)
    v_mfma_f32_16x16x32_bf16 v[44:47], a[152:155], v[36:39], v[44:47]
    ds_read_b128 v[28:31], v2 offset:1120
    v_mfma_f32_16x16x32_bf16 v[52:55], a[156:159], v[36:39], v[52:55]
    buffer_store_dwordx4 v[64:67], v1, s[4:7], s46 offen offset:0 sc1
    v_mfma_f32_16x16x32_bf16 v[48:51], a[152:155], v[40:43], v[48:51]
    ds_read_b128 v[32:35], v2 offset:34144
    s_add_u32 s41, s41, 0x4000
    v_mfma_f32_16x16x32_bf16 v[56:59], a[156:159], v[40:43], v[56:59]
    s_waitcnt lgkmcnt(4)
    v_mfma_f32_16x16x32_bf16 v[44:47], a[160:163], v[12:15], v[44:47]
    ds_read_b128 v[36:39], v2 offset:1136
    v_mfma_f32_16x16x32_bf16 v[52:55], a[164:167], v[12:15], v[52:55]
    buffer_store_dwordx4 v[104:107], v5, s[4:7], s43 offen sc1
    v_mfma_f32_16x16x32_bf16 v[48:51], a[160:163], v[16:19], v[48:51]
    ds_read_b128 v[40:43], v2 offset:34160
    v_mfma_f32_16x16x32_bf16 v[56:59], a[164:167], v[16:19], v[56:59]
    s_waitcnt lgkmcnt(4)
    v_mfma_f32_16x16x32_bf16 v[44:47], a[168:171], v[20:23], v[44:47]
    ds_read_b128 v[12:15], v2 offset:1152
    v_mfma_f32_16x16x32_bf16 v[52:55], a[172:175], v[20:23], v[52:55]
    buffer_store_dwordx4 v[104:107], v1, s[4:7], s48 offen offset:0 sc1
    v_mfma_f32_16x16x32_bf16 v[48:51], a[168:171], v[24:27], v[48:51]
    ds_read_b128 v[16:19], v2 offset:34176
    s_add_u32 s43, s43, 0x4000
    s_add_u32 s48, s48, 0x4000
    v_mfma_f32_16x16x32_bf16 v[56:59], a[172:175], v[24:27], v[56:59]
    s_waitcnt lgkmcnt(4)
    v_mfma_f32_16x16x32_bf16 v[44:47], a[176:179], v[28:31], v[44:47]
    ds_read_b128 v[20:23], v2 offset:1168
    v_mfma_f32_16x16x32_bf16 v[52:55], a[180:183], v[28:31], v[52:55]
    buffer_load_dwordx4 v[68:71], v1, s[16:19], s44 offen
    v_mfma_f32_16x16x32_bf16 v[48:51], a[176:179], v[32:35], v[48:51]
    ds_read_b128 v[24:27], v2 offset:34192
    s_add_u32 s44, s44, 0x10000
    v_mfma_f32_16x16x32_bf16 v[56:59], a[180:183], v[32:35], v[56:59]
    s_waitcnt lgkmcnt(4)
    v_mfma_f32_16x16x32_bf16 v[44:47], a[184:187], v[36:39], v[44:47]
    ds_read_b128 v[28:31], v2 offset:1184
    v_mfma_f32_16x16x32_bf16 v[52:55], a[188:191], v[36:39], v[52:55]
    v_mfma_f32_16x16x32_bf16 v[48:51], a[184:187], v[40:43], v[48:51]
    ds_read_b128 v[32:35], v2 offset:34208
    v_mfma_f32_16x16x32_bf16 v[56:59], a[188:191], v[40:43], v[56:59]
    s_waitcnt lgkmcnt(4)
    v_mfma_f32_16x16x32_bf16 v[44:47], a[192:195], v[12:15], v[44:47]
    ds_read_b128 v[36:39], v2 offset:1200
    v_mfma_f32_16x16x32_bf16 v[52:55], a[196:199], v[12:15], v[52:55]
    v_mfma_f32_16x16x32_bf16 v[48:51], a[192:195], v[16:19], v[48:51]
    ds_read_b128 v[40:43], v2 offset:34224
    v_mfma_f32_16x16x32_bf16 v[56:59], a[196:199], v[16:19], v[56:59]
    s_waitcnt lgkmcnt(4)
    v_mfma_f32_16x16x32_bf16 v[44:47], a[200:203], v[20:23], v[44:47]
    ds_read_b128 v[12:15], v2 offset:1216
    v_mfma_f32_16x16x32_bf16 v[52:55], a[204:207], v[20:23], v[52:55]
    v_mfma_f32_16x16x32_bf16 v[48:51], a[200:203], v[24:27], v[48:51]
    ds_read_b128 v[16:19], v2 offset:34240
    v_mfma_f32_16x16x32_bf16 v[56:59], a[204:207], v[24:27], v[56:59]
    s_waitcnt lgkmcnt(4)
    v_mfma_f32_16x16x32_bf16 v[44:47], a[208:211], v[28:31], v[44:47]
    ds_read_b128 v[20:23], v2 offset:1232
    v_mfma_f32_16x16x32_bf16 v[52:55], a[212:215], v[28:31], v[52:55]
    v_mfma_f32_16x16x32_bf16 v[48:51], a[208:211], v[32:35], v[48:51]
    ds_read_b128 v[24:27], v2 offset:34256
    v_mfma_f32_16x16x32_bf16 v[56:59], a[212:215], v[32:35], v[56:59]
    s_waitcnt lgkmcnt(4)
    v_mfma_f32_16x16x32_bf16 v[44:47], a[216:219], v[36:39], v[44:47]
    ds_read_b128 v[28:31], v2 offset:1248
    v_mfma_f32_16x16x32_bf16 v[52:55], a[220:223], v[36:39], v[52:55]
    v_mfma_f32_16x16x32_bf16 v[48:51], a[216:219], v[40:43], v[48:51]
    ds_read_b128 v[32:35], v2 offset:34272
    v_mfma_f32_16x16x32_bf16 v[56:59], a[220:223], v[40:43], v[56:59]
    s_waitcnt lgkmcnt(4)
    v_mfma_f32_16x16x32_bf16 v[44:47], a[224:227], v[12:15], v[44:47]
    ds_read_b128 v[36:39], v2 offset:1264
    v_mfma_f32_16x16x32_bf16 v[52:55], a[228:231], v[12:15], v[52:55]
    v_mfma_f32_16x16x32_bf16 v[48:51], a[224:227], v[16:19], v[48:51]
    ds_read_b128 v[40:43], v2 offset:34288
    v_mfma_f32_16x16x32_bf16 v[56:59], a[228:231], v[16:19], v[56:59]
    s_waitcnt lgkmcnt(4)
    v_mfma_f32_16x16x32_bf16 v[44:47], a[232:235], v[20:23], v[44:47]
    v_mfma_f32_16x16x32_bf16 v[52:55], a[236:239], v[20:23], v[52:55]
    v_mfma_f32_16x16x32_bf16 v[48:51], a[232:235], v[24:27], v[48:51]
    v_mfma_f32_16x16x32_bf16 v[56:59], a[236:239], v[24:27], v[56:59]
    s_waitcnt lgkmcnt(2)
    v_mfma_f32_16x16x32_bf16 v[44:47], a[240:243], v[28:31], v[44:47]
    v_mfma_f32_16x16x32_bf16 v[52:55], a[244:247], v[28:31], v[52:55]
    v_mfma_f32_16x16x32_bf16 v[48:51], a[240:243], v[32:35], v[48:51]
    v_mfma_f32_16x16x32_bf16 v[56:59], a[244:247], v[32:35], v[56:59]
    s_waitcnt lgkmcnt(0)
    v_mfma_f32_16x16x32_bf16 v[44:47], a[248:251], v[36:39], v[44:47]
    v_mfma_f32_16x16x32_bf16 v[52:55], a[252:255], v[36:39], v[52:55]
    v_mfma_f32_16x16x32_bf16 v[48:51], a[248:251], v[40:43], v[48:51]
    v_mfma_f32_16x16x32_bf16 v[56:59], a[252:255], v[40:43], v[56:59]
    v_sub_u32 v2, v3, v2
    v_cvt_pk_bf16_f32 v60, v44, v52
    v_cvt_pk_bf16_f32 v61, v45, v53
    v_cvt_pk_bf16_f32 v62, v46, v54
    v_cvt_pk_bf16_f32 v63, v47, v55
    s_nop 1
    v_cvt_pk_bf16_f32 v64, v48, v56
    v_cvt_pk_bf16_f32 v65, v49, v57
    v_cvt_pk_bf16_f32 v66, v50, v58
    v_cvt_pk_bf16_f32 v67, v51, v59
    s_add_u32 s37, s37, 1
    s_cmp_lt_u32 s37, 64
    s_waitcnt vmcnt(6)
    s_barrier
    s_cbranch_scc1 L_k_loop
    s_xor_b32 s48, s48, 0x2000
    s_add_u32 s46, s41, 4096
    buffer_store_dwordx4 v[60:63], v1, s[4:7], s41 offen offset:0 sc1
    buffer_store_dwordx4 v[64:67], v1, s[4:7], s46 offen offset:0 sc1
    s_add_u32 s41, s41, 0x4000
    buffer_store_dwordx4 v[104:107], v5, s[4:7], s43 offen sc1
    buffer_store_dwordx4 v[104:107], v1, s[4:7], s48 offen offset:0 sc1
    s_add_u32 s43, s43, 0x4000
    s_add_u32 s48, s48, 0x4000
    s_waitcnt vmcnt(0)
    v_mov_b32 v9, 64
    s_barrier
    buffer_store_dword v9, v4, s[4:7], 0 offen sc1
    s_branch L_o_join2
L_v:
    s_mov_b32 s12, s72
    s_and_b32 s13, s73, 0xffff
    s_mov_b32 s14, 0x800000
    s_mov_b32 s15, 0x20000
    s_mov_b32 s16, s64
    s_and_b32 s17, s65, 0xffff
    s_mov_b32 s18, 0x400000
    s_mov_b32 s19, 0x20000
    v_lshlrev_b32 v1, 4, v0
    s_lshl_b32 s45, s36, 7
    s_lshl_b32 s45, s45, 1
    s_add_u32 s45, s45, 0xe430080
    s_cmp_eq_u32 s32, 0
    s_cselect_b32 s46, 2, 0
    v_bfe_u32 v6, v0, 0, 1
    v_lshlrev_b32 v4, 13, v6
    v_add_u32 v4, s45, v4
    v_mov_b32 v6, 0x40000000
    v_cmp_gt_u32 vcc, s46, v0
    s_nop 1
    v_cndmask_b32 v4, v6, v4, vcc
    v_and_b32 v6, 15, v0
    v_mul_u32_u24 v2, 2064, v6
    v_lshrrev_b32 v6, 4, v0
    v_lshl_add_u32 v2, v6, 8, v2
    v_lshlrev_b32 v3, 1, v2
    v_add_u32 v3, 66048, v3
    s_mul_i32 s39, s32, 16512
    s_lshl_b32 s40, s39, 1
    s_add_u32 s40, s40, 66048
    s_lshl_b32 s38, s32, 14
    s_and_b32 s45, s32, 1
    s_lshl_b32 s45, s45, 3
    v_bfe_u32 v6, v0, 4, 2
    v_lshlrev_b32 v7, 1, v6
    v_add_u32 v7, s45, v7
    v_and_b32 v6, 15, v0
    v_xor_b32 v7, v7, v6
    v_bfe_u32 v6, v0, 4, 2
    v_lshlrev_b32 v12, 13, v6
    v_lshl_add_u32 v12, v7, 4, v12
    s_lshl_b32 s45, s32, 11
    s_add_u32 s45, s45, 132096
    v_add_u32 v13, s45, v1
    s_lshl_b32 s45, s32, 1
    v_bfe_u32 v7, v0, 2, 3
    v_xor_b32 v7, s45, v7
    v_bfe_u32 v6, v0, 4, 2
    v_lshlrev_b32 v14, 11, v6
    v_bfe_u32 v6, v0, 2, 2
    v_lshl_add_u32 v14, v6, 8, v14
    v_bfe_u32 v6, v0, 0, 2
    v_lshl_add_u32 v14, v6, 3, v14
    v_add_u32 v14, 132096, v14
    v_lshl_add_u32 v14, v7, 5, v14
    v_xor_b32 v15, 32, v14
    s_lshl_b32 s47, s36, 8
    s_lshl_b32 s45, s32, 20
    s_add_u32 s47, s47, s45
    s_add_u32 s46, s47, 0x0
    buffer_load_dwordx4 a[0:3], v12, s[12:15], s46 offen nt
    s_add_u32 s46, s47, 0x8000
    buffer_load_dwordx4 a[4:7], v12, s[12:15], s46 offen nt
    s_add_u32 s46, s47, 0x10000
    buffer_load_dwordx4 a[8:11], v12, s[12:15], s46 offen nt
    s_add_u32 s46, s47, 0x18000
    buffer_load_dwordx4 a[12:15], v12, s[12:15], s46 offen nt
    s_add_u32 s46, s47, 0x20000
    buffer_load_dwordx4 a[16:19], v12, s[12:15], s46 offen nt
    s_add_u32 s46, s47, 0x28000
    buffer_load_dwordx4 a[20:23], v12, s[12:15], s46 offen nt
    s_waitcnt vmcnt(6)
    s_barrier
    buffer_atomic_or v254, v255, s[8:11], 0 offen sc0 sc1
    s_add_u32 m0, s39, 0
    s_add_u32 s45, s38, 0
    buffer_load_dwordx4 v1, s[16:19], s45 offen offset:0 lds
    s_add_u32 m0, s39, 66048
    s_add_u32 s45, s38, 65536
    buffer_load_dwordx4 v1, s[16:19], s45 offen offset:0 lds
    s_add_u32 m0, s39, 2064
    s_add_u32 s45, s38, 2048
    buffer_load_dwordx4 v1, s[16:19], s45 offen offset:0 lds
    s_add_u32 m0, s39, 68112
    s_add_u32 s45, s38, 67584
    buffer_load_dwordx4 v1, s[16:19], s45 offen offset:0 lds
    s_add_u32 m0, s39, 4128
    s_add_u32 s45, s38, 4096
    buffer_load_dwordx4 v1, s[16:19], s45 offen offset:0 lds
    s_add_u32 m0, s39, 70176
    s_add_u32 s45, s38, 69632
    buffer_load_dwordx4 v1, s[16:19], s45 offen offset:0 lds
    s_add_u32 m0, s39, 6192
    s_add_u32 s45, s38, 6144
    buffer_load_dwordx4 v1, s[16:19], s45 offen offset:0 lds
    s_add_u32 m0, s39, 72240
    s_add_u32 s45, s38, 71680
    buffer_load_dwordx4 v1, s[16:19], s45 offen offset:0 lds
    s_add_u32 m0, s39, 8256
    s_add_u32 s45, s38, 8192
    buffer_load_dwordx4 v1, s[16:19], s45 offen offset:0 lds
    s_add_u32 m0, s39, 74304
    s_add_u32 s45, s38, 73728
    buffer_load_dwordx4 v1, s[16:19], s45 offen offset:0 lds
    s_add_u32 m0, s39, 10320
    s_add_u32 s45, s38, 10240
    buffer_load_dwordx4 v1, s[16:19], s45 offen offset:0 lds
    s_add_u32 m0, s39, 76368
    s_add_u32 s45, s38, 75776
    buffer_load_dwordx4 v1, s[16:19], s45 offen offset:0 lds
    s_add_u32 m0, s39, 12384
    s_add_u32 s45, s38, 12288
    buffer_load_dwordx4 v1, s[16:19], s45 offen offset:0 lds
    s_add_u32 m0, s39, 78432
    s_add_u32 s45, s38, 77824
    buffer_load_dwordx4 v1, s[16:19], s45 offen offset:0 lds
    s_add_u32 m0, s39, 14448
    s_add_u32 s45, s38, 14336
    buffer_load_dwordx4 v1, s[16:19], s45 offen offset:0 lds
    s_add_u32 m0, s39, 80496
    s_add_u32 s45, s38, 79872
    buffer_load_dwordx4 v1, s[16:19], s45 offen offset:0 lds
    s_add_u32 s46, s47, 0x30000
    buffer_load_dwordx4 a[24:27], v12, s[12:15], s46 offen nt
    s_add_u32 s46, s47, 0x38000
    buffer_load_dwordx4 a[28:31], v12, s[12:15], s46 offen nt
    s_add_u32 s46, s47, 0x40000
    buffer_load_dwordx4 a[32:35], v12, s[12:15], s46 offen nt
    s_add_u32 s46, s47, 0x48000
    buffer_load_dwordx4 a[36:39], v12, s[12:15], s46 offen nt
    s_add_u32 s46, s47, 0x50000
    buffer_load_dwordx4 a[40:43], v12, s[12:15], s46 offen nt
    s_add_u32 s46, s47, 0x58000
    buffer_load_dwordx4 a[44:47], v12, s[12:15], s46 offen nt
    s_mul_i32 s41, s36, 0x208000
    s_lshl_b32 s45, s32, 11
    s_add_u32 s42, s41, s45
    s_add_u32 s42, s42, 0x2000
    s_lshl_b32 s45, s32, 10
    s_add_u32 s41, s41, s45
    s_add_u32 s41, s41, 0x4000000
    v_bfe_u32 v6, v0, 4, 2
    v_lshlrev_b32 v5, 22, v6
    v_bfe_u32 v6, v0, 4, 2
    v_lshl_add_u32 v5, v6, 16, v5
    v_bfe_u32 v6, v0, 0, 4
    v_lshl_add_u32 v5, v6, 4, v5
    s_lshl_b32 s43, s32, 3
    s_bfe_u32 s45, s36, 0x10001
    s_add_u32 s43, s43, s45
    s_mul_i32 s43, s43, 0x208000
    s_and_b32 s45, s36, 1
    s_lshl_b32 s45, s45, 12
    s_add_u32 s43, s43, s45
    s_lshr_b32 s45, s36, 2
    s_lshl_b32 s45, s45, 8
    s_add_u32 s43, s43, s45
    s_add_u32 s43, s43, 0xa000000
    s_lshr_b32 s48, s36, 1
    s_mul_i32 s48, s48, 0x208000
    s_and_b32 s45, s36, 1
    s_lshl_b32 s45, s45, 2
    s_add_u32 s45, s45, s32
    s_lshl_b32 s45, s45, 10
    s_add_u32 s48, s48, s45
    s_add_u32 s48, s48, 0x8000000
    v_mov_b32 v104, -1
    v_mov_b32 v105, -1
    v_mov_b32 v106, -1
    v_mov_b32 v107, -1
    s_and_b32 s44, s63, 15
    s_lshl_b32 s44, s44, 2
    s_add_u32 s44, s44, s32
    s_lshl_b32 s44, s44, 10
    s_add_u32 s44, s44, 0x20000
    v_bfe_u32 v6, v0, 2, 2
    v_lshrrev_b32 v7, 4, v0
    v_cmp_eq_u32 vcc, v6, v7
    v_mov_b32 v7, 0x3f80
    s_nop 0
    v_cndmask_b32 v7, 0, v7, vcc
    v_and_b32 v6, 3, v0
    v_cmp_eq_u32 vcc, 0, v6
    s_nop 1
    v_cndmask_b32 v108, 0, v7, vcc
    v_cmp_eq_u32 vcc, 1, v6
    s_nop 1
    v_cndmask_b32 v109, 0, v7, vcc
    v_cmp_eq_u32 vcc, 2, v6
    s_nop 1
    v_cndmask_b32 v110, 0, v7, vcc
    v_cmp_eq_u32 vcc, 3, v6
    s_nop 1
    v_cndmask_b32 v111, 0, v7, vcc
    v_bfe_u32 v6, v0, 2, 2
    v_lshrrev_b32 v7, 4, v0
    v_cmp_eq_u32 vcc, v6, v7
    v_mov_b32 v7, 0x3f800000
    s_nop 0
    v_cndmask_b32 v7, 0, v7, vcc
    v_and_b32 v6, 3, v0
    v_cmp_eq_u32 vcc, 0, v6
    s_nop 1
    v_cndmask_b32 v112, 0, v7, vcc
    v_cmp_eq_u32 vcc, 1, v6
    s_nop 1
    v_cndmask_b32 v113, 0, v7, vcc
    v_cmp_eq_u32 vcc, 2, v6
    s_nop 1
    v_cndmask_b32 v114, 0, v7, vcc
    v_cmp_eq_u32 vcc, 3, v6
    s_nop 1
    v_cndmask_b32 v115, 0, v7, vcc
    s_mov_b32 s37, 0xe400000
    v_add_u32 v16, 66048, v2
    s_waitcnt vmcnt(6)
    v_mov_b32 v7, 163832
    s_cmp_lg_u32 s32, 0
    s_cbranch_scc1 L_cf_10
    v_readfirstlane_b32 s45, v254
    s_nop 1
    v_mov_b32 v6, s45
    ds_write_b32 v7, v6
    s_waitcnt lgkmcnt(0)
L_cf_10:
    s_barrier
    ds_read_b32 v6, v7
    s_waitcnt lgkmcnt(0)
    v_readfirstlane_b32 s45, v6
    s_nop 0
    s_bitcmp1_b32 s45, s63
    s_cbranch_scc1 L_redo
    ds_write_b128 v13, a[0:3] offset:0
    ds_write_b128 v13, a[4:7] offset:1024
    s_waitcnt lgkmcnt(0)
    s_barrier
    ds_read_b64_tr_b16 a[0:1], v14 offset:0
    ds_read_b64_tr_b16 a[2:3], v14 offset:1024
    ds_read_b64_tr_b16 a[4:5], v15 offset:0
    ds_read_b64_tr_b16 a[6:7], v15 offset:1024
    ds_read_b128 v[28:31], v2 offset:0
    ds_read_b128 v[32:35], v2 offset:33024
    ds_read_b128 v[36:39], v16 offset:0
    ds_read_b128 v[40:43], v16 offset:33024
    s_add_u32 m0, s39, 0
    s_add_u32 s45, s38, 0
    buffer_load_dwordx4 v1, s[16:19], s45 offen offset:1024 lds
    s_add_u32 m0, s39, 66048
    s_add_u32 s45, s38, 65536
    buffer_load_dwordx4 v1, s[16:19], s45 offen offset:1024 lds
    s_add_u32 s46, s47, 0x60000
    buffer_load_dwordx4 a[48:51], v12, s[12:15], s46 offen nt
    s_add_u32 s46, s47, 0x68000
    buffer_load_dwordx4 a[52:55], v12, s[12:15], s46 offen nt
    s_waitcnt vmcnt(12)
    ds_write_b128 v13, a[8:11] offset:8192
    ds_write_b128 v13, a[12:15] offset:9216
    s_waitcnt lgkmcnt(0)
    s_barrier
    ds_read_b64_tr_b16 a[8:9], v14 offset:8192
    ds_read_b64_tr_b16 a[10:11], v14 offset:9216
    ds_read_b64_tr_b16 a[12:13], v15 offset:8192
    ds_read_b64_tr_b16 a[14:15], v15 offset:9216
    ds_read_b128 v[88:91], v2 offset:16
    ds_read_b128 v[92:95], v2 offset:33040
    ds_read_b128 v[96:99], v16 offset:16
    ds_read_b128 v[100:103], v16 offset:33040
    v_mfma_f32_16x16x32_bf16 v[44:47], a[0:3], v[28:31], 0
    s_add_u32 m0, s39, 2064
    s_add_u32 s45, s38, 2048
    buffer_load_dwordx4 v1, s[16:19], s45 offen offset:1024 lds
    v_mfma_f32_16x16x32_bf16 v[52:55], a[4:7], v[28:31], 0
    s_add_u32 m0, s39, 68112
    s_add_u32 s45, s38, 67584
    buffer_load_dwordx4 v1, s[16:19], s45 offen offset:1024 lds
    v_mfma_f32_16x16x32_bf16 v[48:51], a[0:3], v[32:35], 0
    s_add_u32 s46, s47, 0x70000
    buffer_load_dwordx4 a[56:59], v12, s[12:15], s46 offen nt
    v_mfma_f32_16x16x32_bf16 v[56:59], a[4:7], v[32:35], 0
    s_add_u32 s46, s47, 0x78000
    buffer_load_dwordx4 a[60:63], v12, s[12:15], s46 offen nt
    v_mfma_f32_16x16x32_bf16 v[72:75], a[0:3], v[36:39], 0
    s_waitcnt vmcnt(14)
    ds_write_b128 v13, a[16:19] offset:0
    v_mfma_f32_16x16x32_bf16 v[80:83], a[4:7], v[36:39], 0
    ds_write_b128 v13, a[20:23] offset:1024
    v_mfma_f32_16x16x32_bf16 v[76:79], a[0:3], v[40:43], 0
    v_mfma_f32_16x16x32_bf16 v[84:87], a[4:7], v[40:43], 0
    s_waitcnt lgkmcnt(0)
    s_barrier
    ds_read_b64_tr_b16 a[16:17], v14 offset:0
    ds_read_b64_tr_b16 a[18:19], v14 offset:1024
    ds_read_b64_tr_b16 a[20:21], v15 offset:0
    ds_read_b64_tr_b16 a[22:23], v15 offset:1024
    ds_read_b128 v[28:31], v2 offset:32
    ds_read_b128 v[32:35], v2 offset:33056
    ds_read_b128 v[36:39], v16 offset:32
    ds_read_b128 v[40:43], v16 offset:33056
    v_mfma_f32_16x16x32_bf16 v[44:47], a[8:11], v[88:91], v[44:47]
    s_add_u32 m0, s39, 4128
    s_add_u32 s45, s38, 4096
    buffer_load_dwordx4 v1, s[16:19], s45 offen offset:1024 lds
    v_mfma_f32_16x16x32_bf16 v[52:55], a[12:15], v[88:91], v[52:55]
    s_add_u32 m0, s39, 70176
    s_add_u32 s45, s38, 69632
    buffer_load_dwordx4 v1, s[16:19], s45 offen offset:1024 lds
    v_mfma_f32_16x16x32_bf16 v[48:51], a[8:11], v[92:95], v[48:51]
    s_add_u32 s46, s47, 0x80000
    buffer_load_dwordx4 a[64:67], v12, s[12:15], s46 offen nt
    v_mfma_f32_16x16x32_bf16 v[56:59], a[12:15], v[92:95], v[56:59]
    s_add_u32 s46, s47, 0x88000
    buffer_load_dwordx4 a[68:71], v12, s[12:15], s46 offen nt
    v_mfma_f32_16x16x32_bf16 v[72:75], a[8:11], v[96:99], v[72:75]
    s_waitcnt vmcnt(16)
    ds_write_b128 v13, a[24:27] offset:8192
    v_mfma_f32_16x16x32_bf16 v[80:83], a[12:15], v[96:99], v[80:83]
    ds_write_b128 v13, a[28:31] offset:9216
    v_mfma_f32_16x16x32_bf16 v[76:79], a[8:11], v[100:103], v[76:79]
    v_mfma_f32_16x16x32_bf16 v[84:87], a[12:15], v[100:103], v[84:87]
    s_waitcnt lgkmcnt(0)
    s_barrier
    ds_read_b64_tr_b16 a[24:25], v14 offset:8192
    ds_read_b64_tr_b16 a[26:27], v14 offset:9216
    ds_read_b64_tr_b16 a[28:29], v15 offset:8192
    ds_read_b64_tr_b16 a[30:31], v15 offset:9216
    ds_read_b128 v[88:91], v2 offset:48
    ds_read_b128 v[92:95], v2 offset:33072
    ds_read_b128 v[96:99], v16 offset:48
    ds_read_b128 v[100:103], v16 offset:33072
    v_mfma_f32_16x16x32_bf16 v[44:47], a[16:19], v[28:31], v[44:47]
    s_add_u32 m0, s39, 6192
    s_add_u32 s45, s38, 6144
    buffer_load_dwordx4 v1, s[16:19], s45 offen offset:1024 lds
    v_mfma_f32_16x16x32_bf16 v[52:55], a[20:23], v[28:31], v[52:55]
    s_add_u32 m0, s39, 72240
    s_add_u32 s45, s38, 71680
    buffer_load_dwordx4 v1, s[16:19], s45 offen offset:1024 lds
    v_mfma_f32_16x16x32_bf16 v[48:51], a[16:19], v[32:35], v[48:51]
    s_add_u32 s46, s47, 0x90000
    buffer_load_dwordx4 a[72:75], v12, s[12:15], s46 offen nt
    v_mfma_f32_16x16x32_bf16 v[56:59], a[20:23], v[32:35], v[56:59]
    s_add_u32 s46, s47, 0x98000
    buffer_load_dwordx4 a[76:79], v12, s[12:15], s46 offen nt
    v_mfma_f32_16x16x32_bf16 v[72:75], a[16:19], v[36:39], v[72:75]
    s_waitcnt vmcnt(18)
    ds_write_b128 v13, a[32:35] offset:0
    v_mfma_f32_16x16x32_bf16 v[80:83], a[20:23], v[36:39], v[80:83]
    ds_write_b128 v13, a[36:39] offset:1024
    v_mfma_f32_16x16x32_bf16 v[76:79], a[16:19], v[40:43], v[76:79]
    v_mfma_f32_16x16x32_bf16 v[84:87], a[20:23], v[40:43], v[84:87]
    s_waitcnt lgkmcnt(0)
    s_barrier
    ds_read_b64_tr_b16 a[32:33], v14 offset:0
    ds_read_b64_tr_b16 a[34:35], v14 offset:1024
    ds_read_b64_tr_b16 a[36:37], v15 offset:0
    ds_read_b64_tr_b16 a[38:39], v15 offset:1024
    ds_read_b128 v[28:31], v2 offset:64
    ds_read_b128 v[32:35], v2 offset:33088
    ds_read_b128 v[36:39], v16 offset:64
    ds_read_b128 v[40:43], v16 offset:33088
    v_mfma_f32_16x16x32_bf16 v[44:47], a[24:27], v[88:91], v[44:47]
    s_add_u32 m0, s39, 8256
    s_add_u32 s45, s38, 8192
    buffer_load_dwordx4 v1, s[16:19], s45 offen offset:1024 lds
    v_mfma_f32_16x16x32_bf16 v[52:55], a[28:31], v[88:91], v[52:55]
    s_add_u32 m0, s39, 74304
    s_add_u32 s45, s38, 73728
    buffer_load_dwordx4 v1, s[16:19], s45 offen offset:1024 lds
    v_mfma_f32_16x16x32_bf16 v[48:51], a[24:27], v[92:95], v[48:51]
    s_add_u32 s46, s47, 0xa0000
    buffer_load_dwordx4 a[80:83], v12, s[12:15], s46 offen nt
    v_mfma_f32_16x16x32_bf16 v[56:59], a[28:31], v[92:95], v[56:59]
    s_add_u32 s46, s47, 0xa8000
    buffer_load_dwordx4 a[84:87], v12, s[12:15], s46 offen nt
    v_mfma_f32_16x16x32_bf16 v[72:75], a[24:27], v[96:99], v[72:75]
    s_waitcnt vmcnt(20)
    ds_write_b128 v13, a[40:43] offset:8192
    v_mfma_f32_16x16x32_bf16 v[80:83], a[28:31], v[96:99], v[80:83]
    ds_write_b128 v13, a[44:47] offset:9216
    v_mfma_f32_16x16x32_bf16 v[76:79], a[24:27], v[100:103], v[76:79]
    v_mfma_f32_16x16x32_bf16 v[84:87], a[28:31], v[100:103], v[84:87]
    s_waitcnt lgkmcnt(0)
    s_barrier
    ds_read_b64_tr_b16 a[40:41], v14 offset:8192
    ds_read_b64_tr_b16 a[42:43], v14 offset:9216
    ds_read_b64_tr_b16 a[44:45], v15 offset:8192
    ds_read_b64_tr_b16 a[46:47], v15 offset:9216
    ds_read_b128 v[88:91], v2 offset:80
    ds_read_b128 v[92:95], v2 offset:33104
    ds_read_b128 v[96:99], v16 offset:80
    ds_read_b128 v[100:103], v16 offset:33104
    v_mfma_f32_16x16x32_bf16 v[44:47], a[32:35], v[28:31], v[44:47]
    s_add_u32 m0, s39, 10320
    s_add_u32 s45, s38, 10240
    buffer_load_dwordx4 v1, s[16:19], s45 offen offset:1024 lds
    v_mfma_f32_16x16x32_bf16 v[52:55], a[36:39], v[28:31], v[52:55]
    s_add_u32 m0, s39, 76368
    s_add_u32 s45, s38, 75776
    buffer_load_dwordx4 v1, s[16:19], s45 offen offset:1024 lds
    v_mfma_f32_16x16x32_bf16 v[48:51], a[32:35], v[32:35], v[48:51]
    s_add_u32 s46, s47, 0xb0000
    buffer_load_dwordx4 a[88:91], v12, s[12:15], s46 offen nt
    v_mfma_f32_16x16x32_bf16 v[56:59], a[36:39], v[32:35], v[56:59]
    s_add_u32 s46, s47, 0xb8000
    buffer_load_dwordx4 a[92:95], v12, s[12:15], s46 offen nt
    v_mfma_f32_16x16x32_bf16 v[72:75], a[32:35], v[36:39], v[72:75]
    s_waitcnt vmcnt(20)
    ds_write_b128 v13, a[48:51] offset:0
    v_mfma_f32_16x16x32_bf16 v[80:83], a[36:39], v[36:39], v[80:83]
    ds_write_b128 v13, a[52:55] offset:1024
    v_mfma_f32_16x16x32_bf16 v[76:79], a[32:35], v[40:43], v[76:79]
    v_mfma_f32_16x16x32_bf16 v[84:87], a[36:39], v[40:43], v[84:87]
    s_waitcnt lgkmcnt(0)
    s_barrier
    ds_read_b64_tr_b16 a[48:49], v14 offset:0
    ds_read_b64_tr_b16 a[50:51], v14 offset:1024
    ds_read_b64_tr_b16 a[52:53], v15 offset:0
    ds_read_b64_tr_b16 a[54:55], v15 offset:1024
    ds_read_b128 v[28:31], v2 offset:96
    ds_read_b128 v[32:35], v2 offset:33120
    ds_read_b128 v[36:39], v16 offset:96
    ds_read_b128 v[40:43], v16 offset:33120
    v_mfma_f32_16x16x32_bf16 v[44:47], a[40:43], v[88:91], v[44:47]
    s_add_u32 m0, s39, 12384
    s_add_u32 s45, s38, 12288
    buffer_load_dwordx4 v1, s[16:19], s45 offen offset:1024 lds
    v_mfma_f32_16x16x32_bf16 v[52:55], a[44:47], v[88:91], v[52:55]
    s_add_u32 m0, s39, 78432
    s_add_u32 s45, s38, 77824
    buffer_load_dwordx4 v1, s[16:19], s45 offen offset:1024 lds
    v_mfma_f32_16x16x32_bf16 v[48:51], a[40:43], v[92:95], v[48:51]
    s_add_u32 s46, s47, 0xc0000
    buffer_load_dwordx4 a[96:99], v12, s[12:15], s46 offen nt
    v_mfma_f32_16x16x32_bf16 v[56:59], a[44:47], v[92:95], v[56:59]
    s_add_u32 s46, s47, 0xc8000
    buffer_load_dwordx4 a[100:103], v12, s[12:15], s46 offen nt
    v_mfma_f32_16x16x32_bf16 v[72:75], a[40:43], v[96:99], v[72:75]
    s_waitcnt vmcnt(20)
    ds_write_b128 v13, a[56:59] offset:8192
    v_mfma_f32_16x16x32_bf16 v[80:83], a[44:47], v[96:99], v[80:83]
    ds_write_b128 v13, a[60:63] offset:9216
    v_mfma_f32_16x16x32_bf16 v[76:79], a[40:43], v[100:103], v[76:79]
    v_mfma_f32_16x16x32_bf16 v[84:87], a[44:47], v[100:103], v[84:87]
    s_waitcnt lgkmcnt(0)
    s_barrier
    ds_read_b64_tr_b16 a[56:57], v14 offset:8192
    ds_read_b64_tr_b16 a[58:59], v14 offset:9216
    ds_read_b64_tr_b16 a[60:61], v15 offset:8192
    ds_read_b64_tr_b16 a[62:63], v15 offset:9216
    ds_read_b128 v[88:91], v2 offset:112
    ds_read_b128 v[92:95], v2 offset:33136
    ds_read_b128 v[96:99], v16 offset:112
    ds_read_b128 v[100:103], v16 offset:33136
    v_mfma_f32_16x16x32_bf16 v[44:47], a[48:51], v[28:31], v[44:47]
    s_add_u32 m0, s39, 14448
    s_add_u32 s45, s38, 14336
    buffer_load_dwordx4 v1, s[16:19], s45 offen offset:1024 lds
    v_mfma_f32_16x16x32_bf16 v[52:55], a[52:55], v[28:31], v[52:55]
    s_add_u32 s46, s47, 0xd0000
    buffer_load_dwordx4 a[104:107], v12, s[12:15], s46 offen nt
    v_mfma_f32_16x16x32_bf16 v[48:51], a[48:51], v[32:35], v[48:51]
    s_add_u32 s46, s47, 0xd8000
    buffer_load_dwordx4 a[108:111], v12, s[12:15], s46 offen nt
    v_mfma_f32_16x16x32_bf16 v[56:59], a[52:55], v[32:35], v[56:59]
    s_waitcnt vmcnt(19)
    ds_write_b128 v13, a[64:67] offset:0
    v_mfma_f32_16x16x32_bf16 v[72:75], a[48:51], v[36:39], v[72:75]
    ds_write_b128 v13, a[68:71] offset:1024
    v_mfma_f32_16x16x32_bf16 v[80:83], a[52:55], v[36:39], v[80:83]
    v_mfma_f32_16x16x32_bf16 v[76:79], a[48:51], v[40:43], v[76:79]
    v_mfma_f32_16x16x32_bf16 v[84:87], a[52:55], v[40:43], v[84:87]
    s_waitcnt lgkmcnt(0)
    s_barrier
    ds_read_b64_tr_b16 a[64:65], v14 offset:0
    ds_read_b64_tr_b16 a[66:67], v14 offset:1024
    ds_read_b64_tr_b16 a[68:69], v15 offset:0
    ds_read_b64_tr_b16 a[70:71], v15 offset:1024
    ds_read_b128 v[28:31], v2 offset:128
    ds_read_b128 v[32:35], v2 offset:33152
    ds_read_b128 v[36:39], v16 offset:128
    ds_read_b128 v[40:43], v16 offset:33152
    v_mfma_f32_16x16x32_bf16 v[44:47], a[56:59], v[88:91], v[44:47]
    s_add_u32 m0, s39, 80496
    s_add_u32 s45, s38, 79872
    buffer_load_dwordx4 v1, s[16:19], s45 offen offset:1024 lds
    v_mfma_f32_16x16x32_bf16 v[52:55], a[60:63], v[88:91], v[52:55]
    s_add_u32 s46, s47, 0xe0000
    buffer_load_dwordx4 a[112:115], v12, s[12:15], s46 offen nt
    v_mfma_f32_16x16x32_bf16 v[48:51], a[56:59], v[92:95], v[48:51]
    s_add_u32 s46, s47, 0xe8000
    buffer_load_dwordx4 a[116:119], v12, s[12:15], s46 offen nt
    v_mfma_f32_16x16x32_bf16 v[56:59], a[60:63], v[92:95], v[56:59]
    s_waitcnt vmcnt(18)
    ds_write_b128 v13, a[72:75] offset:8192
    v_mfma_f32_16x16x32_bf16 v[72:75], a[56:59], v[96:99], v[72:75]
    ds_write_b128 v13, a[76:79] offset:9216
    v_mfma_f32_16x16x32_bf16 v[80:83], a[60:63], v[96:99], v[80:83]
    v_mfma_f32_16x16x32_bf16 v[76:79], a[56:59], v[100:103], v[76:79]
    v_mfma_f32_16x16x32_bf16 v[84:87], a[60:63], v[100:103], v[84:87]
    s_waitcnt lgkmcnt(0)
    s_barrier
    ds_read_b64_tr_b16 a[72:73], v14 offset:8192
    ds_read_b64_tr_b16 a[74:75], v14 offset:9216
    ds_read_b64_tr_b16 a[76:77], v15 offset:8192
    ds_read_b64_tr_b16 a[78:79], v15 offset:9216
    ds_read_b128 v[88:91], v2 offset:144
    ds_read_b128 v[92:95], v2 offset:33168
    ds_read_b128 v[96:99], v16 offset:144
    ds_read_b128 v[100:103], v16 offset:33168
    v_mfma_f32_16x16x32_bf16 v[44:47], a[64:67], v[28:31], v[44:47]
    s_add_u32 s46, s47, 0xf0000
    buffer_load_dwordx4 a[120:123], v12, s[12:15], s46 offen nt
    v_mfma_f32_16x16x32_bf16 v[52:55], a[68:71], v[28:31], v[52:55]
    s_add_u32 s46, s47, 0xf8000
    buffer_load_dwordx4 a[124:127], v12, s[12:15], s46 offen nt
    v_mfma_f32_16x16x32_bf16 v[48:51], a[64:67], v[32:35], v[48:51]
    s_waitcnt vmcnt(16)
    ds_write_b128 v13, a[80:83] offset:0
    v_mfma_f32_16x16x32_bf16 v[56:59], a[68:71], v[32:35], v[56:59]
    ds_write_b128 v13, a[84:87] offset:1024
    v_mfma_f32_16x16x32_bf16 v[72:75], a[64:67], v[36:39], v[72:75]
    v_mfma_f32_16x16x32_bf16 v[80:83], a[68:71], v[36:39], v[80:83]
    v_mfma_f32_16x16x32_bf16 v[76:79], a[64:67], v[40:43], v[76:79]
    v_mfma_f32_16x16x32_bf16 v[84:87], a[68:71], v[40:43], v[84:87]
    s_waitcnt lgkmcnt(0)
    s_barrier
    ds_read_b64_tr_b16 a[80:81], v14 offset:0
    ds_read_b64_tr_b16 a[82:83], v14 offset:1024
    ds_read_b64_tr_b16 a[84:85], v15 offset:0
    ds_read_b64_tr_b16 a[86:87], v15 offset:1024
    ds_read_b128 v[28:31], v2 offset:160
    ds_read_b128 v[32:35], v2 offset:33184
    ds_read_b128 v[36:39], v16 offset:160
    ds_read_b128 v[40:43], v16 offset:33184
    v_mfma_f32_16x16x32_bf16 v[44:47], a[72:75], v[88:91], v[44:47]
    s_add_u32 s46, s47, 0x400000
    buffer_load_dwordx4 a[128:131], v12, s[12:15], s46 offen nt
    v_mfma_f32_16x16x32_bf16 v[52:55], a[76:79], v[88:91], v[52:55]
    s_add_u32 s46, s47, 0x408000
    buffer_load_dwordx4 a[132:135], v12, s[12:15], s46 offen nt
    v_mfma_f32_16x16x32_bf16 v[48:51], a[72:75], v[92:95], v[48:51]
    s_waitcnt vmcnt(14)
    ds_write_b128 v13, a[88:91] offset:8192
    v_mfma_f32_16x16x32_bf16 v[56:59], a[76:79], v[92:95], v[56:59]
    ds_write_b128 v13, a[92:95] offset:9216
    v_mfma_f32_16x16x32_bf16 v[72:75], a[72:75], v[96:99], v[72:75]
    v_mfma_f32_16x16x32_bf16 v[80:83], a[76:79], v[96:99], v[80:83]
    v_mfma_f32_16x16x32_bf16 v[76:79], a[72:75], v[100:103], v[76:79]
    v_mfma_f32_16x16x32_bf16 v[84:87], a[76:79], v[100:103], v[84:87]
    s_waitcnt lgkmcnt(0)
    s_barrier
    ds_read_b64_tr_b16 a[88:89], v14 offset:8192
    ds_read_b64_tr_b16 a[90:91], v14 offset:9216
    ds_read_b64_tr_b16 a[92:93], v15 offset:8192
    ds_read_b64_tr_b16 a[94:95], v15 offset:9216
    ds_read_b128 v[88:91], v2 offset:176
    ds_read_b128 v[92:95], v2 offset:33200
    ds_read_b128 v[96:99], v16 offset:176
    ds_read_b128 v[100:103], v16 offset:33200
    v_mfma_f32_16x16x32_bf16 v[44:47], a[80:83], v[28:31], v[44:47]
    s_add_u32 s46, s47, 0x410000
    buffer_load_dwordx4 a[136:139], v12, s[12:15], s46 offen nt
    v_mfma_f32_16x16x32_bf16 v[52:55], a[84:87], v[28:31], v[52:55]
    s_add_u32 s46, s47, 0x418000
    buffer_load_dwordx4 a[140:143], v12, s[12:15], s46 offen nt
    v_mfma_f32_16x16x32_bf16 v[48:51], a[80:83], v[32:35], v[48:51]
    s_waitcnt vmcnt(12)
    ds_write_b128 v13, a[96:99] offset:0
    v_mfma_f32_16x16x32_bf16 v[56:59], a[84:87], v[32:35], v[56:59]
    ds_write_b128 v13, a[100:103] offset:1024
    v_mfma_f32_16x16x32_bf16 v[72:75], a[80:83], v[36:39], v[72:75]
    v_mfma_f32_16x16x32_bf16 v[80:83], a[84:87], v[36:39], v[80:83]
    v_mfma_f32_16x16x32_bf16 v[76:79], a[80:83], v[40:43], v[76:79]
    v_mfma_f32_16x16x32_bf16 v[84:87], a[84:87], v[40:43], v[84:87]
    s_waitcnt lgkmcnt(0)
    s_barrier
    ds_read_b64_tr_b16 a[96:97], v14 offset:0
    ds_read_b64_tr_b16 a[98:99], v14 offset:1024
    ds_read_b64_tr_b16 a[100:101], v15 offset:0
    ds_read_b64_tr_b16 a[102:103], v15 offset:1024
    ds_read_b128 v[28:31], v2 offset:192
    ds_read_b128 v[32:35], v2 offset:33216
    ds_read_b128 v[36:39], v16 offset:192
    ds_read_b128 v[40:43], v16 offset:33216
    v_mfma_f32_16x16x32_bf16 v[44:47], a[88:91], v[88:91], v[44:47]
    s_add_u32 s46, s47, 0x420000
    buffer_load_dwordx4 a[144:147], v12, s[12:15], s46 offen nt
    v_mfma_f32_16x16x32_bf16 v[52:55], a[92:95], v[88:91], v[52:55]
    s_add_u32 s46, s47, 0x428000
    buffer_load_dwordx4 a[148:151], v12, s[12:15], s46 offen nt
    v_mfma_f32_16x16x32_bf16 v[48:51], a[88:91], v[92:95], v[48:51]
    s_waitcnt vmcnt(11)
    ds_write_b128 v13, a[104:107] offset:8192
    v_mfma_f32_16x16x32_bf16 v[56:59], a[92:95], v[92:95], v[56:59]
    ds_write_b128 v13, a[108:111] offset:9216
    v_mfma_f32_16x16x32_bf16 v[72:75], a[88:91], v[96:99], v[72:75]
    v_mfma_f32_16x16x32_bf16 v[80:83], a[92:95], v[96:99], v[80:83]
    v_mfma_f32_16x16x32_bf16 v[76:79], a[88:91], v[100:103], v[76:79]
    v_mfma_f32_16x16x32_bf16 v[84:87], a[92:95], v[100:103], v[84:87]
    s_waitcnt lgkmcnt(0)
    s_barrier
    ds_read_b64_tr_b16 a[104:105], v14 offset:8192
    ds_read_b64_tr_b16 a[106:107], v14 offset:9216
    ds_read_b64_tr_b16 a[108:109], v15 offset:8192
    ds_read_b64_tr_b16 a[110:111], v15 offset:9216
    ds_read_b128 v[88:91], v2 offset:208
    ds_read_b128 v[92:95], v2 offset:33232
    ds_read_b128 v[96:99], v16 offset:208
    ds_read_b128 v[100:103], v16 offset:33232
    v_mfma_f32_16x16x32_bf16 v[44:47], a[96:99], v[28:31], v[44:47]
    s_add_u32 s46, s47, 0x430000
    buffer_load_dwordx4 a[152:155], v12, s[12:15], s46 offen nt
    v_mfma_f32_16x16x32_bf16 v[52:55], a[100:103], v[28:31], v[52:55]
    s_add_u32 s46, s47, 0x438000
    buffer_load_dwordx4 a[156:159], v12, s[12:15], s46 offen nt
    v_mfma_f32_16x16x32_bf16 v[48:51], a[96:99], v[32:35], v[48:51]
    s_waitcnt vmcnt(10)
    ds_write_b128 v13, a[112:115] offset:0
    v_mfma_f32_16x16x32_bf16 v[56:59], a[100:103], v[32:35], v[56:59]
    ds_write_b128 v13, a[116:119] offset:1024
    v_mfma_f32_16x16x32_bf16 v[72:75], a[96:99], v[36:39], v[72:75]
    v_mfma_f32_16x16x32_bf16 v[80:83], a[100:103], v[36:39], v[80:83]
    v_mfma_f32_16x16x32_bf16 v[76:79], a[96:99], v[40:43], v[76:79]
    v_mfma_f32_16x16x32_bf16 v[84:87], a[100:103], v[40:43], v[84:87]
    s_waitcnt lgkmcnt(0)
    s_barrier
    ds_read_b64_tr_b16 a[112:113], v14 offset:0
    ds_read_b64_tr_b16 a[114:115], v14 offset:1024
    ds_read_b64_tr_b16 a[116:117], v15 offset:0
    ds_read_b64_tr_b16 a[118:119], v15 offset:1024
    ds_read_b128 v[28:31], v2 offset:224
    ds_read_b128 v[32:35], v2 offset:33248
    ds_read_b128 v[36:39], v16 offset:224
    ds_read_b128 v[40:43], v16 offset:33248
    v_mfma_f32_16x16x32_bf16 v[44:47], a[104:107], v[88:91], v[44:47]
    s_waitcnt vmcnt(8)
    ds_write_b128 v13, a[120:123] offset:8192
    v_mfma_f32_16x16x32_bf16 v[52:55], a[108:111], v[88:91], v[52:55]
    ds_write_b128 v13, a[124:127] offset:9216
    v_mfma_f32_16x16x32_bf16 v[48:51], a[104:107], v[92:95], v[48:51]
    s_add_u32 s46, s47, 0x440000
    buffer_load_dwordx4 a[160:163], v12, s[12:15], s46 offen nt
    v_mfma_f32_16x16x32_bf16 v[56:59], a[108:111], v[92:95], v[56:59]
    s_add_u32 s46, s47, 0x448000
    buffer_load_dwordx4 a[164:167], v12, s[12:15], s46 offen nt
    v_mfma_f32_16x16x32_bf16 v[72:75], a[104:107], v[96:99], v[72:75]
    v_mfma_f32_16x16x32_bf16 v[80:83], a[108:111], v[96:99], v[80:83]
    v_mfma_f32_16x16x32_bf16 v[76:79], a[104:107], v[100:103], v[76:79]
    v_mfma_f32_16x16x32_bf16 v[84:87], a[108:111], v[100:103], v[84:87]
    s_waitcnt lgkmcnt(0)
    s_barrier
    ds_read_b64_tr_b16 a[120:121], v14 offset:8192
    ds_read_b64_tr_b16 a[122:123], v14 offset:9216
    ds_read_b64_tr_b16 a[124:125], v15 offset:8192
    ds_read_b64_tr_b16 a[126:127], v15 offset:9216
    ds_read_b128 v[88:91], v2 offset:240
    ds_read_b128 v[92:95], v2 offset:33264
    ds_read_b128 v[96:99], v16 offset:240
    ds_read_b128 v[100:103], v16 offset:33264
    v_mfma_f32_16x16x32_bf16 v[44:47], a[112:115], v[28:31], v[44:47]
    s_waitcnt vmcnt(8)
    ds_write_b128 v13, a[128:131] offset:0
    v_mfma_f32_16x16x32_bf16 v[52:55], a[116:119], v[28:31], v[52:55]
    ds_write_b128 v13, a[132:135] offset:1024
    v_mfma_f32_16x16x32_bf16 v[48:51], a[112:115], v[32:35], v[48:51]
    s_add_u32 s46, s47, 0x450000
    buffer_load_dwordx4 a[168:171], v12, s[12:15], s46 offen nt
    v_mfma_f32_16x16x32_bf16 v[56:59], a[116:119], v[32:35], v[56:59]
    s_add_u32 s46, s47, 0x458000
    buffer_load_dwordx4 a[172:175], v12, s[12:15], s46 offen nt
    v_mfma_f32_16x16x32_bf16 v[72:75], a[112:115], v[36:39], v[72:75]
    v_mfma_f32_16x16x32_bf16 v[80:83], a[116:119], v[36:39], v[80:83]
    v_mfma_f32_16x16x32_bf16 v[76:79], a[112:115], v[40:43], v[76:79]
    v_mfma_f32_16x16x32_bf16 v[84:87], a[116:119], v[40:43], v[84:87]
    s_waitcnt lgkmcnt(0)
    s_barrier
    ds_read_b64_tr_b16 a[128:129], v14 offset:0
    ds_read_b64_tr_b16 a[130:131], v14 offset:1024
    ds_read_b64_tr_b16 a[132:133], v15 offset:0
    ds_read_b64_tr_b16 a[134:135], v15 offset:1024
    ds_read_b128 v[28:31], v2 offset:1024
    ds_read_b128 v[32:35], v2 offset:34048
    ds_read_b128 v[36:39], v16 offset:1024
    ds_read_b128 v[40:43], v16 offset:34048
    v_mfma_f32_16x16x32_bf16 v[44:47], a[120:123], v[88:91], v[44:47]
    s_waitcnt vmcnt(8)
    ds_write_b128 v13, a[136:139] offset:8192
    v_mfma_f32_16x16x32_bf16 v[52:55], a[124:127], v[88:91], v[52:55]
    ds_write_b128 v13, a[140:143] offset:9216
    v_mfma_f32_16x16x32_bf16 v[48:51], a[120:123], v[92:95], v[48:51]
    s_add_u32 s46, s47, 0x460000
    buffer_load_dwordx4 a[176:179], v12, s[12:15], s46 offen nt
    v_mfma_f32_16x16x32_bf16 v[56:59], a[124:127], v[92:95], v[56:59]
    s_add_u32 s46, s47, 0x468000
    buffer_load_dwordx4 a[180:183], v12, s[12:15], s46 offen nt
    v_mfma_f32_16x16x32_bf16 v[72:75], a[120:123], v[96:99], v[72:75]
    v_mfma_f32_16x16x32_bf16 v[80:83], a[124:127], v[96:99], v[80:83]
    v_mfma_f32_16x16x32_bf16 v[76:79], a[120:123], v[100:103], v[76:79]
    v_mfma_f32_16x16x32_bf16 v[84:87], a[124:127], v[100:103], v[84:87]
    s_waitcnt lgkmcnt(0)
    s_barrier
    ds_read_b64_tr_b16 a[136:137], v14 offset:8192
    ds_read_b64_tr_b16 a[138:139], v14 offset:9216
    ds_read_b64_tr_b16 a[140:141], v15 offset:8192
    ds_read_b64_tr_b16 a[142:143], v15 offset:9216
    ds_read_b128 v[88:91], v2 offset:1040
    ds_read_b128 v[92:95], v2 offset:34064
    ds_read_b128 v[96:99], v16 offset:1040
    ds_read_b128 v[100:103], v16 offset:34064
    v_mfma_f32_16x16x32_bf16 v[44:47], a[128:131], v[28:31], v[44:47]
    s_waitcnt vmcnt(8)
    ds_write_b128 v13, a[144:147] offset:0
    v_mfma_f32_16x16x32_bf16 v[52:55], a[132:135], v[28:31], v[52:55]
    ds_write_b128 v13, a[148:151] offset:1024
    v_mfma_f32_16x16x32_bf16 v[48:51], a[128:131], v[32:35], v[48:51]
    s_add_u32 s46, s47, 0x470000
    buffer_load_dwordx4 a[184:187], v12, s[12:15], s46 offen nt
    v_mfma_f32_16x16x32_bf16 v[56:59], a[132:135], v[32:35], v[56:59]
    s_add_u32 s46, s47, 0x478000
    buffer_load_dwordx4 a[188:191], v12, s[12:15], s46 offen nt
    v_mfma_f32_16x16x32_bf16 v[72:75], a[128:131], v[36:39], v[72:75]
    v_mfma_f32_16x16x32_bf16 v[80:83], a[132:135], v[36:39], v[80:83]
    v_mfma_f32_16x16x32_bf16 v[76:79], a[128:131], v[40:43], v[76:79]
    v_mfma_f32_16x16x32_bf16 v[84:87], a[132:135], v[40:43], v[84:87]
    s_waitcnt lgkmcnt(0)
    s_barrier
    ds_read_b64_tr_b16 a[144:145], v14 offset:0
    ds_read_b64_tr_b16 a[146:147], v14 offset:1024
    ds_read_b64_tr_b16 a[148:149], v15 offset:0
    ds_read_b64_tr_b16 a[150:151], v15 offset:1024
    ds_read_b128 v[28:31], v2 offset:1056
    ds_read_b128 v[32:35], v2 offset:34080
    ds_read_b128 v[36:39], v16 offset:1056
    ds_read_b128 v[40:43], v16 offset:34080
    v_mfma_f32_16x16x32_bf16 v[44:47], a[136:139], v[88:91], v[44:47]
    s_waitcnt vmcnt(8)
    ds_write_b128 v13, a[152:155] offset:8192
    v_mfma_f32_16x16x32_bf16 v[52:55], a[140:143], v[88:91], v[52:55]
    ds_write_b128 v13, a[156:159] offset:9216
    v_mfma_f32_16x16x32_bf16 v[48:51], a[136:139], v[92:95], v[48:51]
    s_add_u32 m0, s39, 0
    s_add_u32 s45, s38, 131072
    buffer_load_dwordx4 v1, s[16:19], s45 offen offset:0 lds
    v_mfma_f32_16x16x32_bf16 v[56:59], a[140:143], v[92:95], v[56:59]
    s_add_u32 s46, s47, 0x480000
    buffer_load_dwordx4 a[192:195], v12, s[12:15], s46 offen nt
    v_mfma_f32_16x16x32_bf16 v[72:75], a[136:139], v[96:99], v[72:75]
    s_add_u32 s46, s47, 0x488000
    buffer_load_dwordx4 a[196:199], v12, s[12:15], s46 offen nt
    v_mfma_f32_16x16x32_bf16 v[80:83], a[140:143], v[96:99], v[80:83]
    v_mfma_f32_16x16x32_bf16 v[76:79], a[136:139], v[100:103], v[76:79]
    v_mfma_f32_16x16x32_bf16 v[84:87], a[140:143], v[100:103], v[84:87]
    s_waitcnt lgkmcnt(0)
    s_barrier
    ds_read_b64_tr_b16 a[152:153], v14 offset:8192
    ds_read_b64_tr_b16 a[154:155], v14 offset:9216
    ds_read_b64_tr_b16 a[156:157], v15 offset:8192
    ds_read_b64_tr_b16 a[158:159], v15 offset:9216
    ds_read_b128 v[88:91], v2 offset:1072
    ds_read_b128 v[92:95], v2 offset:34096
    ds_read_b128 v[96:99], v16 offset:1072
    ds_read_b128 v[100:103], v16 offset:34096
    v_mfma_f32_16x16x32_bf16 v[44:47], a[144:147], v[28:31], v[44:47]
    s_waitcnt vmcnt(9)
    ds_write_b128 v13, a[160:163] offset:0
    v_mfma_f32_16x16x32_bf16 v[52:55], a[148:151], v[28:31], v[52:55]
    ds_write_b128 v13, a[164:167] offset:1024
    v_mfma_f32_16x16x32_bf16 v[48:51], a[144:147], v[32:35], v[48:51]
    s_add_u32 m0, s39, 2064
    s_add_u32 s45, s38, 133120
    buffer_load_dwordx4 v1, s[16:19], s45 offen offset:0 lds
    v_mfma_f32_16x16x32_bf16 v[56:59], a[148:151], v[32:35], v[56:59]
    s_add_u32 s46, s47, 0x490000
    buffer_load_dwordx4 a[200:203], v12, s[12:15], s46 offen nt
    v_mfma_f32_16x16x32_bf16 v[72:75], a[144:147], v[36:39], v[72:75]
    s_add_u32 s46, s47, 0x498000
    buffer_load_dwordx4 a[204:207], v12, s[12:15], s46 offen nt
    v_mfma_f32_16x16x32_bf16 v[80:83], a[148:151], v[36:39], v[80:83]
    v_mfma_f32_16x16x32_bf16 v[76:79], a[144:147], v[40:43], v[76:79]
    v_mfma_f32_16x16x32_bf16 v[84:87], a[148:151], v[40:43], v[84:87]
    s_waitcnt lgkmcnt(0)
    s_barrier
    ds_read_b64_tr_b16 a[160:161], v14 offset:0
    ds_read_b64_tr_b16 a[162:163], v14 offset:1024
    ds_read_b64_tr_b16 a[164:165], v15 offset:0
    ds_read_b64_tr_b16 a[166:167], v15 offset:1024
    ds_read_b128 v[28:31], v2 offset:1088
    ds_read_b128 v[32:35], v2 offset:34112
    ds_read_b128 v[36:39], v16 offset:1088
    ds_read_b128 v[40:43], v16 offset:34112
    v_mfma_f32_16x16x32_bf16 v[44:47], a[152:155], v[88:91], v[44:47]
    s_waitcnt vmcnt(10)
    ds_write_b128 v13, a[168:171] offset:8192
    v_mfma_f32_16x16x32_bf16 v[52:55], a[156:159], v[88:91], v[52:55]
    ds_write_b128 v13, a[172:175] offset:9216
    v_mfma_f32_16x16x32_bf16 v[48:51], a[152:155], v[92:95], v[48:51]
    s_add_u32 m0, s39, 4128
    s_add_u32 s45, s38, 135168
    buffer_load_dwordx4 v1, s[16:19], s45 offen offset:0 lds
    v_mfma_f32_16x16x32_bf16 v[56:59], a[156:159], v[92:95], v[56:59]
    s_add_u32 s46, s47, 0x4a0000
    buffer_load_dwordx4 a[208:211], v12, s[12:15], s46 offen nt
    v_mfma_f32_16x16x32_bf16 v[72:75], a[152:155], v[96:99], v[72:75]
    s_add_u32 s46, s47, 0x4a8000
    buffer_load_dwordx4 a[212:215], v12, s[12:15], s46 offen nt
    v_mfma_f32_16x16x32_bf16 v[80:83], a[156:159], v[96:99], v[80:83]
    v_mfma_f32_16x16x32_bf16 v[76:79], a[152:155], v[100:103], v[76:79]
    v_mfma_f32_16x16x32_bf16 v[84:87], a[156:159], v[100:103], v[84:87]
    s_waitcnt lgkmcnt(0)
    s_barrier
    ds_read_b64_tr_b16 a[168:169], v14 offset:8192
    ds_read_b64_tr_b16 a[170:171], v14 offset:9216
    ds_read_b64_tr_b16 a[172:173], v15 offset:8192
    ds_read_b64_tr_b16 a[174:175], v15 offset:9216
    ds_read_b128 v[88:91], v2 offset:1104
    ds_read_b128 v[92:95], v2 offset:34128
    ds_read_b128 v[96:99], v16 offset:1104
    ds_read_b128 v[100:103], v16 offset:34128
    v_mfma_f32_16x16x32_bf16 v[44:47], a[160:163], v[28:31], v[44:47]
    s_waitcnt vmcnt(11)
    ds_write_b128 v13, a[176:179] offset:0
    v_mfma_f32_16x16x32_bf16 v[52:55], a[164:167], v[28:31], v[52:55]
    ds_write_b128 v13, a[180:183] offset:1024
    v_mfma_f32_16x16x32_bf16 v[48:51], a[160:163], v[32:35], v[48:51]
    s_add_u32 m0, s39, 6192
    s_add_u32 s45, s38, 137216
    buffer_load_dwordx4 v1, s[16:19], s45 offen offset:0 lds
    v_mfma_f32_16x16x32_bf16 v[56:59], a[164:167], v[32:35], v[56:59]
    s_add_u32 s46, s47, 0x4b0000
    buffer_load_dwordx4 a[216:219], v12, s[12:15], s46 offen nt
    v_mfma_f32_16x16x32_bf16 v[72:75], a[160:163], v[36:39], v[72:75]
    s_add_u32 s46, s47, 0x4b8000
    buffer_load_dwordx4 a[220:223], v12, s[12:15], s46 offen nt
    v_mfma_f32_16x16x32_bf16 v[80:83], a[164:167], v[36:39], v[80:83]
    v_mfma_f32_16x16x32_bf16 v[76:79], a[160:163], v[40:43], v[76:79]
    v_mfma_f32_16x16x32_bf16 v[84:87], a[164:167], v[40:43], v[84:87]
    s_waitcnt lgkmcnt(0)
    s_barrier
    ds_read_b64_tr_b16 a[176:177], v14 offset:0
    ds_read_b64_tr_b16 a[178:179], v14 offset:1024
    ds_read_b64_tr_b16 a[180:181], v15 offset:0
    ds_read_b64_tr_b16 a[182:183], v15 offset:1024
    ds_read_b128 v[28:31], v2 offset:1120
    ds_read_b128 v[32:35], v2 offset:34144
    ds_read_b128 v[36:39], v16 offset:1120
    ds_read_b128 v[40:43], v16 offset:34144
    v_mfma_f32_16x16x32_bf16 v[44:47], a[168:171], v[88:91], v[44:47]
    s_waitcnt vmcnt(12)
    ds_write_b128 v13, a[184:187] offset:8192
    v_mfma_f32_16x16x32_bf16 v[52:55], a[172:175], v[88:91], v[52:55]
    ds_write_b128 v13, a[188:191] offset:9216
    v_mfma_f32_16x16x32_bf16 v[48:51], a[168:171], v[92:95], v[48:51]
    s_add_u32 m0, s39, 8256
    s_add_u32 s45, s38, 139264
    buffer_load_dwordx4 v1, s[16:19], s45 offen offset:0 lds
    v_mfma_f32_16x16x32_bf16 v[56:59], a[172:175], v[92:95], v[56:59]
    s_add_u32 s46, s47, 0x4c0000
    buffer_load_dwordx4 a[224:227], v12, s[12:15], s46 offen nt
    v_mfma_f32_16x16x32_bf16 v[72:75], a[168:171], v[96:99], v[72:75]
    s_add_u32 s46, s47, 0x4c8000
    buffer_load_dwordx4 a[228:231], v12, s[12:15], s46 offen nt
    v_mfma_f32_16x16x32_bf16 v[80:83], a[172:175], v[96:99], v[80:83]
    v_mfma_f32_16x16x32_bf16 v[76:79], a[168:171], v[100:103], v[76:79]
    v_mfma_f32_16x16x32_bf16 v[84:87], a[172:175], v[100:103], v[84:87]
    s_waitcnt lgkmcnt(0)
    s_barrier
    ds_read_b64_tr_b16 a[184:185], v14 offset:8192
    ds_read_b64_tr_b16 a[186:187], v14 offset:9216
    ds_read_b64_tr_b16 a[188:189], v15 offset:8192
    ds_read_b64_tr_b16 a[190:191], v15 offset:9216
    ds_read_b128 v[88:91], v2 offset:1136
    ds_read_b128 v[92:95], v2 offset:34160
    ds_read_b128 v[96:99], v16 offset:1136
    ds_read_b128 v[100:103], v16 offset:34160
    v_mfma_f32_16x16x32_bf16 v[44:47], a[176:179], v[28:31], v[44:47]
    s_waitcnt vmcnt(12)
    ds_write_b128 v13, a[192:195] offset:0
    v_mfma_f32_16x16x32_bf16 v[52:55], a[180:183], v[28:31], v[52:55]
    ds_write_b128 v13, a[196:199] offset:1024
    v_mfma_f32_16x16x32_bf16 v[48:51], a[176:179], v[32:35], v[48:51]
    s_add_u32 m0, s39, 10320
    s_add_u32 s45, s38, 141312
    buffer_load_dwordx4 v1, s[16:19], s45 offen offset:0 lds
    v_mfma_f32_16x16x32_bf16 v[56:59], a[180:183], v[32:35], v[56:59]
    s_add_u32 s46, s47, 0x4d0000
    buffer_load_dwordx4 a[232:235], v12, s[12:15], s46 offen nt
    v_mfma_f32_16x16x32_bf16 v[72:75], a[176:179], v[36:39], v[72:75]
    s_add_u32 s46, s47, 0x4d8000
    buffer_load_dwordx4 a[236:239], v12, s[12:15], s46 offen nt
    v_mfma_f32_16x16x32_bf16 v[80:83], a[180:183], v[36:39], v[80:83]
    v_lshlrev_b32 v7, 5, v0
    v_min_u32 v7, 0xe4, v7
    v_cmp_eq_u32 vcc, 9, v0
    s_nop 1
    v_cndmask_b32 v6, 0, 4, vcc
    v_add_u32 v7, v7, v6
    buffer_load_dword v6, v7, s[8:11], 0 offen sc1
    v_mfma_f32_16x16x32_bf16 v[76:79], a[176:179], v[40:43], v[76:79]
    v_mfma_f32_16x16x32_bf16 v[84:87], a[180:183], v[40:43], v[84:87]
    s_waitcnt lgkmcnt(0)
    s_barrier
    ds_read_b64_tr_b16 a[192:193], v14 offset:0
    ds_read_b64_tr_b16 a[194:195], v14 offset:1024
    ds_read_b64_tr_b16 a[196:197], v15 offset:0
    ds_read_b64_tr_b16 a[198:199], v15 offset:1024
    ds_read_b128 v[28:31], v2 offset:1152
    ds_read_b128 v[32:35], v2 offset:34176
    ds_read_b128 v[36:39], v16 offset:1152
    ds_read_b128 v[40:43], v16 offset:34176
    v_mfma_f32_16x16x32_bf16 v[44:47], a[184:187], v[88:91], v[44:47]
    s_waitcnt vmcnt(13)
    ds_write_b128 v13, a[200:203] offset:8192
    v_mfma_f32_16x16x32_bf16 v[52:55], a[188:191], v[88:91], v[52:55]
    ds_write_b128 v13, a[204:207] offset:9216
    v_mfma_f32_16x16x32_bf16 v[48:51], a[184:187], v[92:95], v[48:51]
    s_add_u32 m0, s39, 12384
    s_add_u32 s45, s38, 143360
    buffer_load_dwordx4 v1, s[16:19], s45 offen offset:0 lds
    v_mfma_f32_16x16x32_bf16 v[56:59], a[188:191], v[92:95], v[56:59]
    s_add_u32 s46, s47, 0x4e0000
    buffer_load_dwordx4 a[240:243], v12, s[12:15], s46 offen nt
    v_mfma_f32_16x16x32_bf16 v[72:75], a[184:187], v[96:99], v[72:75]
    s_add_u32 s46, s47, 0x4e8000
    buffer_load_dwordx4 a[244:247], v12, s[12:15], s46 offen nt
    v_mfma_f32_16x16x32_bf16 v[80:83], a[188:191], v[96:99], v[80:83]
    v_mfma_f32_16x16x32_bf16 v[76:79], a[184:187], v[100:103], v[76:79]
    v_mfma_f32_16x16x32_bf16 v[84:87], a[188:191], v[100:103], v[84:87]
    s_waitcnt lgkmcnt(0)
    s_barrier
    ds_read_b64_tr_b16 a[200:201], v14 offset:8192
    ds_read_b64_tr_b16 a[202:203], v14 offset:9216
    ds_read_b64_tr_b16 a[204:205], v15 offset:8192
    ds_read_b64_tr_b16 a[206:207], v15 offset:9216
    ds_read_b128 v[88:91], v2 offset:1168
    ds_read_b128 v[92:95], v2 offset:34192
    ds_read_b128 v[96:99], v16 offset:1168
    ds_read_b128 v[100:103], v16 offset:34192
    v_mfma_f32_16x16x32_bf16 v[44:47], a[192:195], v[28:31], v[44:47]
    s_waitcnt vmcnt(13)
    ds_write_b128 v13, a[208:211] offset:0
    v_mfma_f32_16x16x32_bf16 v[52:55], a[196:199], v[28:31], v[52:55]
    ds_write_b128 v13, a[212:215] offset:1024
    v_mfma_f32_16x16x32_bf16 v[48:51], a[192:195], v[32:35], v[48:51]
    s_add_u32 m0, s39, 14448
    s_add_u32 s45, s38, 145408
    buffer_load_dwordx4 v1, s[16:19], s45 offen offset:0 lds
    v_mfma_f32_16x16x32_bf16 v[56:59], a[196:199], v[32:35], v[56:59]
    s_add_u32 s46, s47, 0x4f0000
    buffer_load_dwordx4 a[248:251], v12, s[12:15], s46 offen nt
    v_mfma_f32_16x16x32_bf16 v[72:75], a[192:195], v[36:39], v[72:75]
    s_add_u32 s46, s47, 0x4f8000
    buffer_load_dwordx4 a[252:255], v12, s[12:15], s46 offen nt
    v_mfma_f32_16x16x32_bf16 v[80:83], a[196:199], v[36:39], v[80:83]
    v_mfma_f32_16x16x32_bf16 v[76:79], a[192:195], v[40:43], v[76:79]
    v_mfma_f32_16x16x32_bf16 v[84:87], a[196:199], v[40:43], v[84:87]
    s_waitcnt lgkmcnt(0)
    s_barrier
    ds_read_b64_tr_b16 a[208:209], v14 offset:0
    ds_read_b64_tr_b16 a[210:211], v14 offset:1024
    ds_read_b64_tr_b16 a[212:213], v15 offset:0
    ds_read_b64_tr_b16 a[214:215], v15 offset:1024
    ds_read_b128 v[28:31], v2 offset:1184
    ds_read_b128 v[32:35], v2 offset:34208
    ds_read_b128 v[36:39], v16 offset:1184
    ds_read_b128 v[40:43], v16 offset:34208
    v_mfma_f32_16x16x32_bf16 v[44:47], a[200:203], v[88:91], v[44:47]
    s_waitcnt vmcnt(13)
    ds_write_b128 v13, a[216:219] offset:8192
    v_mfma_f32_16x16x32_bf16 v[52:55], a[204:207], v[88:91], v[52:55]
    ds_write_b128 v13, a[220:223] offset:9216
    v_mfma_f32_16x16x32_bf16 v[48:51], a[200:203], v[92:95], v[48:51]
    v_mfma_f32_16x16x32_bf16 v[56:59], a[204:207], v[92:95], v[56:59]
    v_mfma_f32_16x16x32_bf16 v[72:75], a[200:203], v[96:99], v[72:75]
    v_mfma_f32_16x16x32_bf16 v[80:83], a[204:207], v[96:99], v[80:83]
    v_mfma_f32_16x16x32_bf16 v[76:79], a[200:203], v[100:103], v[76:79]
    v_mfma_f32_16x16x32_bf16 v[84:87], a[204:207], v[100:103], v[84:87]
    s_waitcnt lgkmcnt(0)
    s_barrier
    ds_read_b64_tr_b16 a[216:217], v14 offset:8192
    ds_read_b64_tr_b16 a[218:219], v14 offset:9216
    ds_read_b64_tr_b16 a[220:221], v15 offset:8192
    ds_read_b64_tr_b16 a[222:223], v15 offset:9216
    ds_read_b128 v[88:91], v2 offset:1200
    ds_read_b128 v[92:95], v2 offset:34224
    ds_read_b128 v[96:99], v16 offset:1200
    ds_read_b128 v[100:103], v16 offset:34224
    v_mfma_f32_16x16x32_bf16 v[44:47], a[208:211], v[28:31], v[44:47]
    s_waitcnt vmcnt(10)
    ds_write_b128 v13, a[224:227] offset:0
    v_mfma_f32_16x16x32_bf16 v[52:55], a[212:215], v[28:31], v[52:55]
    ds_write_b128 v13, a[228:231] offset:1024
    v_mfma_f32_16x16x32_bf16 v[48:51], a[208:211], v[32:35], v[48:51]
    v_mfma_f32_16x16x32_bf16 v[56:59], a[212:215], v[32:35], v[56:59]
    v_mfma_f32_16x16x32_bf16 v[72:75], a[208:211], v[36:39], v[72:75]
    v_mfma_f32_16x16x32_bf16 v[80:83], a[212:215], v[36:39], v[80:83]
    v_mfma_f32_16x16x32_bf16 v[76:79], a[208:211], v[40:43], v[76:79]
    v_mfma_f32_16x16x32_bf16 v[84:87], a[212:215], v[40:43], v[84:87]
    s_waitcnt lgkmcnt(0)
    s_barrier
    ds_read_b64_tr_b16 a[224:225], v14 offset:0
    ds_read_b64_tr_b16 a[226:227], v14 offset:1024
    ds_read_b64_tr_b16 a[228:229], v15 offset:0
    ds_read_b64_tr_b16 a[230:231], v15 offset:1024
    ds_read_b128 v[28:31], v2 offset:1216
    ds_read_b128 v[32:35], v2 offset:34240
    ds_read_b128 v[36:39], v16 offset:1216
    ds_read_b128 v[40:43], v16 offset:34240
    v_mfma_f32_16x16x32_bf16 v[44:47], a[216:219], v[88:91], v[44:47]
    s_waitcnt vmcnt(7)
    ds_write_b128 v13, a[232:235] offset:8192
    v_mfma_f32_16x16x32_bf16 v[52:55], a[220:223], v[88:91], v[52:55]
    ds_write_b128 v13, a[236:239] offset:9216
    v_mfma_f32_16x16x32_bf16 v[48:51], a[216:219], v[92:95], v[48:51]
    v_mfma_f32_16x16x32_bf16 v[56:59], a[220:223], v[92:95], v[56:59]
    v_mfma_f32_16x16x32_bf16 v[72:75], a[216:219], v[96:99], v[72:75]
    v_mfma_f32_16x16x32_bf16 v[80:83], a[220:223], v[96:99], v[80:83]
    v_mfma_f32_16x16x32_bf16 v[76:79], a[216:219], v[100:103], v[76:79]
    v_mfma_f32_16x16x32_bf16 v[84:87], a[220:223], v[100:103], v[84:87]
    s_waitcnt lgkmcnt(0)
    s_barrier
    ds_read_b64_tr_b16 a[232:233], v14 offset:8192
    ds_read_b64_tr_b16 a[234:235], v14 offset:9216
    ds_read_b64_tr_b16 a[236:237], v15 offset:8192
    ds_read_b64_tr_b16 a[238:239], v15 offset:9216
    ds_read_b128 v[88:91], v2 offset:1232
    ds_read_b128 v[92:95], v2 offset:34256
    ds_read_b128 v[96:99], v16 offset:1232
    ds_read_b128 v[100:103], v16 offset:34256
    v_mfma_f32_16x16x32_bf16 v[44:47], a[224:227], v[28:31], v[44:47]
    s_waitcnt vmcnt(3)
    ds_write_b128 v13, a[240:243] offset:0
    v_mfma_f32_16x16x32_bf16 v[52:55], a[228:231], v[28:31], v[52:55]
    ds_write_b128 v13, a[244:247] offset:1024
    v_mfma_f32_16x16x32_bf16 v[48:51], a[224:227], v[32:35], v[48:51]
    v_mfma_f32_16x16x32_bf16 v[56:59], a[228:231], v[32:35], v[56:59]
    v_mfma_f32_16x16x32_bf16 v[72:75], a[224:227], v[36:39], v[72:75]
    v_mfma_f32_16x16x32_bf16 v[80:83], a[228:231], v[36:39], v[80:83]
    v_mfma_f32_16x16x32_bf16 v[76:79], a[224:227], v[40:43], v[76:79]
    v_mfma_f32_16x16x32_bf16 v[84:87], a[228:231], v[40:43], v[84:87]
    s_branch L_wi_13
L_wi_11:
    v_lshlrev_b32 v7, 5, v0
    v_min_u32 v7, 0xe4, v7
    v_cmp_eq_u32 vcc, 9, v0
    s_nop 1
    v_cndmask_b32 v6, 0, 4, vcc
    v_add_u32 v7, v7, v6
    buffer_load_dword v6, v7, s[8:11], 0 offen sc1
    s_waitcnt vmcnt(0)
L_wi_13:
    v_bcnt_u32_b32 v7, v6, 0
    s_nop 0
    v_readlane_b32 s45, v7, 0
    v_readlane_b32 s46, v7, 1
    s_nop 0
    s_add_u32 s45, s45, s46
    v_readlane_b32 s46, v7, 2
    s_nop 0
    s_add_u32 s45, s45, s46
    v_readlane_b32 s46, v7, 3
    s_nop 0
    s_add_u32 s45, s45, s46
    v_readlane_b32 s46, v7, 4
    s_nop 0
    s_add_u32 s45, s45, s46
    v_readlane_b32 s46, v7, 5
    s_nop 0
    s_add_u32 s45, s45, s46
    v_readlane_b32 s46, v7, 6
    s_nop 0
    s_add_u32 s45, s45, s46
    v_readlane_b32 s46, v7, 7
    s_nop 0
    s_add_u32 s45, s45, s46
    v_readlane_b32 s46, v6, 9
    s_nop 0
    s_add_u32 s45, s45, s46
    v_readlane_b32 s62, v6, 8
    s_nop 0
    s_lshr_b32 s46, s62, 16
    s_add_u32 s45, s45, s46
    s_cmp_ge_u32 s45, 272
    s_cbranch_scc1 L_wiok_12
    s_sleep 8
    s_sub_u32 s35, s35, 1
    s_cbranch_scc0 L_wi_11
    s_endpgm
L_wiok_12:
    s_and_b32 s62, s62, 0xffff
    s_cmp_gt_u32 s62, 8
    s_cselect_b32 s62, 0x2000, 0
    s_lshr_b32 s45, s63, 5
    v_readlane_b32 s101, v7, s45
    s_lshr_b32 s45, s41, 8
    s_xor_b32 s45, s45, s62
    s_and_b32 s45, s45, 0x2000
    s_xor_b32 s41, s41, s45
    s_lshr_b32 s45, s42, 8
    s_xor_b32 s45, s45, s62
    s_and_b32 s45, s45, 0x2000
    s_xor_b32 s42, s42, s45
    s_lshr_b32 s45, s48, 8
    s_xor_b32 s45, s45, s62
    s_and_b32 s45, s45, 0x2000
    s_xor_b32 s48, s48, s45
    s_lshr_b32 s45, s43, 8
    s_xor_b32 s45, s45, s62
    s_and_b32 s45, s45, 0x2000
    s_xor_b32 s43, s43, s45
    s_waitcnt lgkmcnt(0)
    s_barrier
    ds_read_b64_tr_b16 a[240:241], v14 offset:0
    ds_read_b64_tr_b16 a[242:243], v14 offset:1024
    ds_read_b64_tr_b16 a[244:245], v15 offset:0
    ds_read_b64_tr_b16 a[246:247], v15 offset:1024
    ds_read_b128 v[28:31], v2 offset:1248
    ds_read_b128 v[32:35], v2 offset:34272
    ds_read_b128 v[36:39], v16 offset:1248
    ds_read_b128 v[40:43], v16 offset:34272
    v_mfma_f32_16x16x32_bf16 v[44:47], a[232:235], v[88:91], v[44:47]
    s_waitcnt vmcnt(0)
    ds_write_b128 v13, a[248:251] offset:8192
    v_mfma_f32_16x16x32_bf16 v[52:55], a[236:239], v[88:91], v[52:55]
    ds_write_b128 v13, a[252:255] offset:9216
    v_mfma_f32_16x16x32_bf16 v[48:51], a[232:235], v[92:95], v[48:51]
    v_mfma_f32_16x16x32_bf16 v[56:59], a[236:239], v[92:95], v[56:59]
    v_mfma_f32_16x16x32_bf16 v[72:75], a[232:235], v[96:99], v[72:75]
    v_mfma_f32_16x16x32_bf16 v[80:83], a[236:239], v[96:99], v[80:83]
    v_mfma_f32_16x16x32_bf16 v[76:79], a[232:235], v[100:103], v[76:79]
    v_mfma_f32_16x16x32_bf16 v[84:87], a[236:239], v[100:103], v[84:87]
    s_waitcnt lgkmcnt(0)
    s_barrier
    ds_read_b64_tr_b16 a[248:249], v14 offset:8192
    ds_read_b64_tr_b16 a[250:251], v14 offset:9216
    ds_read_b64_tr_b16 a[252:253], v15 offset:8192
    ds_read_b64_tr_b16 a[254:255], v15 offset:9216
    ds_read_b128 v[88:91], v2 offset:1264
    ds_read_b128 v[92:95], v2 offset:34288
    ds_read_b128 v[96:99], v16 offset:1264
    ds_read_b128 v[100:103], v16 offset:34288
    v_mfma_f32_16x16x32_bf16 v[44:47], a[240:243], v[28:31], v[44:47]
    v_mfma_f32_16x16x32_bf16 v[52:55], a[244:247], v[28:31], v[52:55]
    v_mfma_f32_16x16x32_bf16 v[48:51], a[240:243], v[32:35], v[48:51]
    v_mfma_f32_16x16x32_bf16 v[56:59], a[244:247], v[32:35], v[56:59]
    v_mfma_f32_16x16x32_bf16 v[72:75], a[240:243], v[36:39], v[72:75]
    v_mfma_f32_16x16x32_bf16 v[80:83], a[244:247], v[36:39], v[80:83]
    v_mfma_f32_16x16x32_bf16 v[76:79], a[240:243], v[40:43], v[76:79]
    v_mfma_f32_16x16x32_bf16 v[84:87], a[244:247], v[40:43], v[84:87]
    s_waitcnt lgkmcnt(0)
    v_mfma_f32_16x16x32_bf16 v[44:47], a[248:251], v[88:91], v[44:47]
    v_mfma_f32_16x16x32_bf16 v[52:55], a[252:255], v[88:91], v[52:55]
    v_mfma_f32_16x16x32_bf16 v[48:51], a[248:251], v[92:95], v[48:51]
    v_mfma_f32_16x16x32_bf16 v[56:59], a[252:255], v[92:95], v[56:59]
    v_mfma_f32_16x16x32_bf16 v[72:75], a[248:251], v[96:99], v[72:75]
    v_mfma_f32_16x16x32_bf16 v[80:83], a[252:255], v[96:99], v[80:83]
    v_mfma_f32_16x16x32_bf16 v[76:79], a[248:251], v[100:103], v[76:79]
    v_mfma_f32_16x16x32_bf16 v[84:87], a[252:255], v[100:103], v[84:87]
    s_add_u32 s38, s38, 0x20000
    s_mov_b32 s37, 0
    s_barrier
    s_add_u32 s44, s44, 0x20000
    v_cvt_pk_bf16_f32 v60, v44, v52
    v_cvt_pk_bf16_f32 v61, v45, v53
    v_cvt_pk_bf16_f32 v62, v46, v54
    v_cvt_pk_bf16_f32 v63, v47, v55
    v_cvt_pk_bf16_f32 v64, v48, v56
    v_cvt_pk_bf16_f32 v65, v49, v57
    v_cvt_pk_bf16_f32 v66, v50, v58
    v_cvt_pk_bf16_f32 v67, v51, v59
    s_add_u32 s46, s41, 4096
    buffer_store_dwordx4 v[60:63], v1, s[4:7], s41 offen offset:0 sc1
    buffer_store_dwordx4 v[64:67], v1, s[4:7], s46 offen offset:0 sc1
    s_add_u32 s41, s41, 0x4000
    v_mfma_f32_16x16x32_bf16 v[116:119], v[60:63], v[108:111], 0
    v_mfma_f32_16x16x32_bf16 v[120:123], v[64:67], v[108:111], 0
    v_mfma_f32_16x16x32_bf16 v[124:127], v[60:63], v[112:115], 0
    v_mfma_f32_16x16x32_bf16 v[128:131], v[64:67], v[112:115], 0
    v_cvt_pk_bf16_f32 v132, v116, v117
    v_cvt_pk_bf16_f32 v133, v118, v119
    v_cvt_pk_bf16_f32 v134, v120, v121
    v_cvt_pk_bf16_f32 v135, v122, v123
    v_cvt_pk_bf16_f32 v136, v124, v125
    v_cvt_pk_bf16_f32 v137, v126, v127
    s_nop 0
    v_cvt_pk_bf16_f32 v138, v128, v129
    v_cvt_pk_bf16_f32 v139, v130, v131
    buffer_store_dwordx4 v[132:135], v1, s[4:7], s42 offen offset:0 sc1
    buffer_store_dwordx4 v[136:139], v1, s[4:7], s42 offen offset:1024 sc1
    s_add_u32 s42, s42, 0x4000
    v_cvt_pk_bf16_f32 v60, v72, v80
    v_cvt_pk_bf16_f32 v61, v73, v81
    v_cvt_pk_bf16_f32 v62, v74, v82
    v_cvt_pk_bf16_f32 v63, v75, v83
    v_cvt_pk_bf16_f32 v64, v76, v84
    v_cvt_pk_bf16_f32 v65, v77, v85
    v_cvt_pk_bf16_f32 v66, v78, v86
    v_cvt_pk_bf16_f32 v67, v79, v87
    v_mfma_f32_16x16x32_bf16 v[116:119], v[60:63], v[108:111], 0
    v_mfma_f32_16x16x32_bf16 v[120:123], v[64:67], v[108:111], 0
    v_mfma_f32_16x16x32_bf16 v[124:127], v[60:63], v[112:115], 0
    v_mfma_f32_16x16x32_bf16 v[128:131], v[64:67], v[112:115], 0
    v_cvt_pk_bf16_f32 v132, v116, v117
    v_cvt_pk_bf16_f32 v133, v118, v119
    v_cvt_pk_bf16_f32 v134, v120, v121
    v_cvt_pk_bf16_f32 v135, v122, v123
    v_cvt_pk_bf16_f32 v136, v124, v125
    v_cvt_pk_bf16_f32 v137, v126, v127
    s_nop 0
    v_cvt_pk_bf16_f32 v138, v128, v129
    v_cvt_pk_bf16_f32 v139, v130, v131
    s_add_u32 s46, s41, 4096
    buffer_store_dwordx4 v[60:63], v1, s[4:7], s41 offen offset:0 sc1
    buffer_store_dwordx4 v[64:67], v1, s[4:7], s46 offen offset:0 sc1
    s_add_u32 s41, s41, 0x4000
    buffer_store_dwordx4 v[132:135], v1, s[4:7], s42 offen offset:0 sc1
    buffer_store_dwordx4 v[136:139], v1, s[4:7], s42 offen offset:1024 sc1
    s_add_u32 s42, s42, 0x4000
    v_mov_b32 v9, 1
    ds_read_b128 v[12:15], v2 offset:0
    ds_read_b128 v[16:19], v2 offset:33024
    ds_read_b128 v[20:23], v2 offset:16
    ds_read_b128 v[24:27], v2 offset:33040
    ds_read_b128 v[28:31], v2 offset:32
    ds_read_b128 v[32:35], v2 offset:33056
    s_waitcnt lgkmcnt(4)
    v_mfma_f32_16x16x32_bf16 v[44:47], a[0:3], v[12:15], 0
    ds_read_b128 v[36:39], v2 offset:48
    s_add_u32 m0, s39, 0
    s_add_u32 s45, s38, 0
    v_mfma_f32_16x16x32_bf16 v[52:55], a[4:7], v[12:15], 0
    buffer_load_dwordx4 v1, s[16:19], s45 offen offset:1024 lds
    v_mfma_f32_16x16x32_bf16 v[48:51], a[0:3], v[16:19], 0
    ds_read_b128 v[40:43], v2 offset:33072
    v_mfma_f32_16x16x32_bf16 v[56:59], a[4:7], v[16:19], 0
    s_waitcnt lgkmcnt(4)
    v_mfma_f32_16x16x32_bf16 v[44:47], a[8:11], v[20:23], v[44:47]
    ds_read_b128 v[12:15], v2 offset:64
    s_add_u32 m0, s39, 2064
    s_add_u32 s45, s38, 2048
    v_mfma_f32_16x16x32_bf16 v[52:55], a[12:15], v[20:23], v[52:55]
    buffer_load_dwordx4 v1, s[16:19], s45 offen offset:1024 lds
    v_mfma_f32_16x16x32_bf16 v[48:51], a[8:11], v[24:27], v[48:51]
    ds_read_b128 v[16:19], v2 offset:33088
    v_mfma_f32_16x16x32_bf16 v[56:59], a[12:15], v[24:27], v[56:59]
    s_waitcnt lgkmcnt(4)
    v_mfma_f32_16x16x32_bf16 v[44:47], a[16:19], v[28:31], v[44:47]
    ds_read_b128 v[20:23], v2 offset:80
    s_add_u32 m0, s39, 4128
    s_add_u32 s45, s38, 4096
    v_mfma_f32_16x16x32_bf16 v[52:55], a[20:23], v[28:31], v[52:55]
    buffer_load_dwordx4 v1, s[16:19], s45 offen offset:1024 lds
    v_mfma_f32_16x16x32_bf16 v[48:51], a[16:19], v[32:35], v[48:51]
    ds_read_b128 v[24:27], v2 offset:33104
    v_mfma_f32_16x16x32_bf16 v[56:59], a[20:23], v[32:35], v[56:59]
    s_waitcnt lgkmcnt(4)
    v_mfma_f32_16x16x32_bf16 v[44:47], a[24:27], v[36:39], v[44:47]
    ds_read_b128 v[28:31], v2 offset:96
    s_add_u32 m0, s39, 6192
    s_add_u32 s45, s38, 6144
    v_mfma_f32_16x16x32_bf16 v[52:55], a[28:31], v[36:39], v[52:55]
    buffer_load_dwordx4 v1, s[16:19], s45 offen offset:1024 lds
    v_mfma_f32_16x16x32_bf16 v[48:51], a[24:27], v[40:43], v[48:51]
    ds_read_b128 v[32:35], v2 offset:33120
    v_mfma_f32_16x16x32_bf16 v[56:59], a[28:31], v[40:43], v[56:59]
    s_waitcnt lgkmcnt(4)
    v_mfma_f32_16x16x32_bf16 v[44:47], a[32:35], v[12:15], v[44:47]
    ds_read_b128 v[36:39], v2 offset:112
    s_add_u32 m0, s39, 8256
    s_add_u32 s45, s38, 8192
    v_mfma_f32_16x16x32_bf16 v[52:55], a[36:39], v[12:15], v[52:55]
    buffer_load_dwordx4 v1, s[16:19], s45 offen offset:1024 lds
    v_mfma_f32_16x16x32_bf16 v[48:51], a[32:35], v[16:19], v[48:51]
    ds_read_b128 v[40:43], v2 offset:33136
    v_mfma_f32_16x16x32_bf16 v[56:59], a[36:39], v[16:19], v[56:59]
    s_waitcnt lgkmcnt(4)
    s_waitcnt vmcnt(11)
    s_barrier
    buffer_store_dword v9, v4, s[4:7], 0 offen sc1
    v_mfma_f32_16x16x32_bf16 v[44:47], a[40:43], v[20:23], v[44:47]
    ds_read_b128 v[12:15], v2 offset:128
    s_add_u32 m0, s39, 10320
    s_add_u32 s45, s38, 10240
    v_mfma_f32_16x16x32_bf16 v[52:55], a[44:47], v[20:23], v[52:55]
    buffer_load_dwordx4 v1, s[16:19], s45 offen offset:1024 lds
    v_mfma_f32_16x16x32_bf16 v[48:51], a[40:43], v[24:27], v[48:51]
    ds_read_b128 v[16:19], v2 offset:33152
    v_mfma_f32_16x16x32_bf16 v[56:59], a[44:47], v[24:27], v[56:59]
    s_waitcnt lgkmcnt(4)
    v_mfma_f32_16x16x32_bf16 v[44:47], a[48:51], v[28:31], v[44:47]
    ds_read_b128 v[20:23], v2 offset:144
    s_add_u32 m0, s39, 12384
    s_add_u32 s45, s38, 12288
    v_mfma_f32_16x16x32_bf16 v[52:55], a[52:55], v[28:31], v[52:55]
    buffer_load_dwordx4 v1, s[16:19], s45 offen offset:1024 lds
    v_mfma_f32_16x16x32_bf16 v[48:51], a[48:51], v[32:35], v[48:51]
    ds_read_b128 v[24:27], v2 offset:33168
    v_mfma_f32_16x16x32_bf16 v[56:59], a[52:55], v[32:35], v[56:59]
    s_waitcnt lgkmcnt(4)
    v_mfma_f32_16x16x32_bf16 v[44:47], a[56:59], v[36:39], v[44:47]
    ds_read_b128 v[28:31], v2 offset:160
    s_add_u32 m0, s39, 14448
    s_add_u32 s45, s38, 14336
    v_mfma_f32_16x16x32_bf16 v[52:55], a[60:63], v[36:39], v[52:55]
    buffer_load_dwordx4 v1, s[16:19], s45 offen offset:1024 lds
    v_mfma_f32_16x16x32_bf16 v[48:51], a[56:59], v[40:43], v[48:51]
    ds_read_b128 v[32:35], v2 offset:33184
    v_mfma_f32_16x16x32_bf16 v[56:59], a[60:63], v[40:43], v[56:59]
    s_waitcnt lgkmcnt(4)
    v_mfma_f32_16x16x32_bf16 v[44:47], a[64:67], v[12:15], v[44:47]
    ds_read_b128 v[36:39], v2 offset:176
    v_mfma_f32_16x16x32_bf16 v[52:55], a[68:71], v[12:15], v[52:55]
    s_sub_u32 s39, s40, s39
    s_add_u32 s38, s38, 0x10000
    v_mov_b32 v9, 2
    v_mfma_f32_16x16x32_bf16 v[48:51], a[64:67], v[16:19], v[48:51]
    ds_read_b128 v[40:43], v2 offset:33200
    v_mfma_f32_16x16x32_bf16 v[56:59], a[68:71], v[16:19], v[56:59]
    s_waitcnt lgkmcnt(4)
    v_mfma_f32_16x16x32_bf16 v[44:47], a[72:75], v[20:23], v[44:47]
    ds_read_b128 v[12:15], v2 offset:192
    v_mfma_f32_16x16x32_bf16 v[52:55], a[76:79], v[20:23], v[52:55]
    v_mfma_f32_16x16x32_bf16 v[48:51], a[72:75], v[24:27], v[48:51]
    ds_read_b128 v[16:19], v2 offset:33216
    v_mfma_f32_16x16x32_bf16 v[56:59], a[76:79], v[24:27], v[56:59]
    s_waitcnt lgkmcnt(4)
    v_mfma_f32_16x16x32_bf16 v[44:47], a[80:83], v[28:31], v[44:47]
    ds_read_b128 v[20:23], v2 offset:208
    v_mfma_f32_16x16x32_bf16 v[52:55], a[84:87], v[28:31], v[52:55]
    v_mfma_f32_16x16x32_bf16 v[48:51], a[80:83], v[32:35], v[48:51]
    ds_read_b128 v[24:27], v2 offset:33232
    v_mfma_f32_16x16x32_bf16 v[56:59], a[84:87], v[32:35], v[56:59]
    s_waitcnt lgkmcnt(4)
    v_mfma_f32_16x16x32_bf16 v[44:47], a[88:91], v[36:39], v[44:47]
    ds_read_b128 v[28:31], v2 offset:224
    v_mfma_f32_16x16x32_bf16 v[52:55], a[92:95], v[36:39], v[52:55]
    v_mfma_f32_16x16x32_bf16 v[48:51], a[88:91], v[40:43], v[48:51]
    ds_read_b128 v[32:35], v2 offset:33248
    v_mfma_f32_16x16x32_bf16 v[56:59], a[92:95], v[40:43], v[56:59]
    s_waitcnt lgkmcnt(4)
    v_mfma_f32_16x16x32_bf16 v[44:47], a[96:99], v[12:15], v[44:47]
    ds_read_b128 v[36:39], v2 offset:240
    v_mfma_f32_16x16x32_bf16 v[52:55], a[100:103], v[12:15], v[52:55]
    v_mfma_f32_16x16x32_bf16 v[48:51], a[96:99], v[16:19], v[48:51]
    ds_read_b128 v[40:43], v2 offset:33264
    v_mfma_f32_16x16x32_bf16 v[56:59], a[100:103], v[16:19], v[56:59]
    s_waitcnt lgkmcnt(4)
    s_waitcnt vmcnt(0)
    s_barrier
    buffer_store_dword v9, v4, s[4:7], 0 offen sc1
    v_mfma_f32_16x16x32_bf16 v[44:47], a[104:107], v[20:23], v[44:47]
    ds_read_b128 v[12:15], v2 offset:1024
    s_add_u32 m0, s39, 0
    s_add_u32 s45, s38, 0
    v_mfma_f32_16x16x32_bf16 v[52:55], a[108:111], v[20:23], v[52:55]
    buffer_load_dwordx4 v1, s[16:19], s45 offen lds
    v_mfma_f32_16x16x32_bf16 v[48:51], a[104:107], v[24:27], v[48:51]
    ds_read_b128 v[16:19], v2 offset:34048
    v_mfma_f32_16x16x32_bf16 v[56:59], a[108:111], v[24:27], v[56:59]
    s_waitcnt lgkmcnt(4)
    v_mfma_f32_16x16x32_bf16 v[44:47], a[112:115], v[28:31], v[44:47]
    ds_read_b128 v[20:23], v2 offset:1040
    v_mfma_f32_16x16x32_bf16 v[52:55], a[116:119], v[28:31], v[52:55]
    buffer_load_dwordx4 v1, s[16:19], s45 offen offset:1024 lds
    v_mfma_f32_16x16x32_bf16 v[48:51], a[112:115], v[32:35], v[48:51]
    ds_read_b128 v[24:27], v2 offset:34064
    v_mfma_f32_16x16x32_bf16 v[56:59], a[116:119], v[32:35], v[56:59]
    s_waitcnt lgkmcnt(4)
    v_mfma_f32_16x16x32_bf16 v[44:47], a[120:123], v[36:39], v[44:47]
    ds_read_b128 v[28:31], v2 offset:1056
    s_add_u32 m0, s39, 2064
    s_add_u32 s45, s38, 2048
    v_mfma_f32_16x16x32_bf16 v[52:55], a[124:127], v[36:39], v[52:55]
    buffer_load_dwordx4 v1, s[16:19], s45 offen lds
    v_mfma_f32_16x16x32_bf16 v[48:51], a[120:123], v[40:43], v[48:51]
    ds_read_b128 v[32:35], v2 offset:34080
    v_mfma_f32_16x16x32_bf16 v[56:59], a[124:127], v[40:43], v[56:59]
    s_waitcnt lgkmcnt(4)
    v_mfma_f32_16x16x32_bf16 v[44:47], a[128:131], v[12:15], v[44:47]
    ds_read_b128 v[36:39], v2 offset:1072
    v_mfma_f32_16x16x32_bf16 v[52:55], a[132:135], v[12:15], v[52:55]
    buffer_load_dwordx4 v1, s[16:19], s45 offen offset:1024 lds
    v_mfma_f32_16x16x32_bf16 v[48:51], a[128:131], v[16:19], v[48:51]
    ds_read_b128 v[40:43], v2 offset:34096
    v_mfma_f32_16x16x32_bf16 v[56:59], a[132:135], v[16:19], v[56:59]
    s_waitcnt lgkmcnt(4)
    v_mfma_f32_16x16x32_bf16 v[44:47], a[136:139], v[20:23], v[44:47]
    ds_read_b128 v[12:15], v2 offset:1088
    s_add_u32 m0, s39, 4128
    s_add_u32 s45, s38, 4096
    v_mfma_f32_16x16x32_bf16 v[52:55], a[140:143], v[20:23], v[52:55]
    buffer_load_dwordx4 v1, s[16:19], s45 offen lds
    v_mfma_f32_16x16x32_bf16 v[48:51], a[136:139], v[24:27], v[48:51]
    ds_read_b128 v[16:19], v2 offset:34112
    v_mfma_f32_16x16x32_bf16 v[56:59], a[140:143], v[24:27], v[56:59]
    s_waitcnt lgkmcnt(4)
    v_mfma_f32_16x16x32_bf16 v[44:47], a[144:147], v[28:31], v[44:47]
    ds_read_b128 v[20:23], v2 offset:1104
    v_mfma_f32_16x16x32_bf16 v[52:55], a[148:151], v[28:31], v[52:55]
    buffer_load_dwordx4 v1, s[16:19], s45 offen offset:1024 lds
    v_mfma_f32_16x16x32_bf16 v[48:51], a[144:147], v[32:35], v[48:51]
    ds_read_b128 v[24:27], v2 offset:34128
    v_mfma_f32_16x16x32_bf16 v[56:59], a[148:151], v[32:35], v[56:59]
    s_waitcnt lgkmcnt(4)
    v_mfma_f32_16x16x32_bf16 v[44:47], a[152:155], v[36:39], v[44:47]
    ds_read_b128 v[28:31], v2 offset:1120
    s_add_u32 m0, s39, 6192
    s_add_u32 s45, s38, 6144
    v_mfma_f32_16x16x32_bf16 v[52:55], a[156:159], v[36:39], v[52:55]
    buffer_load_dwordx4 v1, s[16:19], s45 offen lds
    v_mfma_f32_16x16x32_bf16 v[48:51], a[152:155], v[40:43], v[48:51]
    ds_read_b128 v[32:35], v2 offset:34144
    v_mfma_f32_16x16x32_bf16 v[56:59], a[156:159], v[40:43], v[56:59]
    s_waitcnt lgkmcnt(4)
    v_mfma_f32_16x16x32_bf16 v[44:47], a[160:163], v[12:15], v[44:47]
    ds_read_b128 v[36:39], v2 offset:1136
    v_mfma_f32_16x16x32_bf16 v[52:55], a[164:167], v[12:15], v[52:55]
    buffer_load_dwordx4 v1, s[16:19], s45 offen offset:1024 lds
    v_mfma_f32_16x16x32_bf16 v[48:51], a[160:163], v[16:19], v[48:51]
    ds_read_b128 v[40:43], v2 offset:34160
    v_mfma_f32_16x16x32_bf16 v[56:59], a[164:167], v[16:19], v[56:59]
    s_waitcnt lgkmcnt(4)
    v_mfma_f32_16x16x32_bf16 v[44:47], a[168:171], v[20:23], v[44:47]
    ds_read_b128 v[12:15], v2 offset:1152
    s_add_u32 m0, s39, 8256
    s_add_u32 s45, s38, 8192
    v_mfma_f32_16x16x32_bf16 v[52:55], a[172:175], v[20:23], v[52:55]
    buffer_load_dwordx4 v1, s[16:19], s45 offen lds
    v_mfma_f32_16x16x32_bf16 v[48:51], a[168:171], v[24:27], v[48:51]
    ds_read_b128 v[16:19], v2 offset:34176
    v_mfma_f32_16x16x32_bf16 v[56:59], a[172:175], v[24:27], v[56:59]
    s_waitcnt lgkmcnt(4)
    v_mfma_f32_16x16x32_bf16 v[44:47], a[176:179], v[28:31], v[44:47]
    ds_read_b128 v[20:23], v2 offset:1168
    v_mfma_f32_16x16x32_bf16 v[52:55], a[180:183], v[28:31], v[52:55]
    buffer_load_dwordx4 v1, s[16:19], s45 offen offset:1024 lds
    v_mfma_f32_16x16x32_bf16 v[48:51], a[176:179], v[32:35], v[48:51]
    ds_read_b128 v[24:27], v2 offset:34192
    v_mfma_f32_16x16x32_bf16 v[56:59], a[180:183], v[32:35], v[56:59]
    s_waitcnt lgkmcnt(4)
    v_mfma_f32_16x16x32_bf16 v[44:47], a[184:187], v[36:39], v[44:47]
    ds_read_b128 v[28:31], v2 offset:1184
    s_add_u32 m0, s39, 10320
    s_add_u32 s45, s38, 10240
    v_mfma_f32_16x16x32_bf16 v[52:55], a[188:191], v[36:39], v[52:55]
    buffer_load_dwordx4 v1, s[16:19], s45 offen lds
    v_mfma_f32_16x16x32_bf16 v[48:51], a[184:187], v[40:43], v[48:51]
    ds_read_b128 v[32:35], v2 offset:34208
    v_mfma_f32_16x16x32_bf16 v[56:59], a[188:191], v[40:43], v[56:59]
    s_waitcnt lgkmcnt(4)
    v_mfma_f32_16x16x32_bf16 v[44:47], a[192:195], v[12:15], v[44:47]
    ds_read_b128 v[36:39], v2 offset:1200
    v_mfma_f32_16x16x32_bf16 v[52:55], a[196:199], v[12:15], v[52:55]
    buffer_load_dwordx4 v1, s[16:19], s45 offen offset:1024 lds
    v_mfma_f32_16x16x32_bf16 v[48:51], a[192:195], v[16:19], v[48:51]
    ds_read_b128 v[40:43], v2 offset:34224
    v_mfma_f32_16x16x32_bf16 v[56:59], a[196:199], v[16:19], v[56:59]
    s_waitcnt lgkmcnt(4)
    v_mfma_f32_16x16x32_bf16 v[44:47], a[200:203], v[20:23], v[44:47]
    ds_read_b128 v[12:15], v2 offset:1216
    s_add_u32 m0, s39, 12384
    s_add_u32 s45, s38, 12288
    v_mfma_f32_16x16x32_bf16 v[52:55], a[204:207], v[20:23], v[52:55]
    buffer_load_dwordx4 v1, s[16:19], s45 offen lds
    v_mfma_f32_16x16x32_bf16 v[48:51], a[200:203], v[24:27], v[48:51]
    ds_read_b128 v[16:19], v2 offset:34240
    v_mfma_f32_16x16x32_bf16 v[56:59], a[204:207], v[24:27], v[56:59]
    s_waitcnt lgkmcnt(4)
    v_mfma_f32_16x16x32_bf16 v[44:47], a[208:211], v[28:31], v[44:47]
    ds_read_b128 v[20:23], v2 offset:1232
    v_mfma_f32_16x16x32_bf16 v[52:55], a[212:215], v[28:31], v[52:55]
    buffer_load_dwordx4 v1, s[16:19], s45 offen offset:1024 lds
    v_mfma_f32_16x16x32_bf16 v[48:51], a[208:211], v[32:35], v[48:51]
    ds_read_b128 v[24:27], v2 offset:34256
    v_mfma_f32_16x16x32_bf16 v[56:59], a[212:215], v[32:35], v[56:59]
    s_waitcnt lgkmcnt(4)
    v_mfma_f32_16x16x32_bf16 v[44:47], a[216:219], v[36:39], v[44:47]
    ds_read_b128 v[28:31], v2 offset:1248
    s_add_u32 m0, s39, 14448
    s_add_u32 s45, s38, 14336
    v_mfma_f32_16x16x32_bf16 v[52:55], a[220:223], v[36:39], v[52:55]
    buffer_load_dwordx4 v1, s[16:19], s45 offen lds
    v_mfma_f32_16x16x32_bf16 v[48:51], a[216:219], v[40:43], v[48:51]
    ds_read_b128 v[32:35], v2 offset:34272
    v_mfma_f32_16x16x32_bf16 v[56:59], a[220:223], v[40:43], v[56:59]
    s_waitcnt lgkmcnt(4)
    v_mfma_f32_16x16x32_bf16 v[44:47], a[224:227], v[12:15], v[44:47]
    ds_read_b128 v[36:39], v2 offset:1264
    v_mfma_f32_16x16x32_bf16 v[52:55], a[228:231], v[12:15], v[52:55]
    buffer_load_dwordx4 v1, s[16:19], s45 offen offset:1024 lds
    v_mfma_f32_16x16x32_bf16 v[48:51], a[224:227], v[16:19], v[48:51]
    ds_read_b128 v[40:43], v2 offset:34288
    s_sub_u32 s39, s40, s39
    s_add_u32 s38, s38, 0x10000
    v_mfma_f32_16x16x32_bf16 v[56:59], a[228:231], v[16:19], v[56:59]
    s_waitcnt lgkmcnt(4)
    v_mfma_f32_16x16x32_bf16 v[44:47], a[232:235], v[20:23], v[44:47]
    buffer_load_dwordx4 v[68:71], v1, s[16:19], s44 offen
    v_mfma_f32_16x16x32_bf16 v[52:55], a[236:239], v[20:23], v[52:55]
    s_add_u32 s44, s44, 0x10000
    v_mfma_f32_16x16x32_bf16 v[48:51], a[232:235], v[24:27], v[48:51]
    v_mfma_f32_16x16x32_bf16 v[56:59], a[236:239], v[24:27], v[56:59]
    s_waitcnt lgkmcnt(2)
    v_mfma_f32_16x16x32_bf16 v[44:47], a[240:243], v[28:31], v[44:47]
    v_mfma_f32_16x16x32_bf16 v[52:55], a[244:247], v[28:31], v[52:55]
    v_mfma_f32_16x16x32_bf16 v[48:51], a[240:243], v[32:35], v[48:51]
    v_mfma_f32_16x16x32_bf16 v[56:59], a[244:247], v[32:35], v[56:59]
    s_waitcnt lgkmcnt(0)
    v_mfma_f32_16x16x32_bf16 v[44:47], a[248:251], v[36:39], v[44:47]
    v_mfma_f32_16x16x32_bf16 v[52:55], a[252:255], v[36:39], v[52:55]
    v_mfma_f32_16x16x32_bf16 v[48:51], a[248:251], v[40:43], v[48:51]
    v_mfma_f32_16x16x32_bf16 v[56:59], a[252:255], v[40:43], v[56:59]
    v_sub_u32 v2, v3, v2
    v_cvt_pk_bf16_f32 v60, v44, v52
    v_cvt_pk_bf16_f32 v61, v45, v53
    v_cvt_pk_bf16_f32 v62, v46, v54
    v_cvt_pk_bf16_f32 v63, v47, v55
    s_nop 1
    v_cvt_pk_bf16_f32 v64, v48, v56
    v_cvt_pk_bf16_f32 v65, v49, v57
    v_cvt_pk_bf16_f32 v66, v50, v58
    v_cvt_pk_bf16_f32 v67, v51, v59
    v_mfma_f32_16x16x32_bf16 v[116:119], v[60:63], v[108:111], 0
    v_mfma_f32_16x16x32_bf16 v[120:123], v[64:67], v[108:111], 0
    v_mfma_f32_16x16x32_bf16 v[124:127], v[60:63], v[112:115], 0
    v_mfma_f32_16x16x32_bf16 v[128:131], v[64:67], v[112:115], 0
    v_cvt_pk_bf16_f32 v132, v116, v117
    v_cvt_pk_bf16_f32 v133, v118, v119
    v_cvt_pk_bf16_f32 v134, v120, v121
    v_cvt_pk_bf16_f32 v135, v122, v123
    v_cvt_pk_bf16_f32 v136, v124, v125
    v_cvt_pk_bf16_f32 v137, v126, v127
    s_nop 0
    v_cvt_pk_bf16_f32 v138, v128, v129
    v_cvt_pk_bf16_f32 v139, v130, v131
    s_mov_b32 s37, 3
    s_waitcnt vmcnt(1)
    s_barrier
L_v_loope:
    ds_read_b128 v[12:15], v2 offset:0
    ds_read_b128 v[16:19], v2 offset:33024
    ds_read_b128 v[20:23], v2 offset:16
    ds_read_b128 v[24:27], v2 offset:33040
    ds_read_b128 v[28:31], v2 offset:32
    ds_read_b128 v[32:35], v2 offset:33056
    s_waitcnt lgkmcnt(4)
    v_mfma_f32_16x16x32_bf16 v[44:47], a[0:3], v[12:15], 0
    ds_read_b128 v[36:39], v2 offset:48
    s_add_u32 s46, s41, 4096
    v_mfma_f32_16x16x32_bf16 v[52:55], a[4:7], v[12:15], 0
    buffer_store_dwordx4 v[60:63], v1, s[4:7], s41 offen offset:0 sc1
    v_mfma_f32_16x16x32_bf16 v[48:51], a[0:3], v[16:19], 0
    ds_read_b128 v[40:43], v2 offset:33072
    v_mfma_f32_16x16x32_bf16 v[56:59], a[4:7], v[16:19], 0
    s_waitcnt lgkmcnt(4)
    v_mfma_f32_16x16x32_bf16 v[44:47], a[8:11], v[20:23], v[44:47]
    ds_read_b128 v[12:15], v2 offset:64
    v_mfma_f32_16x16x32_bf16 v[52:55], a[12:15], v[20:23], v[52:55]
    buffer_store_dwordx4 v[64:67], v1, s[4:7], s46 offen offset:0 sc1
    v_mfma_f32_16x16x32_bf16 v[48:51], a[8:11], v[24:27], v[48:51]
    ds_read_b128 v[16:19], v2 offset:33088
    s_add_u32 s41, s41, 0x4000
    v_mfma_f32_16x16x32_bf16 v[56:59], a[12:15], v[24:27], v[56:59]
    s_waitcnt lgkmcnt(4)
    v_mfma_f32_16x16x32_bf16 v[44:47], a[16:19], v[28:31], v[44:47]
    ds_read_b128 v[20:23], v2 offset:80
    v_mfma_f32_16x16x32_bf16 v[52:55], a[20:23], v[28:31], v[52:55]
    buffer_store_dwordx4 v[132:135], v1, s[4:7], s42 offen offset:0 sc1
    v_mfma_f32_16x16x32_bf16 v[48:51], a[16:19], v[32:35], v[48:51]
    ds_read_b128 v[24:27], v2 offset:33104
    v_mfma_f32_16x16x32_bf16 v[56:59], a[20:23], v[32:35], v[56:59]
    s_waitcnt lgkmcnt(4)
    v_mfma_f32_16x16x32_bf16 v[44:47], a[24:27], v[36:39], v[44:47]
    ds_read_b128 v[28:31], v2 offset:96
    v_mfma_f32_16x16x32_bf16 v[52:55], a[28:31], v[36:39], v[52:55]
    buffer_store_dwordx4 v[136:139], v1, s[4:7], s42 offen offset:1024 sc1
    v_mfma_f32_16x16x32_bf16 v[48:51], a[24:27], v[40:43], v[48:51]
    ds_read_b128 v[32:35], v2 offset:33120
    s_add_u32 s42, s42, 0x4000
    v_mov_b32 v9, s37
    v_mfma_f32_16x16x32_bf16 v[56:59], a[28:31], v[40:43], v[56:59]
    s_waitcnt lgkmcnt(4)
    v_mfma_f32_16x16x32_bf16 v[44:47], a[32:35], v[12:15], v[44:47]
    ds_read_b128 v[36:39], v2 offset:112
    s_add_u32 m0, s39, 0
    s_add_u32 s45, s38, 0
    v_mfma_f32_16x16x32_bf16 v[52:55], a[36:39], v[12:15], v[52:55]
    buffer_load_dwordx4 v1, s[16:19], s45 offen lds
    v_mfma_f32_16x16x32_bf16 v[48:51], a[32:35], v[16:19], v[48:51]
    ds_read_b128 v[40:43], v2 offset:33136
    v_mfma_f32_16x16x32_bf16 v[56:59], a[36:39], v[16:19], v[56:59]
    s_waitcnt lgkmcnt(4)
    v_mfma_f32_16x16x32_bf16 v[44:47], a[40:43], v[20:23], v[44:47]
    ds_read_b128 v[12:15], v2 offset:128
    v_mfma_f32_16x16x32_bf16 v[52:55], a[44:47], v[20:23], v[52:55]
    buffer_load_dwordx4 v1, s[16:19], s45 offen offset:1024 lds
    v_mfma_f32_16x16x32_bf16 v[48:51], a[40:43], v[24:27], v[48:51]
    ds_read_b128 v[16:19], v2 offset:33152
    v_mfma_f32_16x16x32_bf16 v[56:59], a[44:47], v[24:27], v[56:59]
    s_waitcnt lgkmcnt(4)
    v_mfma_f32_16x16x32_bf16 v[44:47], a[48:51], v[28:31], v[44:47]
    ds_read_b128 v[20:23], v2 offset:144
    s_add_u32 m0, s39, 2064
    s_add_u32 s45, s38, 2048
    v_mfma_f32_16x16x32_bf16 v[52:55], a[52:55], v[28:31], v[52:55]
    buffer_load_dwordx4 v1, s[16:19], s45 offen lds
    v_mfma_f32_16x16x32_bf16 v[48:51], a[48:51], v[32:35], v[48:51]
    ds_read_b128 v[24:27], v2 offset:33168
    v_mfma_f32_16x16x32_bf16 v[56:59], a[52:55], v[32:35], v[56:59]
    s_waitcnt lgkmcnt(4)
    v_mfma_f32_16x16x32_bf16 v[44:47], a[56:59], v[36:39], v[44:47]
    ds_read_b128 v[28:31], v2 offset:160
    v_mfma_f32_16x16x32_bf16 v[52:55], a[60:63], v[36:39], v[52:55]
    buffer_load_dwordx4 v1, s[16:19], s45 offen offset:1024 lds
    v_mfma_f32_16x16x32_bf16 v[48:51], a[56:59], v[40:43], v[48:51]
    ds_read_b128 v[32:35], v2 offset:33184
    v_mfma_f32_16x16x32_bf16 v[56:59], a[60:63], v[40:43], v[56:59]
    s_waitcnt lgkmcnt(4)
    v_mfma_f32_16x16x32_bf16 v[44:47], a[64:67], v[12:15], v[44:47]
    ds_read_b128 v[36:39], v2 offset:176
    s_add_u32 m0, s39, 4128
    s_add_u32 s45, s38, 4096
    v_mfma_f32_16x16x32_bf16 v[52:55], a[68:71], v[12:15], v[52:55]
    buffer_load_dwordx4 v1, s[16:19], s45 offen lds
    v_mfma_f32_16x16x32_bf16 v[48:51], a[64:67], v[16:19], v[48:51]
    ds_read_b128 v[40:43], v2 offset:33200
    v_mfma_f32_16x16x32_bf16 v[56:59], a[68:71], v[16:19], v[56:59]
    s_waitcnt lgkmcnt(4)
    v_mfma_f32_16x16x32_bf16 v[44:47], a[72:75], v[20:23], v[44:47]
    ds_read_b128 v[12:15], v2 offset:192
    v_mfma_f32_16x16x32_bf16 v[52:55], a[76:79], v[20:23], v[52:55]
    buffer_load_dwordx4 v1, s[16:19], s45 offen offset:1024 lds
    v_mfma_f32_16x16x32_bf16 v[48:51], a[72:75], v[24:27], v[48:51]
    ds_read_b128 v[16:19], v2 offset:33216
    v_mfma_f32_16x16x32_bf16 v[56:59], a[76:79], v[24:27], v[56:59]
    s_waitcnt lgkmcnt(4)
    v_mfma_f32_16x16x32_bf16 v[44:47], a[80:83], v[28:31], v[44:47]
    ds_read_b128 v[20:23], v2 offset:208
    s_add_u32 m0, s39, 6192
    s_add_u32 s45, s38, 6144
    v_mfma_f32_16x16x32_bf16 v[52:55], a[84:87], v[28:31], v[52:55]
    buffer_load_dwordx4 v1, s[16:19], s45 offen lds
    v_mfma_f32_16x16x32_bf16 v[48:51], a[80:83], v[32:35], v[48:51]
    ds_read_b128 v[24:27], v2 offset:33232
    v_mfma_f32_16x16x32_bf16 v[56:59], a[84:87], v[32:35], v[56:59]
    s_waitcnt lgkmcnt(4)
    v_mfma_f32_16x16x32_bf16 v[44:47], a[88:91], v[36:39], v[44:47]
    ds_read_b128 v[28:31], v2 offset:224
    v_mfma_f32_16x16x32_bf16 v[52:55], a[92:95], v[36:39], v[52:55]
    buffer_load_dwordx4 v1, s[16:19], s45 offen offset:1024 lds
    v_mfma_f32_16x16x32_bf16 v[48:51], a[88:91], v[40:43], v[48:51]
    ds_read_b128 v[32:35], v2 offset:33248
    v_mfma_f32_16x16x32_bf16 v[56:59], a[92:95], v[40:43], v[56:59]
    s_waitcnt lgkmcnt(4)
    v_mfma_f32_16x16x32_bf16 v[44:47], a[96:99], v[12:15], v[44:47]
    ds_read_b128 v[36:39], v2 offset:240
    s_add_u32 m0, s39, 8256
    s_add_u32 s45, s38, 8192
    v_mfma_f32_16x16x32_bf16 v[52:55], a[100:103], v[12:15], v[52:55]
    buffer_load_dwordx4 v1, s[16:19], s45 offen lds
    v_mfma_f32_16x16x32_bf16 v[48:51], a[96:99], v[16:19], v[48:51]
    ds_read_b128 v[40:43], v2 offset:33264
    v_mfma_f32_16x16x32_bf16 v[56:59], a[100:103], v[16:19], v[56:59]
    s_waitcnt lgkmcnt(4)
    v_mfma_f32_16x16x32_bf16 v[44:47], a[104:107], v[20:23], v[44:47]
    ds_read_b128 v[12:15], v2 offset:1024
    v_mfma_f32_16x16x32_bf16 v[52:55], a[108:111], v[20:23], v[52:55]
    buffer_load_dwordx4 v1, s[16:19], s45 offen offset:1024 lds
    v_mfma_f32_16x16x32_bf16 v[48:51], a[104:107], v[24:27], v[48:51]
    ds_read_b128 v[16:19], v2 offset:34048
    v_mfma_f32_16x16x32_bf16 v[56:59], a[108:111], v[24:27], v[56:59]
    s_waitcnt lgkmcnt(4)
    v_mfma_f32_16x16x32_bf16 v[44:47], a[112:115], v[28:31], v[44:47]
    ds_read_b128 v[20:23], v2 offset:1040
    s_add_u32 m0, s39, 10320
    s_add_u32 s45, s38, 10240
    v_mfma_f32_16x16x32_bf16 v[52:55], a[116:119], v[28:31], v[52:55]
    buffer_load_dwordx4 v1, s[16:19], s45 offen lds
    v_mfma_f32_16x16x32_bf16 v[48:51], a[112:115], v[32:35], v[48:51]
    ds_read_b128 v[24:27], v2 offset:34064
    v_mfma_f32_16x16x32_bf16 v[56:59], a[116:119], v[32:35], v[56:59]
    s_waitcnt lgkmcnt(4)
    v_mfma_f32_16x16x32_bf16 v[44:47], a[120:123], v[36:39], v[44:47]
    ds_read_b128 v[28:31], v2 offset:1056
    v_mfma_f32_16x16x32_bf16 v[52:55], a[124:127], v[36:39], v[52:55]
    buffer_load_dwordx4 v1, s[16:19], s45 offen offset:1024 lds
    v_mfma_f32_16x16x32_bf16 v[48:51], a[120:123], v[40:43], v[48:51]
    ds_read_b128 v[32:35], v2 offset:34080
    v_mfma_f32_16x16x32_bf16 v[56:59], a[124:127], v[40:43], v[56:59]
    s_waitcnt lgkmcnt(4)
    v_mfma_f32_16x16x32_bf16 v[44:47], a[128:131], v[12:15], v[44:47]
    ds_read_b128 v[36:39], v2 offset:1072
    s_add_u32 m0, s39, 12384
    s_add_u32 s45, s38, 12288
    v_mfma_f32_16x16x32_bf16 v[52:55], a[132:135], v[12:15], v[52:55]
    buffer_load_dwordx4 v1, s[16:19], s45 offen lds
    v_mfma_f32_16x16x32_bf16 v[48:51], a[128:131], v[16:19], v[48:51]
    ds_read_b128 v[40:43], v2 offset:34096
    v_mfma_f32_16x16x32_bf16 v[56:59], a[132:135], v[16:19], v[56:59]
    s_waitcnt lgkmcnt(4)
    v_mfma_f32_16x16x32_bf16 v[44:47], a[136:139], v[20:23], v[44:47]
    ds_read_b128 v[12:15], v2 offset:1088
    v_mfma_f32_16x16x32_bf16 v[52:55], a[140:143], v[20:23], v[52:55]
    buffer_load_dwordx4 v1, s[16:19], s45 offen offset:1024 lds
    v_mfma_f32_16x16x32_bf16 v[48:51], a[136:139], v[24:27], v[48:51]
    ds_read_b128 v[16:19], v2 offset:34112
    v_mfma_f32_16x16x32_bf16 v[56:59], a[140:143], v[24:27], v[56:59]
    s_waitcnt lgkmcnt(4)
    v_mfma_f32_16x16x32_bf16 v[44:47], a[144:147], v[28:31], v[44:47]
    ds_read_b128 v[20:23], v2 offset:1104
    s_add_u32 m0, s39, 14448
    s_add_u32 s45, s38, 14336
    v_mfma_f32_16x16x32_bf16 v[52:55], a[148:151], v[28:31], v[52:55]
    buffer_load_dwordx4 v1, s[16:19], s45 offen lds
    v_mfma_f32_16x16x32_bf16 v[48:51], a[144:147], v[32:35], v[48:51]
    ds_read_b128 v[24:27], v2 offset:34128
    v_mfma_f32_16x16x32_bf16 v[56:59], a[148:151], v[32:35], v[56:59]
    s_waitcnt lgkmcnt(4)
    v_mfma_f32_16x16x32_bf16 v[44:47], a[152:155], v[36:39], v[44:47]
    ds_read_b128 v[28:31], v2 offset:1120
    v_mfma_f32_16x16x32_bf16 v[52:55], a[156:159], v[36:39], v[52:55]
    buffer_load_dwordx4 v1, s[16:19], s45 offen offset:1024 lds
    v_mfma_f32_16x16x32_bf16 v[48:51], a[152:155], v[40:43], v[48:51]
    ds_read_b128 v[32:35], v2 offset:34144
    s_sub_u32 s39, s40, s39
    s_add_u32 s38, s38, 0x10000
    v_mfma_f32_16x16x32_bf16 v[56:59], a[156:159], v[40:43], v[56:59]
    s_waitcnt lgkmcnt(4)
    v_mfma_f32_16x16x32_bf16 v[44:47], a[160:163], v[12:15], v[44:47]
    ds_read_b128 v[36:39], v2 offset:1136
    v_mfma_f32_16x16x32_bf16 v[52:55], a[164:167], v[12:15], v[52:55]
    buffer_load_dwordx4 v[68:71], v1, s[16:19], s44 offen
    s_add_u32 s44, s44, 0x10000
    v_mfma_f32_16x16x32_bf16 v[48:51], a[160:163], v[16:19], v[48:51]
    ds_read_b128 v[40:43], v2 offset:34160
    v_mfma_f32_16x16x32_bf16 v[56:59], a[164:167], v[16:19], v[56:59]
    s_waitcnt lgkmcnt(4)
    s_waitcnt vmcnt(17)
    s_barrier
    buffer_store_dword v9, v4, s[4:7], 0 offen sc1
    v_mfma_f32_16x16x32_bf16 v[44:47], a[168:171], v[20:23], v[44:47]
    ds_read_b128 v[12:15], v2 offset:1152
    v_mfma_f32_16x16x32_bf16 v[52:55], a[172:175], v[20:23], v[52:55]
    v_mfma_f32_16x16x32_bf16 v[48:51], a[168:171], v[24:27], v[48:51]
    ds_read_b128 v[16:19], v2 offset:34176
    v_mfma_f32_16x16x32_bf16 v[56:59], a[172:175], v[24:27], v[56:59]
    s_waitcnt lgkmcnt(4)
    v_mfma_f32_16x16x32_bf16 v[44:47], a[176:179], v[28:31], v[44:47]
    ds_read_b128 v[20:23], v2 offset:1168
    v_mfma_f32_16x16x32_bf16 v[52:55], a[180:183], v[28:31], v[52:55]
    v_mfma_f32_16x16x32_bf16 v[48:51], a[176:179], v[32:35], v[48:51]
    ds_read_b128 v[24:27], v2 offset:34192
    v_mfma_f32_16x16x32_bf16 v[56:59], a[180:183], v[32:35], v[56:59]
    s_waitcnt lgkmcnt(4)
    v_mfma_f32_16x16x32_bf16 v[44:47], a[184:187], v[36:39], v[44:47]
    ds_read_b128 v[28:31], v2 offset:1184
    v_mfma_f32_16x16x32_bf16 v[52:55], a[188:191], v[36:39], v[52:55]
    v_mfma_f32_16x16x32_bf16 v[48:51], a[184:187], v[40:43], v[48:51]
    ds_read_b128 v[32:35], v2 offset:34208
    v_mfma_f32_16x16x32_bf16 v[56:59], a[188:191], v[40:43], v[56:59]
    s_waitcnt lgkmcnt(4)
    v_mfma_f32_16x16x32_bf16 v[44:47], a[192:195], v[12:15], v[44:47]
    ds_read_b128 v[36:39], v2 offset:1200
    v_mfma_f32_16x16x32_bf16 v[52:55], a[196:199], v[12:15], v[52:55]
    v_mfma_f32_16x16x32_bf16 v[48:51], a[192:195], v[16:19], v[48:51]
    ds_read_b128 v[40:43], v2 offset:34224
    v_mfma_f32_16x16x32_bf16 v[56:59], a[196:199], v[16:19], v[56:59]
    s_waitcnt lgkmcnt(4)
    v_mfma_f32_16x16x32_bf16 v[44:47], a[200:203], v[20:23], v[44:47]
    ds_read_b128 v[12:15], v2 offset:1216
    v_mfma_f32_16x16x32_bf16 v[52:55], a[204:207], v[20:23], v[52:55]
    v_mfma_f32_16x16x32_bf16 v[48:51], a[200:203], v[24:27], v[48:51]
    ds_read_b128 v[16:19], v2 offset:34240
    v_mfma_f32_16x16x32_bf16 v[56:59], a[204:207], v[24:27], v[56:59]
    s_waitcnt lgkmcnt(4)
    v_mfma_f32_16x16x32_bf16 v[44:47], a[208:211], v[28:31], v[44:47]
    ds_read_b128 v[20:23], v2 offset:1232
    v_mfma_f32_16x16x32_bf16 v[52:55], a[212:215], v[28:31], v[52:55]
    v_mfma_f32_16x16x32_bf16 v[48:51], a[208:211], v[32:35], v[48:51]
    ds_read_b128 v[24:27], v2 offset:34256
    v_mfma_f32_16x16x32_bf16 v[56:59], a[212:215], v[32:35], v[56:59]
    s_waitcnt lgkmcnt(4)
    v_mfma_f32_16x16x32_bf16 v[44:47], a[216:219], v[36:39], v[44:47]
    ds_read_b128 v[28:31], v2 offset:1248
    v_mfma_f32_16x16x32_bf16 v[52:55], a[220:223], v[36:39], v[52:55]
    v_mfma_f32_16x16x32_bf16 v[48:51], a[216:219], v[40:43], v[48:51]
    ds_read_b128 v[32:35], v2 offset:34272
    v_mfma_f32_16x16x32_bf16 v[56:59], a[220:223], v[40:43], v[56:59]
    s_waitcnt lgkmcnt(4)
    v_mfma_f32_16x16x32_bf16 v[44:47], a[224:227], v[12:15], v[44:47]
    ds_read_b128 v[36:39], v2 offset:1264
    v_mfma_f32_16x16x32_bf16 v[52:55], a[228:231], v[12:15], v[52:55]
    v_mfma_f32_16x16x32_bf16 v[48:51], a[224:227], v[16:19], v[48:51]
    ds_read_b128 v[40:43], v2 offset:34288
    v_mfma_f32_16x16x32_bf16 v[56:59], a[228:231], v[16:19], v[56:59]
    s_waitcnt lgkmcnt(4)
    v_mfma_f32_16x16x32_bf16 v[44:47], a[232:235], v[20:23], v[44:47]
    v_mfma_f32_16x16x32_bf16 v[52:55], a[236:239], v[20:23], v[52:55]
    v_mfma_f32_16x16x32_bf16 v[48:51], a[232:235], v[24:27], v[48:51]
    v_mfma_f32_16x16x32_bf16 v[56:59], a[236:239], v[24:27], v[56:59]
    s_waitcnt lgkmcnt(2)
    v_mfma_f32_16x16x32_bf16 v[44:47], a[240:243], v[28:31], v[44:47]
    v_mfma_f32_16x16x32_bf16 v[52:55], a[244:247], v[28:31], v[52:55]
    v_mfma_f32_16x16x32_bf16 v[48:51], a[240:243], v[32:35], v[48:51]
    v_mfma_f32_16x16x32_bf16 v[56:59], a[244:247], v[32:35], v[56:59]
    s_waitcnt lgkmcnt(0)
    v_mfma_f32_16x16x32_bf16 v[44:47], a[248:251], v[36:39], v[44:47]
    v_mfma_f32_16x16x32_bf16 v[52:55], a[252:255], v[36:39], v[52:55]
    v_mfma_f32_16x16x32_bf16 v[48:51], a[248:251], v[40:43], v[48:51]
    v_mfma_f32_16x16x32_bf16 v[56:59], a[252:255], v[40:43], v[56:59]
    v_sub_u32 v2, v3, v2
    v_cvt_pk_bf16_f32 v60, v44, v52
    v_cvt_pk_bf16_f32 v61, v45, v53
    v_cvt_pk_bf16_f32 v62, v46, v54
    v_cvt_pk_bf16_f32 v63, v47, v55
    s_nop 1
    v_cvt_pk_bf16_f32 v64, v48, v56
    v_cvt_pk_bf16_f32 v65, v49, v57
    v_cvt_pk_bf16_f32 v66, v50, v58
    v_cvt_pk_bf16_f32 v67, v51, v59
    v_mfma_f32_16x16x32_bf16 v[116:119], v[60:63], v[108:111], 0
    v_mfma_f32_16x16x32_bf16 v[120:123], v[64:67], v[108:111], 0
    v_mfma_f32_16x16x32_bf16 v[124:127], v[60:63], v[112:115], 0
    v_mfma_f32_16x16x32_bf16 v[128:131], v[64:67], v[112:115], 0
    v_cvt_pk_bf16_f32 v132, v116, v117
    v_cvt_pk_bf16_f32 v133, v118, v119
    v_cvt_pk_bf16_f32 v134, v120, v121
    v_cvt_pk_bf16_f32 v135, v122, v123
    v_cvt_pk_bf16_f32 v136, v124, v125
    v_cvt_pk_bf16_f32 v137, v126, v127
    s_nop 0
    v_cvt_pk_bf16_f32 v138, v128, v129
    v_cvt_pk_bf16_f32 v139, v130, v131
    s_add_u32 s37, s37, 1
    s_cmp_le_u32 s37, 14
    s_waitcnt vmcnt(2)
    s_barrier
    s_cbranch_scc1 L_v_loope
    .p2align 6
L_v_loop:
    ds_read_b128 v[12:15], v2 offset:0
    ds_read_b128 v[16:19], v2 offset:33024
    ds_read_b128 v[20:23], v2 offset:16
    ds_read_b128 v[24:27], v2 offset:33040
    ds_read_b128 v[28:31], v2 offset:32
    ds_read_b128 v[32:35], v2 offset:33056
    s_waitcnt lgkmcnt(4)
    v_mfma_f32_16x16x32_bf16 v[44:47], a[0:3], v[12:15], 0
    ds_read_b128 v[36:39], v2 offset:48
    s_add_u32 m0, s39, 0
    s_add_u32 s45, s38, 0
    v_mfma_f32_16x16x32_bf16 v[52:55], a[4:7], v[12:15], 0
    buffer_load_dwordx4 v1, s[16:19], s45 offen lds
    v_mfma_f32_16x16x32_bf16 v[48:51], a[0:3], v[16:19], 0
    ds_read_b128 v[40:43], v2 offset:33072
    v_mfma_f32_16x16x32_bf16 v[56:59], a[4:7], v[16:19], 0
    s_waitcnt lgkmcnt(4)
    v_mfma_f32_16x16x32_bf16 v[44:47], a[8:11], v[20:23], v[44:47]
    ds_read_b128 v[12:15], v2 offset:64
    v_mfma_f32_16x16x32_bf16 v[52:55], a[12:15], v[20:23], v[52:55]
    buffer_load_dwordx4 v1, s[16:19], s45 offen offset:1024 lds
    v_mfma_f32_16x16x32_bf16 v[48:51], a[8:11], v[24:27], v[48:51]
    ds_read_b128 v[16:19], v2 offset:33088
    v_mfma_f32_16x16x32_bf16 v[56:59], a[12:15], v[24:27], v[56:59]
    s_waitcnt lgkmcnt(4)
    v_mfma_f32_16x16x32_bf16 v[44:47], a[16:19], v[28:31], v[44:47]
    ds_read_b128 v[20:23], v2 offset:80
    s_add_u32 m0, s39, 2064
    s_add_u32 s45, s38, 2048
    v_mfma_f32_16x16x32_bf16 v[52:55], a[20:23], v[28:31], v[52:55]
    buffer_load_dwordx4 v1, s[16:19], s45 offen lds
    v_mfma_f32_16x16x32_bf16 v[48:51], a[16:19], v[32:35], v[48:51]
    ds_read_b128 v[24:27], v2 offset:33104
    v_mfma_f32_16x16x32_bf16 v[56:59], a[20:23], v[32:35], v[56:59]
    s_waitcnt lgkmcnt(4)
    v_mfma_f32_16x16x32_bf16 v[44:47], a[24:27], v[36:39], v[44:47]
    ds_read_b128 v[28:31], v2 offset:96
    v_mfma_f32_16x16x32_bf16 v[52:55], a[28:31], v[36:39], v[52:55]
    buffer_load_dwordx4 v1, s[16:19], s45 offen offset:1024 lds
    v_mfma_f32_16x16x32_bf16 v[48:51], a[24:27], v[40:43], v[48:51]
    ds_read_b128 v[32:35], v2 offset:33120
    v_mfma_f32_16x16x32_bf16 v[56:59], a[28:31], v[40:43], v[56:59]
    s_waitcnt lgkmcnt(4)
    v_mfma_f32_16x16x32_bf16 v[44:47], a[32:35], v[12:15], v[44:47]
    ds_read_b128 v[36:39], v2 offset:112
    s_add_u32 m0, s39, 4128
    s_add_u32 s45, s38, 4096
    v_mfma_f32_16x16x32_bf16 v[52:55], a[36:39], v[12:15], v[52:55]
    buffer_load_dwordx4 v1, s[16:19], s45 offen lds
    v_mfma_f32_16x16x32_bf16 v[48:51], a[32:35], v[16:19], v[48:51]
    ds_read_b128 v[40:43], v2 offset:33136
    v_mfma_f32_16x16x32_bf16 v[56:59], a[36:39], v[16:19], v[56:59]
    s_waitcnt lgkmcnt(4)
    v_mfma_f32_16x16x32_bf16 v[44:47], a[40:43], v[20:23], v[44:47]
    ds_read_b128 v[12:15], v2 offset:128
    v_mfma_f32_16x16x32_bf16 v[52:55], a[44:47], v[20:23], v[52:55]
    buffer_load_dwordx4 v1, s[16:19], s45 offen offset:1024 lds
    v_mfma_f32_16x16x32_bf16 v[48:51], a[40:43], v[24:27], v[48:51]
    ds_read_b128 v[16:19], v2 offset:33152
    v_mfma_f32_16x16x32_bf16 v[56:59], a[44:47], v[24:27], v[56:59]
    s_waitcnt lgkmcnt(4)
    v_mfma_f32_16x16x32_bf16 v[44:47], a[48:51], v[28:31], v[44:47]
    ds_read_b128 v[20:23], v2 offset:144
    s_add_u32 m0, s39, 6192
    s_add_u32 s45, s38, 6144
    v_mfma_f32_16x16x32_bf16 v[52:55], a[52:55], v[28:31], v[52:55]
    buffer_load_dwordx4 v1, s[16:19], s45 offen lds
    v_mfma_f32_16x16x32_bf16 v[48:51], a[48:51], v[32:35], v[48:51]
    ds_read_b128 v[24:27], v2 offset:33168
    v_mfma_f32_16x16x32_bf16 v[56:59], a[52:55], v[32:35], v[56:59]
    s_waitcnt lgkmcnt(4)
    v_mfma_f32_16x16x32_bf16 v[44:47], a[56:59], v[36:39], v[44:47]
    ds_read_b128 v[28:31], v2 offset:160
    v_mfma_f32_16x16x32_bf16 v[52:55], a[60:63], v[36:39], v[52:55]
    buffer_load_dwordx4 v1, s[16:19], s45 offen offset:1024 lds
    v_mfma_f32_16x16x32_bf16 v[48:51], a[56:59], v[40:43], v[48:51]
    ds_read_b128 v[32:35], v2 offset:33184
    v_mfma_f32_16x16x32_bf16 v[56:59], a[60:63], v[40:43], v[56:59]
    s_waitcnt lgkmcnt(4)
    v_mfma_f32_16x16x32_bf16 v[44:47], a[64:67], v[12:15], v[44:47]
    ds_read_b128 v[36:39], v2 offset:176
    s_add_u32 m0, s39, 8256
    s_add_u32 s45, s38, 8192
    v_mfma_f32_16x16x32_bf16 v[52:55], a[68:71], v[12:15], v[52:55]
    buffer_load_dwordx4 v1, s[16:19], s45 offen lds
    v_mfma_f32_16x16x32_bf16 v[48:51], a[64:67], v[16:19], v[48:51]
    ds_read_b128 v[40:43], v2 offset:33200
    v_mfma_f32_16x16x32_bf16 v[56:59], a[68:71], v[16:19], v[56:59]
    s_waitcnt lgkmcnt(4)
    v_mfma_f32_16x16x32_bf16 v[44:47], a[72:75], v[20:23], v[44:47]
    ds_read_b128 v[12:15], v2 offset:192
    v_mfma_f32_16x16x32_bf16 v[52:55], a[76:79], v[20:23], v[52:55]
    buffer_load_dwordx4 v1, s[16:19], s45 offen offset:1024 lds
    v_mfma_f32_16x16x32_bf16 v[48:51], a[72:75], v[24:27], v[48:51]
    ds_read_b128 v[16:19], v2 offset:33216
    v_mfma_f32_16x16x32_bf16 v[56:59], a[76:79], v[24:27], v[56:59]
    s_waitcnt lgkmcnt(4)
    v_mfma_f32_16x16x32_bf16 v[44:47], a[80:83], v[28:31], v[44:47]
    ds_read_b128 v[20:23], v2 offset:208
    s_add_u32 m0, s39, 10320
    s_add_u32 s45, s38, 10240
    v_mfma_f32_16x16x32_bf16 v[52:55], a[84:87], v[28:31], v[52:55]
    buffer_load_dwordx4 v1, s[16:19], s45 offen lds
    v_mfma_f32_16x16x32_bf16 v[48:51], a[80:83], v[32:35], v[48:51]
    ds_read_b128 v[24:27], v2 offset:33232
    v_mfma_f32_16x16x32_bf16 v[56:59], a[84:87], v[32:35], v[56:59]
    s_waitcnt lgkmcnt(4)
    v_mfma_f32_16x16x32_bf16 v[44:47], a[88:91], v[36:39], v[44:47]
    ds_read_b128 v[28:31], v2 offset:224
    v_mfma_f32_16x16x32_bf16 v[52:55], a[92:95], v[36:39], v[52:55]
    buffer_load_dwordx4 v1, s[16:19], s45 offen offset:1024 lds
    v_mfma_f32_16x16x32_bf16 v[48:51], a[88:91], v[40:43], v[48:51]
    ds_read_b128 v[32:35], v2 offset:33248
    v_mfma_f32_16x16x32_bf16 v[56:59], a[92:95], v[40:43], v[56:59]
    s_waitcnt lgkmcnt(4)
    v_mfma_f32_16x16x32_bf16 v[44:47], a[96:99], v[12:15], v[44:47]
    ds_read_b128 v[36:39], v2 offset:240
    s_add_u32 m0, s39, 12384
    s_add_u32 s45, s38, 12288
    v_mfma_f32_16x16x32_bf16 v[52:55], a[100:103], v[12:15], v[52:55]
    buffer_load_dwordx4 v1, s[16:19], s45 offen lds
    v_mfma_f32_16x16x32_bf16 v[48:51], a[96:99], v[16:19], v[48:51]
    ds_read_b128 v[40:43], v2 offset:33264
    v_mfma_f32_16x16x32_bf16 v[56:59], a[100:103], v[16:19], v[56:59]
    s_waitcnt lgkmcnt(4)
    v_mfma_f32_16x16x32_bf16 v[44:47], a[104:107], v[20:23], v[44:47]
    ds_read_b128 v[12:15], v2 offset:1024
    v_mfma_f32_16x16x32_bf16 v[52:55], a[108:111], v[20:23], v[52:55]
    buffer_load_dwordx4 v1, s[16:19], s45 offen offset:1024 lds
    v_mfma_f32_16x16x32_bf16 v[48:51], a[104:107], v[24:27], v[48:51]
    ds_read_b128 v[16:19], v2 offset:34048
    v_mfma_f32_16x16x32_bf16 v[56:59], a[108:111], v[24:27], v[56:59]
    s_waitcnt lgkmcnt(4)
    v_mfma_f32_16x16x32_bf16 v[44:47], a[112:115], v[28:31], v[44:47]
    ds_read_b128 v[20:23], v2 offset:1040
    s_add_u32 m0, s39, 14448
    s_add_u32 s45, s38, 14336
    v_mfma_f32_16x16x32_bf16 v[52:55], a[116:119], v[28:31], v[52:55]
    buffer_load_dwordx4 v1, s[16:19], s45 offen lds
    v_mfma_f32_16x16x32_bf16 v[48:51], a[112:115], v[32:35], v[48:51]
    ds_read_b128 v[24:27], v2 offset:34064
    v_mfma_f32_16x16x32_bf16 v[56:59], a[116:119], v[32:35], v[56:59]
    s_waitcnt lgkmcnt(4)
    v_mfma_f32_16x16x32_bf16 v[44:47], a[120:123], v[36:39], v[44:47]
    ds_read_b128 v[28:31], v2 offset:1056
    v_mfma_f32_16x16x32_bf16 v[52:55], a[124:127], v[36:39], v[52:55]
    buffer_load_dwordx4 v1, s[16:19], s45 offen offset:1024 lds
    v_mfma_f32_16x16x32_bf16 v[48:51], a[120:123], v[40:43], v[48:51]
    ds_read_b128 v[32:35], v2 offset:34080
    s_sub_u32 s39, s40, s39
    s_add_u32 s38, s38, 0x10000
    v_mfma_f32_16x16x32_bf16 v[56:59], a[124:127], v[40:43], v[56:59]
    s_waitcnt lgkmcnt(4)
    v_mfma_f32_16x16x32_bf16 v[44:47], a[128:131], v[12:15], v[44:47]
    ds_read_b128 v[36:39], v2 offset:1072
    s_sub_u32 s46, s37, 2
    s_max_u32 s46, s46, 14
    v_mfma_f32_16x16x32_bf16 v[52:55], a[132:135], v[12:15], v[52:55]
    v_mov_b32 v9, s46
    v_mfma_f32_16x16x32_bf16 v[48:51], a[128:131], v[16:19], v[48:51]
    ds_read_b128 v[40:43], v2 offset:34096
    v_mfma_f32_16x16x32_bf16 v[56:59], a[132:135], v[16:19], v[56:59]
    s_waitcnt lgkmcnt(4)
    v_mfma_f32_16x16x32_bf16 v[44:47], a[136:139], v[20:23], v[44:47]
    ds_read_b128 v[12:15], v2 offset:1088
    v_mfma_f32_16x16x32_bf16 v[52:55], a[140:143], v[20:23], v[52:55]
    buffer_store_dword v9, v4, s[4:7], 0 offen sc1
    v_mfma_f32_16x16x32_bf16 v[48:51], a[136:139], v[24:27], v[48:51]
    ds_read_b128 v[16:19], v2 offset:34112
    s_add_u32 s46, s41, 4096
    v_mfma_f32_16x16x32_bf16 v[56:59], a[140:143], v[24:27], v[56:59]
    s_waitcnt lgkmcnt(4)
    v_mfma_f32_16x16x32_bf16 v[44:47], a[144:147], v[28:31], v[44:47]
    ds_read_b128 v[20:23], v2 offset:1104
    v_mfma_f32_16x16x32_bf16 v[52:55], a[148:151], v[28:31], v[52:55]
    buffer_store_dwordx4 v[60:63], v1, s[4:7], s41 offen offset:0 sc1
    v_mfma_f32_16x16x32_bf16 v[48:51], a[144:147], v[32:35], v[48:51]
    ds_read_b128 v[24:27], v2 offset:34128
    v_mfma_f32_16x16x32_bf16 v[56:59], a[148:151], v[32:35], v[56:59]
    s_waitcnt lgkmcnt(4)
    v_mfma_f32_16x16x32_bf16 v[44:47], a[152:155], v[36:39], v[44:47]
    ds_read_b128 v[28:31], v2 offset:1120
    v_mfma_f32_16x16x32_bf16 v[52:55], a[156:159], v[36:39], v[52:55]
    buffer_store_dwordx4 v[64:67], v1, s[4:7], s46 offen offset:0 sc1
    v_mfma_f32_16x16x32_bf16 v[48:51], a[152:155], v[40:43], v[48:51]
    ds_read_b128 v[32:35], v2 offset:34144
    s_add_u32 s41, s41, 0x4000
    v_mfma_f32_16x16x32_bf16 v[56:59], a[156:159], v[40:43], v[56:59]
    s_waitcnt lgkmcnt(4)
    v_mfma_f32_16x16x32_bf16 v[44:47], a[160:163], v[12:15], v[44:47]
    ds_read_b128 v[36:39], v2 offset:1136
    v_mfma_f32_16x16x32_bf16 v[52:55], a[164:167], v[12:15], v[52:55]
    buffer_store_dwordx4 v[132:135], v1, s[4:7], s42 offen offset:0 sc1
    v_mfma_f32_16x16x32_bf16 v[48:51], a[160:163], v[16:19], v[48:51]
    ds_read_b128 v[40:43], v2 offset:34160
    v_mfma_f32_16x16x32_bf16 v[56:59], a[164:167], v[16:19], v[56:59]
    s_waitcnt lgkmcnt(4)
    v_mfma_f32_16x16x32_bf16 v[44:47], a[168:171], v[20:23], v[44:47]
    ds_read_b128 v[12:15], v2 offset:1152
    v_mfma_f32_16x16x32_bf16 v[52:55], a[172:175], v[20:23], v[52:55]
    buffer_store_dwordx4 v[136:139], v1, s[4:7], s42 offen offset:1024 sc1
    v_mfma_f32_16x16x32_bf16 v[48:51], a[168:171], v[24:27], v[48:51]
    ds_read_b128 v[16:19], v2 offset:34176
    s_add_u32 s42, s42, 0x4000
    v_mfma_f32_16x16x32_bf16 v[56:59], a[172:175], v[24:27], v[56:59]
    s_waitcnt lgkmcnt(4)
    v_mfma_f32_16x16x32_bf16 v[44:47], a[176:179], v[28:31], v[44:47]
    ds_read_b128 v[20:23], v2 offset:1168
    v_mfma_f32_16x16x32_bf16 v[52:55], a[180:183], v[28:31], v[52:55]
    buffer_load_dwordx4 v[68:71], v1, s[16:19], s44 offen
    v_mfma_f32_16x16x32_bf16 v[48:51], a[176:179], v[32:35], v[48:51]
    ds_read_b128 v[24:27], v2 offset:34192
    s_add_u32 s44, s44, 0x10000
    v_mfma_f32_16x16x32_bf16 v[56:59], a[180:183], v[32:35], v[56:59]
    s_waitcnt lgkmcnt(4)
    v_mfma_f32_16x16x32_bf16 v[44:47], a[184:187], v[36:39], v[44:47]
    ds_read_b128 v[28:31], v2 offset:1184
    v_mfma_f32_16x16x32_bf16 v[52:55], a[188:191], v[36:39], v[52:55]
    v_mfma_f32_16x16x32_bf16 v[48:51], a[184:187], v[40:43], v[48:51]
    ds_read_b128 v[32:35], v2 offset:34208
    v_mfma_f32_16x16x32_bf16 v[56:59], a[188:191], v[40:43], v[56:59]
    s_waitcnt lgkmcnt(4)
    v_mfma_f32_16x16x32_bf16 v[44:47], a[192:195], v[12:15], v[44:47]
    ds_read_b128 v[36:39], v2 offset:1200
    v_mfma_f32_16x16x32_bf16 v[52:55], a[196:199], v[12:15], v[52:55]
    v_mfma_f32_16x16x32_bf16 v[48:51], a[192:195], v[16:19], v[48:51]
    ds_read_b128 v[40:43], v2 offset:34224
    v_mfma_f32_16x16x32_bf16 v[56:59], a[196:199], v[16:19], v[56:59]
    s_waitcnt lgkmcnt(4)
    v_mfma_f32_16x16x32_bf16 v[44:47], a[200:203], v[20:23], v[44:47]
    ds_read_b128 v[12:15], v2 offset:1216
    v_mfma_f32_16x16x32_bf16 v[52:55], a[204:207], v[20:23], v[52:55]
    v_mfma_f32_16x16x32_bf16 v[48:51], a[200:203], v[24:27], v[48:51]
    ds_read_b128 v[16:19], v2 offset:34240
    v_mfma_f32_16x16x32_bf16 v[56:59], a[204:207], v[24:27], v[56:59]
    s_waitcnt lgkmcnt(4)
    v_mfma_f32_16x16x32_bf16 v[44:47], a[208:211], v[28:31], v[44:47]
    ds_read_b128 v[20:23], v2 offset:1232
    v_mfma_f32_16x16x32_bf16 v[52:55], a[212:215], v[28:31], v[52:55]
    v_mfma_f32_16x16x32_bf16 v[48:51], a[208:211], v[32:35], v[48:51]
    ds_read_b128 v[24:27], v2 offset:34256
    v_mfma_f32_16x16x32_bf16 v[56:59], a[212:215], v[32:35], v[56:59]
    s_waitcnt lgkmcnt(4)
    v_mfma_f32_16x16x32_bf16 v[44:47], a[216:219], v[36:39], v[44:47]
    ds_read_b128 v[28:31], v2 offset:1248
    v_mfma_f32_16x16x32_bf16 v[52:55], a[220:223], v[36:39], v[52:55]
    v_mfma_f32_16x16x32_bf16 v[48:51], a[216:219], v[40:43], v[48:51]
    ds_read_b128 v[32:35], v2 offset:34272
    v_mfma_f32_16x16x32_bf16 v[56:59], a[220:223], v[40:43], v[56:59]
    s_waitcnt lgkmcnt(4)
    v_mfma_f32_16x16x32_bf16 v[44:47], a[224:227], v[12:15], v[44:47]
    ds_read_b128 v[36:39], v2 offset:1264
    v_mfma_f32_16x16x32_bf16 v[52:55], a[228:231], v[12:15], v[52:55]
    v_mfma_f32_16x16x32_bf16 v[48:51], a[224:227], v[16:19], v[48:51]
    ds_read_b128 v[40:43], v2 offset:34288
    v_mfma_f32_16x16x32_bf16 v[56:59], a[228:231], v[16:19], v[56:59]
    s_waitcnt lgkmcnt(4)
    v_mfma_f32_16x16x32_bf16 v[44:47], a[232:235], v[20:23], v[44:47]
    v_mfma_f32_16x16x32_bf16 v[52:55], a[236:239], v[20:23], v[52:55]
    v_mfma_f32_16x16x32_bf16 v[48:51], a[232:235], v[24:27], v[48:51]
    v_mfma_f32_16x16x32_bf16 v[56:59], a[236:239], v[24:27], v[56:59]
    s_waitcnt lgkmcnt(2)
    v_mfma_f32_16x16x32_bf16 v[44:47], a[240:243], v[28:31], v[44:47]
    v_mfma_f32_16x16x32_bf16 v[52:55], a[244:247], v[28:31], v[52:55]
    v_mfma_f32_16x16x32_bf16 v[48:51], a[240:243], v[32:35], v[48:51]
    v_mfma_f32_16x16x32_bf16 v[56:59], a[244:247], v[32:35], v[56:59]
    s_waitcnt lgkmcnt(0)
    v_mfma_f32_16x16x32_bf16 v[44:47], a[248:251], v[36:39], v[44:47]
    v_mfma_f32_16x16x32_bf16 v[52:55], a[252:255], v[36:39], v[52:55]
    v_mfma_f32_16x16x32_bf16 v[48:51], a[248:251], v[40:43], v[48:51]
    v_mfma_f32_16x16x32_bf16 v[56:59], a[252:255], v[40:43], v[56:59]
    v_sub_u32 v2, v3, v2
    v_cvt_pk_bf16_f32 v60, v44, v52
    v_cvt_pk_bf16_f32 v61, v45, v53
    v_cvt_pk_bf16_f32 v62, v46, v54
    v_cvt_pk_bf16_f32 v63, v47, v55
    s_nop 1
    v_cvt_pk_bf16_f32 v64, v48, v56
    v_cvt_pk_bf16_f32 v65, v49, v57
    v_cvt_pk_bf16_f32 v66, v50, v58
    v_cvt_pk_bf16_f32 v67, v51, v59
    v_mfma_f32_16x16x32_bf16 v[116:119], v[60:63], v[108:111], 0
    v_mfma_f32_16x16x32_bf16 v[120:123], v[64:67], v[108:111], 0
    v_mfma_f32_16x16x32_bf16 v[124:127], v[60:63], v[112:115], 0
    v_mfma_f32_16x16x32_bf16 v[128:131], v[64:67], v[112:115], 0
    v_cvt_pk_bf16_f32 v132, v116, v117
    v_cvt_pk_bf16_f32 v133, v118, v119
    v_cvt_pk_bf16_f32 v134, v120, v121
    v_cvt_pk_bf16_f32 v135, v122, v123
    v_cvt_pk_bf16_f32 v136, v124, v125
    v_cvt_pk_bf16_f32 v137, v126, v127
    s_nop 0
    v_cvt_pk_bf16_f32 v138, v128, v129
    v_cvt_pk_bf16_f32 v139, v130, v131
    s_add_u32 s37, s37, 1
    s_cmp_lt_u32 s37, 64
    s_waitcnt vmcnt(6)
    s_barrier
    s_cbranch_scc1 L_v_loop
    s_xor_b32 s48, s48, 0x2000
    s_add_u32 s46, s41, 4096
    buffer_store_dwordx4 v[60:63], v1, s[4:7], s41 offen offset:0 sc1
    buffer_store_dwordx4 v[64:67], v1, s[4:7], s46 offen offset:0 sc1
    s_add_u32 s41, s41, 0x4000
    buffer_store_dwordx4 v[132:135], v1, s[4:7], s42 offen offset:0 sc1
    buffer_store_dwordx4 v[136:139], v1, s[4:7], s42 offen offset:1024 sc1
    s_add_u32 s42, s42, 0x4000
    s_waitcnt vmcnt(0)
    v_mov_b32 v9, 64
    s_barrier
    buffer_store_dword v9, v4, s[4:7], 0 offen sc1
    s_branch L_o_join2
L_q:
    s_mov_b32 s12, s68
    s_and_b32 s13, s69, 0xffff
    s_mov_b32 s14, 0x800000
    s_mov_b32 s15, 0x20000
    s_mov_b32 s16, s64
    s_and_b32 s17, s65, 0xffff
    s_mov_b32 s18, 0x400000
    s_mov_b32 s19, 0x20000
    s_mov_b32 s20, s64
    s_and_b32 s21, s65, 0xffff
    s_mov_b32 s22, 0x400000
    s_mov_b32 s23, 0x20000
    s_and_b32 s45, s63, 15
    s_lshl_b32 s45, s45, 2
    s_add_u32 s45, s45, s32
    s_lshl_b32 s45, s45, 11
    v_bfe_u32 v6, v0, 0, 4
    v_lshlrev_b32 v7, 7, v6
    v_bfe_u32 v6, v0, 4, 1
    v_lshl_add_u32 v7, v6, 17, v7
    v_bfe_u32 v6, v0, 5, 1
    v_lshl_add_u32 v7, v6, 30, v7
    buffer_load_dword v252, v7, s[20:23], s45 offen
    s_waitcnt vmcnt(1)
    s_barrier
    buffer_atomic_or v254, v255, s[8:11], 0 offen sc0 sc1
    s_mov_b32 s20, s70
    s_and_b32 s21, s71, 0xffff
    s_mov_b32 s22, 0x800000
    s_mov_b32 s23, 0x20000
    s_and_b32 s45, s36, 3
    s_lshl_b32 s45, s45, 2
    s_add_u32 s45, s45, s32
    s_lshl_b32 s45, s45, 16
    s_and_b32 s46, s36, 28
    s_lshl_b32 s46, s46, 8
    s_add_u32 s46, s46, s45
    v_bfe_u32 v6, v0, 0, 3
    v_lshlrev_b32 v7, 13, v6
    v_bfe_u32 v6, v0, 3, 3
    v_lshl_add_u32 v7, v6, 20, v7
    buffer_load_dword v252, v7, s[20:23], s46 offen offset:384
    s_cmp_ge_u32 s36, 28
    s_cselect_b32 s46, s46, 0x40000000
    buffer_load_dword v252, v7, s[20:23], s46 offen offset:896
    s_lshl_b32 s45, s36, 8
    v_bfe_u32 v6, v0, 1, 3
    v_lshlrev_b32 v7, 13, v6
    v_bfe_u32 v6, v0, 4, 2
    v_lshl_add_u32 v7, v6, 20, v7
    v_bfe_u32 v6, v0, 0, 1
    v_lshl_add_u32 v7, v6, 7, v7
    v_lshl_add_u32 v7, s32, 16, v7
    s_add_u32 s45, s45, 0x440000
    buffer_load_dword v252, v7, s[20:23], s45 offen
    s_add_u32 s45, s45, 0x40000
    buffer_load_dword v252, v7, s[20:23], s45 offen
    s_add_u32 s45, s45, 0x40000
    buffer_load_dword v252, v7, s[20:23], s45 offen
    s_add_u32 s45, s45, 0x40000
    v_lshlrev_b32 v1, 4, v0
    s_lshl_b32 s45, s36, 7
    s_add_u32 s45, s45, 0xe40a000
    s_cmp_eq_u32 s32, 0
    s_cselect_b32 s46, 4, 0
    v_bfe_u32 v6, v0, 0, 1
    v_lshlrev_b32 v4, 12, v6
    v_bfe_u32 v6, v0, 1, 1
    v_lshl_add_u32 v4, v6, 14, v4
    v_add_u32 v4, s45, v4
    v_mov_b32 v6, 0x40000000
    v_cmp_gt_u32 vcc, s46, v0
    s_nop 1
    v_cndmask_b32 v4, v6, v4, vcc
    v_and_b32 v6, 15, v0
    v_mul_u32_u24 v2, 2064, v6
    v_lshrrev_b32 v6, 4, v0
    v_lshl_add_u32 v2, v6, 8, v2
    v_lshlrev_b32 v3, 1, v2
    v_add_u32 v3, 66048, v3
    s_mul_i32 s39, s32, 16512
    s_lshl_b32 s40, s39, 1
    s_add_u32 s40, s40, 66048
    s_lshl_b32 s38, s32, 14
    s_and_b32 s45, s32, 1
    s_lshl_b32 s45, s45, 3
    v_bfe_u32 v6, v0, 4, 2
    v_lshlrev_b32 v7, 1, v6
    v_add_u32 v7, s45, v7
    v_and_b32 v6, 15, v0
    v_xor_b32 v7, v7, v6
    v_bfe_u32 v6, v0, 4, 2
    v_lshlrev_b32 v12, 13, v6
    v_lshl_add_u32 v12, v7, 4, v12
    s_lshl_b32 s45, s32, 11
    s_add_u32 s45, s45, 132096
    v_add_u32 v13, s45, v1
    s_lshl_b32 s45, s32, 1
    v_bfe_u32 v7, v0, 2, 3
    v_xor_b32 v7, s45, v7
    v_bfe_u32 v6, v0, 4, 2
    v_lshlrev_b32 v14, 11, v6
    v_bfe_u32 v6, v0, 2, 2
    v_lshl_add_u32 v14, v6, 8, v14
    v_bfe_u32 v6, v0, 0, 2
    v_lshl_add_u32 v14, v6, 3, v14
    v_add_u32 v14, 132096, v14
    v_lshl_add_u32 v14, v7, 5, v14
    v_xor_b32 v15, 32, v14
    s_lshl_b32 s47, s36, 8
    s_lshl_b32 s45, s32, 20
    s_add_u32 s47, s47, s45
    s_waitcnt vmcnt(0)
    v_mov_b32 v7, 163832
    s_cmp_lg_u32 s32, 0
    s_cbranch_scc1 L_cf_14
    v_readfirstlane_b32 s45, v254
    s_nop 1
    v_mov_b32 v6, s45
    ds_write_b32 v7, v6
    s_waitcnt lgkmcnt(0)
L_cf_14:
    s_barrier
    ds_read_b32 v6, v7
    s_waitcnt lgkmcnt(0)
    v_readfirstlane_b32 s45, v6
    s_nop 0
    s_bitcmp1_b32 s45, s63
    s_cbranch_scc1 L_redo
    s_add_u32 s46, s47, 0x0
    buffer_load_dwordx4 a[0:3], v12, s[12:15], s46 offen nt
    s_add_u32 s46, s47, 0x8000
    buffer_load_dwordx4 a[4:7], v12, s[12:15], s46 offen nt
    s_add_u32 s46, s47, 0x10000
    buffer_load_dwordx4 a[8:11], v12, s[12:15], s46 offen nt
    s_add_u32 s46, s47, 0x18000
    buffer_load_dwordx4 a[12:15], v12, s[12:15], s46 offen nt
    s_add_u32 s46, s47, 0x20000
    buffer_load_dwordx4 a[16:19], v12, s[12:15], s46 offen nt
    s_add_u32 s46, s47, 0x28000
    buffer_load_dwordx4 a[20:23], v12, s[12:15], s46 offen nt
    s_add_u32 m0, s39, 0
    s_add_u32 s45, s38, 0
    buffer_load_dwordx4 v1, s[16:19], s45 offen offset:0 lds
    s_add_u32 m0, s39, 2064
    s_add_u32 s45, s38, 2048
    buffer_load_dwordx4 v1, s[16:19], s45 offen offset:0 lds
    s_add_u32 m0, s39, 4128
    s_add_u32 s45, s38, 4096
    buffer_load_dwordx4 v1, s[16:19], s45 offen offset:0 lds
    s_add_u32 m0, s39, 6192
    s_add_u32 s45, s38, 6144
    buffer_load_dwordx4 v1, s[16:19], s45 offen offset:0 lds
    s_add_u32 m0, s39, 8256
    s_add_u32 s45, s38, 8192
    buffer_load_dwordx4 v1, s[16:19], s45 offen offset:0 lds
    s_add_u32 m0, s39, 10320
    s_add_u32 s45, s38, 10240
    buffer_load_dwordx4 v1, s[16:19], s45 offen offset:0 lds
    s_add_u32 m0, s39, 12384
    s_add_u32 s45, s38, 12288
    buffer_load_dwordx4 v1, s[16:19], s45 offen offset:0 lds
    s_add_u32 m0, s39, 14448
    s_add_u32 s45, s38, 14336
    buffer_load_dwordx4 v1, s[16:19], s45 offen offset:0 lds
    s_add_u32 s46, s47, 0x30000
    buffer_load_dwordx4 a[24:27], v12, s[12:15], s46 offen nt
    s_add_u32 s46, s47, 0x38000
    buffer_load_dwordx4 a[28:31], v12, s[12:15], s46 offen nt
    s_add_u32 s46, s47, 0x40000
    buffer_load_dwordx4 a[32:35], v12, s[12:15], s46 offen nt
    s_add_u32 s46, s47, 0x48000
    buffer_load_dwordx4 a[36:39], v12, s[12:15], s46 offen nt
    s_add_u32 s46, s47, 0x50000
    buffer_load_dwordx4 a[40:43], v12, s[12:15], s46 offen nt
    s_add_u32 s46, s47, 0x58000
    buffer_load_dwordx4 a[44:47], v12, s[12:15], s46 offen nt
    s_mul_i32 s41, s36, 0x208000
    s_lshl_b32 s46, s32, 12
    s_add_u32 s51, s46, 140288
    s_add_u32 s48, s46, s41
    s_add_u32 s48, s48, 0x0
    s_lshr_b32 s45, s32, 1
    s_lshl_b32 s46, s45, 12
    s_add_u32 s46, s46, 148480
    v_add_u32 v8, s46, v1
    v_mov_b32 v212, v8
    v_add_u32 v76, 140288, v1
    s_lshr_b32 s49, s36, 1
    s_mul_i32 s49, s49, 0x208000
    s_and_b32 s46, s36, 1
    s_lshl_b32 s46, s46, 12
    s_add_u32 s49, s49, s46
    s_add_u32 s49, s49, 0x8000000
    s_lshl_b32 s46, s45, 10
    s_add_u32 s50, s49, s46
    s_lshl_b32 s46, s45, 11
    s_add_u32 s41, s41, s46
    s_and_b32 s45, s32, 1
    s_lshl_b32 s46, s45, 12
    s_add_u32 s41, s41, s46
    s_add_u32 s41, s41, 0x4002000
    s_add_u32 s46, s46, 132096
    v_add_u32 v5, s46, v1
    s_lshl_b32 s46, s32, 10
    s_add_u32 s46, s46, 132096
    v_add_u32 v72, s46, v1
    s_mov_b32 s52, 0x3e0293ee
    s_lshl_b32 s45, s45, 4
    v_and_b32 v6, 15, v0
    v_add_u32 v6, s45, v6
    v_lshrrev_b32 v7, 4, v0
    v_lshlrev_b32 v7, 2, v7
    v_sub_u32 v6, v6, v7
    v_mov_b32 v7, 0xf149f2ca
    v_cmp_gt_i32 vcc, 0, v6
    s_nop 1
    v_cndmask_b32 v168, 0, v7, vcc
    v_cmp_gt_i32 vcc, 1, v6
    s_nop 1
    v_cndmask_b32 v169, 0, v7, vcc
    v_cmp_gt_i32 vcc, 2, v6
    s_nop 1
    v_cndmask_b32 v170, 0, v7, vcc
    v_cmp_gt_i32 vcc, 3, v6
    s_nop 1
    v_cndmask_b32 v171, 0, v7, vcc
    v_cmp_gt_i32 vcc, 16, v6
    s_nop 1
    v_cndmask_b32 v172, 0, v7, vcc
    v_cmp_gt_i32 vcc, 17, v6
    s_nop 1
    v_cndmask_b32 v173, 0, v7, vcc
    v_cmp_gt_i32 vcc, 18, v6
    s_nop 1
    v_cndmask_b32 v174, 0, v7, vcc
    v_cmp_gt_i32 vcc, 19, v6
    s_nop 1
    v_cndmask_b32 v175, 0, v7, vcc
    v_mov_b32 v176, 0
    v_mov_b32 v177, 0
    v_mov_b32 v178, 0
    v_mov_b32 v179, 0
    v_mov_b32 v180, 0
    v_mov_b32 v181, 0
    v_mov_b32 v182, 0
    v_mov_b32 v183, 0
    v_mov_b32 v184, 0
    v_mov_b32 v185, 0
    v_mov_b32 v186, 0
    v_mov_b32 v187, 0
    v_mov_b32 v188, 0
    v_mov_b32 v189, 0
    v_mov_b32 v190, 0
    v_mov_b32 v191, 0
    v_mov_b32 v192, 0
    v_mov_b32 v193, 0
    v_mov_b32 v194, 0
    v_mov_b32 v195, 0
    v_bfe_u32 v6, v0, 2, 2
    v_lshrrev_b32 v7, 4, v0
    v_cmp_eq_u32 vcc, v6, v7
    v_mov_b32 v7, 0x3f80
    s_nop 0
    v_cndmask_b32 v7, 0, v7, vcc
    v_and_b32 v6, 3, v0
    v_cmp_eq_u32 vcc, 0, v6
    s_nop 1
    v_cndmask_b32 v180, 0, v7, vcc
    v_cmp_eq_u32 vcc, 1, v6
    s_nop 1
    v_cndmask_b32 v181, 0, v7, vcc
    v_cmp_eq_u32 vcc, 2, v6
    s_nop 1
    v_cndmask_b32 v182, 0, v7, vcc
    v_cmp_eq_u32 vcc, 3, v6
    s_nop 1
    v_cndmask_b32 v183, 0, v7, vcc
    v_bfe_u32 v6, v0, 2, 2
    v_lshrrev_b32 v7, 4, v0
    v_cmp_eq_u32 vcc, v6, v7
    v_mov_b32 v7, 0x3f800000
    s_nop 0
    v_cndmask_b32 v7, 0, v7, vcc
    v_and_b32 v6, 3, v0
    v_cmp_eq_u32 vcc, 0, v6
    s_nop 1
    v_cndmask_b32 v188, 0, v7, vcc
    v_cmp_eq_u32 vcc, 1, v6
    s_nop 1
    v_cndmask_b32 v189, 0, v7, vcc
    v_cmp_eq_u32 vcc, 2, v6
    s_nop 1
    v_cndmask_b32 v190, 0, v7, vcc
    v_cmp_eq_u32 vcc, 3, v6
    s_nop 1
    v_cndmask_b32 v191, 0, v7, vcc
    v_mov_b32 v204, 0x3f803f80
    v_mov_b32 v205, 0x3f803f80
    v_mov_b32 v206, 0x3f803f80
    v_mov_b32 v207, 0x3f803f80
    v_mov_b32 v210, 0x3f003f00
    v_mov_b32 v211, 0x3f003f00
    v_and_b32 v6, 8, v0
    v_cmp_eq_u32 vcc, 0, v6
    v_mov_b32 v7, 0xeeee
    v_mov_b32 v8, 0x4444
    v_cndmask_b32 v73, v7, v8, vcc
    s_lshl_b32 s45, s36, 8
    s_add_u32 s46, s45, 0xe430000
    v_bfe_u32 v6, v0, 0, 1
    v_lshlrev_b32 v9, 7, v6
    v_add_u32 v9, s46, v9
    s_lshl_b32 s45, s32, 10
    v_mov_b32 v6, 0x40000000
    v_mov_b32 v74, s45
    v_cmp_eq_u32 vcc, 0, v0
    s_nop 1
    v_cndmask_b32 v74, v6, v74, vcc
    s_mov_b32 s37, 0xe400000
    s_waitcnt vmcnt(6)
    ds_write_b128 v13, a[0:3] offset:0
    ds_write_b128 v13, a[4:7] offset:1024
    s_waitcnt lgkmcnt(0)
    s_barrier
    ds_read_b64_tr_b16 a[0:1], v14 offset:0
    ds_read_b64_tr_b16 a[2:3], v14 offset:1024
    ds_read_b64_tr_b16 a[4:5], v15 offset:0
    ds_read_b64_tr_b16 a[6:7], v15 offset:1024
    s_add_u32 m0, s39, 0
    s_add_u32 s45, s38, 0
    buffer_load_dwordx4 v1, s[16:19], s45 offen offset:1024 lds
    s_add_u32 s46, s47, 0x60000
    buffer_load_dwordx4 a[48:51], v12, s[12:15], s46 offen nt
    s_add_u32 s46, s47, 0x68000
    buffer_load_dwordx4 a[52:55], v12, s[12:15], s46 offen nt
    s_waitcnt vmcnt(11)
    ds_write_b128 v13, a[8:11] offset:8192
    ds_write_b128 v13, a[12:15] offset:9216
    s_waitcnt lgkmcnt(0)
    s_barrier
    ds_read_b64_tr_b16 a[8:9], v14 offset:8192
    ds_read_b64_tr_b16 a[10:11], v14 offset:9216
    ds_read_b64_tr_b16 a[12:13], v15 offset:8192
    ds_read_b64_tr_b16 a[14:15], v15 offset:9216
    s_add_u32 m0, s39, 2064
    s_add_u32 s45, s38, 2048
    buffer_load_dwordx4 v1, s[16:19], s45 offen offset:1024 lds
    s_add_u32 s46, s47, 0x70000
    buffer_load_dwordx4 a[56:59], v12, s[12:15], s46 offen nt
    s_add_u32 s46, s47, 0x78000
    buffer_load_dwordx4 a[60:63], v12, s[12:15], s46 offen nt
    s_waitcnt vmcnt(12)
    ds_write_b128 v13, a[16:19] offset:0
    ds_write_b128 v13, a[20:23] offset:1024
    s_waitcnt lgkmcnt(0)
    s_barrier
    ds_read_b64_tr_b16 a[16:17], v14 offset:0
    ds_read_b64_tr_b16 a[18:19], v14 offset:1024
    ds_read_b64_tr_b16 a[20:21], v15 offset:0
    ds_read_b64_tr_b16 a[22:23], v15 offset:1024
    s_add_u32 m0, s39, 4128
    s_add_u32 s45, s38, 4096
    buffer_load_dwordx4 v1, s[16:19], s45 offen offset:1024 lds
    s_add_u32 s46, s47, 0x80000
    buffer_load_dwordx4 a[64:67], v12, s[12:15], s46 offen nt
    s_add_u32 s46, s47, 0x88000
    buffer_load_dwordx4 a[68:71], v12, s[12:15], s46 offen nt
    s_waitcnt vmcnt(13)
    ds_write_b128 v13, a[24:27] offset:8192
    ds_write_b128 v13, a[28:31] offset:9216
    s_waitcnt lgkmcnt(0)
    s_barrier
    ds_read_b64_tr_b16 a[24:25], v14 offset:8192
    ds_read_b64_tr_b16 a[26:27], v14 offset:9216
    ds_read_b64_tr_b16 a[28:29], v15 offset:8192
    ds_read_b64_tr_b16 a[30:31], v15 offset:9216
    s_add_u32 m0, s39, 6192
    s_add_u32 s45, s38, 6144
    buffer_load_dwordx4 v1, s[16:19], s45 offen offset:1024 lds
    s_add_u32 s46, s47, 0x90000
    buffer_load_dwordx4 a[72:75], v12, s[12:15], s46 offen nt
    s_add_u32 s46, s47, 0x98000
    buffer_load_dwordx4 a[76:79], v12, s[12:15], s46 offen nt
    s_waitcnt vmcnt(14)
    ds_write_b128 v13, a[32:35] offset:0
    ds_write_b128 v13, a[36:39] offset:1024
    s_waitcnt lgkmcnt(0)
    s_barrier
    ds_read_b64_tr_b16 a[32:33], v14 offset:0
    ds_read_b64_tr_b16 a[34:35], v14 offset:1024
    ds_read_b64_tr_b16 a[36:37], v15 offset:0
    ds_read_b64_tr_b16 a[38:39], v15 offset:1024
    s_add_u32 m0, s39, 8256
    s_add_u32 s45, s38, 8192
    buffer_load_dwordx4 v1, s[16:19], s45 offen offset:1024 lds
    s_add_u32 s46, s47, 0xa0000
    buffer_load_dwordx4 a[80:83], v12, s[12:15], s46 offen nt
    s_add_u32 s46, s47, 0xa8000
    buffer_load_dwordx4 a[84:87], v12, s[12:15], s46 offen nt
    s_waitcnt vmcnt(15)
    ds_write_b128 v13, a[40:43] offset:8192
    ds_write_b128 v13, a[44:47] offset:9216
    s_waitcnt lgkmcnt(0)
    s_barrier
    ds_read_b64_tr_b16 a[40:41], v14 offset:8192
    ds_read_b64_tr_b16 a[42:43], v14 offset:9216
    ds_read_b64_tr_b16 a[44:45], v15 offset:8192
    ds_read_b64_tr_b16 a[46:47], v15 offset:9216
    s_add_u32 m0, s39, 10320
    s_add_u32 s45, s38, 10240
    buffer_load_dwordx4 v1, s[16:19], s45 offen offset:1024 lds
    s_add_u32 s46, s47, 0xb0000
    buffer_load_dwordx4 a[88:91], v12, s[12:15], s46 offen nt
    s_add_u32 s46, s47, 0xb8000
    buffer_load_dwordx4 a[92:95], v12, s[12:15], s46 offen nt
    s_waitcnt vmcnt(15)
    ds_write_b128 v13, a[48:51] offset:0
    ds_write_b128 v13, a[52:55] offset:1024
    s_waitcnt lgkmcnt(0)
    s_barrier
    ds_read_b64_tr_b16 a[48:49], v14 offset:0
    ds_read_b64_tr_b16 a[50:51], v14 offset:1024
    ds_read_b64_tr_b16 a[52:53], v15 offset:0
    ds_read_b64_tr_b16 a[54:55], v15 offset:1024
    s_add_u32 m0, s39, 12384
    s_add_u32 s45, s38, 12288
    buffer_load_dwordx4 v1, s[16:19], s45 offen offset:1024 lds
    s_add_u32 s46, s47, 0xc0000
    buffer_load_dwordx4 a[96:99], v12, s[12:15], s46 offen nt
    s_add_u32 s46, s47, 0xc8000
    buffer_load_dwordx4 a[100:103], v12, s[12:15], s46 offen nt
    s_waitcnt vmcnt(15)
    ds_write_b128 v13, a[56:59] offset:8192
    ds_write_b128 v13, a[60:63] offset:9216
    s_waitcnt lgkmcnt(0)
    s_barrier
    ds_read_b64_tr_b16 a[56:57], v14 offset:8192
    ds_read_b64_tr_b16 a[58:59], v14 offset:9216
    ds_read_b64_tr_b16 a[60:61], v15 offset:8192
    ds_read_b64_tr_b16 a[62:63], v15 offset:9216
    s_add_u32 m0, s39, 14448
    s_add_u32 s45, s38, 14336
    buffer_load_dwordx4 v1, s[16:19], s45 offen offset:1024 lds
    s_add_u32 s46, s47, 0xd0000
    buffer_load_dwordx4 a[104:107], v12, s[12:15], s46 offen nt
    s_add_u32 s46, s47, 0xd8000
    buffer_load_dwordx4 a[108:111], v12, s[12:15], s46 offen nt
    s_waitcnt vmcnt(15)
    ds_write_b128 v13, a[64:67] offset:0
    ds_write_b128 v13, a[68:71] offset:1024
    s_waitcnt lgkmcnt(0)
    s_barrier
    ds_read_b64_tr_b16 a[64:65], v14 offset:0
    ds_read_b64_tr_b16 a[66:67], v14 offset:1024
    ds_read_b64_tr_b16 a[68:69], v15 offset:0
    ds_read_b64_tr_b16 a[70:71], v15 offset:1024
    s_add_u32 s46, s47, 0xe0000
    buffer_load_dwordx4 a[112:115], v12, s[12:15], s46 offen nt
    s_add_u32 s46, s47, 0xe8000
    buffer_load_dwordx4 a[116:119], v12, s[12:15], s46 offen nt
    s_waitcnt vmcnt(14)
    ds_write_b128 v13, a[72:75] offset:8192
    ds_write_b128 v13, a[76:79] offset:9216
    s_waitcnt lgkmcnt(0)
    s_barrier
    ds_read_b64_tr_b16 a[72:73], v14 offset:8192
    ds_read_b64_tr_b16 a[74:75], v14 offset:9216
    ds_read_b64_tr_b16 a[76:77], v15 offset:8192
    ds_read_b64_tr_b16 a[78:79], v15 offset:9216
    s_add_u32 s46, s47, 0xf0000
    buffer_load_dwordx4 a[120:123], v12, s[12:15], s46 offen nt
    s_add_u32 s46, s47, 0xf8000
    buffer_load_dwordx4 a[124:127], v12, s[12:15], s46 offen nt
    s_waitcnt vmcnt(13)
    ds_write_b128 v13, a[80:83] offset:0
    ds_write_b128 v13, a[84:87] offset:1024
    s_waitcnt lgkmcnt(0)
    s_barrier
    ds_read_b64_tr_b16 a[80:81], v14 offset:0
    ds_read_b64_tr_b16 a[82:83], v14 offset:1024
    ds_read_b64_tr_b16 a[84:85], v15 offset:0
    ds_read_b64_tr_b16 a[86:87], v15 offset:1024
    s_add_u32 s46, s47, 0x400000
    buffer_load_dwordx4 a[128:131], v12, s[12:15], s46 offen nt
    s_add_u32 s46, s47, 0x408000
    buffer_load_dwordx4 a[132:135], v12, s[12:15], s46 offen nt
    s_waitcnt vmcnt(12)
    ds_write_b128 v13, a[88:91] offset:8192
    ds_write_b128 v13, a[92:95] offset:9216
    s_waitcnt lgkmcnt(0)
    s_barrier
    ds_read_b64_tr_b16 a[88:89], v14 offset:8192
    ds_read_b64_tr_b16 a[90:91], v14 offset:9216
    ds_read_b64_tr_b16 a[92:93], v15 offset:8192
    ds_read_b64_tr_b16 a[94:95], v15 offset:9216
    s_add_u32 s46, s47, 0x410000
    buffer_load_dwordx4 a[136:139], v12, s[12:15], s46 offen nt
    s_add_u32 s46, s47, 0x418000
    buffer_load_dwordx4 a[140:143], v12, s[12:15], s46 offen nt
    s_waitcnt vmcnt(11)
    ds_write_b128 v13, a[96:99] offset:0
    ds_write_b128 v13, a[100:103] offset:1024
    s_waitcnt lgkmcnt(0)
    s_barrier
    ds_read_b64_tr_b16 a[96:97], v14 offset:0
    ds_read_b64_tr_b16 a[98:99], v14 offset:1024
    ds_read_b64_tr_b16 a[100:101], v15 offset:0
    ds_read_b64_tr_b16 a[102:103], v15 offset:1024
    s_add_u32 s46, s47, 0x420000
    buffer_load_dwordx4 a[144:147], v12, s[12:15], s46 offen nt
    s_add_u32 s46, s47, 0x428000
    buffer_load_dwordx4 a[148:151], v12, s[12:15], s46 offen nt
    s_waitcnt vmcnt(10)
    ds_write_b128 v13, a[104:107] offset:8192
    ds_write_b128 v13, a[108:111] offset:9216
    s_waitcnt lgkmcnt(0)
    s_barrier
    ds_read_b64_tr_b16 a[104:105], v14 offset:8192
    ds_read_b64_tr_b16 a[106:107], v14 offset:9216
    ds_read_b64_tr_b16 a[108:109], v15 offset:8192
    ds_read_b64_tr_b16 a[110:111], v15 offset:9216
    s_add_u32 s46, s47, 0x430000
    buffer_load_dwordx4 a[152:155], v12, s[12:15], s46 offen nt
    s_add_u32 s46, s47, 0x438000
    buffer_load_dwordx4 a[156:159], v12, s[12:15], s46 offen nt
    s_waitcnt vmcnt(10)
    ds_write_b128 v13, a[112:115] offset:0
    ds_write_b128 v13, a[116:119] offset:1024
    s_waitcnt lgkmcnt(0)
    s_barrier
    ds_read_b64_tr_b16 a[112:113], v14 offset:0
    ds_read_b64_tr_b16 a[114:115], v14 offset:1024
    ds_read_b64_tr_b16 a[116:117], v15 offset:0
    ds_read_b64_tr_b16 a[118:119], v15 offset:1024
    s_waitcnt vmcnt(8)
    ds_write_b128 v13, a[120:123] offset:8192
    ds_write_b128 v13, a[124:127] offset:9216
    s_add_u32 s46, s47, 0x440000
    buffer_load_dwordx4 a[160:163], v12, s[12:15], s46 offen nt
    s_add_u32 s46, s47, 0x448000
    buffer_load_dwordx4 a[164:167], v12, s[12:15], s46 offen nt
    s_waitcnt lgkmcnt(0)
    s_barrier
    ds_read_b64_tr_b16 a[120:121], v14 offset:8192
    ds_read_b64_tr_b16 a[122:123], v14 offset:9216
    ds_read_b64_tr_b16 a[124:125], v15 offset:8192
    ds_read_b64_tr_b16 a[126:127], v15 offset:9216
    s_waitcnt vmcnt(8)
    ds_write_b128 v13, a[128:131] offset:0
    ds_write_b128 v13, a[132:135] offset:1024
    s_add_u32 s46, s47, 0x450000
    buffer_load_dwordx4 a[168:171], v12, s[12:15], s46 offen nt
    s_add_u32 s46, s47, 0x458000
    buffer_load_dwordx4 a[172:175], v12, s[12:15], s46 offen nt
    s_waitcnt lgkmcnt(0)
    s_barrier
    ds_read_b64_tr_b16 a[128:129], v14 offset:0
    ds_read_b64_tr_b16 a[130:131], v14 offset:1024
    ds_read_b64_tr_b16 a[132:133], v15 offset:0
    ds_read_b64_tr_b16 a[134:135], v15 offset:1024
    s_waitcnt vmcnt(8)
    ds_write_b128 v13, a[136:139] offset:8192
    ds_write_b128 v13, a[140:143] offset:9216
    s_add_u32 s46, s47, 0x460000
    buffer_load_dwordx4 a[176:179], v12, s[12:15], s46 offen nt
    s_add_u32 s46, s47, 0x468000
    buffer_load_dwordx4 a[180:183], v12, s[12:15], s46 offen nt
    s_waitcnt lgkmcnt(0)
    s_barrier
    ds_read_b64_tr_b16 a[136:137], v14 offset:8192
    ds_read_b64_tr_b16 a[138:139], v14 offset:9216
    ds_read_b64_tr_b16 a[140:141], v15 offset:8192
    ds_read_b64_tr_b16 a[142:143], v15 offset:9216
    s_waitcnt vmcnt(8)
    ds_write_b128 v13, a[144:147] offset:0
    ds_write_b128 v13, a[148:151] offset:1024
    s_add_u32 s46, s47, 0x470000
    buffer_load_dwordx4 a[184:187], v12, s[12:15], s46 offen nt
    s_add_u32 s46, s47, 0x478000
    buffer_load_dwordx4 a[188:191], v12, s[12:15], s46 offen nt
    s_waitcnt lgkmcnt(0)
    s_barrier
    ds_read_b64_tr_b16 a[144:145], v14 offset:0
    ds_read_b64_tr_b16 a[146:147], v14 offset:1024
    ds_read_b64_tr_b16 a[148:149], v15 offset:0
    ds_read_b64_tr_b16 a[150:151], v15 offset:1024
    s_waitcnt vmcnt(8)
    ds_write_b128 v13, a[152:155] offset:8192
    ds_write_b128 v13, a[156:159] offset:9216
    s_add_u32 s46, s47, 0x480000
    buffer_load_dwordx4 a[192:195], v12, s[12:15], s46 offen nt
    s_add_u32 s46, s47, 0x488000
    buffer_load_dwordx4 a[196:199], v12, s[12:15], s46 offen nt
    s_waitcnt lgkmcnt(0)
    s_barrier
    ds_read_b64_tr_b16 a[152:153], v14 offset:8192
    ds_read_b64_tr_b16 a[154:155], v14 offset:9216
    ds_read_b64_tr_b16 a[156:157], v15 offset:8192
    ds_read_b64_tr_b16 a[158:159], v15 offset:9216
    s_waitcnt vmcnt(8)
    ds_write_b128 v13, a[160:163] offset:0
    ds_write_b128 v13, a[164:167] offset:1024
    s_add_u32 s46, s47, 0x490000
    buffer_load_dwordx4 a[200:203], v12, s[12:15], s46 offen nt
    s_add_u32 s46, s47, 0x498000
    buffer_load_dwordx4 a[204:207], v12, s[12:15], s46 offen nt
    s_waitcnt lgkmcnt(0)
    s_barrier
    ds_read_b64_tr_b16 a[160:161], v14 offset:0
    ds_read_b64_tr_b16 a[162:163], v14 offset:1024
    ds_read_b64_tr_b16 a[164:165], v15 offset:0
    ds_read_b64_tr_b16 a[166:167], v15 offset:1024
    s_waitcnt vmcnt(8)
    ds_write_b128 v13, a[168:171] offset:8192
    ds_write_b128 v13, a[172:175] offset:9216
    s_add_u32 s46, s47, 0x4a0000
    buffer_load_dwordx4 a[208:211], v12, s[12:15], s46 offen nt
    s_add_u32 s46, s47, 0x4a8000
    buffer_load_dwordx4 a[212:215], v12, s[12:15], s46 offen nt
    s_waitcnt lgkmcnt(0)
    s_barrier
    ds_read_b64_tr_b16 a[168:169], v14 offset:8192
    ds_read_b64_tr_b16 a[170:171], v14 offset:9216
    ds_read_b64_tr_b16 a[172:173], v15 offset:8192
    ds_read_b64_tr_b16 a[174:175], v15 offset:9216
    s_waitcnt vmcnt(8)
    ds_write_b128 v13, a[176:179] offset:0
    ds_write_b128 v13, a[180:183] offset:1024
    s_add_u32 s46, s47, 0x4b0000
    buffer_load_dwordx4 a[216:219], v12, s[12:15], s46 offen nt
    s_add_u32 s46, s47, 0x4b8000
    buffer_load_dwordx4 a[220:223], v12, s[12:15], s46 offen nt
    s_waitcnt lgkmcnt(0)
    s_barrier
    ds_read_b64_tr_b16 a[176:177], v14 offset:0
    ds_read_b64_tr_b16 a[178:179], v14 offset:1024
    ds_read_b64_tr_b16 a[180:181], v15 offset:0
    ds_read_b64_tr_b16 a[182:183], v15 offset:1024
    s_waitcnt vmcnt(8)
    ds_write_b128 v13, a[184:187] offset:8192
    ds_write_b128 v13, a[188:191] offset:9216
    s_add_u32 s46, s47, 0x4c0000
    buffer_load_dwordx4 a[224:227], v12, s[12:15], s46 offen nt
    s_add_u32 s46, s47, 0x4c8000
    buffer_load_dwordx4 a[228:231], v12, s[12:15], s46 offen nt
    s_waitcnt lgkmcnt(0)
    s_barrier
    ds_read_b64_tr_b16 a[184:185], v14 offset:8192
    ds_read_b64_tr_b16 a[186:187], v14 offset:9216
    ds_read_b64_tr_b16 a[188:189], v15 offset:8192
    ds_read_b64_tr_b16 a[190:191], v15 offset:9216
    s_waitcnt vmcnt(8)
    ds_write_b128 v13, a[192:195] offset:0
    ds_write_b128 v13, a[196:199] offset:1024
    s_add_u32 s46, s47, 0x4d0000
    buffer_load_dwordx4 a[232:235], v12, s[12:15], s46 offen nt
    s_add_u32 s46, s47, 0x4d8000
    buffer_load_dwordx4 a[236:239], v12, s[12:15], s46 offen nt
    v_lshlrev_b32 v7, 5, v0
    v_min_u32 v7, 0xe4, v7
    v_cmp_eq_u32 vcc, 9, v0
    s_nop 1
    v_cndmask_b32 v6, 0, 4, vcc
    v_add_u32 v7, v7, v6
    buffer_load_dword v6, v7, s[8:11], 0 offen sc1
    s_waitcnt lgkmcnt(0)
    s_barrier
    ds_read_b64_tr_b16 a[192:193], v14 offset:0
    ds_read_b64_tr_b16 a[194:195], v14 offset:1024
    ds_read_b64_tr_b16 a[196:197], v15 offset:0
    ds_read_b64_tr_b16 a[198:199], v15 offset:1024
    s_waitcnt vmcnt(9)
    ds_write_b128 v13, a[200:203] offset:8192
    ds_write_b128 v13, a[204:207] offset:9216
    s_add_u32 s46, s47, 0x4e0000
    buffer_load_dwordx4 a[240:243], v12, s[12:15], s46 offen nt
    s_add_u32 s46, s47, 0x4e8000
    buffer_load_dwordx4 a[244:247], v12, s[12:15], s46 offen nt
    s_waitcnt lgkmcnt(0)
    s_barrier
    ds_read_b64_tr_b16 a[200:201], v14 offset:8192
    ds_read_b64_tr_b16 a[202:203], v14 offset:9216
    ds_read_b64_tr_b16 a[204:205], v15 offset:8192
    ds_read_b64_tr_b16 a[206:207], v15 offset:9216
    s_waitcnt vmcnt(9)
    ds_write_b128 v13, a[208:211] offset:0
    ds_write_b128 v13, a[212:215] offset:1024
    s_add_u32 s46, s47, 0x4f0000
    buffer_load_dwordx4 a[248:251], v12, s[12:15], s46 offen nt
    s_add_u32 s46, s47, 0x4f8000
    buffer_load_dwordx4 a[252:255], v12, s[12:15], s46 offen nt
    s_waitcnt lgkmcnt(0)
    s_barrier
    ds_read_b64_tr_b16 a[208:209], v14 offset:0
    ds_read_b64_tr_b16 a[210:211], v14 offset:1024
    ds_read_b64_tr_b16 a[212:213], v15 offset:0
    ds_read_b64_tr_b16 a[214:215], v15 offset:1024
    s_waitcnt vmcnt(9)
    ds_write_b128 v13, a[216:219] offset:8192
    ds_write_b128 v13, a[220:223] offset:9216
    s_waitcnt lgkmcnt(0)
    s_barrier
    ds_read_b64_tr_b16 a[216:217], v14 offset:8192
    ds_read_b64_tr_b16 a[218:219], v14 offset:9216
    ds_read_b64_tr_b16 a[220:221], v15 offset:8192
    ds_read_b64_tr_b16 a[222:223], v15 offset:9216
    s_waitcnt vmcnt(7)
    ds_write_b128 v13, a[224:227] offset:0
    ds_write_b128 v13, a[228:231] offset:1024
    s_waitcnt lgkmcnt(0)
    s_barrier
    ds_read_b64_tr_b16 a[224:225], v14 offset:0
    ds_read_b64_tr_b16 a[226:227], v14 offset:1024
    ds_read_b64_tr_b16 a[228:229], v15 offset:0
    ds_read_b64_tr_b16 a[230:231], v15 offset:1024
    s_waitcnt vmcnt(5)
    ds_write_b128 v13, a[232:235] offset:8192
    ds_write_b128 v13, a[236:239] offset:9216
    s_waitcnt lgkmcnt(0)
    s_barrier
    ds_read_b64_tr_b16 a[232:233], v14 offset:8192
    ds_read_b64_tr_b16 a[234:235], v14 offset:9216
    ds_read_b64_tr_b16 a[236:237], v15 offset:8192
    ds_read_b64_tr_b16 a[238:239], v15 offset:9216
    s_waitcnt vmcnt(2)
    ds_write_b128 v13, a[240:243] offset:0
    ds_write_b128 v13, a[244:247] offset:1024
    s_branch L_wi_17
L_wi_15:
    v_lshlrev_b32 v7, 5, v0
    v_min_u32 v7, 0xe4, v7
    v_cmp_eq_u32 vcc, 9, v0
    s_nop 1
    v_cndmask_b32 v6, 0, 4, vcc
    v_add_u32 v7, v7, v6
    buffer_load_dword v6, v7, s[8:11], 0 offen sc1
    s_waitcnt vmcnt(0)
L_wi_17:
    v_bcnt_u32_b32 v7, v6, 0
    s_nop 0
    v_readlane_b32 s45, v7, 0
    v_readlane_b32 s46, v7, 1
    s_nop 0
    s_add_u32 s45, s45, s46
    v_readlane_b32 s46, v7, 2
    s_nop 0
    s_add_u32 s45, s45, s46
    v_readlane_b32 s46, v7, 3
    s_nop 0
    s_add_u32 s45, s45, s46
    v_readlane_b32 s46, v7, 4
    s_nop 0
    s_add_u32 s45, s45, s46
    v_readlane_b32 s46, v7, 5
    s_nop 0
    s_add_u32 s45, s45, s46
    v_readlane_b32 s46, v7, 6
    s_nop 0
    s_add_u32 s45, s45, s46
    v_readlane_b32 s46, v7, 7
    s_nop 0
    s_add_u32 s45, s45, s46
    v_readlane_b32 s46, v6, 9
    s_nop 0
    s_add_u32 s45, s45, s46
    v_readlane_b32 s62, v6, 8
    s_nop 0
    s_lshr_b32 s46, s62, 16
    s_add_u32 s45, s45, s46
    s_cmp_ge_u32 s45, 272
    s_cbranch_scc1 L_wiok_16
    s_sleep 8
    s_sub_u32 s35, s35, 1
    s_cbranch_scc0 L_wi_15
    s_endpgm
L_wiok_16:
    s_and_b32 s62, s62, 0xffff
    s_cmp_gt_u32 s62, 8
    s_cselect_b32 s62, 0x2000, 0
    s_lshr_b32 s45, s63, 5
    v_readlane_b32 s101, v7, s45
    s_lshr_b32 s45, s48, 8
    s_xor_b32 s45, s45, s62
    s_and_b32 s45, s45, 0x2000
    s_xor_b32 s48, s48, s45
    s_lshr_b32 s45, s49, 8
    s_xor_b32 s45, s45, s62
    s_and_b32 s45, s45, 0x2000
    s_xor_b32 s49, s49, s45
    s_lshr_b32 s45, s50, 8
    s_xor_b32 s45, s45, s62
    s_and_b32 s45, s45, 0x2000
    s_xor_b32 s50, s50, s45
    s_lshr_b32 s45, s41, 8
    s_xor_b32 s45, s45, s62
    s_and_b32 s45, s45, 0x2000
    s_xor_b32 s41, s41, s45
    s_waitcnt lgkmcnt(0)
    s_barrier
    ds_read_b64_tr_b16 a[240:241], v14 offset:0
    ds_read_b64_tr_b16 a[242:243], v14 offset:1024
    ds_read_b64_tr_b16 a[244:245], v15 offset:0
    ds_read_b64_tr_b16 a[246:247], v15 offset:1024
    s_waitcnt vmcnt(0)
    ds_write_b128 v13, a[248:251] offset:8192
    ds_write_b128 v13, a[252:255] offset:9216
    s_waitcnt lgkmcnt(0)
    s_barrier
    ds_read_b64_tr_b16 a[248:249], v14 offset:8192
    ds_read_b64_tr_b16 a[250:251], v14 offset:9216
    ds_read_b64_tr_b16 a[252:253], v15 offset:8192
    ds_read_b64_tr_b16 a[254:255], v15 offset:9216
    s_waitcnt lgkmcnt(0)
    s_sub_u32 s39, s40, s39
    s_add_u32 s38, s38, 0x10000
    v_xor_b32 v4, s62, v4
    s_mov_b32 s37, 0
    s_barrier
    v_bfe_u32 v6, v0, 0, 4
    v_lshlrev_b32 v213, 7, v6
    v_bfe_u32 v6, v0, 4, 2
    v_lshl_add_u32 v213, v6, 30, v213
    s_and_b32 s45, s36, 7
    s_lshl_b32 s45, s45, 13
    s_mul_i32 s46, s32, -14336
    s_add_u32 s45, s45, s46
    s_add_u32 s45, s45, 0x10000
    v_add_u32 v213, s45, v213
    ds_read_b128 v[12:15], v2 offset:0
    ds_read_b128 v[16:19], v2 offset:33024
    ds_read_b128 v[20:23], v2 offset:16
    ds_read_b128 v[24:27], v2 offset:33040
    ds_read_b128 v[28:31], v2 offset:32
    ds_read_b128 v[32:35], v2 offset:33056
    s_waitcnt lgkmcnt(4)
    v_mfma_f32_16x16x32_bf16 v[44:47], a[0:3], v[12:15], 0
    ds_read_b128 v[36:39], v2 offset:48
    s_add_u32 m0, s39, 0
    s_add_u32 s45, s38, 0
    v_mfma_f32_16x16x32_bf16 v[52:55], a[4:7], v[12:15], 0
    buffer_load_dwordx4 v1, s[16:19], s45 offen lds
    v_mfma_f32_16x16x32_bf16 v[48:51], a[0:3], v[16:19], 0
    ds_read_b128 v[40:43], v2 offset:33072
    v_mfma_f32_16x16x32_bf16 v[56:59], a[4:7], v[16:19], 0
    s_waitcnt lgkmcnt(4)
    v_mfma_f32_16x16x32_bf16 v[44:47], a[8:11], v[20:23], v[44:47]
    ds_read_b128 v[12:15], v2 offset:64
    v_mfma_f32_16x16x32_bf16 v[52:55], a[12:15], v[20:23], v[52:55]
    buffer_load_dwordx4 v1, s[16:19], s45 offen offset:1024 lds
    v_mfma_f32_16x16x32_bf16 v[48:51], a[8:11], v[24:27], v[48:51]
    ds_read_b128 v[16:19], v2 offset:33088
    v_mfma_f32_16x16x32_bf16 v[56:59], a[12:15], v[24:27], v[56:59]
    s_waitcnt lgkmcnt(4)
    v_mfma_f32_16x16x32_bf16 v[44:47], a[16:19], v[28:31], v[44:47]
    ds_read_b128 v[20:23], v2 offset:80
    s_add_u32 m0, s39, 2064
    s_add_u32 s45, s38, 2048
    v_mfma_f32_16x16x32_bf16 v[52:55], a[20:23], v[28:31], v[52:55]
    buffer_load_dwordx4 v1, s[16:19], s45 offen lds
    v_mfma_f32_16x16x32_bf16 v[48:51], a[16:19], v[32:35], v[48:51]
    ds_read_b128 v[24:27], v2 offset:33104
    v_mfma_f32_16x16x32_bf16 v[56:59], a[20:23], v[32:35], v[56:59]
    s_waitcnt lgkmcnt(4)
    v_mfma_f32_16x16x32_bf16 v[44:47], a[24:27], v[36:39], v[44:47]
    ds_read_b128 v[28:31], v2 offset:96
    v_mfma_f32_16x16x32_bf16 v[52:55], a[28:31], v[36:39], v[52:55]
    buffer_load_dwordx4 v1, s[16:19], s45 offen offset:1024 lds
    v_mfma_f32_16x16x32_bf16 v[48:51], a[24:27], v[40:43], v[48:51]
    ds_read_b128 v[32:35], v2 offset:33120
    v_mfma_f32_16x16x32_bf16 v[56:59], a[28:31], v[40:43], v[56:59]
    s_waitcnt lgkmcnt(4)
    v_mfma_f32_16x16x32_bf16 v[44:47], a[32:35], v[12:15], v[44:47]
    ds_read_b128 v[36:39], v2 offset:112
    s_add_u32 m0, s39, 4128
    s_add_u32 s45, s38, 4096
    v_mfma_f32_16x16x32_bf16 v[52:55], a[36:39], v[12:15], v[52:55]
    buffer_load_dwordx4 v1, s[16:19], s45 offen lds
    v_mfma_f32_16x16x32_bf16 v[48:51], a[32:35], v[16:19], v[48:51]
    ds_read_b128 v[40:43], v2 offset:33136
    v_mfma_f32_16x16x32_bf16 v[56:59], a[36:39], v[16:19], v[56:59]
    s_waitcnt lgkmcnt(4)
    v_mfma_f32_16x16x32_bf16 v[44:47], a[40:43], v[20:23], v[44:47]
    ds_read_b128 v[12:15], v2 offset:128
    v_mfma_f32_16x16x32_bf16 v[52:55], a[44:47], v[20:23], v[52:55]
    buffer_load_dwordx4 v1, s[16:19], s45 offen offset:1024 lds
    v_mfma_f32_16x16x32_bf16 v[48:51], a[40:43], v[24:27], v[48:51]
    ds_read_b128 v[16:19], v2 offset:33152
    v_mfma_f32_16x16x32_bf16 v[56:59], a[44:47], v[24:27], v[56:59]
    s_waitcnt lgkmcnt(4)
    v_mfma_f32_16x16x32_bf16 v[44:47], a[48:51], v[28:31], v[44:47]
    ds_read_b128 v[20:23], v2 offset:144
    s_add_u32 m0, s39, 6192
    s_add_u32 s45, s38, 6144
    v_mfma_f32_16x16x32_bf16 v[52:55], a[52:55], v[28:31], v[52:55]
    buffer_load_dwordx4 v1, s[16:19], s45 offen lds
    v_mfma_f32_16x16x32_bf16 v[48:51], a[48:51], v[32:35], v[48:51]
    ds_read_b128 v[24:27], v2 offset:33168
    v_mfma_f32_16x16x32_bf16 v[56:59], a[52:55], v[32:35], v[56:59]
    s_waitcnt lgkmcnt(4)
    v_mfma_f32_16x16x32_bf16 v[44:47], a[56:59], v[36:39], v[44:47]
    ds_read_b128 v[28:31], v2 offset:160
    v_mfma_f32_16x16x32_bf16 v[52:55], a[60:63], v[36:39], v[52:55]
    buffer_load_dwordx4 v1, s[16:19], s45 offen offset:1024 lds
    v_mfma_f32_16x16x32_bf16 v[48:51], a[56:59], v[40:43], v[48:51]
    ds_read_b128 v[32:35], v2 offset:33184
    v_mfma_f32_16x16x32_bf16 v[56:59], a[60:63], v[40:43], v[56:59]
    s_waitcnt lgkmcnt(4)
    v_mfma_f32_16x16x32_bf16 v[44:47], a[64:67], v[12:15], v[44:47]
    ds_read_b128 v[36:39], v2 offset:176
    s_add_u32 m0, s39, 8256
    s_add_u32 s45, s38, 8192
    v_mfma_f32_16x16x32_bf16 v[52:55], a[68:71], v[12:15], v[52:55]
    buffer_load_dwordx4 v1, s[16:19], s45 offen lds
    v_mfma_f32_16x16x32_bf16 v[48:51], a[64:67], v[16:19], v[48:51]
    ds_read_b128 v[40:43], v2 offset:33200
    v_mfma_f32_16x16x32_bf16 v[56:59], a[68:71], v[16:19], v[56:59]
    s_waitcnt lgkmcnt(4)
    v_mfma_f32_16x16x32_bf16 v[44:47], a[72:75], v[20:23], v[44:47]
    ds_read_b128 v[12:15], v2 offset:192
    v_mfma_f32_16x16x32_bf16 v[52:55], a[76:79], v[20:23], v[52:55]
    buffer_load_dwordx4 v1, s[16:19], s45 offen offset:1024 lds
    v_mfma_f32_16x16x32_bf16 v[48:51], a[72:75], v[24:27], v[48:51]
    ds_read_b128 v[16:19], v2 offset:33216
    v_mfma_f32_16x16x32_bf16 v[56:59], a[76:79], v[24:27], v[56:59]
    s_waitcnt lgkmcnt(4)
    v_mfma_f32_16x16x32_bf16 v[44:47], a[80:83], v[28:31], v[44:47]
    ds_read_b128 v[20:23], v2 offset:208
    s_add_u32 m0, s39, 10320
    s_add_u32 s45, s38, 10240
    v_mfma_f32_16x16x32_bf16 v[52:55], a[84:87], v[28:31], v[52:55]
    buffer_load_dwordx4 v1, s[16:19], s45 offen lds
    v_mfma_f32_16x16x32_bf16 v[48:51], a[80:83], v[32:35], v[48:51]
    ds_read_b128 v[24:27], v2 offset:33232
    v_mfma_f32_16x16x32_bf16 v[56:59], a[84:87], v[32:35], v[56:59]
    s_waitcnt lgkmcnt(4)
    v_mfma_f32_16x16x32_bf16 v[44:47], a[88:91], v[36:39], v[44:47]
    ds_read_b128 v[28:31], v2 offset:224
    v_mfma_f32_16x16x32_bf16 v[52:55], a[92:95], v[36:39], v[52:55]
    buffer_load_dwordx4 v1, s[16:19], s45 offen offset:1024 lds
    v_mfma_f32_16x16x32_bf16 v[48:51], a[88:91], v[40:43], v[48:51]
    ds_read_b128 v[32:35], v2 offset:33248
    v_mfma_f32_16x16x32_bf16 v[56:59], a[92:95], v[40:43], v[56:59]
    s_waitcnt lgkmcnt(4)
    v_mfma_f32_16x16x32_bf16 v[44:47], a[96:99], v[12:15], v[44:47]
    ds_read_b128 v[36:39], v2 offset:240
    s_add_u32 m0, s39, 12384
    s_add_u32 s45, s38, 12288
    v_mfma_f32_16x16x32_bf16 v[52:55], a[100:103], v[12:15], v[52:55]
    buffer_load_dwordx4 v1, s[16:19], s45 offen lds
    v_mfma_f32_16x16x32_bf16 v[48:51], a[96:99], v[16:19], v[48:51]
    ds_read_b128 v[40:43], v2 offset:33264
    v_mfma_f32_16x16x32_bf16 v[56:59], a[100:103], v[16:19], v[56:59]
    s_waitcnt lgkmcnt(4)
    v_mfma_f32_16x16x32_bf16 v[44:47], a[104:107], v[20:23], v[44:47]
    ds_read_b128 v[12:15], v2 offset:1024
    v_mfma_f32_16x16x32_bf16 v[52:55], a[108:111], v[20:23], v[52:55]
    buffer_load_dwordx4 v1, s[16:19], s45 offen offset:1024 lds
    v_mfma_f32_16x16x32_bf16 v[48:51], a[104:107], v[24:27], v[48:51]
    ds_read_b128 v[16:19], v2 offset:34048
    v_mfma_f32_16x16x32_bf16 v[56:59], a[108:111], v[24:27], v[56:59]
    s_waitcnt lgkmcnt(4)
    v_mfma_f32_16x16x32_bf16 v[44:47], a[112:115], v[28:31], v[44:47]
    ds_read_b128 v[20:23], v2 offset:1040
    s_add_u32 m0, s39, 14448
    s_add_u32 s45, s38, 14336
    v_mfma_f32_16x16x32_bf16 v[52:55], a[116:119], v[28:31], v[52:55]
    buffer_load_dwordx4 v1, s[16:19], s45 offen lds
    v_mfma_f32_16x16x32_bf16 v[48:51], a[112:115], v[32:35], v[48:51]
    ds_read_b128 v[24:27], v2 offset:34064
    v_mfma_f32_16x16x32_bf16 v[56:59], a[116:119], v[32:35], v[56:59]
    s_waitcnt lgkmcnt(4)
    v_mfma_f32_16x16x32_bf16 v[44:47], a[120:123], v[36:39], v[44:47]
    ds_read_b128 v[28:31], v2 offset:1056
    v_mfma_f32_16x16x32_bf16 v[52:55], a[124:127], v[36:39], v[52:55]
    buffer_load_dwordx4 v1, s[16:19], s45 offen offset:1024 lds
    v_mfma_f32_16x16x32_bf16 v[48:51], a[120:123], v[40:43], v[48:51]
    ds_read_b128 v[32:35], v2 offset:34080
    s_sub_u32 s39, s40, s39
    s_add_u32 s38, s38, 0x10000
    v_mfma_f32_16x16x32_bf16 v[56:59], a[124:127], v[40:43], v[56:59]
    s_waitcnt lgkmcnt(4)
    v_mfma_f32_16x16x32_bf16 v[44:47], a[128:131], v[12:15], v[44:47]
    ds_read_b128 v[36:39], v2 offset:1072
    v_mfma_f32_16x16x32_bf16 v[52:55], a[132:135], v[12:15], v[52:55]
    v_mfma_f32_16x16x32_bf16 v[48:51], a[128:131], v[16:19], v[48:51]
    ds_read_b128 v[40:43], v2 offset:34096
    v_mfma_f32_16x16x32_bf16 v[56:59], a[132:135], v[16:19], v[56:59]
    s_waitcnt lgkmcnt(4)
    v_mfma_f32_16x16x32_bf16 v[44:47], a[136:139], v[20:23], v[44:47]
    ds_read_b128 v[12:15], v2 offset:1088
    v_mfma_f32_16x16x32_bf16 v[52:55], a[140:143], v[20:23], v[52:55]
    v_mfma_f32_16x16x32_bf16 v[48:51], a[136:139], v[24:27], v[48:51]
    ds_read_b128 v[16:19], v2 offset:34112
    v_mfma_f32_16x16x32_bf16 v[56:59], a[140:143], v[24:27], v[56:59]
    s_waitcnt lgkmcnt(4)
    v_mfma_f32_16x16x32_bf16 v[44:47], a[144:147], v[28:31], v[44:47]
    ds_read_b128 v[20:23], v2 offset:1104
    v_mfma_f32_16x16x32_bf16 v[52:55], a[148:151], v[28:31], v[52:55]
    v_mfma_f32_16x16x32_bf16 v[48:51], a[144:147], v[32:35], v[48:51]
    ds_read_b128 v[24:27], v2 offset:34128
    v_mfma_f32_16x16x32_bf16 v[56:59], a[148:151], v[32:35], v[56:59]
    s_waitcnt lgkmcnt(4)
    v_mfma_f32_16x16x32_bf16 v[44:47], a[152:155], v[36:39], v[44:47]
    ds_read_b128 v[28:31], v2 offset:1120
    v_mfma_f32_16x16x32_bf16 v[52:55], a[156:159], v[36:39], v[52:55]
    v_mfma_f32_16x16x32_bf16 v[48:51], a[152:155], v[40:43], v[48:51]
    ds_read_b128 v[32:35], v2 offset:34144
    v_mfma_f32_16x16x32_bf16 v[56:59], a[156:159], v[40:43], v[56:59]
    s_waitcnt lgkmcnt(4)
    v_mfma_f32_16x16x32_bf16 v[44:47], a[160:163], v[12:15], v[44:47]
    ds_read_b128 v[36:39], v2 offset:1136
    v_mfma_f32_16x16x32_bf16 v[52:55], a[164:167], v[12:15], v[52:55]
    v_mfma_f32_16x16x32_bf16 v[48:51], a[160:163], v[16:19], v[48:51]
    ds_read_b128 v[40:43], v2 offset:34160
    v_mfma_f32_16x16x32_bf16 v[56:59], a[164:167], v[16:19], v[56:59]
    s_waitcnt lgkmcnt(4)
    v_mfma_f32_16x16x32_bf16 v[44:47], a[168:171], v[20:23], v[44:47]
    ds_read_b128 v[12:15], v2 offset:1152
    v_mfma_f32_16x16x32_bf16 v[52:55], a[172:175], v[20:23], v[52:55]
    v_mfma_f32_16x16x32_bf16 v[48:51], a[168:171], v[24:27], v[48:51]
    ds_read_b128 v[16:19], v2 offset:34176
    v_mfma_f32_16x16x32_bf16 v[56:59], a[172:175], v[24:27], v[56:59]
    s_waitcnt lgkmcnt(4)
    v_mfma_f32_16x16x32_bf16 v[44:47], a[176:179], v[28:31], v[44:47]
    ds_read_b128 v[20:23], v2 offset:1168
    v_mfma_f32_16x16x32_bf16 v[52:55], a[180:183], v[28:31], v[52:55]
    v_mfma_f32_16x16x32_bf16 v[48:51], a[176:179], v[32:35], v[48:51]
    ds_read_b128 v[24:27], v2 offset:34192
    v_mfma_f32_16x16x32_bf16 v[56:59], a[180:183], v[32:35], v[56:59]
    s_waitcnt lgkmcnt(4)
    v_mfma_f32_16x16x32_bf16 v[44:47], a[184:187], v[36:39], v[44:47]
    ds_read_b128 v[28:31], v2 offset:1184
    v_mfma_f32_16x16x32_bf16 v[52:55], a[188:191], v[36:39], v[52:55]
    v_mfma_f32_16x16x32_bf16 v[48:51], a[184:187], v[40:43], v[48:51]
    ds_read_b128 v[32:35], v2 offset:34208
    v_mfma_f32_16x16x32_bf16 v[56:59], a[188:191], v[40:43], v[56:59]
    s_waitcnt lgkmcnt(4)
    v_mfma_f32_16x16x32_bf16 v[44:47], a[192:195], v[12:15], v[44:47]
    ds_read_b128 v[36:39], v2 offset:1200
    v_mfma_f32_16x16x32_bf16 v[52:55], a[196:199], v[12:15], v[52:55]
    v_mfma_f32_16x16x32_bf16 v[48:51], a[192:195], v[16:19], v[48:51]
    ds_read_b128 v[40:43], v2 offset:34224
    v_mfma_f32_16x16x32_bf16 v[56:59], a[196:199], v[16:19], v[56:59]
    s_waitcnt lgkmcnt(4)
    v_mfma_f32_16x16x32_bf16 v[44:47], a[200:203], v[20:23], v[44:47]
    ds_read_b128 v[12:15], v2 offset:1216
    v_mfma_f32_16x16x32_bf16 v[52:55], a[204:207], v[20:23], v[52:55]
    v_mfma_f32_16x16x32_bf16 v[48:51], a[200:203], v[24:27], v[48:51]
    ds_read_b128 v[16:19], v2 offset:34240
    v_mfma_f32_16x16x32_bf16 v[56:59], a[204:207], v[24:27], v[56:59]
    s_waitcnt lgkmcnt(4)
    v_mfma_f32_16x16x32_bf16 v[44:47], a[208:211], v[28:31], v[44:47]
    ds_read_b128 v[20:23], v2 offset:1232
    v_mfma_f32_16x16x32_bf16 v[52:55], a[212:215], v[28:31], v[52:55]
    v_mfma_f32_16x16x32_bf16 v[48:51], a[208:211], v[32:35], v[48:51]
    ds_read_b128 v[24:27], v2 offset:34256
    v_mfma_f32_16x16x32_bf16 v[56:59], a[212:215], v[32:35], v[56:59]
    s_waitcnt lgkmcnt(4)
    v_mfma_f32_16x16x32_bf16 v[44:47], a[216:219], v[36:39], v[44:47]
    ds_read_b128 v[28:31], v2 offset:1248
    v_mfma_f32_16x16x32_bf16 v[52:55], a[220:223], v[36:39], v[52:55]
    v_mfma_f32_16x16x32_bf16 v[48:51], a[216:219], v[40:43], v[48:51]
    ds_read_b128 v[32:35], v2 offset:34272
    v_mfma_f32_16x16x32_bf16 v[56:59], a[220:223], v[40:43], v[56:59]
    s_waitcnt lgkmcnt(4)
    v_mfma_f32_16x16x32_bf16 v[44:47], a[224:227], v[12:15], v[44:47]
    ds_read_b128 v[36:39], v2 offset:1264
    v_mfma_f32_16x16x32_bf16 v[52:55], a[228:231], v[12:15], v[52:55]
    v_mfma_f32_16x16x32_bf16 v[48:51], a[224:227], v[16:19], v[48:51]
    ds_read_b128 v[40:43], v2 offset:34288
    v_mfma_f32_16x16x32_bf16 v[56:59], a[228:231], v[16:19], v[56:59]
    s_waitcnt lgkmcnt(4)
    v_mfma_f32_16x16x32_bf16 v[44:47], a[232:235], v[20:23], v[44:47]
    v_mfma_f32_16x16x32_bf16 v[52:55], a[236:239], v[20:23], v[52:55]
    v_mfma_f32_16x16x32_bf16 v[48:51], a[232:235], v[24:27], v[48:51]
    v_mfma_f32_16x16x32_bf16 v[56:59], a[236:239], v[24:27], v[56:59]
    s_waitcnt lgkmcnt(2)
    v_mfma_f32_16x16x32_bf16 v[44:47], a[240:243], v[28:31], v[44:47]
    v_mfma_f32_16x16x32_bf16 v[52:55], a[244:247], v[28:31], v[52:55]
    v_mfma_f32_16x16x32_bf16 v[48:51], a[240:243], v[32:35], v[48:51]
    v_mfma_f32_16x16x32_bf16 v[56:59], a[244:247], v[32:35], v[56:59]
    s_waitcnt lgkmcnt(0)
    v_mfma_f32_16x16x32_bf16 v[44:47], a[248:251], v[36:39], v[44:47]
    v_mfma_f32_16x16x32_bf16 v[52:55], a[252:255], v[36:39], v[52:55]
    v_mfma_f32_16x16x32_bf16 v[48:51], a[248:251], v[40:43], v[48:51]
    v_mfma_f32_16x16x32_bf16 v[56:59], a[252:255], v[40:43], v[56:59]
    v_sub_u32 v2, v3, v2
    v_cvt_pk_bf16_f32 v60, v44, v52
    v_cvt_pk_bf16_f32 v61, v45, v53
    v_cvt_pk_bf16_f32 v62, v46, v54
    v_cvt_pk_bf16_f32 v63, v47, v55
    s_nop 1
    v_cvt_pk_bf16_f32 v64, v48, v56
    v_cvt_pk_bf16_f32 v65, v49, v57
    v_cvt_pk_bf16_f32 v66, v50, v58
    v_cvt_pk_bf16_f32 v67, v51, v59
    ds_write_b64 v72, v[60:61] offset:0
    ds_write_b64 v72, v[62:63] offset:8
    ds_write_b64 v72, v[64:65] offset:4096
    ds_write_b64 v72, v[66:67] offset:4104
    s_waitcnt vmcnt(0) lgkmcnt(0)
L_wf_18:
    buffer_load_dword v6, v9, s[4:7], 0 offen sc1
    s_waitcnt vmcnt(0)
    v_cmp_gt_i32 vcc, 2, v6
    s_cbranch_vccz L_wfok_19
    s_sleep 4
    s_sub_u32 s35, s35, 1
    s_cbranch_scc0 L_wf_18
    s_endpgm
L_wfok_19:
    s_barrier
    ds_read_b128 v[12:15], v2 offset:0
    ds_read_b128 v[16:19], v2 offset:33024
    ds_read_b128 v[20:23], v2 offset:16
    ds_read_b128 v[24:27], v2 offset:33040
    ds_read_b128 v[28:31], v2 offset:32
    ds_read_b128 v[32:35], v2 offset:33056
    s_waitcnt lgkmcnt(4)
    v_mfma_f32_16x16x32_bf16 v[44:47], a[0:3], v[12:15], 0
    ds_read_b128 v[36:39], v2 offset:48
    s_add_u32 m0, s39, 0
    s_add_u32 s45, s38, 0
    v_mfma_f32_16x16x32_bf16 v[52:55], a[4:7], v[12:15], 0
    buffer_load_dwordx4 v1, s[16:19], s45 offen lds
    v_mfma_f32_16x16x32_bf16 v[48:51], a[0:3], v[16:19], 0
    ds_read_b128 v[40:43], v2 offset:33072
    v_mfma_f32_16x16x32_bf16 v[56:59], a[4:7], v[16:19], 0
    s_waitcnt lgkmcnt(4)
    v_mfma_f32_16x16x32_bf16 v[44:47], a[8:11], v[20:23], v[44:47]
    ds_read_b128 v[12:15], v2 offset:64
    v_mfma_f32_16x16x32_bf16 v[52:55], a[12:15], v[20:23], v[52:55]
    buffer_load_dwordx4 v1, s[16:19], s45 offen offset:1024 lds
    v_mfma_f32_16x16x32_bf16 v[48:51], a[8:11], v[24:27], v[48:51]
    ds_read_b128 v[16:19], v2 offset:33088
    v_mfma_f32_16x16x32_bf16 v[56:59], a[12:15], v[24:27], v[56:59]
    s_waitcnt lgkmcnt(4)
    v_mfma_f32_16x16x32_bf16 v[44:47], a[16:19], v[28:31], v[44:47]
    ds_read_b128 v[20:23], v2 offset:80
    s_add_u32 m0, s39, 2064
    s_add_u32 s45, s38, 2048
    v_mfma_f32_16x16x32_bf16 v[52:55], a[20:23], v[28:31], v[52:55]
    buffer_load_dwordx4 v1, s[16:19], s45 offen lds
    v_mfma_f32_16x16x32_bf16 v[48:51], a[16:19], v[32:35], v[48:51]
    ds_read_b128 v[24:27], v2 offset:33104
    v_mfma_f32_16x16x32_bf16 v[56:59], a[20:23], v[32:35], v[56:59]
    s_waitcnt lgkmcnt(4)
    v_mfma_f32_16x16x32_bf16 v[44:47], a[24:27], v[36:39], v[44:47]
    ds_read_b128 v[28:31], v2 offset:96
    v_mfma_f32_16x16x32_bf16 v[52:55], a[28:31], v[36:39], v[52:55]
    buffer_load_dwordx4 v1, s[16:19], s45 offen offset:1024 lds
    v_mfma_f32_16x16x32_bf16 v[48:51], a[24:27], v[40:43], v[48:51]
    ds_read_b128 v[32:35], v2 offset:33120
    v_mfma_f32_16x16x32_bf16 v[56:59], a[28:31], v[40:43], v[56:59]
    s_waitcnt lgkmcnt(4)
    v_mfma_f32_16x16x32_bf16 v[44:47], a[32:35], v[12:15], v[44:47]
    ds_read_b128 v[36:39], v2 offset:112
    s_add_u32 m0, s39, 4128
    s_add_u32 s45, s38, 4096
    v_mfma_f32_16x16x32_bf16 v[52:55], a[36:39], v[12:15], v[52:55]
    buffer_load_dwordx4 v1, s[16:19], s45 offen lds
    v_mfma_f32_16x16x32_bf16 v[48:51], a[32:35], v[16:19], v[48:51]
    ds_read_b128 v[40:43], v2 offset:33136
    v_mfma_f32_16x16x32_bf16 v[56:59], a[36:39], v[16:19], v[56:59]
    s_waitcnt lgkmcnt(4)
    v_mfma_f32_16x16x32_bf16 v[44:47], a[40:43], v[20:23], v[44:47]
    ds_read_b128 v[12:15], v2 offset:128
    v_mfma_f32_16x16x32_bf16 v[52:55], a[44:47], v[20:23], v[52:55]
    buffer_load_dwordx4 v1, s[16:19], s45 offen offset:1024 lds
    v_mfma_f32_16x16x32_bf16 v[48:51], a[40:43], v[24:27], v[48:51]
    ds_read_b128 v[16:19], v2 offset:33152
    v_mfma_f32_16x16x32_bf16 v[56:59], a[44:47], v[24:27], v[56:59]
    s_waitcnt lgkmcnt(4)
    v_mfma_f32_16x16x32_bf16 v[44:47], a[48:51], v[28:31], v[44:47]
    ds_read_b128 v[20:23], v2 offset:144
    s_add_u32 m0, s39, 6192
    s_add_u32 s45, s38, 6144
    v_mfma_f32_16x16x32_bf16 v[52:55], a[52:55], v[28:31], v[52:55]
    buffer_load_dwordx4 v1, s[16:19], s45 offen lds
    v_mfma_f32_16x16x32_bf16 v[48:51], a[48:51], v[32:35], v[48:51]
    ds_read_b128 v[24:27], v2 offset:33168
    v_mfma_f32_16x16x32_bf16 v[56:59], a[52:55], v[32:35], v[56:59]
    s_waitcnt lgkmcnt(4)
    v_mfma_f32_16x16x32_bf16 v[44:47], a[56:59], v[36:39], v[44:47]
    ds_read_b128 v[28:31], v2 offset:160
    v_mfma_f32_16x16x32_bf16 v[52:55], a[60:63], v[36:39], v[52:55]
    buffer_load_dwordx4 v1, s[16:19], s45 offen offset:1024 lds
    v_mfma_f32_16x16x32_bf16 v[48:51], a[56:59], v[40:43], v[48:51]
    ds_read_b128 v[32:35], v2 offset:33184
    v_mfma_f32_16x16x32_bf16 v[56:59], a[60:63], v[40:43], v[56:59]
    s_waitcnt lgkmcnt(4)
    v_mfma_f32_16x16x32_bf16 v[44:47], a[64:67], v[12:15], v[44:47]
    ds_read_b128 v[36:39], v2 offset:176
    s_add_u32 m0, s39, 8256
    s_add_u32 s45, s38, 8192
    v_mfma_f32_16x16x32_bf16 v[52:55], a[68:71], v[12:15], v[52:55]
    buffer_load_dwordx4 v1, s[16:19], s45 offen lds
    v_mfma_f32_16x16x32_bf16 v[48:51], a[64:67], v[16:19], v[48:51]
    ds_read_b128 v[40:43], v2 offset:33200
    v_mfma_f32_16x16x32_bf16 v[56:59], a[68:71], v[16:19], v[56:59]
    s_waitcnt lgkmcnt(4)
    v_mfma_f32_16x16x32_bf16 v[44:47], a[72:75], v[20:23], v[44:47]
    ds_read_b128 v[12:15], v2 offset:192
    v_mfma_f32_16x16x32_bf16 v[52:55], a[76:79], v[20:23], v[52:55]
    buffer_load_dwordx4 v1, s[16:19], s45 offen offset:1024 lds
    v_mfma_f32_16x16x32_bf16 v[48:51], a[72:75], v[24:27], v[48:51]
    ds_read_b128 v[16:19], v2 offset:33216
    v_mfma_f32_16x16x32_bf16 v[56:59], a[76:79], v[24:27], v[56:59]
    s_waitcnt lgkmcnt(4)
    v_mfma_f32_16x16x32_bf16 v[44:47], a[80:83], v[28:31], v[44:47]
    ds_read_b128 v[20:23], v2 offset:208
    s_add_u32 m0, s39, 10320
    s_add_u32 s45, s38, 10240
    v_mfma_f32_16x16x32_bf16 v[52:55], a[84:87], v[28:31], v[52:55]
    buffer_load_dwordx4 v1, s[16:19], s45 offen lds
    v_mfma_f32_16x16x32_bf16 v[48:51], a[80:83], v[32:35], v[48:51]
    ds_read_b128 v[24:27], v2 offset:33232
    v_mfma_f32_16x16x32_bf16 v[56:59], a[84:87], v[32:35], v[56:59]
    s_waitcnt lgkmcnt(4)
    v_mfma_f32_16x16x32_bf16 v[44:47], a[88:91], v[36:39], v[44:47]
    ds_read_b128 v[28:31], v2 offset:224
    v_mfma_f32_16x16x32_bf16 v[52:55], a[92:95], v[36:39], v[52:55]
    buffer_load_dwordx4 v1, s[16:19], s45 offen offset:1024 lds
    v_mfma_f32_16x16x32_bf16 v[48:51], a[88:91], v[40:43], v[48:51]
    ds_read_b128 v[32:35], v2 offset:33248
    v_mfma_f32_16x16x32_bf16 v[56:59], a[92:95], v[40:43], v[56:59]
    s_waitcnt lgkmcnt(4)
    v_mfma_f32_16x16x32_bf16 v[44:47], a[96:99], v[12:15], v[44:47]
    ds_read_b128 v[36:39], v2 offset:240
    s_add_u32 m0, s39, 12384
    s_add_u32 s45, s38, 12288
    v_mfma_f32_16x16x32_bf16 v[52:55], a[100:103], v[12:15], v[52:55]
    buffer_load_dwordx4 v1, s[16:19], s45 offen lds
    v_mfma_f32_16x16x32_bf16 v[48:51], a[96:99], v[16:19], v[48:51]
    ds_read_b128 v[40:43], v2 offset:33264
    v_mfma_f32_16x16x32_bf16 v[56:59], a[100:103], v[16:19], v[56:59]
    s_waitcnt lgkmcnt(4)
    v_mfma_f32_16x16x32_bf16 v[44:47], a[104:107], v[20:23], v[44:47]
    ds_read_b128 v[12:15], v2 offset:1024
    v_mfma_f32_16x16x32_bf16 v[52:55], a[108:111], v[20:23], v[52:55]
    buffer_load_dwordx4 v1, s[16:19], s45 offen offset:1024 lds
    v_mfma_f32_16x16x32_bf16 v[48:51], a[104:107], v[24:27], v[48:51]
    ds_read_b128 v[16:19], v2 offset:34048
    v_mfma_f32_16x16x32_bf16 v[56:59], a[108:111], v[24:27], v[56:59]
    s_waitcnt lgkmcnt(4)
    v_mfma_f32_16x16x32_bf16 v[44:47], a[112:115], v[28:31], v[44:47]
    ds_read_b128 v[20:23], v2 offset:1040
    s_add_u32 m0, s39, 14448
    s_add_u32 s45, s38, 14336
    v_mfma_f32_16x16x32_bf16 v[52:55], a[116:119], v[28:31], v[52:55]
    buffer_load_dwordx4 v1, s[16:19], s45 offen lds
    v_mfma_f32_16x16x32_bf16 v[48:51], a[112:115], v[32:35], v[48:51]
    ds_read_b128 v[24:27], v2 offset:34064
    v_mfma_f32_16x16x32_bf16 v[56:59], a[116:119], v[32:35], v[56:59]
    s_waitcnt lgkmcnt(4)
    v_mfma_f32_16x16x32_bf16 v[44:47], a[120:123], v[36:39], v[44:47]
    ds_read_b128 v[28:31], v2 offset:1056
    v_mfma_f32_16x16x32_bf16 v[52:55], a[124:127], v[36:39], v[52:55]
    buffer_load_dwordx4 v1, s[16:19], s45 offen offset:1024 lds
    v_mfma_f32_16x16x32_bf16 v[48:51], a[120:123], v[40:43], v[48:51]
    ds_read_b128 v[32:35], v2 offset:34080
    s_sub_u32 s39, s40, s39
    s_add_u32 s38, s38, 0x10000
    v_mfma_f32_16x16x32_bf16 v[56:59], a[124:127], v[40:43], v[56:59]
    s_waitcnt lgkmcnt(4)
    v_mfma_f32_16x16x32_bf16 v[44:47], a[128:131], v[12:15], v[44:47]
    ds_read_b128 v[36:39], v2 offset:1072
    s_mov_b32 m0, s51
    s_nop 0
    v_mfma_f32_16x16x32_bf16 v[52:55], a[132:135], v[12:15], v[52:55]
    buffer_load_dwordx4 v1, s[4:7], s48 offen offset:0 sc1 lds
    v_mfma_f32_16x16x32_bf16 v[48:51], a[128:131], v[16:19], v[48:51]
    ds_read_b128 v[40:43], v2 offset:34096
    v_mfma_f32_16x16x32_bf16 v[56:59], a[132:135], v[16:19], v[56:59]
    s_waitcnt lgkmcnt(4)
    v_mfma_f32_16x16x32_bf16 v[44:47], a[136:139], v[20:23], v[44:47]
    ds_read_b128 v[12:15], v2 offset:1088
    v_mfma_f32_16x16x32_bf16 v[52:55], a[140:143], v[20:23], v[52:55]
    buffer_load_dwordx4 v1, s[4:7], s48 offen offset:1024 sc1 lds
    v_mfma_f32_16x16x32_bf16 v[48:51], a[136:139], v[24:27], v[48:51]
    ds_read_b128 v[16:19], v2 offset:34112
    v_mfma_f32_16x16x32_bf16 v[56:59], a[140:143], v[24:27], v[56:59]
    s_waitcnt lgkmcnt(4)
    v_mfma_f32_16x16x32_bf16 v[44:47], a[144:147], v[28:31], v[44:47]
    ds_read_b128 v[20:23], v2 offset:1104
    v_mfma_f32_16x16x32_bf16 v[52:55], a[148:151], v[28:31], v[52:55]
    buffer_load_dwordx4 v1, s[4:7], s48 offen offset:2048 sc1 lds
    v_mfma_f32_16x16x32_bf16 v[48:51], a[144:147], v[32:35], v[48:51]
    ds_read_b128 v[24:27], v2 offset:34128
    v_mfma_f32_16x16x32_bf16 v[56:59], a[148:151], v[32:35], v[56:59]
    s_waitcnt lgkmcnt(4)
    v_mfma_f32_16x16x32_bf16 v[44:47], a[152:155], v[36:39], v[44:47]
    ds_read_b128 v[28:31], v2 offset:1120
    v_mfma_f32_16x16x32_bf16 v[52:55], a[156:159], v[36:39], v[52:55]
    buffer_load_dwordx4 v1, s[4:7], s48 offen offset:3072 sc1 lds
    v_mfma_f32_16x16x32_bf16 v[48:51], a[152:155], v[40:43], v[48:51]
    ds_read_b128 v[32:35], v2 offset:34144
    s_add_u32 s48, s48, 0x4000
    v_mov_b32 v75, 0
    v_mfma_f32_16x16x32_bf16 v[56:59], a[156:159], v[40:43], v[56:59]
    s_waitcnt lgkmcnt(4)
    v_mfma_f32_16x16x32_bf16 v[44:47], a[160:163], v[12:15], v[44:47]
    ds_read_b128 v[36:39], v2 offset:1136
    v_mfma_f32_16x16x32_bf16 v[52:55], a[164:167], v[12:15], v[52:55]
    buffer_atomic_add v75, v74, s[4:7], s49 offen sc0 sc1
    v_mfma_f32_16x16x32_bf16 v[48:51], a[160:163], v[16:19], v[48:51]
    ds_read_b128 v[40:43], v2 offset:34160
    v_mfma_f32_16x16x32_bf16 v[56:59], a[164:167], v[16:19], v[56:59]
    s_waitcnt lgkmcnt(4)
    v_mfma_f32_16x16x32_bf16 v[44:47], a[168:171], v[20:23], v[44:47]
    ds_read_b128 v[12:15], v2 offset:1152
    v_mfma_f32_16x16x32_bf16 v[52:55], a[172:175], v[20:23], v[52:55]
    v_mfma_f32_16x16x32_bf16 v[48:51], a[168:171], v[24:27], v[48:51]
    ds_read_b128 v[16:19], v2 offset:34176
    v_mfma_f32_16x16x32_bf16 v[56:59], a[172:175], v[24:27], v[56:59]
    s_waitcnt lgkmcnt(4)
    v_mfma_f32_16x16x32_bf16 v[44:47], a[176:179], v[28:31], v[44:47]
    ds_read_b128 v[20:23], v2 offset:1168
    v_mfma_f32_16x16x32_bf16 v[52:55], a[180:183], v[28:31], v[52:55]
    v_mfma_f32_16x16x32_bf16 v[48:51], a[176:179], v[32:35], v[48:51]
    ds_read_b128 v[24:27], v2 offset:34192
    v_mfma_f32_16x16x32_bf16 v[56:59], a[180:183], v[32:35], v[56:59]
    s_waitcnt lgkmcnt(4)
    v_mfma_f32_16x16x32_bf16 v[44:47], a[184:187], v[36:39], v[44:47]
    ds_read_b128 v[28:31], v2 offset:1184
    v_mfma_f32_16x16x32_bf16 v[52:55], a[188:191], v[36:39], v[52:55]
    v_mfma_f32_16x16x32_bf16 v[48:51], a[184:187], v[40:43], v[48:51]
    ds_read_b128 v[32:35], v2 offset:34208
    v_mfma_f32_16x16x32_bf16 v[56:59], a[188:191], v[40:43], v[56:59]
    s_waitcnt lgkmcnt(4)
    v_mfma_f32_16x16x32_bf16 v[44:47], a[192:195], v[12:15], v[44:47]
    ds_read_b128 v[36:39], v2 offset:1200
    v_mfma_f32_16x16x32_bf16 v[52:55], a[196:199], v[12:15], v[52:55]
    v_mfma_f32_16x16x32_bf16 v[48:51], a[192:195], v[16:19], v[48:51]
    ds_read_b128 v[40:43], v2 offset:34224
    v_mfma_f32_16x16x32_bf16 v[56:59], a[196:199], v[16:19], v[56:59]
    s_waitcnt lgkmcnt(4)
    v_mfma_f32_16x16x32_bf16 v[44:47], a[200:203], v[20:23], v[44:47]
    ds_read_b128 v[12:15], v2 offset:1216
    v_mfma_f32_16x16x32_bf16 v[52:55], a[204:207], v[20:23], v[52:55]
    v_mfma_f32_16x16x32_bf16 v[48:51], a[200:203], v[24:27], v[48:51]
    ds_read_b128 v[16:19], v2 offset:34240
    v_mfma_f32_16x16x32_bf16 v[56:59], a[204:207], v[24:27], v[56:59]
    s_waitcnt lgkmcnt(4)
    v_mfma_f32_16x16x32_bf16 v[44:47], a[208:211], v[28:31], v[44:47]
    ds_read_b128 v[20:23], v2 offset:1232
    v_mfma_f32_16x16x32_bf16 v[52:55], a[212:215], v[28:31], v[52:55]
    v_mfma_f32_16x16x32_bf16 v[48:51], a[208:211], v[32:35], v[48:51]
    ds_read_b128 v[24:27], v2 offset:34256
    v_mfma_f32_16x16x32_bf16 v[56:59], a[212:215], v[32:35], v[56:59]
    s_waitcnt lgkmcnt(4)
    v_mfma_f32_16x16x32_bf16 v[44:47], a[216:219], v[36:39], v[44:47]
    ds_read_b128 v[28:31], v2 offset:1248
    v_mfma_f32_16x16x32_bf16 v[52:55], a[220:223], v[36:39], v[52:55]
    v_mfma_f32_16x16x32_bf16 v[48:51], a[216:219], v[40:43], v[48:51]
    ds_read_b128 v[32:35], v2 offset:34272
    v_mfma_f32_16x16x32_bf16 v[56:59], a[220:223], v[40:43], v[56:59]
    s_waitcnt lgkmcnt(4)
    v_mfma_f32_16x16x32_bf16 v[44:47], a[224:227], v[12:15], v[44:47]
    ds_read_b128 v[36:39], v2 offset:1264
    v_mfma_f32_16x16x32_bf16 v[52:55], a[228:231], v[12:15], v[52:55]
    v_mfma_f32_16x16x32_bf16 v[48:51], a[224:227], v[16:19], v[48:51]
    ds_read_b128 v[40:43], v2 offset:34288
    v_mfma_f32_16x16x32_bf16 v[56:59], a[228:231], v[16:19], v[56:59]
    s_waitcnt lgkmcnt(4)
    v_mfma_f32_16x16x32_bf16 v[44:47], a[232:235], v[20:23], v[44:47]
    v_mfma_f32_16x16x32_bf16 v[52:55], a[236:239], v[20:23], v[52:55]
    v_mfma_f32_16x16x32_bf16 v[48:51], a[232:235], v[24:27], v[48:51]
    v_mfma_f32_16x16x32_bf16 v[56:59], a[236:239], v[24:27], v[56:59]
    s_waitcnt lgkmcnt(2)
    v_mfma_f32_16x16x32_bf16 v[44:47], a[240:243], v[28:31], v[44:47]
    v_mfma_f32_16x16x32_bf16 v[52:55], a[244:247], v[28:31], v[52:55]
    v_mfma_f32_16x16x32_bf16 v[48:51], a[240:243], v[32:35], v[48:51]
    v_mfma_f32_16x16x32_bf16 v[56:59], a[244:247], v[32:35], v[56:59]
    s_waitcnt lgkmcnt(0)
    v_mfma_f32_16x16x32_bf16 v[44:47], a[248:251], v[36:39], v[44:47]
    v_mfma_f32_16x16x32_bf16 v[52:55], a[252:255], v[36:39], v[52:55]
    v_mfma_f32_16x16x32_bf16 v[48:51], a[248:251], v[40:43], v[48:51]
    v_mfma_f32_16x16x32_bf16 v[56:59], a[252:255], v[40:43], v[56:59]
    v_sub_u32 v2, v3, v2
    v_cvt_pk_bf16_f32 v60, v44, v52
    v_cvt_pk_bf16_f32 v61, v45, v53
    v_cvt_pk_bf16_f32 v62, v46, v54
    v_cvt_pk_bf16_f32 v63, v47, v55
    s_nop 1
    v_cvt_pk_bf16_f32 v64, v48, v56
    v_cvt_pk_bf16_f32 v65, v49, v57
    v_cvt_pk_bf16_f32 v66, v50, v58
    v_cvt_pk_bf16_f32 v67, v51, v59
    s_waitcnt vmcnt(0)
    v_cmp_eq_u32 vcc, -1, v75
    s_barrier
    .p2align 6
L_q_loop:
    s_cbranch_vccz L_q_go
L_pd_20:
    v_mov_b32 v75, 0
    buffer_atomic_add v75, v74, s[4:7], s49 offen sc0 sc1
    s_waitcnt vmcnt(0)
    v_max_u32 v6, v75, v75
    v_cmp_eq_u32 vcc, -1, v6
    s_cbranch_vccz L_pdok_21
    s_sleep 4
    s_sub_u32 s35, s35, 1
    s_cbranch_scc0 L_pd_20
    s_endpgm
L_pdok_21:
L_q_go:
    ds_read_b128 v[12:15], v2 offset:0
    ds_read_b128 v[16:19], v2 offset:33024
    ds_read_b128 v[20:23], v2 offset:16
    ds_read_b128 v[24:27], v2 offset:33040
    ds_read_b128 v[28:31], v2 offset:32
    ds_read_b128 v[32:35], v2 offset:33056
    s_waitcnt lgkmcnt(4)
    v_mfma_f32_16x16x32_bf16 v[44:47], a[0:3], v[12:15], 0
    ds_read_b128 v[36:39], v2 offset:48
    v_mfma_f32_16x16x32_bf16 v[52:55], a[4:7], v[12:15], 0
    buffer_load_dwordx4 v[128:131], v1, s[4:7], s49 offen offset:0 sc1
    v_mfma_f32_16x16x32_bf16 v[48:51], a[0:3], v[16:19], 0
    ds_read_b128 v[40:43], v2 offset:33072
    ds_read_b128 v[140:143], v5 offset:0
    v_mfma_f32_16x16x32_bf16 v[56:59], a[4:7], v[16:19], 0
    s_waitcnt lgkmcnt(5)
    ds_read_b128 v[144:147], v5 offset:1024
    v_mfma_f32_16x16x32_bf16 v[44:47], a[8:11], v[20:23], v[44:47]
    ds_read_b128 v[12:15], v2 offset:64
    v_mov_b32 v164, 0
    v_mov_b32 v165, 0
    v_mfma_f32_16x16x32_bf16 v[52:55], a[12:15], v[20:23], v[52:55]
    buffer_load_dwordx4 v[132:135], v1, s[4:7], s49 offen offset:1024 sc1
    v_mfma_f32_16x16x32_bf16 v[48:51], a[8:11], v[24:27], v[48:51]
    ds_read_b128 v[16:19], v2 offset:33088
    ds_read_b128 v[148:151], v5 offset:2048
    v_mov_b32 v166, 0
    v_mfma_f32_16x16x32_bf16 v[56:59], a[12:15], v[24:27], v[56:59]
    s_waitcnt lgkmcnt(7)
    ds_read_b128 v[152:155], v5 offset:3072
    v_mov_b32 v167, 0
    v_mfma_f32_16x16x32_bf16 v[44:47], a[16:19], v[28:31], v[44:47]
    ds_read_b128 v[20:23], v2 offset:80
    v_mfma_f32_16x16x32_bf16 v[52:55], a[20:23], v[28:31], v[52:55]
    buffer_load_dwordx4 v[136:139], v1, s[4:7], s50 offen offset:2048 sc1
    v_mfma_f32_16x16x32_bf16 v[48:51], a[16:19], v[32:35], v[48:51]
    ds_read_b128 v[24:27], v2 offset:33104
    ds_read_b128 v[80:83], v76 offset:0
    v_mfma_f32_16x16x32_bf16 v[56:59], a[20:23], v[32:35], v[56:59]
    s_waitcnt lgkmcnt(9)
    ds_read_b128 v[84:87], v76 offset:1024
    v_mfma_f32_16x16x32_bf16 v[44:47], a[24:27], v[36:39], v[44:47]
    ds_read_b128 v[28:31], v2 offset:96
    s_add_u32 m0, s39, 0
    s_add_u32 s45, s38, 0
    v_mfma_f32_16x16x32_bf16 v[52:55], a[28:31], v[36:39], v[52:55]
    buffer_load_dwordx4 v1, s[16:19], s45 offen lds
    v_mfma_f32_16x16x32_bf16 v[48:51], a[24:27], v[40:43], v[48:51]
    ds_read_b128 v[32:35], v2 offset:33120
    ds_read_b128 v[88:91], v76 offset:2048
    v_mfma_f32_16x16x32_bf16 v[56:59], a[28:31], v[40:43], v[56:59]
    s_waitcnt lgkmcnt(9)
    ds_read_b128 v[92:95], v76 offset:3072
    v_mfma_f32_16x16x32_bf16 v[44:47], a[32:35], v[12:15], v[44:47]
    ds_read_b128 v[36:39], v2 offset:112
    v_mfma_f32_16x16x32_bf16 v[52:55], a[36:39], v[12:15], v[52:55]
    buffer_load_dwordx4 v1, s[16:19], s45 offen offset:1024 lds
    v_mfma_f32_16x16x32_bf16 v[48:51], a[32:35], v[16:19], v[48:51]
    ds_read_b128 v[40:43], v2 offset:33136
    ds_read_b128 v[96:99], v76 offset:4096
    v_mfma_f32_16x16x32_bf16 v[56:59], a[36:39], v[16:19], v[56:59]
    s_waitcnt lgkmcnt(9)
    ds_read_b128 v[100:103], v76 offset:5120
    v_mfma_f32_16x16x32_bf16 v[44:47], a[40:43], v[20:23], v[44:47]
    ds_read_b128 v[12:15], v2 offset:128
    s_add_u32 m0, s39, 2064
    s_add_u32 s45, s38, 2048
    v_mfma_f32_16x16x32_bf16 v[52:55], a[44:47], v[20:23], v[52:55]
    buffer_load_dwordx4 v1, s[16:19], s45 offen lds
    v_mfma_f32_16x16x32_bf16 v[48:51], a[40:43], v[24:27], v[48:51]
    ds_read_b128 v[16:19], v2 offset:33152
    ds_read_b128 v[104:107], v76 offset:6144
    v_mfma_f32_16x16x32_bf16 v[56:59], a[44:47], v[24:27], v[56:59]
    s_waitcnt lgkmcnt(9)
    ds_read_b128 v[108:111], v76 offset:7168
    v_mfma_f32_16x16x32_bf16 v[44:47], a[48:51], v[28:31], v[44:47]
    ds_read_b128 v[20:23], v2 offset:144
    v_mfma_f32_16x16x32_bf16 v[52:55], a[52:55], v[28:31], v[52:55]
    buffer_load_dwordx4 v1, s[16:19], s45 offen offset:1024 lds
    v_mfma_f32_16x16x32_bf16 v[48:51], a[48:51], v[32:35], v[48:51]
    ds_read_b128 v[24:27], v2 offset:33168
    ds_read_b128 v[112:115], v212 offset:0
    v_mfma_f32_16x16x32_bf16 v[56:59], a[52:55], v[32:35], v[56:59]
    s_waitcnt lgkmcnt(9)
    ds_read_b128 v[116:119], v212 offset:1024
    v_mfma_f32_16x16x32_bf16 v[44:47], a[56:59], v[36:39], v[44:47]
    ds_read_b128 v[28:31], v2 offset:160
    s_add_u32 m0, s39, 4128
    s_add_u32 s45, s38, 4096
    v_mfma_f32_16x16x32_bf16 v[52:55], a[60:63], v[36:39], v[52:55]
    buffer_load_dwordx4 v1, s[16:19], s45 offen lds
    v_mfma_f32_16x16x32_bf16 v[48:51], a[56:59], v[40:43], v[48:51]
    ds_read_b128 v[32:35], v2 offset:33184
    ds_read_b128 v[120:123], v212 offset:2048
    s_waitcnt lgkmcnt(7)
    v_mfma_f32_16x16x32_bf16 v[156:159], v[80:83], v[140:143], v[168:171]
    v_mfma_f32_16x16x32_bf16 v[160:163], v[96:99], v[140:143], v[172:175]
    v_mfma_f32_16x16x32_bf16 v[156:159], v[84:87], v[144:147], v[156:159]
    v_mfma_f32_16x16x32_bf16 v[160:163], v[100:103], v[144:147], v[160:163]
    v_mfma_f32_16x16x32_bf16 v[156:159], v[88:91], v[148:151], v[156:159]
    v_mfma_f32_16x16x32_bf16 v[160:163], v[104:107], v[148:151], v[160:163]
    v_mfma_f32_16x16x32_bf16 v[156:159], v[92:95], v[152:155], v[156:159]
    v_mfma_f32_16x16x32_bf16 v[160:163], v[108:111], v[152:155], v[160:163]
    v_mov_b32 v80, 0
    v_mov_b32 v81, 0
    v_mfma_f32_16x16x32_bf16 v[56:59], a[60:63], v[40:43], v[56:59]
    s_waitcnt lgkmcnt(9)
    ds_read_b128 v[124:127], v212 offset:3072
    v_mov_b32 v82, 0
    v_mfma_f32_16x16x32_bf16 v[44:47], a[64:67], v[12:15], v[44:47]
    ds_read_b128 v[36:39], v2 offset:176
    v_mov_b32 v83, 0
    v_mov_b32 v84, 0
    v_mfma_f32_16x16x32_bf16 v[52:55], a[68:71], v[12:15], v[52:55]
    buffer_load_dwordx4 v1, s[16:19], s45 offen offset:1024 lds
    v_mfma_f32_16x16x32_bf16 v[48:51], a[64:67], v[16:19], v[48:51]
    ds_read_b128 v[40:43], v2 offset:33200
    v_mov_b32 v85, 0
    v_mov_b32 v86, 0
    v_mfma_f32_16x16x32_bf16 v[56:59], a[68:71], v[16:19], v[56:59]
    s_waitcnt lgkmcnt(8)
    v_mov_b32 v87, 0
    v_mov_b32 v88, 0
    v_mfma_f32_16x16x32_bf16 v[44:47], a[72:75], v[20:23], v[44:47]
    ds_read_b128 v[12:15], v2 offset:192
    s_add_u32 m0, s39, 6192
    s_add_u32 s45, s38, 6144
    v_mfma_f32_16x16x32_bf16 v[52:55], a[76:79], v[20:23], v[52:55]
    buffer_load_dwordx4 v1, s[16:19], s45 offen lds
    v_mfma_f32_16x16x32_bf16 v[48:51], a[72:75], v[24:27], v[48:51]
    ds_read_b128 v[16:19], v2 offset:33216
    v_mov_b32 v89, 0
    v_mov_b32 v90, 0
    v_mfma_f32_16x16x32_bf16 v[56:59], a[76:79], v[24:27], v[56:59]
    s_waitcnt lgkmcnt(6)
    v_mov_b32 v91, 0
    v_mov_b32 v92, 0
    v_mfma_f32_16x16x32_bf16 v[44:47], a[80:83], v[28:31], v[44:47]
    ds_read_b128 v[20:23], v2 offset:208
    v_mov_b32 v93, 0
    v_mov_b32 v94, 0
    v_mfma_f32_16x16x32_bf16 v[52:55], a[84:87], v[28:31], v[52:55]
    buffer_load_dwordx4 v1, s[16:19], s45 offen offset:1024 lds
    v_mfma_f32_16x16x32_bf16 v[48:51], a[80:83], v[32:35], v[48:51]
    ds_read_b128 v[24:27], v2 offset:33232
    v_mov_b32 v95, 0
    s_waitcnt vmcnt(8)
    v_mfma_f32_16x16x32_bf16 v[56:59], a[84:87], v[32:35], v[56:59]
    s_waitcnt lgkmcnt(4)
    v_max_u32 v6, v128, v139
    v_max3_u32 v6, v6, v129, v130
    v_mfma_f32_16x16x32_bf16 v[44:47], a[88:91], v[36:39], v[44:47]
    ds_read_b128 v[28:31], v2 offset:224
    s_add_u32 m0, s39, 8256
    s_add_u32 s45, s38, 8192
    v_mfma_f32_16x16x32_bf16 v[52:55], a[92:95], v[36:39], v[52:55]
    buffer_load_dwordx4 v1, s[16:19], s45 offen lds
    v_mfma_f32_16x16x32_bf16 v[48:51], a[88:91], v[40:43], v[48:51]
    ds_read_b128 v[32:35], v2 offset:33248
    v_max3_u32 v6, v6, v131, v132
    v_max3_u32 v6, v6, v133, v134
    v_mfma_f32_16x16x32_bf16 v[56:59], a[92:95], v[40:43], v[56:59]
    s_waitcnt lgkmcnt(4)
    v_max3_u32 v6, v6, v135, v136
    v_max3_u32 v6, v6, v137, v138
    v_mfma_f32_16x16x32_bf16 v[44:47], a[96:99], v[12:15], v[44:47]
    ds_read_b128 v[36:39], v2 offset:240
    v_cmp_eq_u32 vcc, -1, v6
    v_mfma_f32_16x16x32_bf16 v[52:55], a[100:103], v[12:15], v[52:55]
    buffer_load_dwordx4 v1, s[16:19], s45 offen offset:1024 lds
    v_mfma_f32_16x16x32_bf16 v[48:51], a[96:99], v[16:19], v[48:51]
    ds_read_b128 v[40:43], v2 offset:33264
    s_cbranch_vccnz L_q_bad
L_q_ok:
    v_mfma_f32_16x16x32_bf16 v[56:59], a[100:103], v[16:19], v[56:59]
    s_waitcnt lgkmcnt(4)
    s_add_u32 s49, s49, 0x4000
    s_add_u32 s50, s50, 0x4000
    v_mfma_f32_16x16x32_bf16 v[44:47], a[104:107], v[20:23], v[44:47]
    ds_read_b128 v[12:15], v2 offset:1024
    s_add_u32 m0, s39, 10320
    s_add_u32 s45, s38, 10240
    v_mfma_f32_16x16x32_bf16 v[52:55], a[108:111], v[20:23], v[52:55]
    buffer_load_dwordx4 v1, s[16:19], s45 offen lds
    v_mfma_f32_16x16x32_bf16 v[48:51], a[104:107], v[24:27], v[48:51]
    ds_read_b128 v[16:19], v2 offset:34048
    s_waitcnt vmcnt(14)
    v_mov_b32 v9, s37
    v_mfma_f32_16x16x32_bf16 v[56:59], a[108:111], v[24:27], v[56:59]
    s_waitcnt lgkmcnt(4)
    s_waitcnt lgkmcnt(12)
    v_mfma_f32_16x16x32_bf16 v[44:47], a[112:115], v[28:31], v[44:47]
    ds_read_b128 v[20:23], v2 offset:1040
    s_barrier
    v_smfmac_f32_16x16x64_bf16 v[164:167], v[128:131], v[140:147], v73
    v_smfmac_f32_16x16x64_bf16 v[164:167], v[132:135], v[148:155], v73
    v_smfmac_f32_16x16x64_bf16 v[80:83], v[136:139], v[180:187], v73
    v_max3_f32 v6, v156, v157, v158
    v_smfmac_f32_16x16x64_bf16 v[84:87], v[136:139], v[188:195], v73
    v_max3_f32 v6, v6, v159, v160
    v_smfmac_f32_16x16x64_bf16 v[88:91], v[136:139], v[176:183], v73
    v_max3_f32 v6, v6, v161, v162
    v_smfmac_f32_16x16x64_bf16 v[92:95], v[136:139], v[184:191], v73
    v_max_f32 v6, v6, v163
    v_mfma_f32_16x16x32_bf16 v[52:55], a[116:119], v[28:31], v[52:55]
    buffer_load_dwordx4 v1, s[16:19], s45 offen offset:1024 lds
    v_mfma_f32_16x16x32_bf16 v[48:51], a[112:115], v[32:35], v[48:51]
    ds_read_b128 v[24:27], v2 offset:34064
    v_permlane32_swap_b32 v164, v166
    v_mfma_f32_16x16x32_bf16 v[56:59], a[116:119], v[32:35], v[56:59]
    s_waitcnt lgkmcnt(4)
    v_permlane32_swap_b32 v165, v167
    v_mfma_f32_16x16x32_bf16 v[44:47], a[120:123], v[36:39], v[44:47]
    ds_read_b128 v[28:31], v2 offset:1056
    s_add_u32 m0, s39, 12384
    s_add_u32 s45, s38, 12288
    v_mfma_f32_16x16x32_bf16 v[52:55], a[124:127], v[36:39], v[52:55]
    buffer_load_dwordx4 v1, s[16:19], s45 offen lds
    v_mfma_f32_16x16x32_bf16 v[48:51], a[120:123], v[40:43], v[48:51]
    ds_read_b128 v[32:35], v2 offset:34080
    v_add_f32 v164, v164, v166
    v_add_f32 v165, v165, v167
    v_mfma_f32_16x16x32_bf16 v[56:59], a[124:127], v[40:43], v[56:59]
    s_waitcnt lgkmcnt(4)
    v_max3_f32 v6, v6, v164, v165
    v_mov_b32 v7, v6
    v_mfma_f32_16x16x32_bf16 v[44:47], a[128:131], v[12:15], v[44:47]
    ds_read_b128 v[36:39], v2 offset:1072
    v_cvt_pk_bf16_f32 v148, v80, v81
    v_cvt_pk_bf16_f32 v149, v82, v83
    v_mfma_f32_16x16x32_bf16 v[52:55], a[132:135], v[12:15], v[52:55]
    buffer_load_dwordx4 v1, s[16:19], s45 offen offset:1024 lds
    v_mfma_f32_16x16x32_bf16 v[48:51], a[128:131], v[16:19], v[48:51]
    ds_read_b128 v[40:43], v2 offset:34096
    v_permlane32_swap_b32 v6, v7
    v_mfma_f32_16x16x32_bf16 v[56:59], a[132:135], v[16:19], v[56:59]
    s_waitcnt lgkmcnt(4)
    v_max_f32 v6, v6, v7
    v_mov_b32 v7, v6
    v_mfma_f32_16x16x32_bf16 v[44:47], a[136:139], v[20:23], v[44:47]
    ds_read_b128 v[12:15], v2 offset:1088
    s_add_u32 m0, s39, 14448
    s_add_u32 s45, s38, 14336
    v_mfma_f32_16x16x32_bf16 v[52:55], a[140:143], v[20:23], v[52:55]
    buffer_load_dwordx4 v1, s[16:19], s45 offen lds
    v_mfma_f32_16x16x32_bf16 v[48:51], a[136:139], v[24:27], v[48:51]
    ds_read_b128 v[16:19], v2 offset:34112
    v_cvt_pk_bf16_f32 v150, v84, v85
    v_cvt_pk_bf16_f32 v151, v86, v87
    v_mfma_f32_16x16x32_bf16 v[56:59], a[140:143], v[24:27], v[56:59]
    s_waitcnt lgkmcnt(4)
    v_permlane16_swap_b32 v6, v7
    v_mfma_f32_16x16x32_bf16 v[44:47], a[144:147], v[28:31], v[44:47]
    ds_read_b128 v[20:23], v2 offset:1104
    v_max_f32 v6, v6, v7
    v_mul_f32 v6, s52, v6
    v_mfma_f32_16x16x32_bf16 v[52:55], a[148:151], v[28:31], v[52:55]
    buffer_load_dwordx4 v1, s[16:19], s45 offen offset:1024 lds
    v_mfma_f32_16x16x32_bf16 v[48:51], a[144:147], v[32:35], v[48:51]
    ds_read_b128 v[24:27], v2 offset:34128
    s_sub_u32 s39, s40, s39
    s_add_u32 s38, s38, 0x10000
    v_mfma_f32_16x16x32_bf16 v[56:59], a[148:151], v[32:35], v[56:59]
    s_waitcnt lgkmcnt(4)
    v_fma_f32 v156, v156, s52, -v6
    v_fma_f32 v157, v157, s52, -v6
    v_mfma_f32_16x16x32_bf16 v[44:47], a[152:155], v[36:39], v[44:47]
    ds_read_b128 v[28:31], v2 offset:1120
    s_mov_b32 m0, s51
    v_mov_b32 v75, 0
    v_mfma_f32_16x16x32_bf16 v[52:55], a[156:159], v[36:39], v[52:55]
    buffer_atomic_add v75, v74, s[4:7], s49 offen sc0 sc1
    v_mfma_f32_16x16x32_bf16 v[48:51], a[152:155], v[40:43], v[48:51]
    ds_read_b128 v[32:35], v2 offset:34144
    v_fma_f32 v158, v158, s52, -v6
    v_fma_f32 v159, v159, s52, -v6
    v_mfma_f32_16x16x32_bf16 v[56:59], a[156:159], v[40:43], v[56:59]
    s_waitcnt lgkmcnt(4)
    v_fma_f32 v160, v160, s52, -v6
    v_fma_f32 v161, v161, s52, -v6
    v_mfma_f32_16x16x32_bf16 v[44:47], a[160:163], v[12:15], v[44:47]
    ds_read_b128 v[36:39], v2 offset:1136
    v_fma_f32 v162, v162, s52, -v6
    v_fma_f32 v163, v163, s52, -v6
    v_mfma_f32_16x16x32_bf16 v[52:55], a[164:167], v[12:15], v[52:55]
    buffer_load_dwordx4 v1, s[4:7], s48 offen offset:0 sc1 lds
    v_mfma_f32_16x16x32_bf16 v[48:51], a[160:163], v[16:19], v[48:51]
    ds_read_b128 v[40:43], v2 offset:34160
    v_fma_f32 v164, v164, s52, -v6
    v_fma_f32 v165, v165, s52, -v6
    v_mfma_f32_16x16x32_bf16 v[56:59], a[164:167], v[16:19], v[56:59]
    s_waitcnt lgkmcnt(4)
    v_exp_f32 v156, v156
    v_mfma_f32_16x16x32_bf16 v[44:47], a[168:171], v[20:23], v[44:47]
    ds_read_b128 v[12:15], v2 offset:1152
    v_exp_f32 v157, v157
    v_mfma_f32_16x16x32_bf16 v[52:55], a[172:175], v[20:23], v[52:55]
    buffer_load_dwordx4 v1, s[4:7], s48 offen offset:1024 sc1 lds
    v_mfma_f32_16x16x32_bf16 v[48:51], a[168:171], v[24:27], v[48:51]
    ds_read_b128 v[16:19], v2 offset:34176
    v_exp_f32 v158, v158
    v_mfma_f32_16x16x32_bf16 v[56:59], a[172:175], v[24:27], v[56:59]
    s_waitcnt lgkmcnt(4)
    v_exp_f32 v159, v159
    v_mfma_f32_16x16x32_bf16 v[44:47], a[176:179], v[28:31], v[44:47]
    ds_read_b128 v[20:23], v2 offset:1168
    v_exp_f32 v160, v160
    v_mfma_f32_16x16x32_bf16 v[52:55], a[180:183], v[28:31], v[52:55]
    buffer_load_dwordx4 v1, s[4:7], s48 offen offset:2048 sc1 lds
    v_mfma_f32_16x16x32_bf16 v[48:51], a[176:179], v[32:35], v[48:51]
    ds_read_b128 v[24:27], v2 offset:34192
    v_exp_f32 v161, v161
    v_mfma_f32_16x16x32_bf16 v[56:59], a[180:183], v[32:35], v[56:59]
    s_waitcnt lgkmcnt(4)
    v_exp_f32 v162, v162
    v_mfma_f32_16x16x32_bf16 v[44:47], a[184:187], v[36:39], v[44:47]
    ds_read_b128 v[28:31], v2 offset:1184
    v_exp_f32 v163, v163
    v_mfma_f32_16x16x32_bf16 v[52:55], a[188:191], v[36:39], v[52:55]
    buffer_load_dwordx4 v1, s[4:7], s48 offen offset:3072 sc1 lds
    v_mfma_f32_16x16x32_bf16 v[48:51], a[184:187], v[40:43], v[48:51]
    ds_read_b128 v[32:35], v2 offset:34208
    v_exp_f32 v164, v164
    v_mfma_f32_16x16x32_bf16 v[56:59], a[188:191], v[40:43], v[56:59]
    s_waitcnt lgkmcnt(4)
    v_exp_f32 v165, v165
    v_mfma_f32_16x16x32_bf16 v[44:47], a[192:195], v[12:15], v[44:47]
    ds_read_b128 v[36:39], v2 offset:1200
    v_cvt_pk_bf16_f32 v200, v156, v157
    v_cvt_pk_bf16_f32 v201, v158, v159
    v_mfma_f32_16x16x32_bf16 v[52:55], a[196:199], v[12:15], v[52:55]
    buffer_load_dword v252, v213, s[16:19], s38 offen
    v_mfma_f32_16x16x32_bf16 v[48:51], a[192:195], v[16:19], v[48:51]
    ds_read_b128 v[40:43], v2 offset:34224
    s_add_u32 s48, s48, 0x4000
    v_cvt_pk_bf16_f32 v202, v160, v161
    v_mfma_f32_16x16x32_bf16 v[56:59], a[196:199], v[16:19], v[56:59]
    s_waitcnt lgkmcnt(4)
    v_cvt_pk_bf16_f32 v203, v162, v163
    v_cvt_pk_bf16_f32 v208, v164, v165
    v_mfma_f32_16x16x32_bf16 v[44:47], a[200:203], v[20:23], v[44:47]
    ds_read_b128 v[12:15], v2 offset:1216
    v_cvt_pk_bf16_f32 v209, v164, v165
    v_mfma_f32_16x16x32_bf16 v[196:199], v[204:207], v[200:203], 0
    v_cvt_pk_bf16_f32 v152, v88, v89
    v_mfma_f32_16x16x32_bf16 v[52:55], a[204:207], v[20:23], v[52:55]
    buffer_store_dword v9, v4, s[4:7], 0 offen sc1
    v_mfma_f32_16x16x32_bf16 v[48:51], a[200:203], v[24:27], v[48:51]
    ds_read_b128 v[16:19], v2 offset:34240
    v_permlane32_swap_b32 v208, v209
    v_mfma_f32_16x16x32_bf16 v[96:99], v[112:115], v[200:203], 0
    v_cvt_pk_bf16_f32 v153, v90, v91
    v_mfma_f32_16x16x32_bf16 v[100:103], v[116:119], v[200:203], 0
    v_cvt_pk_bf16_f32 v154, v92, v93
    v_mfma_f32_16x16x32_bf16 v[104:107], v[120:123], v[200:203], 0
    v_cvt_pk_bf16_f32 v155, v94, v95
    v_mfma_f32_16x16x32_bf16 v[108:111], v[124:127], v[200:203], 0
    v_mfma_f32_16x16x16_bf16 v[196:199], v[210:211], v[208:209], v[196:199]
    v_mfma_f32_16x16x16_bf16 v[96:99], v[148:149], v[208:209], v[96:99]
    v_mfma_f32_16x16x16_bf16 v[100:103], v[150:151], v[208:209], v[100:103]
    v_mfma_f32_16x16x16_bf16 v[104:107], v[152:153], v[208:209], v[104:107]
    v_mfma_f32_16x16x16_bf16 v[108:111], v[154:155], v[208:209], v[108:111]
    v_rcp_f32 v6, v196
    v_mfma_f32_16x16x32_bf16 v[56:59], a[204:207], v[24:27], v[56:59]
    s_waitcnt lgkmcnt(4)
    v_mul_f32 v96, v96, v6
    v_mul_f32 v97, v97, v6
    v_mfma_f32_16x16x32_bf16 v[44:47], a[208:211], v[28:31], v[44:47]
    ds_read_b128 v[20:23], v2 offset:1232
    v_mul_f32 v98, v98, v6
    v_mul_f32 v99, v99, v6
    v_mfma_f32_16x16x32_bf16 v[52:55], a[212:215], v[28:31], v[52:55]
    ds_write_b64 v72, v[60:61] offset:0
    v_mfma_f32_16x16x32_bf16 v[48:51], a[208:211], v[32:35], v[48:51]
    ds_read_b128 v[24:27], v2 offset:34256
    v_mul_f32 v100, v100, v6
    v_mul_f32 v101, v101, v6
    v_mfma_f32_16x16x32_bf16 v[56:59], a[212:215], v[32:35], v[56:59]
    s_waitcnt lgkmcnt(5)
    v_mul_f32 v102, v102, v6
    v_mul_f32 v103, v103, v6
    v_mfma_f32_16x16x32_bf16 v[44:47], a[216:219], v[36:39], v[44:47]
    ds_read_b128 v[28:31], v2 offset:1248
    v_cvt_pk_bf16_f32 v140, v96, v100
    v_cvt_pk_bf16_f32 v141, v97, v101
    v_mfma_f32_16x16x32_bf16 v[52:55], a[220:223], v[36:39], v[52:55]
    ds_write_b64 v72, v[62:63] offset:8
    v_mfma_f32_16x16x32_bf16 v[48:51], a[216:219], v[40:43], v[48:51]
    ds_read_b128 v[32:35], v2 offset:34272
    v_cvt_pk_bf16_f32 v142, v98, v102
    v_cvt_pk_bf16_f32 v143, v99, v103
    v_mfma_f32_16x16x32_bf16 v[56:59], a[220:223], v[40:43], v[56:59]
    s_waitcnt lgkmcnt(6)
    v_mfma_f32_16x16x32_bf16 v[44:47], a[224:227], v[12:15], v[44:47]
    ds_read_b128 v[36:39], v2 offset:1264
    v_mfma_f32_16x16x32_bf16 v[52:55], a[228:231], v[12:15], v[52:55]
    ds_write_b64 v72, v[64:65] offset:4096
    v_mfma_f32_16x16x32_bf16 v[48:51], a[224:227], v[16:19], v[48:51]
    ds_read_b128 v[40:43], v2 offset:34288
    v_mfma_f32_16x16x32_bf16 v[56:59], a[228:231], v[16:19], v[56:59]
    s_waitcnt lgkmcnt(6)
    v_mfma_f32_16x16x32_bf16 v[44:47], a[232:235], v[20:23], v[44:47]
    buffer_store_dwordx4 v[140:143], v1, s[4:7], s41 offen offset:0 sc1
    v_mfma_f32_16x16x32_bf16 v[52:55], a[236:239], v[20:23], v[52:55]
    ds_write_b64 v72, v[66:67] offset:4104
    v_mfma_f32_16x16x32_bf16 v[48:51], a[232:235], v[24:27], v[48:51]
    v_mul_f32 v104, v104, v6
    v_mul_f32 v105, v105, v6
    v_mfma_f32_16x16x32_bf16 v[56:59], a[236:239], v[24:27], v[56:59]
    s_waitcnt lgkmcnt(4)
    v_mul_f32 v106, v106, v6
    v_mul_f32 v107, v107, v6
    v_mfma_f32_16x16x32_bf16 v[44:47], a[240:243], v[28:31], v[44:47]
    v_mul_f32 v108, v108, v6
    v_mul_f32 v109, v109, v6
    v_mfma_f32_16x16x32_bf16 v[52:55], a[244:247], v[28:31], v[52:55]
    v_mul_f32 v110, v110, v6
    v_mul_f32 v111, v111, v6
    v_mfma_f32_16x16x32_bf16 v[48:51], a[240:243], v[32:35], v[48:51]
    v_cvt_pk_bf16_f32 v144, v104, v108
    v_cvt_pk_bf16_f32 v145, v105, v109
    v_mfma_f32_16x16x32_bf16 v[56:59], a[244:247], v[32:35], v[56:59]
    s_waitcnt lgkmcnt(1)
    v_cvt_pk_bf16_f32 v146, v106, v110
    v_cvt_pk_bf16_f32 v147, v107, v111
    v_mfma_f32_16x16x32_bf16 v[44:47], a[248:251], v[36:39], v[44:47]
    buffer_store_dwordx4 v[144:147], v1, s[4:7], s41 offen offset:1024 sc1
    v_mfma_f32_16x16x32_bf16 v[52:55], a[252:255], v[36:39], v[52:55]
    s_add_u32 s41, s41, 0x4000
    v_mfma_f32_16x16x32_bf16 v[48:51], a[248:251], v[40:43], v[48:51]
    v_mfma_f32_16x16x32_bf16 v[56:59], a[252:255], v[40:43], v[56:59]
    v_sub_u32 v2, v3, v2
    v_cvt_pk_bf16_f32 v60, v44, v52
    v_cvt_pk_bf16_f32 v61, v45, v53
    v_cvt_pk_bf16_f32 v62, v46, v54
    v_cvt_pk_bf16_f32 v63, v47, v55
    s_nop 1
    v_cvt_pk_bf16_f32 v64, v48, v56
    v_cvt_pk_bf16_f32 v65, v49, v57
    v_cvt_pk_bf16_f32 v66, v50, v58
    v_cvt_pk_bf16_f32 v67, v51, v59
    s_add_u32 s37, s37, 1
    s_cmp_lt_u32 s37, 62
    s_waitcnt vmcnt(4)
    v_cmp_eq_u32 vcc, -1, v75
    s_barrier
    s_cbranch_scc1 L_q_loop
    s_cbranch_vccz L_q_go2
L_pd_22:
    v_mov_b32 v75, 0
    buffer_atomic_add v75, v74, s[4:7], s49 offen sc0 sc1
    s_waitcnt vmcnt(0)
    v_max_u32 v6, v75, v75
    v_cmp_eq_u32 vcc, -1, v6
    s_cbranch_vccz L_pdok_23
    s_sleep 1
    s_sub_u32 s35, s35, 1
    s_cbranch_scc0 L_pd_22
    s_endpgm
L_pdok_23:
L_q_go2:
    buffer_load_dwordx4 v[128:131], v1, s[4:7], s49 offen offset:0 sc1
    buffer_load_dwordx4 v[132:135], v1, s[4:7], s49 offen offset:1024 sc1
    buffer_load_dwordx4 v[136:139], v1, s[4:7], s50 offen offset:2048 sc1
    ds_read_b128 v[140:143], v5 offset:0
    ds_read_b128 v[144:147], v5 offset:1024
    ds_read_b128 v[148:151], v5 offset:2048
    ds_read_b128 v[152:155], v5 offset:3072
    ds_read_b128 v[80:83], v76 offset:0
    ds_read_b128 v[84:87], v76 offset:1024
    ds_read_b128 v[88:91], v76 offset:2048
    ds_read_b128 v[92:95], v76 offset:3072
    ds_read_b128 v[96:99], v76 offset:4096
    ds_read_b128 v[100:103], v76 offset:5120
    ds_read_b128 v[104:107], v76 offset:6144
    ds_read_b128 v[108:111], v76 offset:7168
    s_waitcnt lgkmcnt(0)
    ds_read_b128 v[112:115], v212 offset:0
    ds_read_b128 v[116:119], v212 offset:1024
    ds_read_b128 v[120:123], v212 offset:2048
    ds_read_b128 v[124:127], v212 offset:3072
    v_mov_b32 v164, 0
    v_mov_b32 v165, 0
    v_mov_b32 v166, 0
    v_mov_b32 v167, 0
    v_mfma_f32_16x16x32_bf16 v[156:159], v[80:83], v[140:143], v[168:171]
    v_mfma_f32_16x16x32_bf16 v[160:163], v[96:99], v[140:143], v[172:175]
    v_mfma_f32_16x16x32_bf16 v[156:159], v[84:87], v[144:147], v[156:159]
    v_mfma_f32_16x16x32_bf16 v[160:163], v[100:103], v[144:147], v[160:163]
    v_mfma_f32_16x16x32_bf16 v[156:159], v[88:91], v[148:151], v[156:159]
    v_mfma_f32_16x16x32_bf16 v[160:163], v[104:107], v[148:151], v[160:163]
    v_mfma_f32_16x16x32_bf16 v[156:159], v[92:95], v[152:155], v[156:159]
    v_mfma_f32_16x16x32_bf16 v[160:163], v[108:111], v[152:155], v[160:163]
    v_mov_b32 v9, 62
    s_waitcnt vmcnt(0) lgkmcnt(0)
    s_barrier
    v_max_u32 v6, v128, v139
    v_max3_u32 v6, v6, v129, v130
    v_max3_u32 v6, v6, v131, v132
    v_max3_u32 v6, v6, v133, v134
    v_max3_u32 v6, v6, v135, v136
    v_max3_u32 v6, v6, v137, v138
    v_cmp_eq_u32 vcc, -1, v6
    v_mov_b32 v80, 0
    v_mov_b32 v81, 0
    v_mov_b32 v82, 0
    v_mov_b32 v83, 0
    v_mov_b32 v84, 0
    v_mov_b32 v85, 0
    v_mov_b32 v86, 0
    v_mov_b32 v87, 0
    v_mov_b32 v88, 0
    v_mov_b32 v89, 0
    v_mov_b32 v90, 0
    v_mov_b32 v91, 0
    v_mov_b32 v92, 0
    v_mov_b32 v93, 0
    v_mov_b32 v94, 0
    v_mov_b32 v95, 0
    s_cbranch_vccnz L_q_bady
L_q_oky:
    ds_write_b64 v72, v[60:61] offset:0
    ds_write_b64 v72, v[62:63] offset:8
    ds_write_b64 v72, v[64:65] offset:4096
    ds_write_b64 v72, v[66:67] offset:4104
    s_mov_b32 m0, s51
    s_nop 0
    buffer_load_dwordx4 v1, s[4:7], s48 offen offset:0 sc1 lds
    buffer_load_dwordx4 v1, s[4:7], s48 offen offset:1024 sc1 lds
    buffer_load_dwordx4 v1, s[4:7], s48 offen offset:2048 sc1 lds
    buffer_load_dwordx4 v1, s[4:7], s48 offen offset:3072 sc1 lds
    s_add_u32 s48, s48, 0x4000
    s_add_u32 s49, s49, 0x4000
    s_add_u32 s50, s50, 0x4000
    buffer_store_dword v9, v4, s[4:7], 0 offen sc1
    s_xor_b32 s49, s49, 0x2000
    s_xor_b32 s50, s50, 0x2000
    v_smfmac_f32_16x16x64_bf16 v[164:167], v[128:131], v[140:147], v73
    v_smfmac_f32_16x16x64_bf16 v[164:167], v[132:135], v[148:155], v73
    v_smfmac_f32_16x16x64_bf16 v[80:83], v[136:139], v[180:187], v73
    v_max3_f32 v6, v156, v157, v158
    v_smfmac_f32_16x16x64_bf16 v[84:87], v[136:139], v[188:195], v73
    v_max3_f32 v6, v6, v159, v160
    v_smfmac_f32_16x16x64_bf16 v[88:91], v[136:139], v[176:183], v73
    v_max3_f32 v6, v6, v161, v162
    v_smfmac_f32_16x16x64_bf16 v[92:95], v[136:139], v[184:191], v73
    v_max_f32 v6, v6, v163
    v_permlane32_swap_b32 v164, v166
    v_permlane32_swap_b32 v165, v167
    v_add_f32 v164, v164, v166
    v_add_f32 v165, v165, v167
    v_max3_f32 v6, v6, v164, v165
    v_mov_b32 v7, v6
    v_cvt_pk_bf16_f32 v148, v80, v81
    v_cvt_pk_bf16_f32 v149, v82, v83
    v_permlane32_swap_b32 v6, v7
    v_max_f32 v6, v6, v7
    v_mov_b32 v7, v6
    v_cvt_pk_bf16_f32 v150, v84, v85
    v_cvt_pk_bf16_f32 v151, v86, v87
    v_permlane16_swap_b32 v6, v7
    v_max_f32 v6, v6, v7
    v_mul_f32 v6, s52, v6
    v_fma_f32 v156, v156, s52, -v6
    v_fma_f32 v157, v157, s52, -v6
    v_fma_f32 v158, v158, s52, -v6
    v_fma_f32 v159, v159, s52, -v6
    v_fma_f32 v160, v160, s52, -v6
    v_fma_f32 v161, v161, s52, -v6
    v_fma_f32 v162, v162, s52, -v6
    v_fma_f32 v163, v163, s52, -v6
    v_fma_f32 v164, v164, s52, -v6
    v_fma_f32 v165, v165, s52, -v6
    v_exp_f32 v156, v156
    v_exp_f32 v157, v157
    v_exp_f32 v158, v158
    v_exp_f32 v159, v159
    v_exp_f32 v160, v160
    v_exp_f32 v161, v161
    v_exp_f32 v162, v162
    v_exp_f32 v163, v163
    v_exp_f32 v164, v164
    v_exp_f32 v165, v165
    v_cvt_pk_bf16_f32 v200, v156, v157
    v_cvt_pk_bf16_f32 v201, v158, v159
    v_cvt_pk_bf16_f32 v202, v160, v161
    v_cvt_pk_bf16_f32 v203, v162, v163
    v_cvt_pk_bf16_f32 v208, v164, v165
    v_cvt_pk_bf16_f32 v209, v164, v165
    v_mfma_f32_16x16x32_bf16 v[196:199], v[204:207], v[200:203], 0
    v_cvt_pk_bf16_f32 v152, v88, v89
    v_permlane32_swap_b32 v208, v209
    v_mfma_f32_16x16x32_bf16 v[96:99], v[112:115], v[200:203], 0
    v_cvt_pk_bf16_f32 v153, v90, v91
    v_mfma_f32_16x16x32_bf16 v[100:103], v[116:119], v[200:203], 0
    v_cvt_pk_bf16_f32 v154, v92, v93
    v_mfma_f32_16x16x32_bf16 v[104:107], v[120:123], v[200:203], 0
    v_cvt_pk_bf16_f32 v155, v94, v95
    v_mfma_f32_16x16x32_bf16 v[108:111], v[124:127], v[200:203], 0
    v_mfma_f32_16x16x16_bf16 v[196:199], v[210:211], v[208:209], v[196:199]
    v_mfma_f32_16x16x16_bf16 v[96:99], v[148:149], v[208:209], v[96:99]
    v_mfma_f32_16x16x16_bf16 v[100:103], v[150:151], v[208:209], v[100:103]
    v_mfma_f32_16x16x16_bf16 v[104:107], v[152:153], v[208:209], v[104:107]
    v_mfma_f32_16x16x16_bf16 v[108:111], v[154:155], v[208:209], v[108:111]
    v_rcp_f32 v6, v196
    s_nop 0
    v_mul_f32 v96, v96, v6
    v_mul_f32 v97, v97, v6
    v_mul_f32 v98, v98, v6
    v_mul_f32 v99, v99, v6
    v_mul_f32 v100, v100, v6
    v_mul_f32 v101, v101, v6
    v_mul_f32 v102, v102, v6
    v_mul_f32 v103, v103, v6
    v_cvt_pk_bf16_f32 v140, v96, v100
    v_cvt_pk_bf16_f32 v141, v97, v101
    v_cvt_pk_bf16_f32 v142, v98, v102
    v_cvt_pk_bf16_f32 v143, v99, v103
    buffer_store_dwordx4 v[140:143], v1, s[4:7], s41 offen offset:0 sc1
    v_mul_f32 v104, v104, v6
    v_mul_f32 v105, v105, v6
    v_mul_f32 v106, v106, v6
    v_mul_f32 v107, v107, v6
    v_mul_f32 v108, v108, v6
    v_mul_f32 v109, v109, v6
    v_mul_f32 v110, v110, v6
    v_mul_f32 v111, v111, v6
    v_cvt_pk_bf16_f32 v144, v104, v108
    v_cvt_pk_bf16_f32 v145, v105, v109
    v_cvt_pk_bf16_f32 v146, v106, v110
    v_cvt_pk_bf16_f32 v147, v107, v111
    buffer_store_dwordx4 v[144:147], v1, s[4:7], s41 offen offset:1024 sc1
    s_add_u32 s41, s41, 0x4000
    s_waitcnt vmcnt(3) lgkmcnt(0)
    s_barrier
    v_mov_b32 v75, 0
    buffer_atomic_add v75, v74, s[4:7], s49 offen sc0 sc1
    ds_read_b128 v[140:143], v5 offset:0
    ds_read_b128 v[144:147], v5 offset:1024
    ds_read_b128 v[148:151], v5 offset:2048
    ds_read_b128 v[152:155], v5 offset:3072
    ds_read_b128 v[80:83], v76 offset:0
    ds_read_b128 v[84:87], v76 offset:1024
    ds_read_b128 v[88:91], v76 offset:2048
    ds_read_b128 v[92:95], v76 offset:3072
    ds_read_b128 v[96:99], v76 offset:4096
    ds_read_b128 v[100:103], v76 offset:5120
    ds_read_b128 v[104:107], v76 offset:6144
    ds_read_b128 v[108:111], v76 offset:7168
    s_waitcnt lgkmcnt(0)
    ds_read_b128 v[112:115], v212 offset:0
    ds_read_b128 v[116:119], v212 offset:1024
    ds_read_b128 v[120:123], v212 offset:2048
    ds_read_b128 v[124:127], v212 offset:3072
    v_mov_b32 v164, 0
    v_mov_b32 v165, 0
    v_mov_b32 v166, 0
    v_mov_b32 v167, 0
    v_mfma_f32_16x16x32_bf16 v[156:159], v[80:83], v[140:143], v[168:171]
    v_mfma_f32_16x16x32_bf16 v[160:163], v[96:99], v[140:143], v[172:175]
    v_mfma_f32_16x16x32_bf16 v[156:159], v[84:87], v[144:147], v[156:159]
    v_mfma_f32_16x16x32_bf16 v[160:163], v[100:103], v[144:147], v[160:163]
    v_mfma_f32_16x16x32_bf16 v[156:159], v[88:91], v[148:151], v[156:159]
    v_mfma_f32_16x16x32_bf16 v[160:163], v[104:107], v[148:151], v[160:163]
    v_mfma_f32_16x16x32_bf16 v[156:159], v[92:95], v[152:155], v[156:159]
    v_mfma_f32_16x16x32_bf16 v[160:163], v[108:111], v[152:155], v[160:163]
    v_mov_b32 v9, 63
    s_waitcnt vmcnt(0) lgkmcnt(0)
    s_barrier
    v_cmp_eq_u32 vcc, -1, v75
    s_cbranch_vccz L_q_go3
L_pd_24:
    v_mov_b32 v75, 0
    buffer_atomic_add v75, v74, s[4:7], s49 offen sc0 sc1
    s_waitcnt vmcnt(0)
    v_max_u32 v6, v75, v75
    v_cmp_eq_u32 vcc, -1, v6
    s_cbranch_vccz L_pdok_25
    s_sub_u32 s35, s35, 1
    s_cbranch_scc0 L_pd_24
    s_endpgm
L_pdok_25:
L_q_go3:
    buffer_load_dwordx4 v[128:131], v1, s[4:7], s49 offen offset:0 sc1
    buffer_load_dwordx4 v[132:135], v1, s[4:7], s49 offen offset:1024 sc1
    buffer_load_dwordx4 v[136:139], v1, s[4:7], s50 offen offset:2048 sc1
    buffer_store_dword v9, v4, s[4:7], 0 offen sc1
    s_waitcnt vmcnt(1)
    v_max_u32 v6, v128, v139
    v_max3_u32 v6, v6, v129, v130
    v_max3_u32 v6, v6, v131, v132
    v_max3_u32 v6, v6, v133, v134
    v_max3_u32 v6, v6, v135, v136
    v_max3_u32 v6, v6, v137, v138
    v_cmp_eq_u32 vcc, -1, v6
    v_mov_b32 v80, 0
    v_mov_b32 v81, 0
    v_mov_b32 v82, 0
    v_mov_b32 v83, 0
    v_mov_b32 v84, 0
    v_mov_b32 v85, 0
    v_mov_b32 v86, 0
    v_mov_b32 v87, 0
    v_mov_b32 v88, 0
    v_mov_b32 v89, 0
    v_mov_b32 v90, 0
    v_mov_b32 v91, 0
    v_mov_b32 v92, 0
    v_mov_b32 v93, 0
    v_mov_b32 v94, 0
    v_mov_b32 v95, 0
    s_cbranch_vccnz L_q_badz
L_q_okz:
    v_smfmac_f32_16x16x64_bf16 v[164:167], v[128:131], v[140:147], v73
    v_smfmac_f32_16x16x64_bf16 v[164:167], v[132:135], v[148:155], v73
    v_smfmac_f32_16x16x64_bf16 v[80:83], v[136:139], v[180:187], v73
    v_max3_f32 v6, v156, v157, v158
    v_smfmac_f32_16x16x64_bf16 v[84:87], v[136:139], v[188:195], v73
    v_max3_f32 v6, v6, v159, v160
    v_smfmac_f32_16x16x64_bf16 v[88:91], v[136:139], v[176:183], v73
    v_max3_f32 v6, v6, v161, v162
    v_smfmac_f32_16x16x64_bf16 v[92:95], v[136:139], v[184:191], v73
    v_max_f32 v6, v6, v163
    v_permlane32_swap_b32 v164, v166
    v_permlane32_swap_b32 v165, v167
    v_add_f32 v164, v164, v166
    v_add_f32 v165, v165, v167
    v_max3_f32 v6, v6, v164, v165
    v_mov_b32 v7, v6
    v_cvt_pk_bf16_f32 v148, v80, v81
    v_cvt_pk_bf16_f32 v149, v82, v83
    v_permlane32_swap_b32 v6, v7
    v_max_f32 v6, v6, v7
    v_mov_b32 v7, v6
    v_cvt_pk_bf16_f32 v150, v84, v85
    v_cvt_pk_bf16_f32 v151, v86, v87
    v_permlane16_swap_b32 v6, v7
    v_max_f32 v6, v6, v7
    v_mul_f32 v6, s52, v6
    v_fma_f32 v156, v156, s52, -v6
    v_fma_f32 v157, v157, s52, -v6
    v_fma_f32 v158, v158, s52, -v6
    v_fma_f32 v159, v159, s52, -v6
    v_fma_f32 v160, v160, s52, -v6
    v_fma_f32 v161, v161, s52, -v6
    v_fma_f32 v162, v162, s52, -v6
    v_fma_f32 v163, v163, s52, -v6
    v_fma_f32 v164, v164, s52, -v6
    v_fma_f32 v165, v165, s52, -v6
    v_exp_f32 v156, v156
    v_exp_f32 v157, v157
    v_exp_f32 v158, v158
    v_exp_f32 v159, v159
    v_exp_f32 v160, v160
    v_exp_f32 v161, v161
    v_exp_f32 v162, v162
    v_exp_f32 v163, v163
    v_exp_f32 v164, v164
    v_exp_f32 v165, v165
    v_cvt_pk_bf16_f32 v200, v156, v157
    v_cvt_pk_bf16_f32 v201, v158, v159
    v_cvt_pk_bf16_f32 v202, v160, v161
    v_cvt_pk_bf16_f32 v203, v162, v163
    v_cvt_pk_bf16_f32 v208, v164, v165
    v_cvt_pk_bf16_f32 v209, v164, v165
    v_mfma_f32_16x16x32_bf16 v[196:199], v[204:207], v[200:203], 0
    v_cvt_pk_bf16_f32 v152, v88, v89
    v_permlane32_swap_b32 v208, v209
    v_mfma_f32_16x16x32_bf16 v[96:99], v[112:115], v[200:203], 0
    v_cvt_pk_bf16_f32 v153, v90, v91
    v_mfma_f32_16x16x32_bf16 v[100:103], v[116:119], v[200:203], 0
    v_cvt_pk_bf16_f32 v154, v92, v93
    v_mfma_f32_16x16x32_bf16 v[104:107], v[120:123], v[200:203], 0
    v_cvt_pk_bf16_f32 v155, v94, v95
    v_mfma_f32_16x16x32_bf16 v[108:111], v[124:127], v[200:203], 0
    v_mfma_f32_16x16x16_bf16 v[196:199], v[210:211], v[208:209], v[196:199]
    v_mfma_f32_16x16x16_bf16 v[96:99], v[148:149], v[208:209], v[96:99]
    v_mfma_f32_16x16x16_bf16 v[100:103], v[150:151], v[208:209], v[100:103]
    v_mfma_f32_16x16x16_bf16 v[104:107], v[152:153], v[208:209], v[104:107]
    v_mfma_f32_16x16x16_bf16 v[108:111], v[154:155], v[208:209], v[108:111]
    v_rcp_f32 v6, v196
    s_nop 0
    v_mul_f32 v96, v96, v6
    v_mul_f32 v97, v97, v6
    v_mul_f32 v98, v98, v6
    v_mul_f32 v99, v99, v6
    v_mul_f32 v100, v100, v6
    v_mul_f32 v101, v101, v6
    v_mul_f32 v102, v102, v6
    v_mul_f32 v103, v103, v6
    v_cvt_pk_bf16_f32 v140, v96, v100
    v_cvt_pk_bf16_f32 v141, v97, v101
    v_cvt_pk_bf16_f32 v142, v98, v102
    v_cvt_pk_bf16_f32 v143, v99, v103
    buffer_store_dwordx4 v[140:143], v1, s[4:7], s41 offen offset:0 sc1
    v_mul_f32 v104, v104, v6
    v_mul_f32 v105, v105, v6
    v_mul_f32 v106, v106, v6
    v_mul_f32 v107, v107, v6
    v_mul_f32 v108, v108, v6
    v_mul_f32 v109, v109, v6
    v_mul_f32 v110, v110, v6
    v_mul_f32 v111, v111, v6
    v_cvt_pk_bf16_f32 v144, v104, v108
    v_cvt_pk_bf16_f32 v145, v105, v109
    v_cvt_pk_bf16_f32 v146, v106, v110
    v_cvt_pk_bf16_f32 v147, v107, v111
    buffer_store_dwordx4 v[144:147], v1, s[4:7], s41 offen offset:1024 sc1
    s_add_u32 s41, s41, 0x4000
    s_branch L_q_fin
L_q_bad:
L_pd_26:
    buffer_load_dwordx4 v[128:131], v1, s[4:7], s49 offen offset:0 sc1
    buffer_load_dwordx4 v[132:135], v1, s[4:7], s49 offen offset:1024 sc1
    buffer_load_dwordx4 v[136:139], v1, s[4:7], s50 offen offset:2048 sc1
    s_waitcnt vmcnt(0)
    v_max_u32 v6, v128, v139
    v_max3_u32 v6, v6, v129, v130
    v_max3_u32 v6, v6, v131, v132
    v_max3_u32 v6, v6, v133, v134
    v_max3_u32 v6, v6, v135, v136
    v_max3_u32 v6, v6, v137, v138
    v_cmp_eq_u32 vcc, -1, v6
    s_cbranch_vccz L_pdok_27
    s_sleep 1
    s_sub_u32 s35, s35, 1
    s_cbranch_scc0 L_pd_26
    s_endpgm
L_pdok_27:
    s_branch L_q_ok
L_q_bady:
L_pd_28:
    buffer_load_dwordx4 v[128:131], v1, s[4:7], s49 offen offset:0 sc1
    buffer_load_dwordx4 v[132:135], v1, s[4:7], s49 offen offset:1024 sc1
    buffer_load_dwordx4 v[136:139], v1, s[4:7], s50 offen offset:2048 sc1
    s_waitcnt vmcnt(0)
    v_max_u32 v6, v128, v139
    v_max3_u32 v6, v6, v129, v130
    v_max3_u32 v6, v6, v131, v132
    v_max3_u32 v6, v6, v133, v134
    v_max3_u32 v6, v6, v135, v136
    v_max3_u32 v6, v6, v137, v138
    v_cmp_eq_u32 vcc, -1, v6
    s_cbranch_vccz L_pdok_29
    s_sleep 1
    s_sub_u32 s35, s35, 1
    s_cbranch_scc0 L_pd_28
    s_endpgm
L_pdok_29:
    s_branch L_q_oky
L_q_badz:
L_pd_30:
    buffer_load_dwordx4 v[128:131], v1, s[4:7], s49 offen offset:0 sc1
    buffer_load_dwordx4 v[132:135], v1, s[4:7], s49 offen offset:1024 sc1
    buffer_load_dwordx4 v[136:139], v1, s[4:7], s50 offen offset:2048 sc1
    s_waitcnt vmcnt(0)
    v_max_u32 v6, v128, v139
    v_max3_u32 v6, v6, v129, v130
    v_max3_u32 v6, v6, v131, v132
    v_max3_u32 v6, v6, v133, v134
    v_max3_u32 v6, v6, v135, v136
    v_max3_u32 v6, v6, v137, v138
    v_cmp_eq_u32 vcc, -1, v6
    s_cbranch_vccz L_pdok_31
    s_sleep 1
    s_sub_u32 s35, s35, 1
    s_cbranch_scc0 L_pd_30
    s_endpgm
L_pdok_31:
    s_branch L_q_okz
L_q_fin:
    s_waitcnt vmcnt(0)
    v_mov_b32 v9, 64
    s_barrier
    buffer_store_dword v9, v4, s[4:7], 0 offen sc1
    s_endpgm
L_o:
    s_mov_b32 s20, s64
    s_and_b32 s21, s65, 0xffff
    s_mov_b32 s22, 0x400000
    s_mov_b32 s23, 0x20000
    s_and_b32 s37, s63, 15
    s_lshl_b32 s37, s37, 2
    s_add_u32 s37, s37, s32
    s_lshl_b32 s37, s37, 11
    v_bfe_u32 v6, v0, 0, 4
    v_lshlrev_b32 v7, 7, v6
    v_bfe_u32 v6, v0, 4, 1
    v_lshl_add_u32 v7, v6, 17, v7
    v_bfe_u32 v6, v0, 5, 1
    v_lshl_add_u32 v7, v6, 30, v7
    buffer_load_dword v252, v7, s[20:23], s37 offen
    s_waitcnt vmcnt(1)
    s_barrier
    buffer_atomic_or v254, v255, s[8:11], 0 offen sc0 sc1
    s_mov_b32 s20, s72
    s_and_b32 s21, s73, 0xffff
    s_mov_b32 s22, 0x800000
    s_mov_b32 s23, 0x20000
    s_and_b32 s37, s36, 3
    s_lshl_b32 s37, s37, 2
    s_add_u32 s37, s37, s32
    s_lshl_b32 s37, s37, 16
    s_and_b32 s38, s36, 28
    s_lshl_b32 s38, s38, 8
    s_add_u32 s38, s38, s37
    v_bfe_u32 v6, v0, 0, 3
    v_lshlrev_b32 v7, 13, v6
    v_bfe_u32 v6, v0, 3, 3
    v_lshl_add_u32 v7, v6, 20, v7
    buffer_load_dword v252, v7, s[20:23], s38 offen offset:384
    s_cmp_ge_u32 s36, 28
    s_cselect_b32 s38, s38, 0x40000000
    buffer_load_dword v252, v7, s[20:23], s38 offen offset:896
    s_waitcnt vmcnt(0)
    v_mov_b32 v7, 163832
    s_cmp_lg_u32 s32, 0
    s_cbranch_scc1 L_cf_32
    v_readfirstlane_b32 s37, v254
    s_nop 1
    v_mov_b32 v6, s37
    ds_write_b32 v7, v6
    s_waitcnt lgkmcnt(0)
L_cf_32:
    s_barrier
    ds_read_b32 v6, v7
    s_waitcnt lgkmcnt(0)
    v_readfirstlane_b32 s37, v6
    s_nop 0
    s_bitcmp1_b32 s37, s63
    s_cbranch_scc1 L_redo
    s_and_b32 s37, s36, 1
    s_or_b32 s37, s37, s32
    s_cbranch_scc1 L_vote_done
    v_lshlrev_b32 v7, 2, v0
    v_mov_b32 v8, 0
    s_mul_i32 s40, s36, 0x700000
    s_add_u32 s40, s40, 0x1f8000
    s_mov_b32 s41, -1
    s_mov_b32 s42, -1
    s_memtime s[96:97]
    s_waitcnt vmcnt(0) lgkmcnt(0)
    buffer_store_dword v8, v7, s[4:7], s40 offen offset:0 sc1
    s_waitcnt vmcnt(0)
    s_memtime s[98:99]
    s_xor_b32 s40, s40, 0x2000
    s_waitcnt lgkmcnt(0)
    s_sub_u32 s98, s98, s96
    s_min_u32 s41, s41, s98
    s_memtime s[96:97]
    s_waitcnt vmcnt(0) lgkmcnt(0)
    buffer_store_dword v8, v7, s[4:7], s40 offen offset:0 sc1
    s_waitcnt vmcnt(0)
    s_memtime s[98:99]
    s_xor_b32 s40, s40, 0x2000
    s_waitcnt lgkmcnt(0)
    s_sub_u32 s98, s98, s96
    s_min_u32 s42, s42, s98
    s_memtime s[96:97]
    s_waitcnt vmcnt(0) lgkmcnt(0)
    buffer_store_dword v8, v7, s[4:7], s40 offen offset:256 sc1
    s_waitcnt vmcnt(0)
    s_memtime s[98:99]
    s_xor_b32 s40, s40, 0x2000
    s_waitcnt lgkmcnt(0)
    s_sub_u32 s98, s98, s96
    s_min_u32 s41, s41, s98
    s_memtime s[96:97]
    s_waitcnt vmcnt(0) lgkmcnt(0)
    buffer_store_dword v8, v7, s[4:7], s40 offen offset:256 sc1
    s_waitcnt vmcnt(0)
    s_memtime s[98:99]
    s_xor_b32 s40, s40, 0x2000
    s_waitcnt lgkmcnt(0)
    s_sub_u32 s98, s98, s96
    s_min_u32 s42, s42, s98
    s_memtime s[96:97]
    s_waitcnt vmcnt(0) lgkmcnt(0)
    buffer_store_dword v8, v7, s[4:7], s40 offen offset:512 sc1
    s_waitcnt vmcnt(0)
    s_memtime s[98:99]
    s_xor_b32 s40, s40, 0x2000
    s_waitcnt lgkmcnt(0)
    s_sub_u32 s98, s98, s96
    s_min_u32 s41, s41, s98
    s_memtime s[96:97]
    s_waitcnt vmcnt(0) lgkmcnt(0)
    buffer_store_dword v8, v7, s[4:7], s40 offen offset:512 sc1
    s_waitcnt vmcnt(0)
    s_memtime s[98:99]
    s_xor_b32 s40, s40, 0x2000
    s_waitcnt lgkmcnt(0)
    s_sub_u32 s98, s98, s96
    s_min_u32 s42, s42, s98
    s_cmp_lt_u32 s42, s41
    s_cselect_b32 s37, 1, 0
    s_lshr_b32 s38, s100, 2
    s_xor_b32 s37, s37, s38
    s_bfe_u32 s38, s40, 0x10015
    s_xor_b32 s37, s37, s38
    s_add_u32 s37, s37, 0x10000
    v_mov_b32 v6, s37
    s_mov_b64 exec, 1
    buffer_atomic_add v6, v8, s[8:11], 0 offen offset:228 sc1
    s_mov_b64 exec, -1
L_vote_done:
    s_barrier
    s_lshl_b32 s37, s36, 8
    v_bfe_u32 v6, v0, 1, 3
    v_lshlrev_b32 v7, 13, v6
    v_bfe_u32 v6, v0, 4, 2
    v_lshl_add_u32 v7, v6, 20, v7
    v_bfe_u32 v6, v0, 0, 1
    v_lshl_add_u32 v7, v6, 7, v7
    v_lshl_add_u32 v7, s32, 16, v7
    s_add_u32 s37, s37, 0x440000
    buffer_load_dword v252, v7, s[20:23], s37 offen
    s_add_u32 s37, s37, 0x40000
    buffer_load_dword v252, v7, s[20:23], s37 offen
    s_add_u32 s37, s37, 0x40000
    buffer_load_dword v252, v7, s[20:23], s37 offen
    s_add_u32 s37, s37, 0x40000
    s_mov_b32 s12, s80
    s_and_b32 s13, s81, 0xffff
    s_mov_b32 s14, 0x800
    s_mov_b32 s15, 0x20000
    s_mov_b32 s16, s64
    s_and_b32 s17, s65, 0xffff
    s_mov_b32 s18, 0x400000
    s_mov_b32 s19, 0x20000
    s_mov_b32 s20, s88
    s_and_b32 s21, s89, 0xffff
    s_mov_b32 s22, 0x800
    s_mov_b32 s23, 0x20000
    s_mov_b32 s24, s82
    s_and_b32 s25, s83, 0xffff
    s_mov_b32 s26, 0x700000
    s_mov_b32 s27, 0x20000
    s_mov_b32 s28, s84
    s_and_b32 s29, s85, 0xffff
    s_mov_b32 s30, 0x700000
    s_mov_b32 s31, 0x20000
    s_mov_b32 s44, 0xffff0000
    v_lshlrev_b32 v1, 4, v0
    v_lshlrev_b32 v2, 2, v0
    buffer_load_dwordx4 v[20:23], v1, s[12:15], 0 offen offset:0
    buffer_load_dwordx4 v[24:27], v1, s[12:15], 0 offen offset:1024
    buffer_load_dwordx4 v[28:31], v1, s[20:23], 0 offen offset:0
    buffer_load_dwordx4 v[32:35], v1, s[20:23], 0 offen offset:1024
    v_bfe_u32 v6, v0, 0, 4
    v_lshlrev_b32 v8, 11, v6
    v_bfe_u32 v6, v0, 4, 2
    v_lshl_add_u32 v8, v6, 4, v8
    s_lshl_b32 s37, s36, 2
    s_add_u32 s37, s37, s32
    s_lshl_b32 s40, s37, 4
    s_lshl_b32 s37, s37, 15
    buffer_load_dwordx4 a[0:3], v8, s[16:19], s37 offen offset:0
    buffer_load_dwordx4 a[4:7], v8, s[16:19], s37 offen offset:64
    buffer_load_dwordx4 a[8:11], v8, s[16:19], s37 offen offset:128
    buffer_load_dwordx4 a[12:15], v8, s[16:19], s37 offen offset:192
    buffer_load_dwordx4 a[16:19], v8, s[16:19], s37 offen offset:256
    buffer_load_dwordx4 a[20:23], v8, s[16:19], s37 offen offset:320
    buffer_load_dwordx4 a[24:27], v8, s[16:19], s37 offen offset:384
    buffer_load_dwordx4 a[28:31], v8, s[16:19], s37 offen offset:448
    buffer_load_dwordx4 a[32:35], v8, s[16:19], s37 offen offset:512
    buffer_load_dwordx4 a[36:39], v8, s[16:19], s37 offen offset:576
    buffer_load_dwordx4 a[40:43], v8, s[16:19], s37 offen offset:640
    buffer_load_dwordx4 a[44:47], v8, s[16:19], s37 offen offset:704
    buffer_load_dwordx4 a[48:51], v8, s[16:19], s37 offen offset:768
    buffer_load_dwordx4 a[52:55], v8, s[16:19], s37 offen offset:832
    buffer_load_dwordx4 a[56:59], v8, s[16:19], s37 offen offset:896
    buffer_load_dwordx4 a[60:63], v8, s[16:19], s37 offen offset:960
    buffer_load_dwordx4 a[64:67], v8, s[16:19], s37 offen offset:1024
    buffer_load_dwordx4 a[68:71], v8, s[16:19], s37 offen offset:1088
    buffer_load_dwordx4 a[72:75], v8, s[16:19], s37 offen offset:1152
    buffer_load_dwordx4 a[76:79], v8, s[16:19], s37 offen offset:1216
    buffer_load_dwordx4 a[80:83], v8, s[16:19], s37 offen offset:1280
    buffer_load_dwordx4 a[84:87], v8, s[16:19], s37 offen offset:1344
    buffer_load_dwordx4 a[88:91], v8, s[16:19], s37 offen offset:1408
    buffer_load_dwordx4 a[92:95], v8, s[16:19], s37 offen offset:1472
    buffer_load_dwordx4 a[96:99], v8, s[16:19], s37 offen offset:1536
    buffer_load_dwordx4 a[100:103], v8, s[16:19], s37 offen offset:1600
    buffer_load_dwordx4 a[104:107], v8, s[16:19], s37 offen offset:1664
    buffer_load_dwordx4 a[108:111], v8, s[16:19], s37 offen offset:1728
    buffer_load_dwordx4 a[112:115], v8, s[16:19], s37 offen offset:1792
    buffer_load_dwordx4 a[116:119], v8, s[16:19], s37 offen offset:1856
    buffer_load_dwordx4 a[120:123], v8, s[16:19], s37 offen offset:1920
    buffer_load_dwordx4 a[124:127], v8, s[16:19], s37 offen offset:1984
    v_lshrrev_b32 v6, 4, v0
    v_mul_u32_u24 v6, 57344, v6
    v_and_b32 v9, 15, v0
    v_lshl_add_u32 v5, v9, 4, v6
    s_cmp_lt_u32 s36, 28
    s_cselect_b32 s38, 0, 0x40000000
    v_add_u32 v5, s38, v5
    s_mul_i32 s42, s32, 1835008
    s_lshl_b32 s37, s36, 8
    s_add_u32 s42, s42, s37
    s_add_u32 s37, s42, 0x0
    buffer_load_dwordx4 v[52:55], v5, s[24:27], s37 offen nt
    s_add_u32 s37, s42, 0x1c00
    buffer_load_dwordx4 v[56:59], v5, s[24:27], s37 offen nt
    s_add_u32 s37, s42, 0x3800
    buffer_load_dwordx4 v[60:63], v5, s[24:27], s37 offen nt
    s_add_u32 s37, s42, 0x5400
    buffer_load_dwordx4 v[64:67], v5, s[24:27], s37 offen nt
    s_add_u32 s37, s42, 0x7000
    buffer_load_dwordx4 v[68:71], v5, s[24:27], s37 offen nt
    s_add_u32 s37, s42, 0x8c00
    buffer_load_dwordx4 v[72:75], v5, s[24:27], s37 offen nt
    s_add_u32 s37, s42, 0xa800
    buffer_load_dwordx4 v[76:79], v5, s[24:27], s37 offen nt
    s_add_u32 s37, s42, 0xc400
    buffer_load_dwordx4 v[80:83], v5, s[24:27], s37 offen nt
    s_add_u32 s37, s42, 0x0
    buffer_load_dwordx4 v[84:87], v5, s[28:31], s37 offen nt
    s_add_u32 s37, s42, 0x1c00
    buffer_load_dwordx4 v[88:91], v5, s[28:31], s37 offen nt
    s_add_u32 s37, s42, 0x3800
    buffer_load_dwordx4 v[92:95], v5, s[28:31], s37 offen nt
    s_add_u32 s37, s42, 0x5400
    buffer_load_dwordx4 v[96:99], v5, s[28:31], s37 offen nt
    s_add_u32 s37, s42, 0x7000
    buffer_load_dwordx4 v[100:103], v5, s[28:31], s37 offen nt
    s_add_u32 s37, s42, 0x8c00
    buffer_load_dwordx4 v[104:107], v5, s[28:31], s37 offen nt
    s_add_u32 s37, s42, 0xa800
    buffer_load_dwordx4 v[108:111], v5, s[28:31], s37 offen nt
    s_add_u32 s37, s42, 0xc400
    buffer_load_dwordx4 v[112:115], v5, s[28:31], s37 offen nt
    s_lshl_b32 s37, s32, 12
    v_add_u32 v9, s37, v1
    v_bfe_u32 v6, v0, 0, 1
    v_lshlrev_b32 v10, 11, v6
    v_bfe_u32 v6, v0, 4, 2
    v_lshl_add_u32 v10, v6, 4, v10
    v_add_u32 v10, s37, v10
    s_waitcnt vmcnt(48)
    ds_write_b128 v9, v[20:23] offset:0
    ds_write_b128 v9, v[24:27] offset:1024
    ds_write_b128 v9, v[28:31] offset:2048
    ds_write_b128 v9, v[32:35] offset:3072
    s_waitcnt vmcnt(16) lgkmcnt(0)
    v_mov_b32 v116, 0x3f803f80
    v_mov_b32 v117, 0x3f803f80
    v_mov_b32 v118, 0x3f803f80
    v_mov_b32 v119, 0x3f803f80
    v_and_b32 v10, 0xfffff7ff, v10
    ds_read_b128 v[20:23], v10 offset:0
    ds_read_b128 v[24:27], v10 offset:2048
    ds_read_b128 v[28:31], v10 offset:64
    ds_read_b128 v[32:35], v10 offset:2112
    ds_read_b128 v[36:39], v10 offset:128
    ds_read_b128 v[40:43], v10 offset:2176
    ds_read_b128 v[44:47], v10 offset:192
    ds_read_b128 v[48:51], v10 offset:2240
    s_waitcnt lgkmcnt(0)
    v_mfma_f32_16x16x32_bf16 v[12:15], v[20:23], a[0:3], 0
    v_accvgpr_read_b32 v6, a0
    v_lshlrev_b32 v8, 16, v24
    v_lshlrev_b32 v7, 16, v6
    v_mul_f32 v7, v7, v8
    v_and_b32 v6, s44, v6
    v_and_b32 v8, s44, v24
    v_mul_f32 v6, v6, v8
    v_cvt_pk_bf16_f32 v120, v7, v6
    v_accvgpr_read_b32 v6, a1
    v_lshlrev_b32 v8, 16, v25
    v_lshlrev_b32 v7, 16, v6
    v_mul_f32 v7, v7, v8
    v_and_b32 v6, s44, v6
    v_and_b32 v8, s44, v25
    v_mul_f32 v6, v6, v8
    v_cvt_pk_bf16_f32 v121, v7, v6
    v_accvgpr_read_b32 v6, a2
    v_lshlrev_b32 v8, 16, v26
    v_lshlrev_b32 v7, 16, v6
    v_mul_f32 v7, v7, v8
    v_and_b32 v6, s44, v6
    v_and_b32 v8, s44, v26
    v_mul_f32 v6, v6, v8
    v_cvt_pk_bf16_f32 v122, v7, v6
    v_accvgpr_read_b32 v6, a3
    v_lshlrev_b32 v8, 16, v27
    v_lshlrev_b32 v7, 16, v6
    v_mul_f32 v7, v7, v8
    v_and_b32 v6, s44, v6
    v_and_b32 v8, s44, v27
    v_mul_f32 v6, v6, v8
    v_cvt_pk_bf16_f32 v123, v7, v6
    s_nop 1
    v_mfma_f32_16x16x32_bf16 v[16:19], v[116:119], v[120:123], 0
    v_mfma_f32_16x16x32_bf16 v[12:15], v[28:31], a[4:7], v[12:15]
    v_accvgpr_read_b32 v6, a4
    v_lshlrev_b32 v8, 16, v32
    v_lshlrev_b32 v7, 16, v6
    v_mul_f32 v7, v7, v8
    v_and_b32 v6, s44, v6
    v_and_b32 v8, s44, v32
    v_mul_f32 v6, v6, v8
    v_cvt_pk_bf16_f32 v124, v7, v6
    v_accvgpr_read_b32 v6, a5
    v_lshlrev_b32 v8, 16, v33
    v_lshlrev_b32 v7, 16, v6
    v_mul_f32 v7, v7, v8
    v_and_b32 v6, s44, v6
    v_and_b32 v8, s44, v33
    v_mul_f32 v6, v6, v8
    v_cvt_pk_bf16_f32 v125, v7, v6
    v_accvgpr_read_b32 v6, a6
    v_lshlrev_b32 v8, 16, v34
    v_lshlrev_b32 v7, 16, v6
    v_mul_f32 v7, v7, v8
    v_and_b32 v6, s44, v6
    v_and_b32 v8, s44, v34
    v_mul_f32 v6, v6, v8
    v_cvt_pk_bf16_f32 v126, v7, v6
    v_accvgpr_read_b32 v6, a7
    v_lshlrev_b32 v8, 16, v35
    v_lshlrev_b32 v7, 16, v6
    v_mul_f32 v7, v7, v8
    v_and_b32 v6, s44, v6
    v_and_b32 v8, s44, v35
    v_mul_f32 v6, v6, v8
    v_cvt_pk_bf16_f32 v127, v7, v6
    s_nop 1
    v_mfma_f32_16x16x32_bf16 v[16:19], v[116:119], v[124:127], v[16:19]
    v_mfma_f32_16x16x32_bf16 v[12:15], v[36:39], a[8:11], v[12:15]
    v_accvgpr_read_b32 v6, a8
    v_lshlrev_b32 v8, 16, v40
    v_lshlrev_b32 v7, 16, v6
    v_mul_f32 v7, v7, v8
    v_and_b32 v6, s44, v6
    v_and_b32 v8, s44, v40
    v_mul_f32 v6, v6, v8
    v_cvt_pk_bf16_f32 v120, v7, v6
    v_accvgpr_read_b32 v6, a9
    v_lshlrev_b32 v8, 16, v41
    v_lshlrev_b32 v7, 16, v6
    v_mul_f32 v7, v7, v8
    v_and_b32 v6, s44, v6
    v_and_b32 v8, s44, v41
    v_mul_f32 v6, v6, v8
    v_cvt_pk_bf16_f32 v121, v7, v6
    v_accvgpr_read_b32 v6, a10
    v_lshlrev_b32 v8, 16, v42
    v_lshlrev_b32 v7, 16, v6
    v_mul_f32 v7, v7, v8
    v_and_b32 v6, s44, v6
    v_and_b32 v8, s44, v42
    v_mul_f32 v6, v6, v8
    v_cvt_pk_bf16_f32 v122, v7, v6
    v_accvgpr_read_b32 v6, a11
    v_lshlrev_b32 v8, 16, v43
    v_lshlrev_b32 v7, 16, v6
    v_mul_f32 v7, v7, v8
    v_and_b32 v6, s44, v6
    v_and_b32 v8, s44, v43
    v_mul_f32 v6, v6, v8
    v_cvt_pk_bf16_f32 v123, v7, v6
    s_nop 1
    v_mfma_f32_16x16x32_bf16 v[16:19], v[116:119], v[120:123], v[16:19]
    v_mfma_f32_16x16x32_bf16 v[12:15], v[44:47], a[12:15], v[12:15]
    v_accvgpr_read_b32 v6, a12
    v_lshlrev_b32 v8, 16, v48
    v_lshlrev_b32 v7, 16, v6
    v_mul_f32 v7, v7, v8
    v_and_b32 v6, s44, v6
    v_and_b32 v8, s44, v48
    v_mul_f32 v6, v6, v8
    v_cvt_pk_bf16_f32 v124, v7, v6
    v_accvgpr_read_b32 v6, a13
    v_lshlrev_b32 v8, 16, v49
    v_lshlrev_b32 v7, 16, v6
    v_mul_f32 v7, v7, v8
    v_and_b32 v6, s44, v6
    v_and_b32 v8, s44, v49
    v_mul_f32 v6, v6, v8
    v_cvt_pk_bf16_f32 v125, v7, v6
    v_accvgpr_read_b32 v6, a14
    v_lshlrev_b32 v8, 16, v50
    v_lshlrev_b32 v7, 16, v6
    v_mul_f32 v7, v7, v8
    v_and_b32 v6, s44, v6
    v_and_b32 v8, s44, v50
    v_mul_f32 v6, v6, v8
    v_cvt_pk_bf16_f32 v126, v7, v6
    v_accvgpr_read_b32 v6, a15
    v_lshlrev_b32 v8, 16, v51
    v_lshlrev_b32 v7, 16, v6
    v_mul_f32 v7, v7, v8
    v_and_b32 v6, s44, v6
    v_and_b32 v8, s44, v51
    v_mul_f32 v6, v6, v8
    v_cvt_pk_bf16_f32 v127, v7, v6
    s_nop 1
    v_mfma_f32_16x16x32_bf16 v[16:19], v[116:119], v[124:127], v[16:19]
    ds_read_b128 v[20:23], v10 offset:256
    ds_read_b128 v[24:27], v10 offset:2304
    ds_read_b128 v[28:31], v10 offset:320
    ds_read_b128 v[32:35], v10 offset:2368
    ds_read_b128 v[36:39], v10 offset:384
    ds_read_b128 v[40:43], v10 offset:2432
    ds_read_b128 v[44:47], v10 offset:448
    ds_read_b128 v[48:51], v10 offset:2496
    s_waitcnt lgkmcnt(0)
    v_mfma_f32_16x16x32_bf16 v[12:15], v[20:23], a[16:19], v[12:15]
    v_accvgpr_read_b32 v6, a16
    v_lshlrev_b32 v8, 16, v24
    v_lshlrev_b32 v7, 16, v6
    v_mul_f32 v7, v7, v8
    v_and_b32 v6, s44, v6
    v_and_b32 v8, s44, v24
    v_mul_f32 v6, v6, v8
    v_cvt_pk_bf16_f32 v120, v7, v6
    v_accvgpr_read_b32 v6, a17
    v_lshlrev_b32 v8, 16, v25
    v_lshlrev_b32 v7, 16, v6
    v_mul_f32 v7, v7, v8
    v_and_b32 v6, s44, v6
    v_and_b32 v8, s44, v25
    v_mul_f32 v6, v6, v8
    v_cvt_pk_bf16_f32 v121, v7, v6
    v_accvgpr_read_b32 v6, a18
    v_lshlrev_b32 v8, 16, v26
    v_lshlrev_b32 v7, 16, v6
    v_mul_f32 v7, v7, v8
    v_and_b32 v6, s44, v6
    v_and_b32 v8, s44, v26
    v_mul_f32 v6, v6, v8
    v_cvt_pk_bf16_f32 v122, v7, v6
    v_accvgpr_read_b32 v6, a19
    v_lshlrev_b32 v8, 16, v27
    v_lshlrev_b32 v7, 16, v6
    v_mul_f32 v7, v7, v8
    v_and_b32 v6, s44, v6
    v_and_b32 v8, s44, v27
    v_mul_f32 v6, v6, v8
    v_cvt_pk_bf16_f32 v123, v7, v6
    s_nop 1
    v_mfma_f32_16x16x32_bf16 v[16:19], v[116:119], v[120:123], v[16:19]
    v_mfma_f32_16x16x32_bf16 v[12:15], v[28:31], a[20:23], v[12:15]
    v_accvgpr_read_b32 v6, a20
    v_lshlrev_b32 v8, 16, v32
    v_lshlrev_b32 v7, 16, v6
    v_mul_f32 v7, v7, v8
    v_and_b32 v6, s44, v6
    v_and_b32 v8, s44, v32
    v_mul_f32 v6, v6, v8
    v_cvt_pk_bf16_f32 v124, v7, v6
    v_accvgpr_read_b32 v6, a21
    v_lshlrev_b32 v8, 16, v33
    v_lshlrev_b32 v7, 16, v6
    v_mul_f32 v7, v7, v8
    v_and_b32 v6, s44, v6
    v_and_b32 v8, s44, v33
    v_mul_f32 v6, v6, v8
    v_cvt_pk_bf16_f32 v125, v7, v6
    v_accvgpr_read_b32 v6, a22
    v_lshlrev_b32 v8, 16, v34
    v_lshlrev_b32 v7, 16, v6
    v_mul_f32 v7, v7, v8
    v_and_b32 v6, s44, v6
    v_and_b32 v8, s44, v34
    v_mul_f32 v6, v6, v8
    v_cvt_pk_bf16_f32 v126, v7, v6
    v_accvgpr_read_b32 v6, a23
    v_lshlrev_b32 v8, 16, v35
    v_lshlrev_b32 v7, 16, v6
    v_mul_f32 v7, v7, v8
    v_and_b32 v6, s44, v6
    v_and_b32 v8, s44, v35
    v_mul_f32 v6, v6, v8
    v_cvt_pk_bf16_f32 v127, v7, v6
    s_nop 1
    v_mfma_f32_16x16x32_bf16 v[16:19], v[116:119], v[124:127], v[16:19]
    v_mfma_f32_16x16x32_bf16 v[12:15], v[36:39], a[24:27], v[12:15]
    v_accvgpr_read_b32 v6, a24
    v_lshlrev_b32 v8, 16, v40
    v_lshlrev_b32 v7, 16, v6
    v_mul_f32 v7, v7, v8
    v_and_b32 v6, s44, v6
    v_and_b32 v8, s44, v40
    v_mul_f32 v6, v6, v8
    v_cvt_pk_bf16_f32 v120, v7, v6
    v_accvgpr_read_b32 v6, a25
    v_lshlrev_b32 v8, 16, v41
    v_lshlrev_b32 v7, 16, v6
    v_mul_f32 v7, v7, v8
    v_and_b32 v6, s44, v6
    v_and_b32 v8, s44, v41
    v_mul_f32 v6, v6, v8
    v_cvt_pk_bf16_f32 v121, v7, v6
    v_accvgpr_read_b32 v6, a26
    v_lshlrev_b32 v8, 16, v42
    v_lshlrev_b32 v7, 16, v6
    v_mul_f32 v7, v7, v8
    v_and_b32 v6, s44, v6
    v_and_b32 v8, s44, v42
    v_mul_f32 v6, v6, v8
    v_cvt_pk_bf16_f32 v122, v7, v6
    v_accvgpr_read_b32 v6, a27
    v_lshlrev_b32 v8, 16, v43
    v_lshlrev_b32 v7, 16, v6
    v_mul_f32 v7, v7, v8
    v_and_b32 v6, s44, v6
    v_and_b32 v8, s44, v43
    v_mul_f32 v6, v6, v8
    v_cvt_pk_bf16_f32 v123, v7, v6
    s_nop 1
    v_mfma_f32_16x16x32_bf16 v[16:19], v[116:119], v[120:123], v[16:19]
    v_mfma_f32_16x16x32_bf16 v[12:15], v[44:47], a[28:31], v[12:15]
    v_accvgpr_read_b32 v6, a28
    v_lshlrev_b32 v8, 16, v48
    v_lshlrev_b32 v7, 16, v6
    v_mul_f32 v7, v7, v8
    v_and_b32 v6, s44, v6
    v_and_b32 v8, s44, v48
    v_mul_f32 v6, v6, v8
    v_cvt_pk_bf16_f32 v124, v7, v6
    v_accvgpr_read_b32 v6, a29
    v_lshlrev_b32 v8, 16, v49
    v_lshlrev_b32 v7, 16, v6
    v_mul_f32 v7, v7, v8
    v_and_b32 v6, s44, v6
    v_and_b32 v8, s44, v49
    v_mul_f32 v6, v6, v8
    v_cvt_pk_bf16_f32 v125, v7, v6
    v_accvgpr_read_b32 v6, a30
    v_lshlrev_b32 v8, 16, v50
    v_lshlrev_b32 v7, 16, v6
    v_mul_f32 v7, v7, v8
    v_and_b32 v6, s44, v6
    v_and_b32 v8, s44, v50
    v_mul_f32 v6, v6, v8
    v_cvt_pk_bf16_f32 v126, v7, v6
    v_accvgpr_read_b32 v6, a31
    v_lshlrev_b32 v8, 16, v51
    v_lshlrev_b32 v7, 16, v6
    v_mul_f32 v7, v7, v8
    v_and_b32 v6, s44, v6
    v_and_b32 v8, s44, v51
    v_mul_f32 v6, v6, v8
    v_cvt_pk_bf16_f32 v127, v7, v6
    s_nop 1
    v_mfma_f32_16x16x32_bf16 v[16:19], v[116:119], v[124:127], v[16:19]
    ds_read_b128 v[20:23], v10 offset:512
    ds_read_b128 v[24:27], v10 offset:2560
    ds_read_b128 v[28:31], v10 offset:576
    ds_read_b128 v[32:35], v10 offset:2624
    ds_read_b128 v[36:39], v10 offset:640
    ds_read_b128 v[40:43], v10 offset:2688
    ds_read_b128 v[44:47], v10 offset:704
    ds_read_b128 v[48:51], v10 offset:2752
    s_waitcnt lgkmcnt(0)
    v_mfma_f32_16x16x32_bf16 v[12:15], v[20:23], a[32:35], v[12:15]
    v_accvgpr_read_b32 v6, a32
    v_lshlrev_b32 v8, 16, v24
    v_lshlrev_b32 v7, 16, v6
    v_mul_f32 v7, v7, v8
    v_and_b32 v6, s44, v6
    v_and_b32 v8, s44, v24
    v_mul_f32 v6, v6, v8
    v_cvt_pk_bf16_f32 v120, v7, v6
    v_accvgpr_read_b32 v6, a33
    v_lshlrev_b32 v8, 16, v25
    v_lshlrev_b32 v7, 16, v6
    v_mul_f32 v7, v7, v8
    v_and_b32 v6, s44, v6
    v_and_b32 v8, s44, v25
    v_mul_f32 v6, v6, v8
    v_cvt_pk_bf16_f32 v121, v7, v6
    v_accvgpr_read_b32 v6, a34
    v_lshlrev_b32 v8, 16, v26
    v_lshlrev_b32 v7, 16, v6
    v_mul_f32 v7, v7, v8
    v_and_b32 v6, s44, v6
    v_and_b32 v8, s44, v26
    v_mul_f32 v6, v6, v8
    v_cvt_pk_bf16_f32 v122, v7, v6
    v_accvgpr_read_b32 v6, a35
    v_lshlrev_b32 v8, 16, v27
    v_lshlrev_b32 v7, 16, v6
    v_mul_f32 v7, v7, v8
    v_and_b32 v6, s44, v6
    v_and_b32 v8, s44, v27
    v_mul_f32 v6, v6, v8
    v_cvt_pk_bf16_f32 v123, v7, v6
    s_nop 1
    v_mfma_f32_16x16x32_bf16 v[16:19], v[116:119], v[120:123], v[16:19]
    v_mfma_f32_16x16x32_bf16 v[12:15], v[28:31], a[36:39], v[12:15]
    v_accvgpr_read_b32 v6, a36
    v_lshlrev_b32 v8, 16, v32
    v_lshlrev_b32 v7, 16, v6
    v_mul_f32 v7, v7, v8
    v_and_b32 v6, s44, v6
    v_and_b32 v8, s44, v32
    v_mul_f32 v6, v6, v8
    v_cvt_pk_bf16_f32 v124, v7, v6
    v_accvgpr_read_b32 v6, a37
    v_lshlrev_b32 v8, 16, v33
    v_lshlrev_b32 v7, 16, v6
    v_mul_f32 v7, v7, v8
    v_and_b32 v6, s44, v6
    v_and_b32 v8, s44, v33
    v_mul_f32 v6, v6, v8
    v_cvt_pk_bf16_f32 v125, v7, v6
    v_accvgpr_read_b32 v6, a38
    v_lshlrev_b32 v8, 16, v34
    v_lshlrev_b32 v7, 16, v6
    v_mul_f32 v7, v7, v8
    v_and_b32 v6, s44, v6
    v_and_b32 v8, s44, v34
    v_mul_f32 v6, v6, v8
    v_cvt_pk_bf16_f32 v126, v7, v6
    v_accvgpr_read_b32 v6, a39
    v_lshlrev_b32 v8, 16, v35
    v_lshlrev_b32 v7, 16, v6
    v_mul_f32 v7, v7, v8
    v_and_b32 v6, s44, v6
    v_and_b32 v8, s44, v35
    v_mul_f32 v6, v6, v8
    v_cvt_pk_bf16_f32 v127, v7, v6
    s_nop 1
    v_mfma_f32_16x16x32_bf16 v[16:19], v[116:119], v[124:127], v[16:19]
    v_mfma_f32_16x16x32_bf16 v[12:15], v[36:39], a[40:43], v[12:15]
    v_accvgpr_read_b32 v6, a40
    v_lshlrev_b32 v8, 16, v40
    v_lshlrev_b32 v7, 16, v6
    v_mul_f32 v7, v7, v8
    v_and_b32 v6, s44, v6
    v_and_b32 v8, s44, v40
    v_mul_f32 v6, v6, v8
    v_cvt_pk_bf16_f32 v120, v7, v6
    v_accvgpr_read_b32 v6, a41
    v_lshlrev_b32 v8, 16, v41
    v_lshlrev_b32 v7, 16, v6
    v_mul_f32 v7, v7, v8
    v_and_b32 v6, s44, v6
    v_and_b32 v8, s44, v41
    v_mul_f32 v6, v6, v8
    v_cvt_pk_bf16_f32 v121, v7, v6
    v_accvgpr_read_b32 v6, a42
    v_lshlrev_b32 v8, 16, v42
    v_lshlrev_b32 v7, 16, v6
    v_mul_f32 v7, v7, v8
    v_and_b32 v6, s44, v6
    v_and_b32 v8, s44, v42
    v_mul_f32 v6, v6, v8
    v_cvt_pk_bf16_f32 v122, v7, v6
    v_accvgpr_read_b32 v6, a43
    v_lshlrev_b32 v8, 16, v43
    v_lshlrev_b32 v7, 16, v6
    v_mul_f32 v7, v7, v8
    v_and_b32 v6, s44, v6
    v_and_b32 v8, s44, v43
    v_mul_f32 v6, v6, v8
    v_cvt_pk_bf16_f32 v123, v7, v6
    s_nop 1
    v_mfma_f32_16x16x32_bf16 v[16:19], v[116:119], v[120:123], v[16:19]
    v_mfma_f32_16x16x32_bf16 v[12:15], v[44:47], a[44:47], v[12:15]
    v_accvgpr_read_b32 v6, a44
    v_lshlrev_b32 v8, 16, v48
    v_lshlrev_b32 v7, 16, v6
    v_mul_f32 v7, v7, v8
    v_and_b32 v6, s44, v6
    v_and_b32 v8, s44, v48
    v_mul_f32 v6, v6, v8
    v_cvt_pk_bf16_f32 v124, v7, v6
    v_accvgpr_read_b32 v6, a45
    v_lshlrev_b32 v8, 16, v49
    v_lshlrev_b32 v7, 16, v6
    v_mul_f32 v7, v7, v8
    v_and_b32 v6, s44, v6
    v_and_b32 v8, s44, v49
    v_mul_f32 v6, v6, v8
    v_cvt_pk_bf16_f32 v125, v7, v6
    v_accvgpr_read_b32 v6, a46
    v_lshlrev_b32 v8, 16, v50
    v_lshlrev_b32 v7, 16, v6
    v_mul_f32 v7, v7, v8
    v_and_b32 v6, s44, v6
    v_and_b32 v8, s44, v50
    v_mul_f32 v6, v6, v8
    v_cvt_pk_bf16_f32 v126, v7, v6
    v_accvgpr_read_b32 v6, a47
    v_lshlrev_b32 v8, 16, v51
    v_lshlrev_b32 v7, 16, v6
    v_mul_f32 v7, v7, v8
    v_and_b32 v6, s44, v6
    v_and_b32 v8, s44, v51
    v_mul_f32 v6, v6, v8
    v_cvt_pk_bf16_f32 v127, v7, v6
    s_nop 1
    v_mfma_f32_16x16x32_bf16 v[16:19], v[116:119], v[124:127], v[16:19]
    ds_read_b128 v[20:23], v10 offset:768
    ds_read_b128 v[24:27], v10 offset:2816
    ds_read_b128 v[28:31], v10 offset:832
    ds_read_b128 v[32:35], v10 offset:2880
    ds_read_b128 v[36:39], v10 offset:896
    ds_read_b128 v[40:43], v10 offset:2944
    ds_read_b128 v[44:47], v10 offset:960
    ds_read_b128 v[48:51], v10 offset:3008
    s_waitcnt lgkmcnt(0)
    v_mfma_f32_16x16x32_bf16 v[12:15], v[20:23], a[48:51], v[12:15]
    v_accvgpr_read_b32 v6, a48
    v_lshlrev_b32 v8, 16, v24
    v_lshlrev_b32 v7, 16, v6
    v_mul_f32 v7, v7, v8
    v_and_b32 v6, s44, v6
    v_and_b32 v8, s44, v24
    v_mul_f32 v6, v6, v8
    v_cvt_pk_bf16_f32 v120, v7, v6
    v_accvgpr_read_b32 v6, a49
    v_lshlrev_b32 v8, 16, v25
    v_lshlrev_b32 v7, 16, v6
    v_mul_f32 v7, v7, v8
    v_and_b32 v6, s44, v6
    v_and_b32 v8, s44, v25
    v_mul_f32 v6, v6, v8
    v_cvt_pk_bf16_f32 v121, v7, v6
    v_accvgpr_read_b32 v6, a50
    v_lshlrev_b32 v8, 16, v26
    v_lshlrev_b32 v7, 16, v6
    v_mul_f32 v7, v7, v8
    v_and_b32 v6, s44, v6
    v_and_b32 v8, s44, v26
    v_mul_f32 v6, v6, v8
    v_cvt_pk_bf16_f32 v122, v7, v6
    v_accvgpr_read_b32 v6, a51
    v_lshlrev_b32 v8, 16, v27
    v_lshlrev_b32 v7, 16, v6
    v_mul_f32 v7, v7, v8
    v_and_b32 v6, s44, v6
    v_and_b32 v8, s44, v27
    v_mul_f32 v6, v6, v8
    v_cvt_pk_bf16_f32 v123, v7, v6
    s_nop 1
    v_mfma_f32_16x16x32_bf16 v[16:19], v[116:119], v[120:123], v[16:19]
    v_mfma_f32_16x16x32_bf16 v[12:15], v[28:31], a[52:55], v[12:15]
    v_accvgpr_read_b32 v6, a52
    v_lshlrev_b32 v8, 16, v32
    v_lshlrev_b32 v7, 16, v6
    v_mul_f32 v7, v7, v8
    v_and_b32 v6, s44, v6
    v_and_b32 v8, s44, v32
    v_mul_f32 v6, v6, v8
    v_cvt_pk_bf16_f32 v124, v7, v6
    v_accvgpr_read_b32 v6, a53
    v_lshlrev_b32 v8, 16, v33
    v_lshlrev_b32 v7, 16, v6
    v_mul_f32 v7, v7, v8
    v_and_b32 v6, s44, v6
    v_and_b32 v8, s44, v33
    v_mul_f32 v6, v6, v8
    v_cvt_pk_bf16_f32 v125, v7, v6
    v_accvgpr_read_b32 v6, a54
    v_lshlrev_b32 v8, 16, v34
    v_lshlrev_b32 v7, 16, v6
    v_mul_f32 v7, v7, v8
    v_and_b32 v6, s44, v6
    v_and_b32 v8, s44, v34
    v_mul_f32 v6, v6, v8
    v_cvt_pk_bf16_f32 v126, v7, v6
    v_accvgpr_read_b32 v6, a55
    v_lshlrev_b32 v8, 16, v35
    v_lshlrev_b32 v7, 16, v6
    v_mul_f32 v7, v7, v8
    v_and_b32 v6, s44, v6
    v_and_b32 v8, s44, v35
    v_mul_f32 v6, v6, v8
    v_cvt_pk_bf16_f32 v127, v7, v6
    s_nop 1
    v_mfma_f32_16x16x32_bf16 v[16:19], v[116:119], v[124:127], v[16:19]
    v_mfma_f32_16x16x32_bf16 v[12:15], v[36:39], a[56:59], v[12:15]
    v_accvgpr_read_b32 v6, a56
    v_lshlrev_b32 v8, 16, v40
    v_lshlrev_b32 v7, 16, v6
    v_mul_f32 v7, v7, v8
    v_and_b32 v6, s44, v6
    v_and_b32 v8, s44, v40
    v_mul_f32 v6, v6, v8
    v_cvt_pk_bf16_f32 v120, v7, v6
    v_accvgpr_read_b32 v6, a57
    v_lshlrev_b32 v8, 16, v41
    v_lshlrev_b32 v7, 16, v6
    v_mul_f32 v7, v7, v8
    v_and_b32 v6, s44, v6
    v_and_b32 v8, s44, v41
    v_mul_f32 v6, v6, v8
    v_cvt_pk_bf16_f32 v121, v7, v6
    v_accvgpr_read_b32 v6, a58
    v_lshlrev_b32 v8, 16, v42
    v_lshlrev_b32 v7, 16, v6
    v_mul_f32 v7, v7, v8
    v_and_b32 v6, s44, v6
    v_and_b32 v8, s44, v42
    v_mul_f32 v6, v6, v8
    v_cvt_pk_bf16_f32 v122, v7, v6
    v_accvgpr_read_b32 v6, a59
    v_lshlrev_b32 v8, 16, v43
    v_lshlrev_b32 v7, 16, v6
    v_mul_f32 v7, v7, v8
    v_and_b32 v6, s44, v6
    v_and_b32 v8, s44, v43
    v_mul_f32 v6, v6, v8
    v_cvt_pk_bf16_f32 v123, v7, v6
    s_nop 1
    v_mfma_f32_16x16x32_bf16 v[16:19], v[116:119], v[120:123], v[16:19]
    v_mfma_f32_16x16x32_bf16 v[12:15], v[44:47], a[60:63], v[12:15]
    v_accvgpr_read_b32 v6, a60
    v_lshlrev_b32 v8, 16, v48
    v_lshlrev_b32 v7, 16, v6
    v_mul_f32 v7, v7, v8
    v_and_b32 v6, s44, v6
    v_and_b32 v8, s44, v48
    v_mul_f32 v6, v6, v8
    v_cvt_pk_bf16_f32 v124, v7, v6
    v_accvgpr_read_b32 v6, a61
    v_lshlrev_b32 v8, 16, v49
    v_lshlrev_b32 v7, 16, v6
    v_mul_f32 v7, v7, v8
    v_and_b32 v6, s44, v6
    v_and_b32 v8, s44, v49
    v_mul_f32 v6, v6, v8
    v_cvt_pk_bf16_f32 v125, v7, v6
    v_accvgpr_read_b32 v6, a62
    v_lshlrev_b32 v8, 16, v50
    v_lshlrev_b32 v7, 16, v6
    v_mul_f32 v7, v7, v8
    v_and_b32 v6, s44, v6
    v_and_b32 v8, s44, v50
    v_mul_f32 v6, v6, v8
    v_cvt_pk_bf16_f32 v126, v7, v6
    v_accvgpr_read_b32 v6, a63
    v_lshlrev_b32 v8, 16, v51
    v_lshlrev_b32 v7, 16, v6
    v_mul_f32 v7, v7, v8
    v_and_b32 v6, s44, v6
    v_and_b32 v8, s44, v51
    v_mul_f32 v6, v6, v8
    v_cvt_pk_bf16_f32 v127, v7, v6
    s_nop 1
    v_mfma_f32_16x16x32_bf16 v[16:19], v[116:119], v[124:127], v[16:19]
    ds_read_b128 v[20:23], v10 offset:1024
    ds_read_b128 v[24:27], v10 offset:3072
    ds_read_b128 v[28:31], v10 offset:1088
    ds_read_b128 v[32:35], v10 offset:3136
    ds_read_b128 v[36:39], v10 offset:1152
    ds_read_b128 v[40:43], v10 offset:3200
    ds_read_b128 v[44:47], v10 offset:1216
    ds_read_b128 v[48:51], v10 offset:3264
    s_waitcnt lgkmcnt(0)
    v_mfma_f32_16x16x32_bf16 v[12:15], v[20:23], a[64:67], v[12:15]
    v_accvgpr_read_b32 v6, a64
    v_lshlrev_b32 v8, 16, v24
    v_lshlrev_b32 v7, 16, v6
    v_mul_f32 v7, v7, v8
    v_and_b32 v6, s44, v6
    v_and_b32 v8, s44, v24
    v_mul_f32 v6, v6, v8
    v_cvt_pk_bf16_f32 v120, v7, v6
    v_accvgpr_read_b32 v6, a65
    v_lshlrev_b32 v8, 16, v25
    v_lshlrev_b32 v7, 16, v6
    v_mul_f32 v7, v7, v8
    v_and_b32 v6, s44, v6
    v_and_b32 v8, s44, v25
    v_mul_f32 v6, v6, v8
    v_cvt_pk_bf16_f32 v121, v7, v6
    v_accvgpr_read_b32 v6, a66
    v_lshlrev_b32 v8, 16, v26
    v_lshlrev_b32 v7, 16, v6
    v_mul_f32 v7, v7, v8
    v_and_b32 v6, s44, v6
    v_and_b32 v8, s44, v26
    v_mul_f32 v6, v6, v8
    v_cvt_pk_bf16_f32 v122, v7, v6
    v_accvgpr_read_b32 v6, a67
    v_lshlrev_b32 v8, 16, v27
    v_lshlrev_b32 v7, 16, v6
    v_mul_f32 v7, v7, v8
    v_and_b32 v6, s44, v6
    v_and_b32 v8, s44, v27
    v_mul_f32 v6, v6, v8
    v_cvt_pk_bf16_f32 v123, v7, v6
    s_nop 1
    v_mfma_f32_16x16x32_bf16 v[16:19], v[116:119], v[120:123], v[16:19]
    v_mfma_f32_16x16x32_bf16 v[12:15], v[28:31], a[68:71], v[12:15]
    v_accvgpr_read_b32 v6, a68
    v_lshlrev_b32 v8, 16, v32
    v_lshlrev_b32 v7, 16, v6
    v_mul_f32 v7, v7, v8
    v_and_b32 v6, s44, v6
    v_and_b32 v8, s44, v32
    v_mul_f32 v6, v6, v8
    v_cvt_pk_bf16_f32 v124, v7, v6
    v_accvgpr_read_b32 v6, a69
    v_lshlrev_b32 v8, 16, v33
    v_lshlrev_b32 v7, 16, v6
    v_mul_f32 v7, v7, v8
    v_and_b32 v6, s44, v6
    v_and_b32 v8, s44, v33
    v_mul_f32 v6, v6, v8
    v_cvt_pk_bf16_f32 v125, v7, v6
    v_accvgpr_read_b32 v6, a70
    v_lshlrev_b32 v8, 16, v34
    v_lshlrev_b32 v7, 16, v6
    v_mul_f32 v7, v7, v8
    v_and_b32 v6, s44, v6
    v_and_b32 v8, s44, v34
    v_mul_f32 v6, v6, v8
    v_cvt_pk_bf16_f32 v126, v7, v6
    v_accvgpr_read_b32 v6, a71
    v_lshlrev_b32 v8, 16, v35
    v_lshlrev_b32 v7, 16, v6
    v_mul_f32 v7, v7, v8
    v_and_b32 v6, s44, v6
    v_and_b32 v8, s44, v35
    v_mul_f32 v6, v6, v8
    v_cvt_pk_bf16_f32 v127, v7, v6
    s_nop 1
    v_mfma_f32_16x16x32_bf16 v[16:19], v[116:119], v[124:127], v[16:19]
    v_mfma_f32_16x16x32_bf16 v[12:15], v[36:39], a[72:75], v[12:15]
    v_accvgpr_read_b32 v6, a72
    v_lshlrev_b32 v8, 16, v40
    v_lshlrev_b32 v7, 16, v6
    v_mul_f32 v7, v7, v8
    v_and_b32 v6, s44, v6
    v_and_b32 v8, s44, v40
    v_mul_f32 v6, v6, v8
    v_cvt_pk_bf16_f32 v120, v7, v6
    v_accvgpr_read_b32 v6, a73
    v_lshlrev_b32 v8, 16, v41
    v_lshlrev_b32 v7, 16, v6
    v_mul_f32 v7, v7, v8
    v_and_b32 v6, s44, v6
    v_and_b32 v8, s44, v41
    v_mul_f32 v6, v6, v8
    v_cvt_pk_bf16_f32 v121, v7, v6
    v_accvgpr_read_b32 v6, a74
    v_lshlrev_b32 v8, 16, v42
    v_lshlrev_b32 v7, 16, v6
    v_mul_f32 v7, v7, v8
    v_and_b32 v6, s44, v6
    v_and_b32 v8, s44, v42
    v_mul_f32 v6, v6, v8
    v_cvt_pk_bf16_f32 v122, v7, v6
    v_accvgpr_read_b32 v6, a75
    v_lshlrev_b32 v8, 16, v43
    v_lshlrev_b32 v7, 16, v6
    v_mul_f32 v7, v7, v8
    v_and_b32 v6, s44, v6
    v_and_b32 v8, s44, v43
    v_mul_f32 v6, v6, v8
    v_cvt_pk_bf16_f32 v123, v7, v6
    s_nop 1
    v_mfma_f32_16x16x32_bf16 v[16:19], v[116:119], v[120:123], v[16:19]
    v_mfma_f32_16x16x32_bf16 v[12:15], v[44:47], a[76:79], v[12:15]
    v_accvgpr_read_b32 v6, a76
    v_lshlrev_b32 v8, 16, v48
    v_lshlrev_b32 v7, 16, v6
    v_mul_f32 v7, v7, v8
    v_and_b32 v6, s44, v6
    v_and_b32 v8, s44, v48
    v_mul_f32 v6, v6, v8
    v_cvt_pk_bf16_f32 v124, v7, v6
    v_accvgpr_read_b32 v6, a77
    v_lshlrev_b32 v8, 16, v49
    v_lshlrev_b32 v7, 16, v6
    v_mul_f32 v7, v7, v8
    v_and_b32 v6, s44, v6
    v_and_b32 v8, s44, v49
    v_mul_f32 v6, v6, v8
    v_cvt_pk_bf16_f32 v125, v7, v6
    v_accvgpr_read_b32 v6, a78
    v_lshlrev_b32 v8, 16, v50
    v_lshlrev_b32 v7, 16, v6
    v_mul_f32 v7, v7, v8
    v_and_b32 v6, s44, v6
    v_and_b32 v8, s44, v50
    v_mul_f32 v6, v6, v8
    v_cvt_pk_bf16_f32 v126, v7, v6
    v_accvgpr_read_b32 v6, a79
    v_lshlrev_b32 v8, 16, v51
    v_lshlrev_b32 v7, 16, v6
    v_mul_f32 v7, v7, v8
    v_and_b32 v6, s44, v6
    v_and_b32 v8, s44, v51
    v_mul_f32 v6, v6, v8
    v_cvt_pk_bf16_f32 v127, v7, v6
    s_nop 1
    v_mfma_f32_16x16x32_bf16 v[16:19], v[116:119], v[124:127], v[16:19]
    ds_read_b128 v[20:23], v10 offset:1280
    ds_read_b128 v[24:27], v10 offset:3328
    ds_read_b128 v[28:31], v10 offset:1344
    ds_read_b128 v[32:35], v10 offset:3392
    ds_read_b128 v[36:39], v10 offset:1408
    ds_read_b128 v[40:43], v10 offset:3456
    ds_read_b128 v[44:47], v10 offset:1472
    ds_read_b128 v[48:51], v10 offset:3520
    s_waitcnt lgkmcnt(0)
    v_mfma_f32_16x16x32_bf16 v[12:15], v[20:23], a[80:83], v[12:15]
    v_accvgpr_read_b32 v6, a80
    v_lshlrev_b32 v8, 16, v24
    v_lshlrev_b32 v7, 16, v6
    v_mul_f32 v7, v7, v8
    v_and_b32 v6, s44, v6
    v_and_b32 v8, s44, v24
    v_mul_f32 v6, v6, v8
    v_cvt_pk_bf16_f32 v120, v7, v6
    v_accvgpr_read_b32 v6, a81
    v_lshlrev_b32 v8, 16, v25
    v_lshlrev_b32 v7, 16, v6
    v_mul_f32 v7, v7, v8
    v_and_b32 v6, s44, v6
    v_and_b32 v8, s44, v25
    v_mul_f32 v6, v6, v8
    v_cvt_pk_bf16_f32 v121, v7, v6
    v_accvgpr_read_b32 v6, a82
    v_lshlrev_b32 v8, 16, v26
    v_lshlrev_b32 v7, 16, v6
    v_mul_f32 v7, v7, v8
    v_and_b32 v6, s44, v6
    v_and_b32 v8, s44, v26
    v_mul_f32 v6, v6, v8
    v_cvt_pk_bf16_f32 v122, v7, v6
    v_accvgpr_read_b32 v6, a83
    v_lshlrev_b32 v8, 16, v27
    v_lshlrev_b32 v7, 16, v6
    v_mul_f32 v7, v7, v8
    v_and_b32 v6, s44, v6
    v_and_b32 v8, s44, v27
    v_mul_f32 v6, v6, v8
    v_cvt_pk_bf16_f32 v123, v7, v6
    s_nop 1
    v_mfma_f32_16x16x32_bf16 v[16:19], v[116:119], v[120:123], v[16:19]
    v_mfma_f32_16x16x32_bf16 v[12:15], v[28:31], a[84:87], v[12:15]
    v_accvgpr_read_b32 v6, a84
    v_lshlrev_b32 v8, 16, v32
    v_lshlrev_b32 v7, 16, v6
    v_mul_f32 v7, v7, v8
    v_and_b32 v6, s44, v6
    v_and_b32 v8, s44, v32
    v_mul_f32 v6, v6, v8
    v_cvt_pk_bf16_f32 v124, v7, v6
    v_accvgpr_read_b32 v6, a85
    v_lshlrev_b32 v8, 16, v33
    v_lshlrev_b32 v7, 16, v6
    v_mul_f32 v7, v7, v8
    v_and_b32 v6, s44, v6
    v_and_b32 v8, s44, v33
    v_mul_f32 v6, v6, v8
    v_cvt_pk_bf16_f32 v125, v7, v6
    v_accvgpr_read_b32 v6, a86
    v_lshlrev_b32 v8, 16, v34
    v_lshlrev_b32 v7, 16, v6
    v_mul_f32 v7, v7, v8
    v_and_b32 v6, s44, v6
    v_and_b32 v8, s44, v34
    v_mul_f32 v6, v6, v8
    v_cvt_pk_bf16_f32 v126, v7, v6
    v_accvgpr_read_b32 v6, a87
    v_lshlrev_b32 v8, 16, v35
    v_lshlrev_b32 v7, 16, v6
    v_mul_f32 v7, v7, v8
    v_and_b32 v6, s44, v6
    v_and_b32 v8, s44, v35
    v_mul_f32 v6, v6, v8
    v_cvt_pk_bf16_f32 v127, v7, v6
    s_nop 1
    v_mfma_f32_16x16x32_bf16 v[16:19], v[116:119], v[124:127], v[16:19]
    v_mfma_f32_16x16x32_bf16 v[12:15], v[36:39], a[88:91], v[12:15]
    v_accvgpr_read_b32 v6, a88
    v_lshlrev_b32 v8, 16, v40
    v_lshlrev_b32 v7, 16, v6
    v_mul_f32 v7, v7, v8
    v_and_b32 v6, s44, v6
    v_and_b32 v8, s44, v40
    v_mul_f32 v6, v6, v8
    v_cvt_pk_bf16_f32 v120, v7, v6
    v_accvgpr_read_b32 v6, a89
    v_lshlrev_b32 v8, 16, v41
    v_lshlrev_b32 v7, 16, v6
    v_mul_f32 v7, v7, v8
    v_and_b32 v6, s44, v6
    v_and_b32 v8, s44, v41
    v_mul_f32 v6, v6, v8
    v_cvt_pk_bf16_f32 v121, v7, v6
    v_accvgpr_read_b32 v6, a90
    v_lshlrev_b32 v8, 16, v42
    v_lshlrev_b32 v7, 16, v6
    v_mul_f32 v7, v7, v8
    v_and_b32 v6, s44, v6
    v_and_b32 v8, s44, v42
    v_mul_f32 v6, v6, v8
    v_cvt_pk_bf16_f32 v122, v7, v6
    v_accvgpr_read_b32 v6, a91
    v_lshlrev_b32 v8, 16, v43
    v_lshlrev_b32 v7, 16, v6
    v_mul_f32 v7, v7, v8
    v_and_b32 v6, s44, v6
    v_and_b32 v8, s44, v43
    v_mul_f32 v6, v6, v8
    v_cvt_pk_bf16_f32 v123, v7, v6
    s_nop 1
    v_mfma_f32_16x16x32_bf16 v[16:19], v[116:119], v[120:123], v[16:19]
    v_mfma_f32_16x16x32_bf16 v[12:15], v[44:47], a[92:95], v[12:15]
    v_accvgpr_read_b32 v6, a92
    v_lshlrev_b32 v8, 16, v48
    v_lshlrev_b32 v7, 16, v6
    v_mul_f32 v7, v7, v8
    v_and_b32 v6, s44, v6
    v_and_b32 v8, s44, v48
    v_mul_f32 v6, v6, v8
    v_cvt_pk_bf16_f32 v124, v7, v6
    v_accvgpr_read_b32 v6, a93
    v_lshlrev_b32 v8, 16, v49
    v_lshlrev_b32 v7, 16, v6
    v_mul_f32 v7, v7, v8
    v_and_b32 v6, s44, v6
    v_and_b32 v8, s44, v49
    v_mul_f32 v6, v6, v8
    v_cvt_pk_bf16_f32 v125, v7, v6
    v_accvgpr_read_b32 v6, a94
    v_lshlrev_b32 v8, 16, v50
    v_lshlrev_b32 v7, 16, v6
    v_mul_f32 v7, v7, v8
    v_and_b32 v6, s44, v6
    v_and_b32 v8, s44, v50
    v_mul_f32 v6, v6, v8
    v_cvt_pk_bf16_f32 v126, v7, v6
    v_accvgpr_read_b32 v6, a95
    v_lshlrev_b32 v8, 16, v51
    v_lshlrev_b32 v7, 16, v6
    v_mul_f32 v7, v7, v8
    v_and_b32 v6, s44, v6
    v_and_b32 v8, s44, v51
    v_mul_f32 v6, v6, v8
    v_cvt_pk_bf16_f32 v127, v7, v6
    s_nop 1
    v_mfma_f32_16x16x32_bf16 v[16:19], v[116:119], v[124:127], v[16:19]
    ds_read_b128 v[20:23], v10 offset:1536
    ds_read_b128 v[24:27], v10 offset:3584
    ds_read_b128 v[28:31], v10 offset:1600
    ds_read_b128 v[32:35], v10 offset:3648
    ds_read_b128 v[36:39], v10 offset:1664
    ds_read_b128 v[40:43], v10 offset:3712
    ds_read_b128 v[44:47], v10 offset:1728
    ds_read_b128 v[48:51], v10 offset:3776
    s_waitcnt lgkmcnt(0)
    v_mfma_f32_16x16x32_bf16 v[12:15], v[20:23], a[96:99], v[12:15]
    v_accvgpr_read_b32 v6, a96
    v_lshlrev_b32 v8, 16, v24
    v_lshlrev_b32 v7, 16, v6
    v_mul_f32 v7, v7, v8
    v_and_b32 v6, s44, v6
    v_and_b32 v8, s44, v24
    v_mul_f32 v6, v6, v8
    v_cvt_pk_bf16_f32 v120, v7, v6
    v_accvgpr_read_b32 v6, a97
    v_lshlrev_b32 v8, 16, v25
    v_lshlrev_b32 v7, 16, v6
    v_mul_f32 v7, v7, v8
    v_and_b32 v6, s44, v6
    v_and_b32 v8, s44, v25
    v_mul_f32 v6, v6, v8
    v_cvt_pk_bf16_f32 v121, v7, v6
    v_accvgpr_read_b32 v6, a98
    v_lshlrev_b32 v8, 16, v26
    v_lshlrev_b32 v7, 16, v6
    v_mul_f32 v7, v7, v8
    v_and_b32 v6, s44, v6
    v_and_b32 v8, s44, v26
    v_mul_f32 v6, v6, v8
    v_cvt_pk_bf16_f32 v122, v7, v6
    v_accvgpr_read_b32 v6, a99
    v_lshlrev_b32 v8, 16, v27
    v_lshlrev_b32 v7, 16, v6
    v_mul_f32 v7, v7, v8
    v_and_b32 v6, s44, v6
    v_and_b32 v8, s44, v27
    v_mul_f32 v6, v6, v8
    v_cvt_pk_bf16_f32 v123, v7, v6
    s_nop 1
    v_mfma_f32_16x16x32_bf16 v[16:19], v[116:119], v[120:123], v[16:19]
    v_mfma_f32_16x16x32_bf16 v[12:15], v[28:31], a[100:103], v[12:15]
    v_accvgpr_read_b32 v6, a100
    v_lshlrev_b32 v8, 16, v32
    v_lshlrev_b32 v7, 16, v6
    v_mul_f32 v7, v7, v8
    v_and_b32 v6, s44, v6
    v_and_b32 v8, s44, v32
    v_mul_f32 v6, v6, v8
    v_cvt_pk_bf16_f32 v124, v7, v6
    v_accvgpr_read_b32 v6, a101
    v_lshlrev_b32 v8, 16, v33
    v_lshlrev_b32 v7, 16, v6
    v_mul_f32 v7, v7, v8
    v_and_b32 v6, s44, v6
    v_and_b32 v8, s44, v33
    v_mul_f32 v6, v6, v8
    v_cvt_pk_bf16_f32 v125, v7, v6
    v_accvgpr_read_b32 v6, a102
    v_lshlrev_b32 v8, 16, v34
    v_lshlrev_b32 v7, 16, v6
    v_mul_f32 v7, v7, v8
    v_and_b32 v6, s44, v6
    v_and_b32 v8, s44, v34
    v_mul_f32 v6, v6, v8
    v_cvt_pk_bf16_f32 v126, v7, v6
    v_accvgpr_read_b32 v6, a103
    v_lshlrev_b32 v8, 16, v35
    v_lshlrev_b32 v7, 16, v6
    v_mul_f32 v7, v7, v8
    v_and_b32 v6, s44, v6
    v_and_b32 v8, s44, v35
    v_mul_f32 v6, v6, v8
    v_cvt_pk_bf16_f32 v127, v7, v6
    s_nop 1
    v_mfma_f32_16x16x32_bf16 v[16:19], v[116:119], v[124:127], v[16:19]
    v_mfma_f32_16x16x32_bf16 v[12:15], v[36:39], a[104:107], v[12:15]
    v_accvgpr_read_b32 v6, a104
    v_lshlrev_b32 v8, 16, v40
    v_lshlrev_b32 v7, 16, v6
    v_mul_f32 v7, v7, v8
    v_and_b32 v6, s44, v6
    v_and_b32 v8, s44, v40
    v_mul_f32 v6, v6, v8
    v_cvt_pk_bf16_f32 v120, v7, v6
    v_accvgpr_read_b32 v6, a105
    v_lshlrev_b32 v8, 16, v41
    v_lshlrev_b32 v7, 16, v6
    v_mul_f32 v7, v7, v8
    v_and_b32 v6, s44, v6
    v_and_b32 v8, s44, v41
    v_mul_f32 v6, v6, v8
    v_cvt_pk_bf16_f32 v121, v7, v6
    v_accvgpr_read_b32 v6, a106
    v_lshlrev_b32 v8, 16, v42
    v_lshlrev_b32 v7, 16, v6
    v_mul_f32 v7, v7, v8
    v_and_b32 v6, s44, v6
    v_and_b32 v8, s44, v42
    v_mul_f32 v6, v6, v8
    v_cvt_pk_bf16_f32 v122, v7, v6
    v_accvgpr_read_b32 v6, a107
    v_lshlrev_b32 v8, 16, v43
    v_lshlrev_b32 v7, 16, v6
    v_mul_f32 v7, v7, v8
    v_and_b32 v6, s44, v6
    v_and_b32 v8, s44, v43
    v_mul_f32 v6, v6, v8
    v_cvt_pk_bf16_f32 v123, v7, v6
    s_nop 1
    v_mfma_f32_16x16x32_bf16 v[16:19], v[116:119], v[120:123], v[16:19]
    v_mfma_f32_16x16x32_bf16 v[12:15], v[44:47], a[108:111], v[12:15]
    v_accvgpr_read_b32 v6, a108
    v_lshlrev_b32 v8, 16, v48
    v_lshlrev_b32 v7, 16, v6
    v_mul_f32 v7, v7, v8
    v_and_b32 v6, s44, v6
    v_and_b32 v8, s44, v48
    v_mul_f32 v6, v6, v8
    v_cvt_pk_bf16_f32 v124, v7, v6
    v_accvgpr_read_b32 v6, a109
    v_lshlrev_b32 v8, 16, v49
    v_lshlrev_b32 v7, 16, v6
    v_mul_f32 v7, v7, v8
    v_and_b32 v6, s44, v6
    v_and_b32 v8, s44, v49
    v_mul_f32 v6, v6, v8
    v_cvt_pk_bf16_f32 v125, v7, v6
    v_accvgpr_read_b32 v6, a110
    v_lshlrev_b32 v8, 16, v50
    v_lshlrev_b32 v7, 16, v6
    v_mul_f32 v7, v7, v8
    v_and_b32 v6, s44, v6
    v_and_b32 v8, s44, v50
    v_mul_f32 v6, v6, v8
    v_cvt_pk_bf16_f32 v126, v7, v6
    v_accvgpr_read_b32 v6, a111
    v_lshlrev_b32 v8, 16, v51
    v_lshlrev_b32 v7, 16, v6
    v_mul_f32 v7, v7, v8
    v_and_b32 v6, s44, v6
    v_and_b32 v8, s44, v51
    v_mul_f32 v6, v6, v8
    v_cvt_pk_bf16_f32 v127, v7, v6
    s_nop 1
    v_mfma_f32_16x16x32_bf16 v[16:19], v[116:119], v[124:127], v[16:19]
    ds_read_b128 v[20:23], v10 offset:1792
    ds_read_b128 v[24:27], v10 offset:3840
    ds_read_b128 v[28:31], v10 offset:1856
    ds_read_b128 v[32:35], v10 offset:3904
    ds_read_b128 v[36:39], v10 offset:1920
    ds_read_b128 v[40:43], v10 offset:3968
    ds_read_b128 v[44:47], v10 offset:1984
    ds_read_b128 v[48:51], v10 offset:4032
    s_waitcnt lgkmcnt(0)
    v_mfma_f32_16x16x32_bf16 v[12:15], v[20:23], a[112:115], v[12:15]
    v_accvgpr_read_b32 v6, a112
    v_lshlrev_b32 v8, 16, v24
    v_lshlrev_b32 v7, 16, v6
    v_mul_f32 v7, v7, v8
    v_and_b32 v6, s44, v6
    v_and_b32 v8, s44, v24
    v_mul_f32 v6, v6, v8
    v_cvt_pk_bf16_f32 v120, v7, v6
    v_accvgpr_read_b32 v6, a113
    v_lshlrev_b32 v8, 16, v25
    v_lshlrev_b32 v7, 16, v6
    v_mul_f32 v7, v7, v8
    v_and_b32 v6, s44, v6
    v_and_b32 v8, s44, v25
    v_mul_f32 v6, v6, v8
    v_cvt_pk_bf16_f32 v121, v7, v6
    v_accvgpr_read_b32 v6, a114
    v_lshlrev_b32 v8, 16, v26
    v_lshlrev_b32 v7, 16, v6
    v_mul_f32 v7, v7, v8
    v_and_b32 v6, s44, v6
    v_and_b32 v8, s44, v26
    v_mul_f32 v6, v6, v8
    v_cvt_pk_bf16_f32 v122, v7, v6
    v_accvgpr_read_b32 v6, a115
    v_lshlrev_b32 v8, 16, v27
    v_lshlrev_b32 v7, 16, v6
    v_mul_f32 v7, v7, v8
    v_and_b32 v6, s44, v6
    v_and_b32 v8, s44, v27
    v_mul_f32 v6, v6, v8
    v_cvt_pk_bf16_f32 v123, v7, v6
    s_nop 1
    v_mfma_f32_16x16x32_bf16 v[16:19], v[116:119], v[120:123], v[16:19]
    v_mfma_f32_16x16x32_bf16 v[12:15], v[28:31], a[116:119], v[12:15]
    v_accvgpr_read_b32 v6, a116
    v_lshlrev_b32 v8, 16, v32
    v_lshlrev_b32 v7, 16, v6
    v_mul_f32 v7, v7, v8
    v_and_b32 v6, s44, v6
    v_and_b32 v8, s44, v32
    v_mul_f32 v6, v6, v8
    v_cvt_pk_bf16_f32 v124, v7, v6
    v_accvgpr_read_b32 v6, a117
    v_lshlrev_b32 v8, 16, v33
    v_lshlrev_b32 v7, 16, v6
    v_mul_f32 v7, v7, v8
    v_and_b32 v6, s44, v6
    v_and_b32 v8, s44, v33
    v_mul_f32 v6, v6, v8
    v_cvt_pk_bf16_f32 v125, v7, v6
    v_accvgpr_read_b32 v6, a118
    v_lshlrev_b32 v8, 16, v34
    v_lshlrev_b32 v7, 16, v6
    v_mul_f32 v7, v7, v8
    v_and_b32 v6, s44, v6
    v_and_b32 v8, s44, v34
    v_mul_f32 v6, v6, v8
    v_cvt_pk_bf16_f32 v126, v7, v6
    v_accvgpr_read_b32 v6, a119
    v_lshlrev_b32 v8, 16, v35
    v_lshlrev_b32 v7, 16, v6
    v_mul_f32 v7, v7, v8
    v_and_b32 v6, s44, v6
    v_and_b32 v8, s44, v35
    v_mul_f32 v6, v6, v8
    v_cvt_pk_bf16_f32 v127, v7, v6
    s_nop 1
    v_mfma_f32_16x16x32_bf16 v[16:19], v[116:119], v[124:127], v[16:19]
    v_mfma_f32_16x16x32_bf16 v[12:15], v[36:39], a[120:123], v[12:15]
    v_accvgpr_read_b32 v6, a120
    v_lshlrev_b32 v8, 16, v40
    v_lshlrev_b32 v7, 16, v6
    v_mul_f32 v7, v7, v8
    v_and_b32 v6, s44, v6
    v_and_b32 v8, s44, v40
    v_mul_f32 v6, v6, v8
    v_cvt_pk_bf16_f32 v120, v7, v6
    v_accvgpr_read_b32 v6, a121
    v_lshlrev_b32 v8, 16, v41
    v_lshlrev_b32 v7, 16, v6
    v_mul_f32 v7, v7, v8
    v_and_b32 v6, s44, v6
    v_and_b32 v8, s44, v41
    v_mul_f32 v6, v6, v8
    v_cvt_pk_bf16_f32 v121, v7, v6
    v_accvgpr_read_b32 v6, a122
    v_lshlrev_b32 v8, 16, v42
    v_lshlrev_b32 v7, 16, v6
    v_mul_f32 v7, v7, v8
    v_and_b32 v6, s44, v6
    v_and_b32 v8, s44, v42
    v_mul_f32 v6, v6, v8
    v_cvt_pk_bf16_f32 v122, v7, v6
    v_accvgpr_read_b32 v6, a123
    v_lshlrev_b32 v8, 16, v43
    v_lshlrev_b32 v7, 16, v6
    v_mul_f32 v7, v7, v8
    v_and_b32 v6, s44, v6
    v_and_b32 v8, s44, v43
    v_mul_f32 v6, v6, v8
    v_cvt_pk_bf16_f32 v123, v7, v6
    s_nop 1
    v_mfma_f32_16x16x32_bf16 v[16:19], v[116:119], v[120:123], v[16:19]
    v_mfma_f32_16x16x32_bf16 v[12:15], v[44:47], a[124:127], v[12:15]
    v_accvgpr_read_b32 v6, a124
    v_lshlrev_b32 v8, 16, v48
    v_lshlrev_b32 v7, 16, v6
    v_mul_f32 v7, v7, v8
    v_and_b32 v6, s44, v6
    v_and_b32 v8, s44, v48
    v_mul_f32 v6, v6, v8
    v_cvt_pk_bf16_f32 v124, v7, v6
    v_accvgpr_read_b32 v6, a125
    v_lshlrev_b32 v8, 16, v49
    v_lshlrev_b32 v7, 16, v6
    v_mul_f32 v7, v7, v8
    v_and_b32 v6, s44, v6
    v_and_b32 v8, s44, v49
    v_mul_f32 v6, v6, v8
    v_cvt_pk_bf16_f32 v125, v7, v6
    v_accvgpr_read_b32 v6, a126
    v_lshlrev_b32 v8, 16, v50
    v_lshlrev_b32 v7, 16, v6
    v_mul_f32 v7, v7, v8
    v_and_b32 v6, s44, v6
    v_and_b32 v8, s44, v50
    v_mul_f32 v6, v6, v8
    v_cvt_pk_bf16_f32 v126, v7, v6
    v_accvgpr_read_b32 v6, a127
    v_lshlrev_b32 v8, 16, v51
    v_lshlrev_b32 v7, 16, v6
    v_mul_f32 v7, v7, v8
    v_and_b32 v6, s44, v6
    v_and_b32 v8, s44, v51
    v_mul_f32 v6, v6, v8
    v_cvt_pk_bf16_f32 v127, v7, v6
    s_nop 1
    v_mfma_f32_16x16x32_bf16 v[16:19], v[116:119], v[124:127], v[16:19]
    s_nop 7
    v_mov_b32 v13, v16
    v_cvt_pk_bf16_f32 v6, v13, v12
    v_lshlrev_b32 v13, 16, v6
    v_and_b32 v12, s44, v6
    v_mul_f32 v7, 0xbfb8aa3b, v13
    v_exp_f32 v7, v7
    s_nop 0
    v_add_f32 v7, 1.0, v7
    v_rcp_f32 v7, v7
    v_ashrrev_i32 v8, 31, v12
    v_or_b32 v8, 0x80000000, v8
    v_cvt_pk_bf16_f32 v7, v7, v7
    v_and_b32 v7, s44, v7
    v_xor_b32 v8, v8, v12
    s_sub_u32 s37, 2047, s40
    v_sub_u32 v9, s37, v0
    v_and_or_b32 v8, v8, s44, v9
    v_mov_b32 v9, 0x40000000
    v_cmp_gt_u32 vcc, 16, v0
    s_nop 1
    v_cndmask_b32 v9, v9, v2, vcc
L_wi_33:
    v_lshlrev_b32 v10, 5, v0
    v_min_u32 v10, 0xe4, v10
    v_cmp_eq_u32 vcc, 9, v0
    s_nop 1
    v_cndmask_b32 v6, 0, 4, vcc
    v_add_u32 v10, v10, v6
    buffer_load_dword v6, v10, s[8:11], 0 offen sc1
L_wi_35:
    s_waitcnt vmcnt(0)
    v_bcnt_u32_b32 v10, v6, 0
    s_nop 0
    v_readlane_b32 s37, v10, 0
    v_readlane_b32 s38, v10, 1
    s_nop 0
    s_add_u32 s37, s37, s38
    v_readlane_b32 s38, v10, 2
    s_nop 0
    s_add_u32 s37, s37, s38
    v_readlane_b32 s38, v10, 3
    s_nop 0
    s_add_u32 s37, s37, s38
    v_readlane_b32 s38, v10, 4
    s_nop 0
    s_add_u32 s37, s37, s38
    v_readlane_b32 s38, v10, 5
    s_nop 0
    s_add_u32 s37, s37, s38
    v_readlane_b32 s38, v10, 6
    s_nop 0
    s_add_u32 s37, s37, s38
    v_readlane_b32 s38, v10, 7
    s_nop 0
    s_add_u32 s37, s37, s38
    v_readlane_b32 s38, v6, 9
    s_nop 0
    s_add_u32 s37, s37, s38
    v_readlane_b32 s62, v6, 8
    s_nop 0
    s_lshr_b32 s38, s62, 16
    s_add_u32 s37, s37, s38
    s_cmp_ge_u32 s37, 272
    s_cbranch_scc1 L_wiok_34
    s_sleep 8
    s_sub_u32 s35, s35, 1
    s_cbranch_scc0 L_wi_33
    s_endpgm
L_wiok_34:
    s_and_b32 s62, s62, 0xffff
    s_cmp_gt_u32 s62, 8
    s_cselect_b32 s62, 0x2000, 0
    s_lshr_b32 s37, s63, 5
    v_readlane_b32 s101, v10, s37
    s_lshl_b32 s37, s40, 2
    s_add_u32 s38, s37, 0xe404000
    s_add_u32 s37, s37, 0xe406000
    buffer_store_dword v7, v9, s[4:7], s37 offen sc1
    s_waitcnt vmcnt(0)
    buffer_store_dword v8, v9, s[4:7], s38 offen sc1
    s_add_u32 s37, s42, 0x38000
    buffer_load_dwordx4 v[116:119], v5, s[24:27], s37 offen nt
    s_add_u32 s37, s42, 0x39c00
    buffer_load_dwordx4 v[120:123], v5, s[24:27], s37 offen nt
    s_add_u32 s37, s42, 0x3b800
    buffer_load_dwordx4 v[124:127], v5, s[24:27], s37 offen nt
    s_add_u32 s37, s42, 0x3d400
    buffer_load_dwordx4 v[128:131], v5, s[24:27], s37 offen nt
    s_add_u32 s37, s42, 0x3f000
    buffer_load_dwordx4 v[132:135], v5, s[24:27], s37 offen nt
    s_add_u32 s37, s42, 0x40c00
    buffer_load_dwordx4 v[136:139], v5, s[24:27], s37 offen nt
    s_add_u32 s37, s42, 0x42800
    buffer_load_dwordx4 v[140:143], v5, s[24:27], s37 offen nt
    s_add_u32 s37, s42, 0x44400
    buffer_load_dwordx4 v[144:147], v5, s[24:27], s37 offen nt
    s_add_u32 s37, s42, 0x38000
    buffer_load_dwordx4 v[148:151], v5, s[28:31], s37 offen nt
    s_add_u32 s37, s42, 0x39c00
    buffer_load_dwordx4 v[152:155], v5, s[28:31], s37 offen nt
    s_add_u32 s37, s42, 0x3b800
    buffer_load_dwordx4 v[156:159], v5, s[28:31], s37 offen nt
    s_add_u32 s37, s42, 0x3d400
    buffer_load_dwordx4 v[160:163], v5, s[28:31], s37 offen nt
    s_add_u32 s37, s42, 0x3f000
    buffer_load_dwordx4 v[164:167], v5, s[28:31], s37 offen nt
    s_add_u32 s37, s42, 0x40c00
    buffer_load_dwordx4 v[168:171], v5, s[28:31], s37 offen nt
    s_add_u32 s37, s42, 0x42800
    buffer_load_dwordx4 v[172:175], v5, s[28:31], s37 offen nt
    s_add_u32 s37, s42, 0x44400
    buffer_load_dwordx4 v[176:179], v5, s[28:31], s37 offen nt
    s_add_u32 s37, s42, 0x70000
    buffer_load_dwordx4 v[180:183], v5, s[24:27], s37 offen nt
    s_add_u32 s37, s42, 0x71c00
    buffer_load_dwordx4 v[184:187], v5, s[24:27], s37 offen nt
    s_add_u32 s37, s42, 0x73800
    buffer_load_dwordx4 v[188:191], v5, s[24:27], s37 offen nt
    s_add_u32 s37, s42, 0x75400
    buffer_load_dwordx4 v[192:195], v5, s[24:27], s37 offen nt
    s_add_u32 s37, s42, 0x77000
    buffer_load_dwordx4 v[196:199], v5, s[24:27], s37 offen nt
    s_add_u32 s37, s42, 0x78c00
    buffer_load_dwordx4 v[200:203], v5, s[24:27], s37 offen nt
    s_add_u32 s37, s42, 0x7a800
    buffer_load_dwordx4 v[204:207], v5, s[24:27], s37 offen nt
    s_add_u32 s37, s42, 0x7c400
    buffer_load_dwordx4 v[208:211], v5, s[24:27], s37 offen nt
    s_add_u32 s37, s42, 0x70000
    buffer_load_dwordx4 v[212:215], v5, s[28:31], s37 offen nt
    s_add_u32 s37, s42, 0x71c00
    buffer_load_dwordx4 v[216:219], v5, s[28:31], s37 offen nt
    s_add_u32 s37, s42, 0x73800
    buffer_load_dwordx4 v[220:223], v5, s[28:31], s37 offen nt
    s_add_u32 s37, s42, 0x75400
    buffer_load_dwordx4 v[224:227], v5, s[28:31], s37 offen nt
    s_add_u32 s37, s42, 0x77000
    buffer_load_dwordx4 v[228:231], v5, s[28:31], s37 offen nt
    s_add_u32 s37, s42, 0x78c00
    buffer_load_dwordx4 v[232:235], v5, s[28:31], s37 offen nt
    s_add_u32 s37, s42, 0x7a800
    buffer_load_dwordx4 v[236:239], v5, s[28:31], s37 offen nt
    s_add_u32 s37, s42, 0x7c400
    buffer_load_dwordx4 v[240:243], v5, s[28:31], s37 offen nt
    s_mov_b32 s37, 0xe404000
    s_mov_b32 s38, 0xe405000
    s_waitcnt vmcnt(16)
L_pd_36:
    buffer_load_dwordx4 v[20:23], v1, s[4:7], s37 offen offset:0 sc1
    buffer_load_dwordx4 v[24:27], v1, s[4:7], s37 offen offset:1024 sc1
    buffer_load_dwordx4 v[28:31], v1, s[4:7], s37 offen offset:2048 sc1
    buffer_load_dwordx4 v[32:35], v1, s[4:7], s37 offen offset:3072 sc1
    buffer_load_dwordx4 v[36:39], v1, s[4:7], s38 offen offset:0 sc1
    buffer_load_dwordx4 v[40:43], v1, s[4:7], s38 offen offset:1024 sc1
    buffer_load_dwordx4 v[44:47], v1, s[4:7], s38 offen offset:2048 sc1
    buffer_load_dwordx4 v[48:51], v1, s[4:7], s38 offen offset:3072 sc1
    s_waitcnt vmcnt(0)
    v_max_u32 v6, v20, v51
    v_max3_u32 v6, v6, v21, v22
    v_max3_u32 v6, v6, v23, v24
    v_max3_u32 v6, v6, v25, v26
    v_max3_u32 v6, v6, v27, v28
    v_max3_u32 v6, v6, v29, v30
    v_max3_u32 v6, v6, v31, v32
    v_max3_u32 v6, v6, v33, v34
    v_max3_u32 v6, v6, v35, v36
    v_max3_u32 v6, v6, v37, v38
    v_max3_u32 v6, v6, v39, v40
    v_max3_u32 v6, v6, v41, v42
    v_max3_u32 v6, v6, v43, v44
    v_max3_u32 v6, v6, v45, v46
    v_max3_u32 v6, v6, v47, v48
    v_max3_u32 v6, v6, v49, v50
    v_cmp_eq_u32 vcc, -1, v6
    s_cbranch_vccz L_pdok_37
    s_sleep 16
    s_sub_u32 s35, s35, 1
    s_cbranch_scc0 L_pd_36
    s_endpgm
L_pdok_37:
    s_mov_b32 s45, 0
    s_mov_b32 s39, 0
    v_mov_b32 v4, 0
L_top:
    v_mov_b32 v6, 0
    v_subrev_u32 v7, s45, v20
    v_subrev_u32 v8, s45, v21
    v_max3_u32 v6, v6, v7, v8
    v_subrev_u32 v7, s45, v22
    v_subrev_u32 v8, s45, v23
    v_max3_u32 v6, v6, v7, v8
    v_subrev_u32 v7, s45, v24
    v_subrev_u32 v8, s45, v25
    v_max3_u32 v6, v6, v7, v8
    v_subrev_u32 v7, s45, v26
    v_subrev_u32 v8, s45, v27
    v_max3_u32 v6, v6, v7, v8
    v_subrev_u32 v7, s45, v28
    v_subrev_u32 v8, s45, v29
    v_max3_u32 v6, v6, v7, v8
    v_subrev_u32 v7, s45, v30
    v_subrev_u32 v8, s45, v31
    v_max3_u32 v6, v6, v7, v8
    v_subrev_u32 v7, s45, v32
    v_subrev_u32 v8, s45, v33
    v_max3_u32 v6, v6, v7, v8
    v_subrev_u32 v7, s45, v34
    v_subrev_u32 v8, s45, v35
    v_max3_u32 v6, v6, v7, v8
    v_subrev_u32 v7, s45, v36
    v_subrev_u32 v8, s45, v37
    v_max3_u32 v6, v6, v7, v8
    v_subrev_u32 v7, s45, v38
    v_subrev_u32 v8, s45, v39
    v_max3_u32 v6, v6, v7, v8
    v_subrev_u32 v7, s45, v40
    v_subrev_u32 v8, s45, v41
    v_max3_u32 v6, v6, v7, v8
    v_subrev_u32 v7, s45, v42
    v_subrev_u32 v8, s45, v43
    v_max3_u32 v6, v6, v7, v8
    v_subrev_u32 v7, s45, v44
    v_subrev_u32 v8, s45, v45
    v_max3_u32 v6, v6, v7, v8
    v_subrev_u32 v7, s45, v46
    v_subrev_u32 v8, s45, v47
    v_max3_u32 v6, v6, v7, v8
    v_subrev_u32 v7, s45, v48
    v_subrev_u32 v8, s45, v49
    v_max3_u32 v6, v6, v7, v8
    v_subrev_u32 v7, s45, v50
    v_subrev_u32 v8, s45, v51
    v_max3_u32 v6, v6, v7, v8
    s_nop 1
    v_max_u32_dpp v6, v6, v6 row_ror:8 row_mask:0xf bank_mask:0xf
    s_nop 1
    v_max_u32_dpp v6, v6, v6 row_ror:4 row_mask:0xf bank_mask:0xf
    s_nop 1
    v_max_u32_dpp v6, v6, v6 row_ror:2 row_mask:0xf bank_mask:0xf
    s_nop 1
    v_max_u32_dpp v6, v6, v6 row_ror:1 row_mask:0xf bank_mask:0xf
    v_mov_b32 v7, v6
    s_nop 1
    v_permlane32_swap_b32 v6, v7
    v_max_u32 v6, v6, v7
    v_mov_b32 v7, v6
    s_nop 1
    v_permlane16_swap_b32 v6, v7
    v_max_u32 v6, v6, v7
    s_nop 0
    v_readfirstlane_b32 s37, v6
    s_mov_b32 m0, s39
    s_add_u32 s45, s45, s37
    v_writelane_b32 v4, s45, m0
    s_add_u32 s39, s39, 1
    s_cmp_lt_u32 s39, 8
    s_cbranch_scc1 L_top
    v_bfe_u32 v6, v0, 0, 3
    v_lshlrev_b32 v7, 2, v6
    ds_bpermute_b32 v8, v7, v4
    s_waitcnt lgkmcnt(0)
    v_and_b32 v8, 0x7ff, v8
    v_sub_u32 v8, 2047, v8
    v_lshlrev_b32 v8, 11, v8
    v_lshrrev_b32 v6, 4, v0
    v_lshl_add_u32 v8, v6, 4, v8
    s_lshl_b32 s37, s32, 9
    buffer_load_dwordx4 a[128:131], v8, s[16:19], s37 offen offset:0
    buffer_load_dwordx4 a[132:135], v8, s[16:19], s37 offen offset:64
    buffer_load_dwordx4 a[136:139], v8, s[16:19], s37 offen offset:128
    buffer_load_dwordx4 a[140:143], v8, s[16:19], s37 offen offset:192
    buffer_load_dwordx4 a[144:147], v8, s[16:19], s37 offen offset:256
    buffer_load_dwordx4 a[148:151], v8, s[16:19], s37 offen offset:320
    buffer_load_dwordx4 a[152:155], v8, s[16:19], s37 offen offset:384
    buffer_load_dwordx4 a[156:159], v8, s[16:19], s37 offen offset:448
    s_mov_b32 s39, 0x05040100
    s_mov_b32 s40, 0x07060302
    s_waitcnt vmcnt(0)
    v_perm_b32 v20, v56, v52, s39
    v_perm_b32 v21, v64, v60, s39
    v_perm_b32 v22, v72, v68, s39
    v_perm_b32 v23, v80, v76, s39
    v_perm_b32 v24, v56, v52, s40
    v_perm_b32 v25, v64, v60, s40
    v_perm_b32 v26, v72, v68, s40
    v_perm_b32 v27, v80, v76, s40
    v_mfma_f32_16x16x32_bf16 a[160:163], a[128:131], v[20:23], 0
    v_perm_b32 v28, v57, v53, s39
    v_perm_b32 v29, v65, v61, s39
    v_perm_b32 v30, v73, v69, s39
    v_perm_b32 v31, v81, v77, s39
    v_mfma_f32_16x16x32_bf16 a[164:167], a[128:131], v[24:27], 0
    v_perm_b32 v32, v57, v53, s40
    v_perm_b32 v33, v65, v61, s40
    v_perm_b32 v34, v73, v69, s40
    v_perm_b32 v35, v81, v77, s40
    v_mfma_f32_16x16x32_bf16 a[168:171], a[128:131], v[28:31], 0
    v_perm_b32 v36, v58, v54, s39
    v_perm_b32 v37, v66, v62, s39
    v_perm_b32 v38, v74, v70, s39
    v_perm_b32 v39, v82, v78, s39
    v_mfma_f32_16x16x32_bf16 a[172:175], a[128:131], v[32:35], 0
    v_perm_b32 v40, v58, v54, s40
    v_perm_b32 v41, v66, v62, s40
    v_perm_b32 v42, v74, v70, s40
    v_perm_b32 v43, v82, v78, s40
    v_mfma_f32_16x16x32_bf16 a[176:179], a[128:131], v[36:39], 0
    v_perm_b32 v44, v59, v55, s39
    v_perm_b32 v45, v67, v63, s39
    v_perm_b32 v46, v75, v71, s39
    v_perm_b32 v47, v83, v79, s39
    v_mfma_f32_16x16x32_bf16 a[180:183], a[128:131], v[40:43], 0
    v_perm_b32 v48, v59, v55, s40
    v_perm_b32 v49, v67, v63, s40
    v_perm_b32 v50, v75, v71, s40
    v_perm_b32 v51, v83, v79, s40
    v_mfma_f32_16x16x32_bf16 a[184:187], a[128:131], v[44:47], 0
    s_add_u32 s37, s42, 0xa8000
    buffer_load_dwordx4 v[52:55], v5, s[24:27], s37 offen nt
    s_add_u32 s37, s42, 0xa9c00
    buffer_load_dwordx4 v[56:59], v5, s[24:27], s37 offen nt
    s_add_u32 s37, s42, 0xab800
    buffer_load_dwordx4 v[60:63], v5, s[24:27], s37 offen nt
    s_add_u32 s37, s42, 0xad400
    buffer_load_dwordx4 v[64:67], v5, s[24:27], s37 offen nt
    s_add_u32 s37, s42, 0xaf000
    buffer_load_dwordx4 v[68:71], v5, s[24:27], s37 offen nt
    s_add_u32 s37, s42, 0xb0c00
    buffer_load_dwordx4 v[72:75], v5, s[24:27], s37 offen nt
    s_add_u32 s37, s42, 0xb2800
    buffer_load_dwordx4 v[76:79], v5, s[24:27], s37 offen nt
    s_add_u32 s37, s42, 0xb4400
    buffer_load_dwordx4 v[80:83], v5, s[24:27], s37 offen nt
    v_mfma_f32_16x16x32_bf16 a[188:191], a[128:131], v[48:51], 0
    v_perm_b32 v20, v88, v84, s39
    v_perm_b32 v21, v96, v92, s39
    v_perm_b32 v22, v104, v100, s39
    v_perm_b32 v23, v112, v108, s39
    v_perm_b32 v24, v88, v84, s40
    v_perm_b32 v25, v96, v92, s40
    v_perm_b32 v26, v104, v100, s40
    v_perm_b32 v27, v112, v108, s40
    v_mfma_f32_16x16x32_bf16 a[192:195], a[128:131], v[20:23], 0
    v_perm_b32 v28, v89, v85, s39
    v_perm_b32 v29, v97, v93, s39
    v_perm_b32 v30, v105, v101, s39
    v_perm_b32 v31, v113, v109, s39
    v_mfma_f32_16x16x32_bf16 a[196:199], a[128:131], v[24:27], 0
    v_perm_b32 v32, v89, v85, s40
    v_perm_b32 v33, v97, v93, s40
    v_perm_b32 v34, v105, v101, s40
    v_perm_b32 v35, v113, v109, s40
    v_mfma_f32_16x16x32_bf16 a[200:203], a[128:131], v[28:31], 0
    v_perm_b32 v36, v90, v86, s39
    v_perm_b32 v37, v98, v94, s39
    v_perm_b32 v38, v106, v102, s39
    v_perm_b32 v39, v114, v110, s39
    v_mfma_f32_16x16x32_bf16 a[204:207], a[128:131], v[32:35], 0
    v_perm_b32 v40, v90, v86, s40
    v_perm_b32 v41, v98, v94, s40
    v_perm_b32 v42, v106, v102, s40
    v_perm_b32 v43, v114, v110, s40
    v_mfma_f32_16x16x32_bf16 a[208:211], a[128:131], v[36:39], 0
    v_perm_b32 v44, v91, v87, s39
    v_perm_b32 v45, v99, v95, s39
    v_perm_b32 v46, v107, v103, s39
    v_perm_b32 v47, v115, v111, s39
    v_mfma_f32_16x16x32_bf16 a[212:215], a[128:131], v[40:43], 0
    v_perm_b32 v48, v91, v87, s40
    v_perm_b32 v49, v99, v95, s40
    v_perm_b32 v50, v107, v103, s40
    v_perm_b32 v51, v115, v111, s40
    v_mfma_f32_16x16x32_bf16 a[216:219], a[128:131], v[44:47], 0
    s_add_u32 s37, s42, 0xa8000
    buffer_load_dwordx4 v[84:87], v5, s[28:31], s37 offen nt
    s_add_u32 s37, s42, 0xa9c00
    buffer_load_dwordx4 v[88:91], v5, s[28:31], s37 offen nt
    s_add_u32 s37, s42, 0xab800
    buffer_load_dwordx4 v[92:95], v5, s[28:31], s37 offen nt
    s_add_u32 s37, s42, 0xad400
    buffer_load_dwordx4 v[96:99], v5, s[28:31], s37 offen nt
    s_add_u32 s37, s42, 0xaf000
    buffer_load_dwordx4 v[100:103], v5, s[28:31], s37 offen nt
    s_add_u32 s37, s42, 0xb0c00
    buffer_load_dwordx4 v[104:107], v5, s[28:31], s37 offen nt
    s_add_u32 s37, s42, 0xb2800
    buffer_load_dwordx4 v[108:111], v5, s[28:31], s37 offen nt
    s_add_u32 s37, s42, 0xb4400
    buffer_load_dwordx4 v[112:115], v5, s[28:31], s37 offen nt
    v_mfma_f32_16x16x32_bf16 a[220:223], a[128:131], v[48:51], 0
    v_perm_b32 v20, v120, v116, s39
    v_perm_b32 v21, v128, v124, s39
    v_perm_b32 v22, v136, v132, s39
    v_perm_b32 v23, v144, v140, s39
    v_perm_b32 v24, v120, v116, s40
    v_perm_b32 v25, v128, v124, s40
    v_perm_b32 v26, v136, v132, s40
    v_perm_b32 v27, v144, v140, s40
    v_mfma_f32_16x16x32_bf16 a[160:163], a[132:135], v[20:23], a[160:163]
    v_perm_b32 v28, v121, v117, s39
    v_perm_b32 v29, v129, v125, s39
    v_perm_b32 v30, v137, v133, s39
    v_perm_b32 v31, v145, v141, s39
    v_mfma_f32_16x16x32_bf16 a[164:167], a[132:135], v[24:27], a[164:167]
    v_perm_b32 v32, v121, v117, s40
    v_perm_b32 v33, v129, v125, s40
    v_perm_b32 v34, v137, v133, s40
    v_perm_b32 v35, v145, v141, s40
    v_mfma_f32_16x16x32_bf16 a[168:171], a[132:135], v[28:31], a[168:171]
    v_perm_b32 v36, v122, v118, s39
    v_perm_b32 v37, v130, v126, s39
    v_perm_b32 v38, v138, v134, s39
    v_perm_b32 v39, v146, v142, s39
    v_mfma_f32_16x16x32_bf16 a[172:175], a[132:135], v[32:35], a[172:175]
    v_perm_b32 v40, v122, v118, s40
    v_perm_b32 v41, v130, v126, s40
    v_perm_b32 v42, v138, v134, s40
    v_perm_b32 v43, v146, v142, s40
    v_mfma_f32_16x16x32_bf16 a[176:179], a[132:135], v[36:39], a[176:179]
    v_perm_b32 v44, v123, v119, s39
    v_perm_b32 v45, v131, v127, s39
    v_perm_b32 v46, v139, v135, s39
    v_perm_b32 v47, v147, v143, s39
    v_mfma_f32_16x16x32_bf16 a[180:183], a[132:135], v[40:43], a[180:183]
    v_perm_b32 v48, v123, v119, s40
    v_perm_b32 v49, v131, v127, s40
    v_perm_b32 v50, v139, v135, s40
    v_perm_b32 v51, v147, v143, s40
    v_mfma_f32_16x16x32_bf16 a[184:187], a[132:135], v[44:47], a[184:187]
    s_add_u32 s37, s42, 0xe0000
    buffer_load_dwordx4 v[116:119], v5, s[24:27], s37 offen nt
    s_add_u32 s37, s42, 0xe1c00
    buffer_load_dwordx4 v[120:123], v5, s[24:27], s37 offen nt
    s_add_u32 s37, s42, 0xe3800
    buffer_load_dwordx4 v[124:127], v5, s[24:27], s37 offen nt
    s_add_u32 s37, s42, 0xe5400
    buffer_load_dwordx4 v[128:131], v5, s[24:27], s37 offen nt
    s_add_u32 s37, s42, 0xe7000
    buffer_load_dwordx4 v[132:135], v5, s[24:27], s37 offen nt
    s_add_u32 s37, s42, 0xe8c00
    buffer_load_dwordx4 v[136:139], v5, s[24:27], s37 offen nt
    s_add_u32 s37, s42, 0xea800
    buffer_load_dwordx4 v[140:143], v5, s[24:27], s37 offen nt
    s_add_u32 s37, s42, 0xec400
    buffer_load_dwordx4 v[144:147], v5, s[24:27], s37 offen nt
    v_mfma_f32_16x16x32_bf16 a[188:191], a[132:135], v[48:51], a[188:191]
    v_perm_b32 v20, v152, v148, s39
    v_perm_b32 v21, v160, v156, s39
    v_perm_b32 v22, v168, v164, s39
    v_perm_b32 v23, v176, v172, s39
    v_perm_b32 v24, v152, v148, s40
    v_perm_b32 v25, v160, v156, s40
    v_perm_b32 v26, v168, v164, s40
    v_perm_b32 v27, v176, v172, s40
    v_mfma_f32_16x16x32_bf16 a[192:195], a[132:135], v[20:23], a[192:195]
    v_perm_b32 v28, v153, v149, s39
    v_perm_b32 v29, v161, v157, s39
    v_perm_b32 v30, v169, v165, s39
    v_perm_b32 v31, v177, v173, s39
    v_mfma_f32_16x16x32_bf16 a[196:199], a[132:135], v[24:27], a[196:199]
    v_perm_b32 v32, v153, v149, s40
    v_perm_b32 v33, v161, v157, s40
    v_perm_b32 v34, v169, v165, s40
    v_perm_b32 v35, v177, v173, s40
    v_mfma_f32_16x16x32_bf16 a[200:203], a[132:135], v[28:31], a[200:203]
    v_perm_b32 v36, v154, v150, s39
    v_perm_b32 v37, v162, v158, s39
    v_perm_b32 v38, v170, v166, s39
    v_perm_b32 v39, v178, v174, s39
    v_mfma_f32_16x16x32_bf16 a[204:207], a[132:135], v[32:35], a[204:207]
    v_perm_b32 v40, v154, v150, s40
    v_perm_b32 v41, v162, v158, s40
    v_perm_b32 v42, v170, v166, s40
    v_perm_b32 v43, v178, v174, s40
    v_mfma_f32_16x16x32_bf16 a[208:211], a[132:135], v[36:39], a[208:211]
    v_perm_b32 v44, v155, v151, s39
    v_perm_b32 v45, v163, v159, s39
    v_perm_b32 v46, v171, v167, s39
    v_perm_b32 v47, v179, v175, s39
    v_mfma_f32_16x16x32_bf16 a[212:215], a[132:135], v[40:43], a[212:215]
    v_perm_b32 v48, v155, v151, s40
    v_perm_b32 v49, v163, v159, s40
    v_perm_b32 v50, v171, v167, s40
    v_perm_b32 v51, v179, v175, s40
    v_mfma_f32_16x16x32_bf16 a[216:219], a[132:135], v[44:47], a[216:219]
    s_add_u32 s37, s42, 0xe0000
    buffer_load_dwordx4 v[148:151], v5, s[28:31], s37 offen nt
    s_add_u32 s37, s42, 0xe1c00
    buffer_load_dwordx4 v[152:155], v5, s[28:31], s37 offen nt
    s_add_u32 s37, s42, 0xe3800
    buffer_load_dwordx4 v[156:159], v5, s[28:31], s37 offen nt
    s_add_u32 s37, s42, 0xe5400
    buffer_load_dwordx4 v[160:163], v5, s[28:31], s37 offen nt
    s_add_u32 s37, s42, 0xe7000
    buffer_load_dwordx4 v[164:167], v5, s[28:31], s37 offen nt
    s_add_u32 s37, s42, 0xe8c00
    buffer_load_dwordx4 v[168:171], v5, s[28:31], s37 offen nt
    s_add_u32 s37, s42, 0xea800
    buffer_load_dwordx4 v[172:175], v5, s[28:31], s37 offen nt
    s_add_u32 s37, s42, 0xec400
    buffer_load_dwordx4 v[176:179], v5, s[28:31], s37 offen nt
    v_mfma_f32_16x16x32_bf16 a[220:223], a[132:135], v[48:51], a[220:223]
    v_perm_b32 v20, v184, v180, s39
    v_perm_b32 v21, v192, v188, s39
    v_perm_b32 v22, v200, v196, s39
    v_perm_b32 v23, v208, v204, s39
    v_perm_b32 v24, v184, v180, s40
    v_perm_b32 v25, v192, v188, s40
    v_perm_b32 v26, v200, v196, s40
    v_perm_b32 v27, v208, v204, s40
    v_mfma_f32_16x16x32_bf16 a[160:163], a[136:139], v[20:23], a[160:163]
    v_perm_b32 v28, v185, v181, s39
    v_perm_b32 v29, v193, v189, s39
    v_perm_b32 v30, v201, v197, s39
    v_perm_b32 v31, v209, v205, s39
    v_mfma_f32_16x16x32_bf16 a[164:167], a[136:139], v[24:27], a[164:167]
    v_perm_b32 v32, v185, v181, s40
    v_perm_b32 v33, v193, v189, s40
    v_perm_b32 v34, v201, v197, s40
    v_perm_b32 v35, v209, v205, s40
    v_mfma_f32_16x16x32_bf16 a[168:171], a[136:139], v[28:31], a[168:171]
    v_perm_b32 v36, v186, v182, s39
    v_perm_b32 v37, v194, v190, s39
    v_perm_b32 v38, v202, v198, s39
    v_perm_b32 v39, v210, v206, s39
    v_mfma_f32_16x16x32_bf16 a[172:175], a[136:139], v[32:35], a[172:175]
    v_perm_b32 v40, v186, v182, s40
    v_perm_b32 v41, v194, v190, s40
    v_perm_b32 v42, v202, v198, s40
    v_perm_b32 v43, v210, v206, s40
    v_mfma_f32_16x16x32_bf16 a[176:179], a[136:139], v[36:39], a[176:179]
    v_perm_b32 v44, v187, v183, s39
    v_perm_b32 v45, v195, v191, s39
    v_perm_b32 v46, v203, v199, s39
    v_perm_b32 v47, v211, v207, s39
    v_mfma_f32_16x16x32_bf16 a[180:183], a[136:139], v[40:43], a[180:183]
    v_perm_b32 v48, v187, v183, s40
    v_perm_b32 v49, v195, v191, s40
    v_perm_b32 v50, v203, v199, s40
    v_perm_b32 v51, v211, v207, s40
    v_mfma_f32_16x16x32_bf16 a[184:187], a[136:139], v[44:47], a[184:187]
    s_add_u32 s37, s42, 0x118000
    buffer_load_dwordx4 v[180:183], v5, s[24:27], s37 offen nt
    s_add_u32 s37, s42, 0x119c00
    buffer_load_dwordx4 v[184:187], v5, s[24:27], s37 offen nt
    s_add_u32 s37, s42, 0x11b800
    buffer_load_dwordx4 v[188:191], v5, s[24:27], s37 offen nt
    s_add_u32 s37, s42, 0x11d400
    buffer_load_dwordx4 v[192:195], v5, s[24:27], s37 offen nt
    s_add_u32 s37, s42, 0x11f000
    buffer_load_dwordx4 v[196:199], v5, s[24:27], s37 offen nt
    s_add_u32 s37, s42, 0x120c00
    buffer_load_dwordx4 v[200:203], v5, s[24:27], s37 offen nt
    s_add_u32 s37, s42, 0x122800
    buffer_load_dwordx4 v[204:207], v5, s[24:27], s37 offen nt
    s_add_u32 s37, s42, 0x124400
    buffer_load_dwordx4 v[208:211], v5, s[24:27], s37 offen nt
    v_mfma_f32_16x16x32_bf16 a[188:191], a[136:139], v[48:51], a[188:191]
    v_perm_b32 v20, v216, v212, s39
    v_perm_b32 v21, v224, v220, s39
    v_perm_b32 v22, v232, v228, s39
    v_perm_b32 v23, v240, v236, s39
    v_perm_b32 v24, v216, v212, s40
    v_perm_b32 v25, v224, v220, s40
    v_perm_b32 v26, v232, v228, s40
    v_perm_b32 v27, v240, v236, s40
    v_mfma_f32_16x16x32_bf16 a[192:195], a[136:139], v[20:23], a[192:195]
    v_perm_b32 v28, v217, v213, s39
    v_perm_b32 v29, v225, v221, s39
    v_perm_b32 v30, v233, v229, s39
    v_perm_b32 v31, v241, v237, s39
    v_mfma_f32_16x16x32_bf16 a[196:199], a[136:139], v[24:27], a[196:199]
    v_perm_b32 v32, v217, v213, s40
    v_perm_b32 v33, v225, v221, s40
    v_perm_b32 v34, v233, v229, s40
    v_perm_b32 v35, v241, v237, s40
    v_mfma_f32_16x16x32_bf16 a[200:203], a[136:139], v[28:31], a[200:203]
    v_perm_b32 v36, v218, v214, s39
    v_perm_b32 v37, v226, v222, s39
    v_perm_b32 v38, v234, v230, s39
    v_perm_b32 v39, v242, v238, s39
    v_mfma_f32_16x16x32_bf16 a[204:207], a[136:139], v[32:35], a[204:207]
    v_perm_b32 v40, v218, v214, s40
    v_perm_b32 v41, v226, v222, s40
    v_perm_b32 v42, v234, v230, s40
    v_perm_b32 v43, v242, v238, s40
    v_mfma_f32_16x16x32_bf16 a[208:211], a[136:139], v[36:39], a[208:211]
    v_perm_b32 v44, v219, v215, s39
    v_perm_b32 v45, v227, v223, s39
    v_perm_b32 v46, v235, v231, s39
    v_perm_b32 v47, v243, v239, s39
    v_mfma_f32_16x16x32_bf16 a[212:215], a[136:139], v[40:43], a[212:215]
    v_perm_b32 v48, v219, v215, s40
    v_perm_b32 v49, v227, v223, s40
    v_perm_b32 v50, v235, v231, s40
    v_perm_b32 v51, v243, v239, s40
    v_mfma_f32_16x16x32_bf16 a[216:219], a[136:139], v[44:47], a[216:219]
    s_add_u32 s37, s42, 0x118000
    buffer_load_dwordx4 v[212:215], v5, s[28:31], s37 offen nt
    s_add_u32 s37, s42, 0x119c00
    buffer_load_dwordx4 v[216:219], v5, s[28:31], s37 offen nt
    s_add_u32 s37, s42, 0x11b800
    buffer_load_dwordx4 v[220:223], v5, s[28:31], s37 offen nt
    s_add_u32 s37, s42, 0x11d400
    buffer_load_dwordx4 v[224:227], v5, s[28:31], s37 offen nt
    s_add_u32 s37, s42, 0x11f000
    buffer_load_dwordx4 v[228:231], v5, s[28:31], s37 offen nt
    s_add_u32 s37, s42, 0x120c00
    buffer_load_dwordx4 v[232:235], v5, s[28:31], s37 offen nt
    s_add_u32 s37, s42, 0x122800
    buffer_load_dwordx4 v[236:239], v5, s[28:31], s37 offen nt
    s_add_u32 s37, s42, 0x124400
    buffer_load_dwordx4 v[240:243], v5, s[28:31], s37 offen nt
    v_mfma_f32_16x16x32_bf16 a[220:223], a[136:139], v[48:51], a[220:223]
    s_waitcnt vmcnt(40)
    v_perm_b32 v20, v56, v52, s39
    v_perm_b32 v21, v64, v60, s39
    v_perm_b32 v22, v72, v68, s39
    v_perm_b32 v23, v80, v76, s39
    v_perm_b32 v24, v56, v52, s40
    v_perm_b32 v25, v64, v60, s40
    v_perm_b32 v26, v72, v68, s40
    v_perm_b32 v27, v80, v76, s40
    v_mfma_f32_16x16x32_bf16 a[160:163], a[140:143], v[20:23], a[160:163]
    v_perm_b32 v28, v57, v53, s39
    v_perm_b32 v29, v65, v61, s39
    v_perm_b32 v30, v73, v69, s39
    v_perm_b32 v31, v81, v77, s39
    v_mfma_f32_16x16x32_bf16 a[164:167], a[140:143], v[24:27], a[164:167]
    v_perm_b32 v32, v57, v53, s40
    v_perm_b32 v33, v65, v61, s40
    v_perm_b32 v34, v73, v69, s40
    v_perm_b32 v35, v81, v77, s40
    v_mfma_f32_16x16x32_bf16 a[168:171], a[140:143], v[28:31], a[168:171]
    v_perm_b32 v36, v58, v54, s39
    v_perm_b32 v37, v66, v62, s39
    v_perm_b32 v38, v74, v70, s39
    v_perm_b32 v39, v82, v78, s39
    v_mfma_f32_16x16x32_bf16 a[172:175], a[140:143], v[32:35], a[172:175]
    v_perm_b32 v40, v58, v54, s40
    v_perm_b32 v41, v66, v62, s40
    v_perm_b32 v42, v74, v70, s40
    v_perm_b32 v43, v82, v78, s40
    v_mfma_f32_16x16x32_bf16 a[176:179], a[140:143], v[36:39], a[176:179]
    v_perm_b32 v44, v59, v55, s39
    v_perm_b32 v45, v67, v63, s39
    v_perm_b32 v46, v75, v71, s39
    v_perm_b32 v47, v83, v79, s39
    v_mfma_f32_16x16x32_bf16 a[180:183], a[140:143], v[40:43], a[180:183]
    v_perm_b32 v48, v59, v55, s40
    v_perm_b32 v49, v67, v63, s40
    v_perm_b32 v50, v75, v71, s40
    v_perm_b32 v51, v83, v79, s40
    v_mfma_f32_16x16x32_bf16 a[184:187], a[140:143], v[44:47], a[184:187]
    s_add_u32 s37, s42, 0x150000
    buffer_load_dwordx4 v[52:55], v5, s[24:27], s37 offen nt
    s_add_u32 s37, s42, 0x151c00
    buffer_load_dwordx4 v[56:59], v5, s[24:27], s37 offen nt
    s_add_u32 s37, s42, 0x153800
    buffer_load_dwordx4 v[60:63], v5, s[24:27], s37 offen nt
    s_add_u32 s37, s42, 0x155400
    buffer_load_dwordx4 v[64:67], v5, s[24:27], s37 offen nt
    s_add_u32 s37, s42, 0x157000
    buffer_load_dwordx4 v[68:71], v5, s[24:27], s37 offen nt
    s_add_u32 s37, s42, 0x158c00
    buffer_load_dwordx4 v[72:75], v5, s[24:27], s37 offen nt
    s_add_u32 s37, s42, 0x15a800
    buffer_load_dwordx4 v[76:79], v5, s[24:27], s37 offen nt
    s_add_u32 s37, s42, 0x15c400
    buffer_load_dwordx4 v[80:83], v5, s[24:27], s37 offen nt
    v_mfma_f32_16x16x32_bf16 a[188:191], a[140:143], v[48:51], a[188:191]
    s_waitcnt vmcnt(40)
    v_perm_b32 v20, v88, v84, s39
    v_perm_b32 v21, v96, v92, s39
    v_perm_b32 v22, v104, v100, s39
    v_perm_b32 v23, v112, v108, s39
    v_perm_b32 v24, v88, v84, s40
    v_perm_b32 v25, v96, v92, s40
    v_perm_b32 v26, v104, v100, s40
    v_perm_b32 v27, v112, v108, s40
    v_mfma_f32_16x16x32_bf16 a[192:195], a[140:143], v[20:23], a[192:195]
    v_perm_b32 v28, v89, v85, s39
    v_perm_b32 v29, v97, v93, s39
    v_perm_b32 v30, v105, v101, s39
    v_perm_b32 v31, v113, v109, s39
    v_mfma_f32_16x16x32_bf16 a[196:199], a[140:143], v[24:27], a[196:199]
    v_perm_b32 v32, v89, v85, s40
    v_perm_b32 v33, v97, v93, s40
    v_perm_b32 v34, v105, v101, s40
    v_perm_b32 v35, v113, v109, s40
    v_mfma_f32_16x16x32_bf16 a[200:203], a[140:143], v[28:31], a[200:203]
    v_perm_b32 v36, v90, v86, s39
    v_perm_b32 v37, v98, v94, s39
    v_perm_b32 v38, v106, v102, s39
    v_perm_b32 v39, v114, v110, s39
    v_mfma_f32_16x16x32_bf16 a[204:207], a[140:143], v[32:35], a[204:207]
    v_perm_b32 v40, v90, v86, s40
    v_perm_b32 v41, v98, v94, s40
    v_perm_b32 v42, v106, v102, s40
    v_perm_b32 v43, v114, v110, s40
    v_mfma_f32_16x16x32_bf16 a[208:211], a[140:143], v[36:39], a[208:211]
    v_perm_b32 v44, v91, v87, s39
    v_perm_b32 v45, v99, v95, s39
    v_perm_b32 v46, v107, v103, s39
    v_perm_b32 v47, v115, v111, s39
    v_mfma_f32_16x16x32_bf16 a[212:215], a[140:143], v[40:43], a[212:215]
    v_perm_b32 v48, v91, v87, s40
    v_perm_b32 v49, v99, v95, s40
    v_perm_b32 v50, v107, v103, s40
    v_perm_b32 v51, v115, v111, s40
    v_mfma_f32_16x16x32_bf16 a[216:219], a[140:143], v[44:47], a[216:219]
    s_add_u32 s37, s42, 0x150000
    buffer_load_dwordx4 v[84:87], v5, s[28:31], s37 offen nt
    s_add_u32 s37, s42, 0x151c00
    buffer_load_dwordx4 v[88:91], v5, s[28:31], s37 offen nt
    s_add_u32 s37, s42, 0x153800
    buffer_load_dwordx4 v[92:95], v5, s[28:31], s37 offen nt
    s_add_u32 s37, s42, 0x155400
    buffer_load_dwordx4 v[96:99], v5, s[28:31], s37 offen nt
    s_add_u32 s37, s42, 0x157000
    buffer_load_dwordx4 v[100:103], v5, s[28:31], s37 offen nt
    s_add_u32 s37, s42, 0x158c00
    buffer_load_dwordx4 v[104:107], v5, s[28:31], s37 offen nt
    s_add_u32 s37, s42, 0x15a800
    buffer_load_dwordx4 v[108:111], v5, s[28:31], s37 offen nt
    s_add_u32 s37, s42, 0x15c400
    buffer_load_dwordx4 v[112:115], v5, s[28:31], s37 offen nt
    v_mfma_f32_16x16x32_bf16 a[220:223], a[140:143], v[48:51], a[220:223]
    s_waitcnt vmcnt(40)
    v_perm_b32 v20, v120, v116, s39
    v_perm_b32 v21, v128, v124, s39
    v_perm_b32 v22, v136, v132, s39
    v_perm_b32 v23, v144, v140, s39
    v_perm_b32 v24, v120, v116, s40
    v_perm_b32 v25, v128, v124, s40
    v_perm_b32 v26, v136, v132, s40
    v_perm_b32 v27, v144, v140, s40
    v_mfma_f32_16x16x32_bf16 a[160:163], a[144:147], v[20:23], a[160:163]
    v_perm_b32 v28, v121, v117, s39
    v_perm_b32 v29, v129, v125, s39
    v_perm_b32 v30, v137, v133, s39
    v_perm_b32 v31, v145, v141, s39
    v_mfma_f32_16x16x32_bf16 a[164:167], a[144:147], v[24:27], a[164:167]
    v_perm_b32 v32, v121, v117, s40
    v_perm_b32 v33, v129, v125, s40
    v_perm_b32 v34, v137, v133, s40
    v_perm_b32 v35, v145, v141, s40
    v_mfma_f32_16x16x32_bf16 a[168:171], a[144:147], v[28:31], a[168:171]
    v_perm_b32 v36, v122, v118, s39
    v_perm_b32 v37, v130, v126, s39
    v_perm_b32 v38, v138, v134, s39
    v_perm_b32 v39, v146, v142, s39
    v_mfma_f32_16x16x32_bf16 a[172:175], a[144:147], v[32:35], a[172:175]
    v_perm_b32 v40, v122, v118, s40
    v_perm_b32 v41, v130, v126, s40
    v_perm_b32 v42, v138, v134, s40
    v_perm_b32 v43, v146, v142, s40
    v_mfma_f32_16x16x32_bf16 a[176:179], a[144:147], v[36:39], a[176:179]
    v_perm_b32 v44, v123, v119, s39
    v_perm_b32 v45, v131, v127, s39
    v_perm_b32 v46, v139, v135, s39
    v_perm_b32 v47, v147, v143, s39
    v_mfma_f32_16x16x32_bf16 a[180:183], a[144:147], v[40:43], a[180:183]
    v_perm_b32 v48, v123, v119, s40
    v_perm_b32 v49, v131, v127, s40
    v_perm_b32 v50, v139, v135, s40
    v_perm_b32 v51, v147, v143, s40
    v_mfma_f32_16x16x32_bf16 a[184:187], a[144:147], v[44:47], a[184:187]
    s_add_u32 s37, s42, 0x188000
    buffer_load_dwordx4 v[116:119], v5, s[24:27], s37 offen nt
    s_add_u32 s37, s42, 0x189c00
    buffer_load_dwordx4 v[120:123], v5, s[24:27], s37 offen nt
    s_add_u32 s37, s42, 0x18b800
    buffer_load_dwordx4 v[124:127], v5, s[24:27], s37 offen nt
    s_add_u32 s37, s42, 0x18d400
    buffer_load_dwordx4 v[128:131], v5, s[24:27], s37 offen nt
    s_add_u32 s37, s42, 0x18f000
    buffer_load_dwordx4 v[132:135], v5, s[24:27], s37 offen nt
    s_add_u32 s37, s42, 0x190c00
    buffer_load_dwordx4 v[136:139], v5, s[24:27], s37 offen nt
    s_add_u32 s37, s42, 0x192800
    buffer_load_dwordx4 v[140:143], v5, s[24:27], s37 offen nt
    s_add_u32 s37, s42, 0x194400
    buffer_load_dwordx4 v[144:147], v5, s[24:27], s37 offen nt
    v_mfma_f32_16x16x32_bf16 a[188:191], a[144:147], v[48:51], a[188:191]
    s_waitcnt vmcnt(40)
    v_perm_b32 v20, v152, v148, s39
    v_perm_b32 v21, v160, v156, s39
    v_perm_b32 v22, v168, v164, s39
    v_perm_b32 v23, v176, v172, s39
    v_perm_b32 v24, v152, v148, s40
    v_perm_b32 v25, v160, v156, s40
    v_perm_b32 v26, v168, v164, s40
    v_perm_b32 v27, v176, v172, s40
    v_mfma_f32_16x16x32_bf16 a[192:195], a[144:147], v[20:23], a[192:195]
    v_perm_b32 v28, v153, v149, s39
    v_perm_b32 v29, v161, v157, s39
    v_perm_b32 v30, v169, v165, s39
    v_perm_b32 v31, v177, v173, s39
    v_mfma_f32_16x16x32_bf16 a[196:199], a[144:147], v[24:27], a[196:199]
    v_perm_b32 v32, v153, v149, s40
    v_perm_b32 v33, v161, v157, s40
    v_perm_b32 v34, v169, v165, s40
    v_perm_b32 v35, v177, v173, s40
    v_mfma_f32_16x16x32_bf16 a[200:203], a[144:147], v[28:31], a[200:203]
    v_perm_b32 v36, v154, v150, s39
    v_perm_b32 v37, v162, v158, s39
    v_perm_b32 v38, v170, v166, s39
    v_perm_b32 v39, v178, v174, s39
    v_mfma_f32_16x16x32_bf16 a[204:207], a[144:147], v[32:35], a[204:207]
    v_perm_b32 v40, v154, v150, s40
    v_perm_b32 v41, v162, v158, s40
    v_perm_b32 v42, v170, v166, s40
    v_perm_b32 v43, v178, v174, s40
    v_mfma_f32_16x16x32_bf16 a[208:211], a[144:147], v[36:39], a[208:211]
    v_perm_b32 v44, v155, v151, s39
    v_perm_b32 v45, v163, v159, s39
    v_perm_b32 v46, v171, v167, s39
    v_perm_b32 v47, v179, v175, s39
    v_mfma_f32_16x16x32_bf16 a[212:215], a[144:147], v[40:43], a[212:215]
    v_perm_b32 v48, v155, v151, s40
    v_perm_b32 v49, v163, v159, s40
    v_perm_b32 v50, v171, v167, s40
    v_perm_b32 v51, v179, v175, s40
    v_mfma_f32_16x16x32_bf16 a[216:219], a[144:147], v[44:47], a[216:219]
    s_add_u32 s37, s42, 0x188000
    buffer_load_dwordx4 v[148:151], v5, s[28:31], s37 offen nt
    s_add_u32 s37, s42, 0x189c00
    buffer_load_dwordx4 v[152:155], v5, s[28:31], s37 offen nt
    s_add_u32 s37, s42, 0x18b800
    buffer_load_dwordx4 v[156:159], v5, s[28:31], s37 offen nt
    s_add_u32 s37, s42, 0x18d400
    buffer_load_dwordx4 v[160:163], v5, s[28:31], s37 offen nt
    s_add_u32 s37, s42, 0x18f000
    buffer_load_dwordx4 v[164:167], v5, s[28:31], s37 offen nt
    s_add_u32 s37, s42, 0x190c00
    buffer_load_dwordx4 v[168:171], v5, s[28:31], s37 offen nt
    s_add_u32 s37, s42, 0x192800
    buffer_load_dwordx4 v[172:175], v5, s[28:31], s37 offen nt
    s_add_u32 s37, s42, 0x194400
    buffer_load_dwordx4 v[176:179], v5, s[28:31], s37 offen nt
    v_mfma_f32_16x16x32_bf16 a[220:223], a[144:147], v[48:51], a[220:223]
    s_waitcnt vmcnt(40)
    v_perm_b32 v20, v184, v180, s39
    v_perm_b32 v21, v192, v188, s39
    v_perm_b32 v22, v200, v196, s39
    v_perm_b32 v23, v208, v204, s39
    v_perm_b32 v24, v184, v180, s40
    v_perm_b32 v25, v192, v188, s40
    v_perm_b32 v26, v200, v196, s40
    v_perm_b32 v27, v208, v204, s40
    v_mfma_f32_16x16x32_bf16 a[160:163], a[148:151], v[20:23], a[160:163]
    v_perm_b32 v28, v185, v181, s39
    v_perm_b32 v29, v193, v189, s39
    v_perm_b32 v30, v201, v197, s39
    v_perm_b32 v31, v209, v205, s39
    v_mfma_f32_16x16x32_bf16 a[164:167], a[148:151], v[24:27], a[164:167]
    v_perm_b32 v32, v185, v181, s40
    v_perm_b32 v33, v193, v189, s40
    v_perm_b32 v34, v201, v197, s40
    v_perm_b32 v35, v209, v205, s40
    v_mfma_f32_16x16x32_bf16 a[168:171], a[148:151], v[28:31], a[168:171]
    v_perm_b32 v36, v186, v182, s39
    v_perm_b32 v37, v194, v190, s39
    v_perm_b32 v38, v202, v198, s39
    v_perm_b32 v39, v210, v206, s39
    v_mfma_f32_16x16x32_bf16 a[172:175], a[148:151], v[32:35], a[172:175]
    v_perm_b32 v40, v186, v182, s40
    v_perm_b32 v41, v194, v190, s40
    v_perm_b32 v42, v202, v198, s40
    v_perm_b32 v43, v210, v206, s40
    v_mfma_f32_16x16x32_bf16 a[176:179], a[148:151], v[36:39], a[176:179]
    v_perm_b32 v44, v187, v183, s39
    v_perm_b32 v45, v195, v191, s39
    v_perm_b32 v46, v203, v199, s39
    v_perm_b32 v47, v211, v207, s39
    v_mfma_f32_16x16x32_bf16 a[180:183], a[148:151], v[40:43], a[180:183]
    v_perm_b32 v48, v187, v183, s40
    v_perm_b32 v49, v195, v191, s40
    v_perm_b32 v50, v203, v199, s40
    v_perm_b32 v51, v211, v207, s40
    v_mfma_f32_16x16x32_bf16 a[184:187], a[148:151], v[44:47], a[184:187]
    v_mfma_f32_16x16x32_bf16 a[188:191], a[148:151], v[48:51], a[188:191]
    s_waitcnt vmcnt(32)
    v_perm_b32 v20, v216, v212, s39
    v_perm_b32 v21, v224, v220, s39
    v_perm_b32 v22, v232, v228, s39
    v_perm_b32 v23, v240, v236, s39
    v_perm_b32 v24, v216, v212, s40
    v_perm_b32 v25, v224, v220, s40
    v_perm_b32 v26, v232, v228, s40
    v_perm_b32 v27, v240, v236, s40
    v_mfma_f32_16x16x32_bf16 a[192:195], a[148:151], v[20:23], a[192:195]
    v_perm_b32 v28, v217, v213, s39
    v_perm_b32 v29, v225, v221, s39
    v_perm_b32 v30, v233, v229, s39
    v_perm_b32 v31, v241, v237, s39
    v_mfma_f32_16x16x32_bf16 a[196:199], a[148:151], v[24:27], a[196:199]
    v_perm_b32 v32, v217, v213, s40
    v_perm_b32 v33, v225, v221, s40
    v_perm_b32 v34, v233, v229, s40
    v_perm_b32 v35, v241, v237, s40
    v_mfma_f32_16x16x32_bf16 a[200:203], a[148:151], v[28:31], a[200:203]
    v_perm_b32 v36, v218, v214, s39
    v_perm_b32 v37, v226, v222, s39
    v_perm_b32 v38, v234, v230, s39
    v_perm_b32 v39, v242, v238, s39
    v_mfma_f32_16x16x32_bf16 a[204:207], a[148:151], v[32:35], a[204:207]
    v_perm_b32 v40, v218, v214, s40
    v_perm_b32 v41, v226, v222, s40
    v_perm_b32 v42, v234, v230, s40
    v_perm_b32 v43, v242, v238, s40
    v_mfma_f32_16x16x32_bf16 a[208:211], a[148:151], v[36:39], a[208:211]
    v_perm_b32 v44, v219, v215, s39
    v_perm_b32 v45, v227, v223, s39
    v_perm_b32 v46, v235, v231, s39
    v_perm_b32 v47, v243, v239, s39
    v_mfma_f32_16x16x32_bf16 a[212:215], a[148:151], v[40:43], a[212:215]
    v_perm_b32 v48, v219, v215, s40
    v_perm_b32 v49, v227, v223, s40
    v_perm_b32 v50, v235, v231, s40
    v_perm_b32 v51, v243, v239, s40
    v_mfma_f32_16x16x32_bf16 a[216:219], a[148:151], v[44:47], a[216:219]
    v_mfma_f32_16x16x32_bf16 a[220:223], a[148:151], v[48:51], a[220:223]
    s_waitcnt vmcnt(24)
    v_perm_b32 v20, v56, v52, s39
    v_perm_b32 v21, v64, v60, s39
    v_perm_b32 v22, v72, v68, s39
    v_perm_b32 v23, v80, v76, s39
    v_perm_b32 v24, v56, v52, s40
    v_perm_b32 v25, v64, v60, s40
    v_perm_b32 v26, v72, v68, s40
    v_perm_b32 v27, v80, v76, s40
    v_mfma_f32_16x16x32_bf16 a[160:163], a[152:155], v[20:23], a[160:163]
    v_perm_b32 v28, v57, v53, s39
    v_perm_b32 v29, v65, v61, s39
    v_perm_b32 v30, v73, v69, s39
    v_perm_b32 v31, v81, v77, s39
    v_mfma_f32_16x16x32_bf16 a[164:167], a[152:155], v[24:27], a[164:167]
    v_perm_b32 v32, v57, v53, s40
    v_perm_b32 v33, v65, v61, s40
    v_perm_b32 v34, v73, v69, s40
    v_perm_b32 v35, v81, v77, s40
    v_mfma_f32_16x16x32_bf16 a[168:171], a[152:155], v[28:31], a[168:171]
    v_perm_b32 v36, v58, v54, s39
    v_perm_b32 v37, v66, v62, s39
    v_perm_b32 v38, v74, v70, s39
    v_perm_b32 v39, v82, v78, s39
    v_mfma_f32_16x16x32_bf16 a[172:175], a[152:155], v[32:35], a[172:175]
    v_perm_b32 v40, v58, v54, s40
    v_perm_b32 v41, v66, v62, s40
    v_perm_b32 v42, v74, v70, s40
    v_perm_b32 v43, v82, v78, s40
    v_mfma_f32_16x16x32_bf16 a[176:179], a[152:155], v[36:39], a[176:179]
    v_perm_b32 v44, v59, v55, s39
    v_perm_b32 v45, v67, v63, s39
    v_perm_b32 v46, v75, v71, s39
    v_perm_b32 v47, v83, v79, s39
    v_mfma_f32_16x16x32_bf16 a[180:183], a[152:155], v[40:43], a[180:183]
    v_perm_b32 v48, v59, v55, s40
    v_perm_b32 v49, v67, v63, s40
    v_perm_b32 v50, v75, v71, s40
    v_perm_b32 v51, v83, v79, s40
    v_mfma_f32_16x16x32_bf16 a[184:187], a[152:155], v[44:47], a[184:187]
    v_mfma_f32_16x16x32_bf16 a[188:191], a[152:155], v[48:51], a[188:191]
    s_waitcnt vmcnt(16)
    v_perm_b32 v20, v88, v84, s39
    v_perm_b32 v21, v96, v92, s39
    v_perm_b32 v22, v104, v100, s39
    v_perm_b32 v23, v112, v108, s39
    v_perm_b32 v24, v88, v84, s40
    v_perm_b32 v25, v96, v92, s40
    v_perm_b32 v26, v104, v100, s40
    v_perm_b32 v27, v112, v108, s40
    v_mfma_f32_16x16x32_bf16 a[192:195], a[152:155], v[20:23], a[192:195]
    v_perm_b32 v28, v89, v85, s39
    v_perm_b32 v29, v97, v93, s39
    v_perm_b32 v30, v105, v101, s39
    v_perm_b32 v31, v113, v109, s39
    v_mfma_f32_16x16x32_bf16 a[196:199], a[152:155], v[24:27], a[196:199]
    v_perm_b32 v32, v89, v85, s40
    v_perm_b32 v33, v97, v93, s40
    v_perm_b32 v34, v105, v101, s40
    v_perm_b32 v35, v113, v109, s40
    v_mfma_f32_16x16x32_bf16 a[200:203], a[152:155], v[28:31], a[200:203]
    v_perm_b32 v36, v90, v86, s39
    v_perm_b32 v37, v98, v94, s39
    v_perm_b32 v38, v106, v102, s39
    v_perm_b32 v39, v114, v110, s39
    v_mfma_f32_16x16x32_bf16 a[204:207], a[152:155], v[32:35], a[204:207]
    v_perm_b32 v40, v90, v86, s40
    v_perm_b32 v41, v98, v94, s40
    v_perm_b32 v42, v106, v102, s40
    v_perm_b32 v43, v114, v110, s40
    v_mfma_f32_16x16x32_bf16 a[208:211], a[152:155], v[36:39], a[208:211]
    v_perm_b32 v44, v91, v87, s39
    v_perm_b32 v45, v99, v95, s39
    v_perm_b32 v46, v107, v103, s39
    v_perm_b32 v47, v115, v111, s39
    v_mfma_f32_16x16x32_bf16 a[212:215], a[152:155], v[40:43], a[212:215]
    v_perm_b32 v48, v91, v87, s40
    v_perm_b32 v49, v99, v95, s40
    v_perm_b32 v50, v107, v103, s40
    v_perm_b32 v51, v115, v111, s40
    v_mfma_f32_16x16x32_bf16 a[216:219], a[152:155], v[44:47], a[216:219]
    v_mfma_f32_16x16x32_bf16 a[220:223], a[152:155], v[48:51], a[220:223]
    s_waitcnt vmcnt(8)
    v_perm_b32 v20, v120, v116, s39
    v_perm_b32 v21, v128, v124, s39
    v_perm_b32 v22, v136, v132, s39
    v_perm_b32 v23, v144, v140, s39
    v_perm_b32 v24, v120, v116, s40
    v_perm_b32 v25, v128, v124, s40
    v_perm_b32 v26, v136, v132, s40
    v_perm_b32 v27, v144, v140, s40
    v_mfma_f32_16x16x32_bf16 a[160:163], a[156:159], v[20:23], a[160:163]
    v_perm_b32 v28, v121, v117, s39
    v_perm_b32 v29, v129, v125, s39
    v_perm_b32 v30, v137, v133, s39
    v_perm_b32 v31, v145, v141, s39
    v_mfma_f32_16x16x32_bf16 a[164:167], a[156:159], v[24:27], a[164:167]
    v_perm_b32 v32, v121, v117, s40
    v_perm_b32 v33, v129, v125, s40
    v_perm_b32 v34, v137, v133, s40
    v_perm_b32 v35, v145, v141, s40
    v_mfma_f32_16x16x32_bf16 a[168:171], a[156:159], v[28:31], a[168:171]
    v_perm_b32 v36, v122, v118, s39
    v_perm_b32 v37, v130, v126, s39
    v_perm_b32 v38, v138, v134, s39
    v_perm_b32 v39, v146, v142, s39
    v_mfma_f32_16x16x32_bf16 a[172:175], a[156:159], v[32:35], a[172:175]
    v_perm_b32 v40, v122, v118, s40
    v_perm_b32 v41, v130, v126, s40
    v_perm_b32 v42, v138, v134, s40
    v_perm_b32 v43, v146, v142, s40
    v_mfma_f32_16x16x32_bf16 a[176:179], a[156:159], v[36:39], a[176:179]
    v_perm_b32 v44, v123, v119, s39
    v_perm_b32 v45, v131, v127, s39
    v_perm_b32 v46, v139, v135, s39
    v_perm_b32 v47, v147, v143, s39
    v_mfma_f32_16x16x32_bf16 a[180:183], a[156:159], v[40:43], a[180:183]
    v_perm_b32 v48, v123, v119, s40
    v_perm_b32 v49, v131, v127, s40
    v_perm_b32 v50, v139, v135, s40
    v_perm_b32 v51, v147, v143, s40
    v_mfma_f32_16x16x32_bf16 a[184:187], a[156:159], v[44:47], a[184:187]
    v_mfma_f32_16x16x32_bf16 a[188:191], a[156:159], v[48:51], a[188:191]
    s_waitcnt vmcnt(0)
    v_perm_b32 v20, v152, v148, s39
    v_perm_b32 v21, v160, v156, s39
    v_perm_b32 v22, v168, v164, s39
    v_perm_b32 v23, v176, v172, s39
    v_perm_b32 v24, v152, v148, s40
    v_perm_b32 v25, v160, v156, s40
    v_perm_b32 v26, v168, v164, s40
    v_perm_b32 v27, v176, v172, s40
    v_mfma_f32_16x16x32_bf16 a[192:195], a[156:159], v[20:23], a[192:195]
    v_perm_b32 v28, v153, v149, s39
    v_perm_b32 v29, v161, v157, s39
    v_perm_b32 v30, v169, v165, s39
    v_perm_b32 v31, v177, v173, s39
    v_mfma_f32_16x16x32_bf16 a[196:199], a[156:159], v[24:27], a[196:199]
    v_perm_b32 v32, v153, v149, s40
    v_perm_b32 v33, v161, v157, s40
    v_perm_b32 v34, v169, v165, s40
    v_perm_b32 v35, v177, v173, s40
    v_mfma_f32_16x16x32_bf16 a[200:203], a[156:159], v[28:31], a[200:203]
    v_perm_b32 v36, v154, v150, s39
    v_perm_b32 v37, v162, v158, s39
    v_perm_b32 v38, v170, v166, s39
    v_perm_b32 v39, v178, v174, s39
    v_mfma_f32_16x16x32_bf16 a[204:207], a[156:159], v[32:35], a[204:207]
    v_perm_b32 v40, v154, v150, s40
    v_perm_b32 v41, v162, v158, s40
    v_perm_b32 v42, v170, v166, s40
    v_perm_b32 v43, v178, v174, s40
    v_mfma_f32_16x16x32_bf16 a[208:211], a[156:159], v[36:39], a[208:211]
    v_perm_b32 v44, v155, v151, s39
    v_perm_b32 v45, v163, v159, s39
    v_perm_b32 v46, v171, v167, s39
    v_perm_b32 v47, v179, v175, s39
    v_mfma_f32_16x16x32_bf16 a[212:215], a[156:159], v[40:43], a[212:215]
    v_perm_b32 v48, v155, v151, s40
    v_perm_b32 v49, v163, v159, s40
    v_perm_b32 v50, v171, v167, s40
    v_perm_b32 v51, v179, v175, s40
    v_mfma_f32_16x16x32_bf16 a[216:219], a[156:159], v[44:47], a[216:219]
    v_mfma_f32_16x16x32_bf16 a[220:223], a[156:159], v[48:51], a[220:223]
    s_lshl_b32 s37, s32, 14
    v_add_u32 v9, s37, v1
    s_barrier
    ds_write_b128 v9, a[160:163] offset:0
    ds_write_b128 v9, a[164:167] offset:1024
    ds_write_b128 v9, a[168:171] offset:2048
    ds_write_b128 v9, a[172:175] offset:3072
    ds_write_b128 v9, a[176:179] offset:4096
    ds_write_b128 v9, a[180:183] offset:5120
    ds_write_b128 v9, a[184:187] offset:6144
    ds_write_b128 v9, a[188:191] offset:7168
    s_waitcnt lgkmcnt(0)
    ds_write_b128 v9, a[192:195] offset:8192
    ds_write_b128 v9, a[196:199] offset:9216
    ds_write_b128 v9, a[200:203] offset:10240
    ds_write_b128 v9, a[204:207] offset:11264
    ds_write_b128 v9, a[208:211] offset:12288
    ds_write_b128 v9, a[212:215] offset:13312
    ds_write_b128 v9, a[216:219] offset:14336
    ds_write_b128 v9, a[220:223] offset:15360
    s_and_b32 s37, s32, 1
    s_lshl_b32 s37, s37, 8
    s_lshr_b32 s38, s32, 1
    s_lshl_b32 s38, s38, 3
    s_add_u32 s37, s37, s38
    v_bfe_u32 v6, v0, 0, 2
    v_lshlrev_b32 v9, 11, v6
    v_bfe_u32 v6, v0, 2, 4
    v_lshl_add_u32 v9, v6, 4, v9
    v_add_u32 v9, s37, v9
    s_waitcnt lgkmcnt(0)
    s_barrier
    ds_read_b64 v[20:21], v9 offset:0
    ds_read_b64 v[22:23], v9 offset:16384
    ds_read_b64 v[24:25], v9 offset:32768
    ds_read_b64 v[26:27], v9 offset:49152
    ds_read_b64 v[28:29], v9 offset:1024
    ds_read_b64 v[30:31], v9 offset:17408
    ds_read_b64 v[32:33], v9 offset:33792
    ds_read_b64 v[34:35], v9 offset:50176
    s_waitcnt lgkmcnt(0)
    ds_read_b64 v[36:37], v9 offset:8192
    ds_read_b64 v[38:39], v9 offset:24576
    ds_read_b64 v[40:41], v9 offset:40960
    ds_read_b64 v[42:43], v9 offset:57344
    ds_read_b64 v[44:45], v9 offset:9216
    ds_read_b64 v[46:47], v9 offset:25600
    ds_read_b64 v[48:49], v9 offset:41984
    ds_read_b64 v[50:51], v9 offset:58368
    s_waitcnt lgkmcnt(0)
    v_pk_add_f32 v[20:21], v[20:21], v[22:23]
    v_pk_add_f32 v[24:25], v[24:25], v[26:27]
    v_pk_add_f32 v[20:21], v[20:21], v[24:25]
    v_cvt_pk_bf16_f32 v6, v20, v21
    v_lshlrev_b32 v20, 16, v6
    v_and_b32 v21, s44, v6
    v_pk_add_f32 v[28:29], v[28:29], v[30:31]
    v_pk_add_f32 v[32:33], v[32:33], v[34:35]
    v_pk_add_f32 v[28:29], v[28:29], v[32:33]
    v_cvt_pk_bf16_f32 v6, v28, v29
    v_lshlrev_b32 v28, 16, v6
    v_and_b32 v29, s44, v6
    v_pk_add_f32 v[36:37], v[36:37], v[38:39]
    v_pk_add_f32 v[40:41], v[40:41], v[42:43]
    v_pk_add_f32 v[36:37], v[36:37], v[40:41]
    v_cvt_pk_bf16_f32 v6, v36, v37
    v_lshlrev_b32 v36, 16, v6
    v_and_b32 v37, s44, v6
    v_pk_add_f32 v[44:45], v[44:45], v[46:47]
    v_pk_add_f32 v[48:49], v[48:49], v[50:51]
    v_pk_add_f32 v[44:45], v[44:45], v[48:49]
    v_cvt_pk_bf16_f32 v6, v44, v45
    v_lshlrev_b32 v44, 16, v6
    v_and_b32 v45, s44, v6
    v_mul_f32 v22, 0xbfb8aa3b, v20
    v_exp_f32 v22, v22
    s_nop 0
    v_add_f32 v22, 1.0, v22
    v_rcp_f32 v22, v22
    s_nop 0
    v_mul_f32 v20, v20, v22
    v_mul_f32 v23, 0xbfb8aa3b, v21
    v_exp_f32 v23, v23
    s_nop 0
    v_add_f32 v23, 1.0, v23
    v_rcp_f32 v23, v23
    s_nop 0
    v_mul_f32 v21, v21, v23
    v_cvt_pk_bf16_f32 v6, v20, v21
    v_lshlrev_b32 v20, 16, v6
    v_and_b32 v21, s44, v6
    v_mul_f32 v20, v20, v36
    v_mul_f32 v21, v21, v37
    v_mul_f32 v30, 0xbfb8aa3b, v28
    v_exp_f32 v30, v30
    s_nop 0
    v_add_f32 v30, 1.0, v30
    v_rcp_f32 v30, v30
    s_nop 0
    v_mul_f32 v28, v28, v30
    v_mul_f32 v31, 0xbfb8aa3b, v29
    v_exp_f32 v31, v31
    s_nop 0
    v_add_f32 v31, 1.0, v31
    v_rcp_f32 v31, v31
    s_nop 0
    v_mul_f32 v29, v29, v31
    v_cvt_pk_bf16_f32 v6, v28, v29
    v_lshlrev_b32 v28, 16, v6
    v_and_b32 v29, s44, v6
    v_mul_f32 v28, v28, v44
    v_mul_f32 v29, v29, v45
    v_cvt_pk_bf16_f32 v7, v20, v28
    v_cvt_pk_bf16_f32 v8, v21, v29
    v_min_u32 v7, -2, v7
    v_min_u32 v8, -2, v8
    s_and_b32 s37, s32, 1
    s_lshl_b32 s37, s37, 2
    s_and_b32 s38, s32, 2
    s_add_u32 s37, s37, s38
    s_mul_i32 s37, s37, 7168
    s_lshl_b32 s38, s36, 8
    s_add_u32 s37, s37, s38
    s_add_u32 s37, s37, 0xe410000
    s_add_u32 s38, s37, 7168
    s_cmp_lt_u32 s36, 28
    s_cselect_b32 s40, 0, 0x40000000
    v_add_u32 v9, s40, v2
    buffer_store_dword v7, v9, s[4:7], s37 offen sc1
    buffer_store_dword v8, v9, s[4:7], s38 offen sc1
    s_mov_b32 s12, s86
    s_and_b32 s13, s87, 0xffff
    s_mov_b32 s14, 0x700000
    s_mov_b32 s15, 0x20000
    s_lshr_b32 s40, s36, 4
    s_lshl_b32 s37, s40, 2
    s_add_u32 s39, s37, s32
    s_mul_i32 s42, s39, 917504
    s_add_u32 s37, s36, 4
    s_and_b32 s37, s37, 15
    s_lshl_b32 s38, s37, 1
    s_add_u32 s40, s40, s38
    s_lshl_b32 s37, s37, 7
    s_add_u32 s42, s42, s37
    v_bfe_u32 v6, v0, 3, 3
    v_lshlrev_b32 v5, 11, v6
    v_bfe_u32 v6, v0, 0, 3
    v_lshl_add_u32 v5, v6, 4, v5
    s_lshl_b32 s37, s32, 12
    s_add_u32 s37, s37, 65536
    v_add_u32 v9, s37, v1
    v_bfe_u32 v6, v0, 4, 2
    v_lshlrev_b32 v10, 10, v6
    v_bfe_u32 v6, v0, 2, 2
    v_lshl_add_u32 v10, v6, 7, v10
    v_bfe_u32 v6, v0, 0, 2
    v_lshl_add_u32 v10, v6, 3, v10
    v_add_u32 v10, s37, v10
    s_add_u32 s38, s42, 0x0
    buffer_load_dwordx4 a[0:3], v5, s[12:15], s38 offen nt
    s_add_u32 s38, s42, 0x4000
    buffer_load_dwordx4 a[4:7], v5, s[12:15], s38 offen nt
    s_add_u32 s38, s42, 0x8000
    buffer_load_dwordx4 a[8:11], v5, s[12:15], s38 offen nt
    s_add_u32 s38, s42, 0xc000
    buffer_load_dwordx4 a[12:15], v5, s[12:15], s38 offen nt
    s_add_u32 s38, s42, 0x10000
    buffer_load_dwordx4 a[16:19], v5, s[12:15], s38 offen nt
    s_add_u32 s38, s42, 0x14000
    buffer_load_dwordx4 a[20:23], v5, s[12:15], s38 offen nt
    s_add_u32 s38, s42, 0x18000
    buffer_load_dwordx4 a[24:27], v5, s[12:15], s38 offen nt
    s_add_u32 s38, s42, 0x1c000
    buffer_load_dwordx4 a[28:31], v5, s[12:15], s38 offen nt
    s_add_u32 s38, s42, 0x20000
    buffer_load_dwordx4 a[32:35], v5, s[12:15], s38 offen nt
    s_add_u32 s38, s42, 0x24000
    buffer_load_dwordx4 a[36:39], v5, s[12:15], s38 offen nt
    s_add_u32 s38, s42, 0x28000
    buffer_load_dwordx4 a[40:43], v5, s[12:15], s38 offen nt
    s_add_u32 s38, s42, 0x2c000
    buffer_load_dwordx4 a[44:47], v5, s[12:15], s38 offen nt
    s_add_u32 s38, s42, 0x30000
    buffer_load_dwordx4 a[48:51], v5, s[12:15], s38 offen nt
    s_add_u32 s38, s42, 0x34000
    buffer_load_dwordx4 a[52:55], v5, s[12:15], s38 offen nt
    s_add_u32 s38, s42, 0x38000
    buffer_load_dwordx4 a[56:59], v5, s[12:15], s38 offen nt
    s_add_u32 s38, s42, 0x3c000
    buffer_load_dwordx4 a[60:63], v5, s[12:15], s38 offen nt
    s_waitcnt vmcnt(12) lgkmcnt(0)
    ds_write_b128 v9, a[0:3] offset:0
    ds_write_b128 v9, a[4:7] offset:1024
    ds_write_b128 v9, a[8:11] offset:2048
    ds_write_b128 v9, a[12:15] offset:3072
    ds_read_b64_tr_b16 a[0:1], v10 offset:0
    ds_read_b64_tr_b16 a[2:3], v10 offset:512
    ds_read_b64_tr_b16 a[4:5], v10 offset:32
    ds_read_b64_tr_b16 a[6:7], v10 offset:544
    ds_read_b64_tr_b16 a[8:9], v10 offset:64
    ds_read_b64_tr_b16 a[10:11], v10 offset:576
    ds_read_b64_tr_b16 a[12:13], v10 offset:96
    ds_read_b64_tr_b16 a[14:15], v10 offset:608
    s_add_u32 s38, s42, 0x40000
    buffer_load_dwordx4 a[64:67], v5, s[12:15], s38 offen nt
    s_add_u32 s38, s42, 0x44000
    buffer_load_dwordx4 a[68:71], v5, s[12:15], s38 offen nt
    s_add_u32 s38, s42, 0x48000
    buffer_load_dwordx4 a[72:75], v5, s[12:15], s38 offen nt
    s_add_u32 s38, s42, 0x4c000
    buffer_load_dwordx4 a[76:79], v5, s[12:15], s38 offen nt
    s_waitcnt vmcnt(12) lgkmcnt(0)
    ds_write_b128 v9, a[16:19] offset:0
    ds_write_b128 v9, a[20:23] offset:1024
    ds_write_b128 v9, a[24:27] offset:2048
    ds_write_b128 v9, a[28:31] offset:3072
    ds_read_b64_tr_b16 a[16:17], v10 offset:0
    ds_read_b64_tr_b16 a[18:19], v10 offset:512
    ds_read_b64_tr_b16 a[20:21], v10 offset:32
    ds_read_b64_tr_b16 a[22:23], v10 offset:544
    ds_read_b64_tr_b16 a[24:25], v10 offset:64
    ds_read_b64_tr_b16 a[26:27], v10 offset:576
    ds_read_b64_tr_b16 a[28:29], v10 offset:96
    ds_read_b64_tr_b16 a[30:31], v10 offset:608
    s_add_u32 s38, s42, 0x50000
    buffer_load_dwordx4 a[80:83], v5, s[12:15], s38 offen nt
    s_add_u32 s38, s42, 0x54000
    buffer_load_dwordx4 a[84:87], v5, s[12:15], s38 offen nt
    s_add_u32 s38, s42, 0x58000
    buffer_load_dwordx4 a[88:91], v5, s[12:15], s38 offen nt
    s_add_u32 s38, s42, 0x5c000
    buffer_load_dwordx4 a[92:95], v5, s[12:15], s38 offen nt
    s_waitcnt vmcnt(12) lgkmcnt(0)
    ds_write_b128 v9, a[32:35] offset:0
    ds_write_b128 v9, a[36:39] offset:1024
    ds_write_b128 v9, a[40:43] offset:2048
    ds_write_b128 v9, a[44:47] offset:3072
    ds_read_b64_tr_b16 a[32:33], v10 offset:0
    ds_read_b64_tr_b16 a[34:35], v10 offset:512
    ds_read_b64_tr_b16 a[36:37], v10 offset:32
    ds_read_b64_tr_b16 a[38:39], v10 offset:544
    ds_read_b64_tr_b16 a[40:41], v10 offset:64
    ds_read_b64_tr_b16 a[42:43], v10 offset:576
    ds_read_b64_tr_b16 a[44:45], v10 offset:96
    ds_read_b64_tr_b16 a[46:47], v10 offset:608
    s_add_u32 s38, s42, 0x60000
    buffer_load_dwordx4 a[96:99], v5, s[12:15], s38 offen nt
    s_add_u32 s38, s42, 0x64000
    buffer_load_dwordx4 a[100:103], v5, s[12:15], s38 offen nt
    s_add_u32 s38, s42, 0x68000
    buffer_load_dwordx4 a[104:107], v5, s[12:15], s38 offen nt
    s_add_u32 s38, s42, 0x6c000
    buffer_load_dwordx4 a[108:111], v5, s[12:15], s38 offen nt
    s_waitcnt vmcnt(12) lgkmcnt(0)
    ds_write_b128 v9, a[48:51] offset:0
    ds_write_b128 v9, a[52:55] offset:1024
    ds_write_b128 v9, a[56:59] offset:2048
    ds_write_b128 v9, a[60:63] offset:3072
    ds_read_b64_tr_b16 a[48:49], v10 offset:0
    ds_read_b64_tr_b16 a[50:51], v10 offset:512
    ds_read_b64_tr_b16 a[52:53], v10 offset:32
    ds_read_b64_tr_b16 a[54:55], v10 offset:544
    ds_read_b64_tr_b16 a[56:57], v10 offset:64
    ds_read_b64_tr_b16 a[58:59], v10 offset:576
    ds_read_b64_tr_b16 a[60:61], v10 offset:96
    ds_read_b64_tr_b16 a[62:63], v10 offset:608
    s_add_u32 s38, s42, 0x70000
    buffer_load_dwordx4 a[112:115], v5, s[12:15], s38 offen nt
    s_add_u32 s38, s42, 0x74000
    buffer_load_dwordx4 a[116:119], v5, s[12:15], s38 offen nt
    s_add_u32 s38, s42, 0x78000
    buffer_load_dwordx4 a[120:123], v5, s[12:15], s38 offen nt
    s_add_u32 s38, s42, 0x7c000
    buffer_load_dwordx4 a[124:127], v5, s[12:15], s38 offen nt
    s_waitcnt vmcnt(12) lgkmcnt(0)
    ds_write_b128 v9, a[64:67] offset:0
    ds_write_b128 v9, a[68:71] offset:1024
    ds_write_b128 v9, a[72:75] offset:2048
    ds_write_b128 v9, a[76:79] offset:3072
    ds_read_b64_tr_b16 a[64:65], v10 offset:0
    ds_read_b64_tr_b16 a[66:67], v10 offset:512
    ds_read_b64_tr_b16 a[68:69], v10 offset:32
    ds_read_b64_tr_b16 a[70:71], v10 offset:544
    ds_read_b64_tr_b16 a[72:73], v10 offset:64
    ds_read_b64_tr_b16 a[74:75], v10 offset:576
    ds_read_b64_tr_b16 a[76:77], v10 offset:96
    ds_read_b64_tr_b16 a[78:79], v10 offset:608
    s_add_u32 s38, s42, 0x80000
    buffer_load_dwordx4 a[128:131], v5, s[12:15], s38 offen nt
    s_add_u32 s38, s42, 0x84000
    buffer_load_dwordx4 a[132:135], v5, s[12:15], s38 offen nt
    s_add_u32 s38, s42, 0x88000
    buffer_load_dwordx4 a[136:139], v5, s[12:15], s38 offen nt
    s_add_u32 s38, s42, 0x8c000
    buffer_load_dwordx4 a[140:143], v5, s[12:15], s38 offen nt
    s_waitcnt vmcnt(12) lgkmcnt(0)
    ds_write_b128 v9, a[80:83] offset:0
    ds_write_b128 v9, a[84:87] offset:1024
    ds_write_b128 v9, a[88:91] offset:2048
    ds_write_b128 v9, a[92:95] offset:3072
    ds_read_b64_tr_b16 a[80:81], v10 offset:0
    ds_read_b64_tr_b16 a[82:83], v10 offset:512
    ds_read_b64_tr_b16 a[84:85], v10 offset:32
    ds_read_b64_tr_b16 a[86:87], v10 offset:544
    ds_read_b64_tr_b16 a[88:89], v10 offset:64
    ds_read_b64_tr_b16 a[90:91], v10 offset:576
    ds_read_b64_tr_b16 a[92:93], v10 offset:96
    ds_read_b64_tr_b16 a[94:95], v10 offset:608
    s_add_u32 s38, s42, 0x90000
    buffer_load_dwordx4 a[144:147], v5, s[12:15], s38 offen nt
    s_add_u32 s38, s42, 0x94000
    buffer_load_dwordx4 a[148:151], v5, s[12:15], s38 offen nt
    s_add_u32 s38, s42, 0x98000
    buffer_load_dwordx4 a[152:155], v5, s[12:15], s38 offen nt
    s_add_u32 s38, s42, 0x9c000
    buffer_load_dwordx4 a[156:159], v5, s[12:15], s38 offen nt
    s_waitcnt vmcnt(12) lgkmcnt(0)
    ds_write_b128 v9, a[96:99] offset:0
    ds_write_b128 v9, a[100:103] offset:1024
    ds_write_b128 v9, a[104:107] offset:2048
    ds_write_b128 v9, a[108:111] offset:3072
    ds_read_b64_tr_b16 a[96:97], v10 offset:0
    ds_read_b64_tr_b16 a[98:99], v10 offset:512
    ds_read_b64_tr_b16 a[100:101], v10 offset:32
    ds_read_b64_tr_b16 a[102:103], v10 offset:544
    ds_read_b64_tr_b16 a[104:105], v10 offset:64
    ds_read_b64_tr_b16 a[106:107], v10 offset:576
    ds_read_b64_tr_b16 a[108:109], v10 offset:96
    ds_read_b64_tr_b16 a[110:111], v10 offset:608
    s_add_u32 s38, s42, 0xa0000
    buffer_load_dwordx4 a[160:163], v5, s[12:15], s38 offen nt
    s_add_u32 s38, s42, 0xa4000
    buffer_load_dwordx4 a[164:167], v5, s[12:15], s38 offen nt
    s_add_u32 s38, s42, 0xa8000
    buffer_load_dwordx4 a[168:171], v5, s[12:15], s38 offen nt
    s_add_u32 s38, s42, 0xac000
    buffer_load_dwordx4 a[172:175], v5, s[12:15], s38 offen nt
    s_waitcnt vmcnt(12) lgkmcnt(0)
    ds_write_b128 v9, a[112:115] offset:0
    ds_write_b128 v9, a[116:119] offset:1024
    ds_write_b128 v9, a[120:123] offset:2048
    ds_write_b128 v9, a[124:127] offset:3072
    ds_read_b64_tr_b16 a[112:113], v10 offset:0
    ds_read_b64_tr_b16 a[114:115], v10 offset:512
    ds_read_b64_tr_b16 a[116:117], v10 offset:32
    ds_read_b64_tr_b16 a[118:119], v10 offset:544
    ds_read_b64_tr_b16 a[120:121], v10 offset:64
    ds_read_b64_tr_b16 a[122:123], v10 offset:576
    ds_read_b64_tr_b16 a[124:125], v10 offset:96
    ds_read_b64_tr_b16 a[126:127], v10 offset:608
    s_add_u32 s38, s42, 0xb0000
    buffer_load_dwordx4 a[176:179], v5, s[12:15], s38 offen nt
    s_add_u32 s38, s42, 0xb4000
    buffer_load_dwordx4 a[180:183], v5, s[12:15], s38 offen nt
    s_add_u32 s38, s42, 0xb8000
    buffer_load_dwordx4 a[184:187], v5, s[12:15], s38 offen nt
    s_add_u32 s38, s42, 0xbc000
    buffer_load_dwordx4 a[188:191], v5, s[12:15], s38 offen nt
    s_waitcnt vmcnt(12) lgkmcnt(0)
    ds_write_b128 v9, a[128:131] offset:0
    ds_write_b128 v9, a[132:135] offset:1024
    ds_write_b128 v9, a[136:139] offset:2048
    ds_write_b128 v9, a[140:143] offset:3072
    ds_read_b64_tr_b16 a[128:129], v10 offset:0
    ds_read_b64_tr_b16 a[130:131], v10 offset:512
    ds_read_b64_tr_b16 a[132:133], v10 offset:32
    ds_read_b64_tr_b16 a[134:135], v10 offset:544
    ds_read_b64_tr_b16 a[136:137], v10 offset:64
    ds_read_b64_tr_b16 a[138:139], v10 offset:576
    ds_read_b64_tr_b16 a[140:141], v10 offset:96
    ds_read_b64_tr_b16 a[142:143], v10 offset:608
    s_add_u32 s38, s42, 0xc0000
    buffer_load_dwordx4 a[192:195], v5, s[12:15], s38 offen nt
    s_add_u32 s38, s42, 0xc4000
    buffer_load_dwordx4 a[196:199], v5, s[12:15], s38 offen nt
    s_add_u32 s38, s42, 0xc8000
    buffer_load_dwordx4 a[200:203], v5, s[12:15], s38 offen nt
    s_add_u32 s38, s42, 0xcc000
    buffer_load_dwordx4 a[204:207], v5, s[12:15], s38 offen nt
    s_waitcnt vmcnt(12) lgkmcnt(0)
    ds_write_b128 v9, a[144:147] offset:0
    ds_write_b128 v9, a[148:151] offset:1024
    ds_write_b128 v9, a[152:155] offset:2048
    ds_write_b128 v9, a[156:159] offset:3072
    ds_read_b64_tr_b16 a[144:145], v10 offset:0
    ds_read_b64_tr_b16 a[146:147], v10 offset:512
    ds_read_b64_tr_b16 a[148:149], v10 offset:32
    ds_read_b64_tr_b16 a[150:151], v10 offset:544
    ds_read_b64_tr_b16 a[152:153], v10 offset:64
    ds_read_b64_tr_b16 a[154:155], v10 offset:576
    ds_read_b64_tr_b16 a[156:157], v10 offset:96
    ds_read_b64_tr_b16 a[158:159], v10 offset:608
    s_add_u32 s38, s42, 0xd0000
    buffer_load_dwordx4 a[208:211], v5, s[12:15], s38 offen nt
    s_add_u32 s38, s42, 0xd4000
    buffer_load_dwordx4 a[212:215], v5, s[12:15], s38 offen nt
    s_add_u32 s38, s42, 0xd8000
    buffer_load_dwordx4 a[216:219], v5, s[12:15], s38 offen nt
    s_add_u32 s38, s42, 0xdc000
    buffer_load_dwordx4 a[220:223], v5, s[12:15], s38 offen nt
    s_waitcnt vmcnt(12) lgkmcnt(0)
    ds_write_b128 v9, a[160:163] offset:0
    ds_write_b128 v9, a[164:167] offset:1024
    ds_write_b128 v9, a[168:171] offset:2048
    ds_write_b128 v9, a[172:175] offset:3072
    ds_read_b64_tr_b16 a[160:161], v10 offset:0
    ds_read_b64_tr_b16 a[162:163], v10 offset:512
    ds_read_b64_tr_b16 a[164:165], v10 offset:32
    ds_read_b64_tr_b16 a[166:167], v10 offset:544
    ds_read_b64_tr_b16 a[168:169], v10 offset:64
    ds_read_b64_tr_b16 a[170:171], v10 offset:576
    ds_read_b64_tr_b16 a[172:173], v10 offset:96
    ds_read_b64_tr_b16 a[174:175], v10 offset:608
    s_waitcnt vmcnt(8) lgkmcnt(0)
    ds_write_b128 v9, a[176:179] offset:0
    ds_write_b128 v9, a[180:183] offset:1024
    ds_write_b128 v9, a[184:187] offset:2048
    ds_write_b128 v9, a[188:191] offset:3072
    ds_read_b64_tr_b16 a[176:177], v10 offset:0
    ds_read_b64_tr_b16 a[178:179], v10 offset:512
    ds_read_b64_tr_b16 a[180:181], v10 offset:32
    ds_read_b64_tr_b16 a[182:183], v10 offset:544
    ds_read_b64_tr_b16 a[184:185], v10 offset:64
    ds_read_b64_tr_b16 a[186:187], v10 offset:576
    ds_read_b64_tr_b16 a[188:189], v10 offset:96
    ds_read_b64_tr_b16 a[190:191], v10 offset:608
    s_waitcnt vmcnt(4) lgkmcnt(0)
    ds_write_b128 v9, a[192:195] offset:0
    ds_write_b128 v9, a[196:199] offset:1024
    ds_write_b128 v9, a[200:203] offset:2048
    ds_write_b128 v9, a[204:207] offset:3072
    ds_read_b64_tr_b16 a[192:193], v10 offset:0
    ds_read_b64_tr_b16 a[194:195], v10 offset:512
    ds_read_b64_tr_b16 a[196:197], v10 offset:32
    ds_read_b64_tr_b16 a[198:199], v10 offset:544
    ds_read_b64_tr_b16 a[200:201], v10 offset:64
    ds_read_b64_tr_b16 a[202:203], v10 offset:576
    ds_read_b64_tr_b16 a[204:205], v10 offset:96
    ds_read_b64_tr_b16 a[206:207], v10 offset:608
    s_waitcnt vmcnt(0) lgkmcnt(0)
    ds_write_b128 v9, a[208:211] offset:0
    ds_write_b128 v9, a[212:215] offset:1024
    ds_write_b128 v9, a[216:219] offset:2048
    ds_write_b128 v9, a[220:223] offset:3072
    ds_read_b64_tr_b16 a[208:209], v10 offset:0
    ds_read_b64_tr_b16 a[210:211], v10 offset:512
    ds_read_b64_tr_b16 a[212:213], v10 offset:32
    ds_read_b64_tr_b16 a[214:215], v10 offset:544
    ds_read_b64_tr_b16 a[216:217], v10 offset:64
    ds_read_b64_tr_b16 a[218:219], v10 offset:576
    ds_read_b64_tr_b16 a[220:221], v10 offset:96
    ds_read_b64_tr_b16 a[222:223], v10 offset:608
    v_and_b32 v6, 7, v0
    v_mul_u32_u24 v8, 7168, v6
    v_lshrrev_b32 v6, 4, v0
    v_lshl_add_u32 v8, v6, 4, v8
    s_mul_i32 s37, s39, 896
    s_add_u32 s37, s37, 0xe410000
L_pd_38:
    buffer_load_dwordx4 v[52:55], v8, s[4:7], s37 offen offset:0 sc1
    buffer_load_dwordx4 v[56:59], v8, s[4:7], s37 offen offset:64 sc1
    buffer_load_dwordx4 v[60:63], v8, s[4:7], s37 offen offset:128 sc1
    buffer_load_dwordx4 v[64:67], v8, s[4:7], s37 offen offset:192 sc1
    buffer_load_dwordx4 v[68:71], v8, s[4:7], s37 offen offset:256 sc1
    buffer_load_dwordx4 v[72:75], v8, s[4:7], s37 offen offset:320 sc1
    buffer_load_dwordx4 v[76:79], v8, s[4:7], s37 offen offset:384 sc1
    buffer_load_dwordx4 v[80:83], v8, s[4:7], s37 offen offset:448 sc1
    buffer_load_dwordx4 v[84:87], v8, s[4:7], s37 offen offset:512 sc1
    buffer_load_dwordx4 v[88:91], v8, s[4:7], s37 offen offset:576 sc1
    buffer_load_dwordx4 v[92:95], v8, s[4:7], s37 offen offset:640 sc1
    buffer_load_dwordx4 v[96:99], v8, s[4:7], s37 offen offset:704 sc1
    buffer_load_dwordx4 v[100:103], v8, s[4:7], s37 offen offset:768 sc1
    buffer_load_dwordx4 v[104:107], v8, s[4:7], s37 offen offset:832 sc1
    s_waitcnt vmcnt(0)
    v_max_u32 v6, v52, v107
    v_max3_u32 v6, v6, v53, v54
    v_max3_u32 v6, v6, v55, v56
    v_max3_u32 v6, v6, v57, v58
    v_max3_u32 v6, v6, v59, v60
    v_max3_u32 v6, v6, v61, v62
    v_max3_u32 v6, v6, v63, v64
    v_max3_u32 v6, v6, v65, v66
    v_max3_u32 v6, v6, v67, v68
    v_max3_u32 v6, v6, v69, v70
    v_max3_u32 v6, v6, v71, v72
    v_max3_u32 v6, v6, v73, v74
    v_max3_u32 v6, v6, v75, v76
    v_max3_u32 v6, v6, v77, v78
    v_max3_u32 v6, v6, v79, v80
    v_max3_u32 v6, v6, v81, v82
    v_max3_u32 v6, v6, v83, v84
    v_max3_u32 v6, v6, v85, v86
    v_max3_u32 v6, v6, v87, v88
    v_max3_u32 v6, v6, v89, v90
    v_max3_u32 v6, v6, v91, v92
    v_max3_u32 v6, v6, v93, v94
    v_max3_u32 v6, v6, v95, v96
    v_max3_u32 v6, v6, v97, v98
    v_max3_u32 v6, v6, v99, v100
    v_max3_u32 v6, v6, v101, v102
    v_max3_u32 v6, v6, v103, v104
    v_max3_u32 v6, v6, v105, v106
    v_cmp_eq_u32 vcc, -1, v6
    s_cbranch_vccz L_pdok_39
    s_sleep 16
    s_sub_u32 s35, s35, 1
    s_cbranch_scc0 L_pd_38
    s_endpgm
L_pdok_39:
    s_waitcnt lgkmcnt(0)
    v_mfma_f32_16x16x32_bf16 v[20:23], a[0:3], v[52:55], 0
    v_mfma_f32_16x16x32_bf16 v[24:27], a[4:7], v[52:55], 0
    v_mfma_f32_16x16x32_bf16 v[28:31], a[8:11], v[52:55], 0
    v_mfma_f32_16x16x32_bf16 v[32:35], a[12:15], v[52:55], 0
    v_mfma_f32_16x16x32_bf16 v[20:23], a[16:19], v[56:59], v[20:23]
    v_mfma_f32_16x16x32_bf16 v[24:27], a[20:23], v[56:59], v[24:27]
    v_mfma_f32_16x16x32_bf16 v[28:31], a[24:27], v[56:59], v[28:31]
    v_mfma_f32_16x16x32_bf16 v[32:35], a[28:31], v[56:59], v[32:35]
    v_mfma_f32_16x16x32_bf16 v[20:23], a[32:35], v[60:63], v[20:23]
    v_mfma_f32_16x16x32_bf16 v[24:27], a[36:39], v[60:63], v[24:27]
    v_mfma_f32_16x16x32_bf16 v[28:31], a[40:43], v[60:63], v[28:31]
    v_mfma_f32_16x16x32_bf16 v[32:35], a[44:47], v[60:63], v[32:35]
    v_mfma_f32_16x16x32_bf16 v[20:23], a[48:51], v[64:67], v[20:23]
    v_mfma_f32_16x16x32_bf16 v[24:27], a[52:55], v[64:67], v[24:27]
    v_mfma_f32_16x16x32_bf16 v[28:31], a[56:59], v[64:67], v[28:31]
    v_mfma_f32_16x16x32_bf16 v[32:35], a[60:63], v[64:67], v[32:35]
    v_mfma_f32_16x16x32_bf16 v[20:23], a[64:67], v[68:71], v[20:23]
    v_mfma_f32_16x16x32_bf16 v[24:27], a[68:71], v[68:71], v[24:27]
    v_mfma_f32_16x16x32_bf16 v[28:31], a[72:75], v[68:71], v[28:31]
    v_mfma_f32_16x16x32_bf16 v[32:35], a[76:79], v[68:71], v[32:35]
    v_mfma_f32_16x16x32_bf16 v[20:23], a[80:83], v[72:75], v[20:23]
    v_mfma_f32_16x16x32_bf16 v[24:27], a[84:87], v[72:75], v[24:27]
    v_mfma_f32_16x16x32_bf16 v[28:31], a[88:91], v[72:75], v[28:31]
    v_mfma_f32_16x16x32_bf16 v[32:35], a[92:95], v[72:75], v[32:35]
    v_mfma_f32_16x16x32_bf16 v[20:23], a[96:99], v[76:79], v[20:23]
    v_mfma_f32_16x16x32_bf16 v[24:27], a[100:103], v[76:79], v[24:27]
    v_mfma_f32_16x16x32_bf16 v[28:31], a[104:107], v[76:79], v[28:31]
    v_mfma_f32_16x16x32_bf16 v[32:35], a[108:111], v[76:79], v[32:35]
    v_mfma_f32_16x16x32_bf16 v[20:23], a[112:115], v[80:83], v[20:23]
    v_mfma_f32_16x16x32_bf16 v[24:27], a[116:119], v[80:83], v[24:27]
    v_mfma_f32_16x16x32_bf16 v[28:31], a[120:123], v[80:83], v[28:31]
    v_mfma_f32_16x16x32_bf16 v[32:35], a[124:127], v[80:83], v[32:35]
    v_mfma_f32_16x16x32_bf16 v[20:23], a[128:131], v[84:87], v[20:23]
    v_mfma_f32_16x16x32_bf16 v[24:27], a[132:135], v[84:87], v[24:27]
    v_mfma_f32_16x16x32_bf16 v[28:31], a[136:139], v[84:87], v[28:31]
    v_mfma_f32_16x16x32_bf16 v[32:35], a[140:143], v[84:87], v[32:35]
    v_mfma_f32_16x16x32_bf16 v[20:23], a[144:147], v[88:91], v[20:23]
    v_mfma_f32_16x16x32_bf16 v[24:27], a[148:151], v[88:91], v[24:27]
    v_mfma_f32_16x16x32_bf16 v[28:31], a[152:155], v[88:91], v[28:31]
    v_mfma_f32_16x16x32_bf16 v[32:35], a[156:159], v[88:91], v[32:35]
    v_mfma_f32_16x16x32_bf16 v[20:23], a[160:163], v[92:95], v[20:23]
    v_mfma_f32_16x16x32_bf16 v[24:27], a[164:167], v[92:95], v[24:27]
    v_mfma_f32_16x16x32_bf16 v[28:31], a[168:171], v[92:95], v[28:31]
    v_mfma_f32_16x16x32_bf16 v[32:35], a[172:175], v[92:95], v[32:35]
    v_mfma_f32_16x16x32_bf16 v[20:23], a[176:179], v[96:99], v[20:23]
    v_mfma_f32_16x16x32_bf16 v[24:27], a[180:183], v[96:99], v[24:27]
    v_mfma_f32_16x16x32_bf16 v[28:31], a[184:187], v[96:99], v[28:31]
    v_mfma_f32_16x16x32_bf16 v[32:35], a[188:191], v[96:99], v[32:35]
    v_mfma_f32_16x16x32_bf16 v[20:23], a[192:195], v[100:103], v[20:23]
    v_mfma_f32_16x16x32_bf16 v[24:27], a[196:199], v[100:103], v[24:27]
    v_mfma_f32_16x16x32_bf16 v[28:31], a[200:203], v[100:103], v[28:31]
    v_mfma_f32_16x16x32_bf16 v[32:35], a[204:207], v[100:103], v[32:35]
    v_mfma_f32_16x16x32_bf16 v[20:23], a[208:211], v[104:107], v[20:23]
    v_mfma_f32_16x16x32_bf16 v[24:27], a[212:215], v[104:107], v[24:27]
    v_mfma_f32_16x16x32_bf16 v[28:31], a[216:219], v[104:107], v[28:31]
    v_mfma_f32_16x16x32_bf16 v[32:35], a[220:223], v[104:107], v[32:35]
    ds_write_b128 v9, v[20:23] offset:0
    ds_write_b128 v9, v[24:27] offset:1024
    ds_write_b128 v9, v[28:31] offset:2048
    ds_write_b128 v9, v[32:35] offset:3072
    s_lshl_b32 s37, s32, 6
    s_add_u32 s37, s37, 65536
    v_bfe_u32 v6, v0, 0, 4
    v_lshlrev_b32 v10, 8, v6
    v_bfe_u32 v6, v0, 4, 2
    v_lshl_add_u32 v10, v6, 4, v10
    v_add_u32 v10, s37, v10
    s_waitcnt lgkmcnt(0)
    s_barrier
    ds_read_b128 v[36:39], v10 offset:0
    ds_read_b128 v[40:43], v10 offset:4096
    ds_read_b128 v[44:47], v10 offset:8192
    ds_read_b128 v[48:51], v10 offset:12288
    s_waitcnt lgkmcnt(0)
    v_pk_add_f32 v[36:37], v[36:37], v[40:41]
    v_pk_add_f32 v[38:39], v[38:39], v[42:43]
    v_pk_add_f32 v[36:37], v[36:37], v[44:45]
    v_pk_add_f32 v[38:39], v[38:39], v[46:47]
    v_pk_add_f32 v[36:37], v[36:37], v[48:49]
    v_pk_add_f32 v[38:39], v[38:39], v[50:51]
    v_min_u32 v36, -2, v36
    v_min_u32 v37, -2, v37
    v_min_u32 v38, -2, v38
    v_min_u32 v39, -2, v39
    s_cmp_ge_u32 s32, 2
    s_cbranch_scc1 L_o_join
    s_lshl_b32 s37, s40, 1
    s_add_u32 s37, s37, s32
    s_lshl_b32 s37, s37, 10
    s_add_u32 s37, s37, 0xe420000
    buffer_store_dwordx4 v[36:39], v1, s[4:7], s37 offen sc1
    s_lshl_b32 s37, s36, 8
    s_add_u32 s37, s37, 0xe400000
    buffer_store_dword v4, v2, s[4:7], s37 offen sc1
L_o_join2:
L_o_join:
    s_mov_b32 s20, s74
    s_and_b32 s21, s75, 0xffff
    s_mov_b32 s22, 0x800000
    s_mov_b32 s23, 0x20000
    s_and_b32 s37, s36, 7
    s_lshl_b32 s38, s32, 3
    s_add_u32 s37, s37, s38
    s_lshl_b32 s37, s37, 18
    s_and_b32 s38, s36, 8
    s_lshl_b32 s38, s38, 7
    s_add_u32 s37, s37, s38
    s_add_u32 s38, s37, 0x20000
    v_lshlrev_b32 v10, 11, v0
    buffer_load_dword v255, v10, s[20:23], s37 offen offset:384
    buffer_load_dword v255, v10, s[20:23], s38 offen offset:384
    s_mov_b32 s12, s74
    s_and_b32 s13, s75, 0xffff
    s_mov_b32 s14, 0x800000
    s_mov_b32 s15, 0x20000
    s_mov_b32 s16, s64
    s_and_b32 s17, s65, 0xffff
    s_mov_b32 s18, 0x400000
    s_mov_b32 s19, 0x20000
    s_mov_b32 s20, s90
    s_and_b32 s21, s91, 0xffff
    s_mov_b32 s22, 0x400000
    s_mov_b32 s23, 0x20000
    s_mov_b32 s44, 0xffff0000
    v_lshlrev_b32 v1, 4, v0
    s_add_u32 s45, s34, 1
    s_and_b32 s45, s45, 3
    s_lshl_b32 s45, s45, 1
    s_lshr_b32 s37, s36, 4
    s_add_u32 s45, s45, s37
    s_and_b32 s36, s36, 15
    s_and_b32 s43, s36, 7
    s_barrier
    s_add_u32 s37, s43, 0
    s_and_b32 s37, s37, 7
    s_lshl_b32 s38, s32, 3
    s_add_u32 s37, s37, s38
    s_lshl_b32 s37, s37, 18
    s_lshl_b32 s38, s36, 7
    s_add_u32 s48, s37, s38
    s_add_u32 s37, s43, 1
    s_and_b32 s37, s37, 7
    s_lshl_b32 s38, s32, 3
    s_add_u32 s37, s37, s38
    s_lshl_b32 s37, s37, 18
    s_lshl_b32 s38, s36, 7
    s_add_u32 s49, s37, s38
    s_add_u32 s37, s43, 2
    s_and_b32 s37, s37, 7
    s_lshl_b32 s38, s32, 3
    s_add_u32 s37, s37, s38
    s_lshl_b32 s37, s37, 18
    s_lshl_b32 s38, s36, 7
    s_add_u32 s50, s37, s38
    s_add_u32 s37, s43, 3
    s_and_b32 s37, s37, 7
    s_lshl_b32 s38, s32, 3
    s_add_u32 s37, s37, s38
    s_lshl_b32 s37, s37, 18
    s_lshl_b32 s38, s36, 7
    s_add_u32 s51, s37, s38
    s_add_u32 s37, s43, 4
    s_and_b32 s37, s37, 7
    s_lshl_b32 s38, s32, 3
    s_add_u32 s37, s37, s38
    s_lshl_b32 s37, s37, 18
    s_lshl_b32 s38, s36, 7
    s_add_u32 s52, s37, s38
    s_add_u32 s37, s43, 5
    s_and_b32 s37, s37, 7
    s_lshl_b32 s38, s32, 3
    s_add_u32 s37, s37, s38
    s_lshl_b32 s37, s37, 18
    s_lshl_b32 s38, s36, 7
    s_add_u32 s53, s37, s38
    s_add_u32 s37, s43, 6
    s_and_b32 s37, s37, 7
    s_lshl_b32 s38, s32, 3
    s_add_u32 s37, s37, s38
    s_lshl_b32 s37, s37, 18
    s_lshl_b32 s38, s36, 7
    s_add_u32 s54, s37, s38
    s_add_u32 s37, s43, 7
    s_and_b32 s37, s37, 7
    s_lshl_b32 s38, s32, 3
    s_add_u32 s37, s37, s38
    s_lshl_b32 s37, s37, 18
    s_lshl_b32 s38, s36, 7
    s_add_u32 s55, s37, s38
    v_bfe_u32 v10, v0, 3, 3
    v_lshlrev_b32 v2, 11, v10
    v_bfe_u32 v10, v0, 0, 3
    v_lshl_add_u32 v2, v10, 4, v2
    s_lshl_b32 s37, s32, 13
    s_add_u32 s37, s37, 131072
    v_add_u32 v5, s37, v1
    v_bfe_u32 v10, v0, 2, 1
    v_lshlrev_b32 v3, 11, v10
    v_bfe_u32 v10, v0, 4, 2
    v_lshl_add_u32 v3, v10, 9, v3
    v_bfe_u32 v10, v0, 3, 1
    v_lshl_add_u32 v3, v10, 7, v3
    v_bfe_u32 v10, v0, 0, 2
    v_lshl_add_u32 v3, v10, 3, v3
    v_add_u32 v3, s37, v3
    s_lshl_b32 s37, s32, 15
    v_add_u32 v8, s37, v1
    s_add_u32 s38, s48, 0x0
    buffer_load_dwordx4 a[0:3], v2, s[12:15], s38 offen nt
    s_add_u32 s38, s48, 0x4000
    buffer_load_dwordx4 a[4:7], v2, s[12:15], s38 offen nt
    s_add_u32 s38, s48, 0x8000
    buffer_load_dwordx4 v[124:127], v2, s[12:15], s38 offen nt
    s_add_u32 s38, s48, 0xc000
    buffer_load_dwordx4 v[60:63], v2, s[12:15], s38 offen nt
    s_add_u32 s38, s48, 0x10000
    buffer_load_dwordx4 a[8:11], v2, s[12:15], s38 offen nt
    s_add_u32 s38, s48, 0x14000
    buffer_load_dwordx4 a[12:15], v2, s[12:15], s38 offen nt
    s_add_u32 s38, s48, 0x18000
    buffer_load_dwordx4 v[128:131], v2, s[12:15], s38 offen nt
    s_add_u32 s38, s48, 0x1c000
    buffer_load_dwordx4 v[64:67], v2, s[12:15], s38 offen nt
    s_add_u32 s38, s48, 0x20000
    buffer_load_dwordx4 a[16:19], v2, s[12:15], s38 offen nt
    s_add_u32 s38, s48, 0x24000
    buffer_load_dwordx4 a[20:23], v2, s[12:15], s38 offen nt
    s_add_u32 s38, s48, 0x28000
    buffer_load_dwordx4 v[132:135], v2, s[12:15], s38 offen nt
    s_add_u32 s38, s48, 0x2c000
    buffer_load_dwordx4 v[68:71], v2, s[12:15], s38 offen nt
    s_add_u32 s38, s48, 0x30000
    buffer_load_dwordx4 a[24:27], v2, s[12:15], s38 offen nt
    s_add_u32 s38, s48, 0x34000
    buffer_load_dwordx4 a[28:31], v2, s[12:15], s38 offen nt
    s_add_u32 s38, s48, 0x38000
    buffer_load_dwordx4 v[136:139], v2, s[12:15], s38 offen nt
    s_add_u32 s38, s48, 0x3c000
    buffer_load_dwordx4 v[72:75], v2, s[12:15], s38 offen nt
    s_waitcnt vmcnt(12)
    ds_write_b128 v5, a[0:3] offset:0
    ds_write_b128 v5, a[4:7] offset:1024
    ds_write_b128 v5, v[124:127] offset:2048
    ds_write_b128 v5, v[60:63] offset:3072
    s_add_u32 s38, s49, 0x0
    buffer_load_dwordx4 a[32:35], v2, s[12:15], s38 offen nt
    s_add_u32 s38, s49, 0x4000
    buffer_load_dwordx4 a[36:39], v2, s[12:15], s38 offen nt
    s_add_u32 s38, s49, 0x8000
    buffer_load_dwordx4 v[140:143], v2, s[12:15], s38 offen nt
    s_add_u32 s38, s49, 0xc000
    buffer_load_dwordx4 v[76:79], v2, s[12:15], s38 offen nt
    ds_read_b64_tr_b16 a[0:1], v3 offset:0
    ds_read_b64_tr_b16 a[2:3], v3 offset:256
    ds_read_b64_tr_b16 a[4:5], v3 offset:32
    ds_read_b64_tr_b16 a[6:7], v3 offset:288
    ds_read_b64_tr_b16 v[124:125], v3 offset:64
    ds_read_b64_tr_b16 v[126:127], v3 offset:320
    ds_read_b64_tr_b16 v[32:33], v3 offset:96
    ds_read_b64_tr_b16 v[34:35], v3 offset:352
    s_waitcnt vmcnt(12)
    ds_write_b128 v5, a[8:11] offset:4096
    ds_write_b128 v5, a[12:15] offset:5120
    ds_write_b128 v5, v[128:131] offset:6144
    ds_write_b128 v5, v[64:67] offset:7168
    s_add_u32 s38, s49, 0x10000
    buffer_load_dwordx4 a[40:43], v2, s[12:15], s38 offen nt
    s_add_u32 s38, s49, 0x14000
    buffer_load_dwordx4 a[44:47], v2, s[12:15], s38 offen nt
    s_add_u32 s38, s49, 0x18000
    buffer_load_dwordx4 v[144:147], v2, s[12:15], s38 offen nt
    s_add_u32 s38, s49, 0x1c000
    buffer_load_dwordx4 v[80:83], v2, s[12:15], s38 offen nt
    s_waitcnt lgkmcnt(4)
    ds_write_b128 v8, v[32:35] offset:0
    ds_read_b64_tr_b16 a[8:9], v3 offset:4096
    ds_read_b64_tr_b16 a[10:11], v3 offset:4352
    ds_read_b64_tr_b16 a[12:13], v3 offset:4128
    ds_read_b64_tr_b16 a[14:15], v3 offset:4384
    ds_read_b64_tr_b16 v[128:129], v3 offset:4160
    ds_read_b64_tr_b16 v[130:131], v3 offset:4416
    ds_read_b64_tr_b16 v[36:37], v3 offset:4192
    ds_read_b64_tr_b16 v[38:39], v3 offset:4448
    s_waitcnt vmcnt(12)
    ds_write_b128 v5, a[16:19] offset:0
    ds_write_b128 v5, a[20:23] offset:1024
    ds_write_b128 v5, v[132:135] offset:2048
    ds_write_b128 v5, v[68:71] offset:3072
    s_add_u32 s38, s49, 0x20000
    buffer_load_dwordx4 a[48:51], v2, s[12:15], s38 offen nt
    s_add_u32 s38, s49, 0x24000
    buffer_load_dwordx4 a[52:55], v2, s[12:15], s38 offen nt
    s_add_u32 s38, s49, 0x28000
    buffer_load_dwordx4 v[148:151], v2, s[12:15], s38 offen nt
    s_add_u32 s38, s49, 0x2c000
    buffer_load_dwordx4 v[84:87], v2, s[12:15], s38 offen nt
    s_waitcnt lgkmcnt(4)
    ds_write_b128 v8, v[36:39] offset:1024
    ds_read_b64_tr_b16 a[16:17], v3 offset:0
    ds_read_b64_tr_b16 a[18:19], v3 offset:256
    ds_read_b64_tr_b16 a[20:21], v3 offset:32
    ds_read_b64_tr_b16 a[22:23], v3 offset:288
    ds_read_b64_tr_b16 v[132:133], v3 offset:64
    ds_read_b64_tr_b16 v[134:135], v3 offset:320
    ds_read_b64_tr_b16 v[32:33], v3 offset:96
    ds_read_b64_tr_b16 v[34:35], v3 offset:352
    s_waitcnt vmcnt(12)
    ds_write_b128 v5, a[24:27] offset:4096
    ds_write_b128 v5, a[28:31] offset:5120
    ds_write_b128 v5, v[136:139] offset:6144
    ds_write_b128 v5, v[72:75] offset:7168
    s_add_u32 s38, s49, 0x30000
    buffer_load_dwordx4 a[56:59], v2, s[12:15], s38 offen nt
    s_add_u32 s38, s49, 0x34000
    buffer_load_dwordx4 a[60:63], v2, s[12:15], s38 offen nt
    s_add_u32 s38, s49, 0x38000
    buffer_load_dwordx4 v[152:155], v2, s[12:15], s38 offen nt
    s_add_u32 s38, s49, 0x3c000
    buffer_load_dwordx4 v[88:91], v2, s[12:15], s38 offen nt
    s_waitcnt lgkmcnt(4)
    ds_write_b128 v8, v[32:35] offset:2048
    ds_read_b64_tr_b16 a[24:25], v3 offset:4096
    ds_read_b64_tr_b16 a[26:27], v3 offset:4352
    ds_read_b64_tr_b16 a[28:29], v3 offset:4128
    ds_read_b64_tr_b16 a[30:31], v3 offset:4384
    ds_read_b64_tr_b16 v[136:137], v3 offset:4160
    ds_read_b64_tr_b16 v[138:139], v3 offset:4416
    ds_read_b64_tr_b16 v[36:37], v3 offset:4192
    ds_read_b64_tr_b16 v[38:39], v3 offset:4448
    s_waitcnt vmcnt(12)
    ds_write_b128 v5, a[32:35] offset:0
    ds_write_b128 v5, a[36:39] offset:1024
    ds_write_b128 v5, v[140:143] offset:2048
    ds_write_b128 v5, v[76:79] offset:3072
    s_add_u32 s38, s50, 0x0
    buffer_load_dwordx4 a[64:67], v2, s[12:15], s38 offen nt
    s_add_u32 s38, s50, 0x4000
    buffer_load_dwordx4 a[68:71], v2, s[12:15], s38 offen nt
    s_add_u32 s38, s50, 0x8000
    buffer_load_dwordx4 v[156:159], v2, s[12:15], s38 offen nt
    s_add_u32 s38, s50, 0xc000
    buffer_load_dwordx4 v[92:95], v2, s[12:15], s38 offen nt
    s_waitcnt lgkmcnt(4)
    ds_write_b128 v8, v[36:39] offset:3072
    ds_read_b64_tr_b16 a[32:33], v3 offset:0
    ds_read_b64_tr_b16 a[34:35], v3 offset:256
    ds_read_b64_tr_b16 a[36:37], v3 offset:32
    ds_read_b64_tr_b16 a[38:39], v3 offset:288
    ds_read_b64_tr_b16 v[140:141], v3 offset:64
    ds_read_b64_tr_b16 v[142:143], v3 offset:320
    ds_read_b64_tr_b16 v[32:33], v3 offset:96
    ds_read_b64_tr_b16 v[34:35], v3 offset:352
    s_waitcnt vmcnt(12)
    ds_write_b128 v5, a[40:43] offset:4096
    ds_write_b128 v5, a[44:47] offset:5120
    ds_write_b128 v5, v[144:147] offset:6144
    ds_write_b128 v5, v[80:83] offset:7168
    s_add_u32 s38, s50, 0x10000
    buffer_load_dwordx4 a[72:75], v2, s[12:15], s38 offen nt
    s_add_u32 s38, s50, 0x14000
    buffer_load_dwordx4 a[76:79], v2, s[12:15], s38 offen nt
    s_add_u32 s38, s50, 0x18000
    buffer_load_dwordx4 v[160:163], v2, s[12:15], s38 offen nt
    s_add_u32 s38, s50, 0x1c000
    buffer_load_dwordx4 v[96:99], v2, s[12:15], s38 offen nt
    s_waitcnt lgkmcnt(4)
    ds_write_b128 v8, v[32:35] offset:4096
    ds_read_b64_tr_b16 a[40:41], v3 offset:4096
    ds_read_b64_tr_b16 a[42:43], v3 offset:4352
    ds_read_b64_tr_b16 a[44:45], v3 offset:4128
    ds_read_b64_tr_b16 a[46:47], v3 offset:4384
    ds_read_b64_tr_b16 v[144:145], v3 offset:4160
    ds_read_b64_tr_b16 v[146:147], v3 offset:4416
    ds_read_b64_tr_b16 v[36:37], v3 offset:4192
    ds_read_b64_tr_b16 v[38:39], v3 offset:4448
    s_waitcnt vmcnt(12)
    ds_write_b128 v5, a[48:51] offset:0
    ds_write_b128 v5, a[52:55] offset:1024
    ds_write_b128 v5, v[148:151] offset:2048
    ds_write_b128 v5, v[84:87] offset:3072
    s_add_u32 s38, s50, 0x20000
    buffer_load_dwordx4 a[80:83], v2, s[12:15], s38 offen nt
    s_add_u32 s38, s50, 0x24000
    buffer_load_dwordx4 a[84:87], v2, s[12:15], s38 offen nt
    s_add_u32 s38, s50, 0x28000
    buffer_load_dwordx4 v[164:167], v2, s[12:15], s38 offen nt
    s_add_u32 s38, s50, 0x2c000
    buffer_load_dwordx4 v[100:103], v2, s[12:15], s38 offen nt
    s_waitcnt lgkmcnt(4)
    ds_write_b128 v8, v[36:39] offset:5120
    ds_read_b64_tr_b16 a[48:49], v3 offset:0
    ds_read_b64_tr_b16 a[50:51], v3 offset:256
    ds_read_b64_tr_b16 a[52:53], v3 offset:32
    ds_read_b64_tr_b16 a[54:55], v3 offset:288
    ds_read_b64_tr_b16 v[148:149], v3 offset:64
    ds_read_b64_tr_b16 v[150:151], v3 offset:320
    ds_read_b64_tr_b16 v[32:33], v3 offset:96
    ds_read_b64_tr_b16 v[34:35], v3 offset:352
    s_waitcnt vmcnt(12)
    ds_write_b128 v5, a[56:59] offset:4096
    ds_write_b128 v5, a[60:63] offset:5120
    ds_write_b128 v5, v[152:155] offset:6144
    ds_write_b128 v5, v[88:91] offset:7168
    s_add_u32 s38, s50, 0x30000
    buffer_load_dwordx4 a[88:91], v2, s[12:15], s38 offen nt
    s_add_u32 s38, s50, 0x34000
    buffer_load_dwordx4 a[92:95], v2, s[12:15], s38 offen nt
    s_add_u32 s38, s50, 0x38000
    buffer_load_dwordx4 v[168:171], v2, s[12:15], s38 offen nt
    s_add_u32 s38, s50, 0x3c000
    buffer_load_dwordx4 v[104:107], v2, s[12:15], s38 offen nt
    s_waitcnt lgkmcnt(4)
    ds_write_b128 v8, v[32:35] offset:6144
    ds_read_b64_tr_b16 a[56:57], v3 offset:4096
    ds_read_b64_tr_b16 a[58:59], v3 offset:4352
    ds_read_b64_tr_b16 a[60:61], v3 offset:4128
    ds_read_b64_tr_b16 a[62:63], v3 offset:4384
    ds_read_b64_tr_b16 v[152:153], v3 offset:4160
    ds_read_b64_tr_b16 v[154:155], v3 offset:4416
    ds_read_b64_tr_b16 v[36:37], v3 offset:4192
    ds_read_b64_tr_b16 v[38:39], v3 offset:4448
    s_waitcnt vmcnt(12)
    ds_write_b128 v5, a[64:67] offset:0
    ds_write_b128 v5, a[68:71] offset:1024
    ds_write_b128 v5, v[156:159] offset:2048
    ds_write_b128 v5, v[92:95] offset:3072
    s_add_u32 s38, s51, 0x0
    buffer_load_dwordx4 a[96:99], v2, s[12:15], s38 offen nt
    s_add_u32 s38, s51, 0x4000
    buffer_load_dwordx4 a[100:103], v2, s[12:15], s38 offen nt
    s_add_u32 s38, s51, 0x8000
    buffer_load_dwordx4 v[172:175], v2, s[12:15], s38 offen nt
    s_add_u32 s38, s51, 0xc000
    buffer_load_dwordx4 v[108:111], v2, s[12:15], s38 offen nt
    s_waitcnt lgkmcnt(4)
    ds_write_b128 v8, v[36:39] offset:7168
    ds_read_b64_tr_b16 a[64:65], v3 offset:0
    ds_read_b64_tr_b16 a[66:67], v3 offset:256
    ds_read_b64_tr_b16 a[68:69], v3 offset:32
    ds_read_b64_tr_b16 a[70:71], v3 offset:288
    ds_read_b64_tr_b16 v[156:157], v3 offset:64
    ds_read_b64_tr_b16 v[158:159], v3 offset:320
    ds_read_b64_tr_b16 v[32:33], v3 offset:96
    ds_read_b64_tr_b16 v[34:35], v3 offset:352
    s_waitcnt vmcnt(12)
    ds_write_b128 v5, a[72:75] offset:4096
    ds_write_b128 v5, a[76:79] offset:5120
    ds_write_b128 v5, v[160:163] offset:6144
    ds_write_b128 v5, v[96:99] offset:7168
    s_add_u32 s38, s51, 0x10000
    buffer_load_dwordx4 a[104:107], v2, s[12:15], s38 offen nt
    s_add_u32 s38, s51, 0x14000
    buffer_load_dwordx4 a[108:111], v2, s[12:15], s38 offen nt
    s_add_u32 s38, s51, 0x18000
    buffer_load_dwordx4 v[176:179], v2, s[12:15], s38 offen nt
    s_add_u32 s38, s51, 0x1c000
    buffer_load_dwordx4 v[112:115], v2, s[12:15], s38 offen nt
    s_waitcnt lgkmcnt(4)
    ds_write_b128 v8, v[32:35] offset:8192
    ds_read_b64_tr_b16 a[72:73], v3 offset:4096
    ds_read_b64_tr_b16 a[74:75], v3 offset:4352
    ds_read_b64_tr_b16 a[76:77], v3 offset:4128
    ds_read_b64_tr_b16 a[78:79], v3 offset:4384
    ds_read_b64_tr_b16 v[160:161], v3 offset:4160
    ds_read_b64_tr_b16 v[162:163], v3 offset:4416
    ds_read_b64_tr_b16 v[36:37], v3 offset:4192
    ds_read_b64_tr_b16 v[38:39], v3 offset:4448
    s_waitcnt vmcnt(12)
    ds_write_b128 v5, a[80:83] offset:0
    ds_write_b128 v5, a[84:87] offset:1024
    ds_write_b128 v5, v[164:167] offset:2048
    ds_write_b128 v5, v[100:103] offset:3072
    s_add_u32 s38, s51, 0x20000
    buffer_load_dwordx4 a[112:115], v2, s[12:15], s38 offen nt
    s_add_u32 s38, s51, 0x24000
    buffer_load_dwordx4 a[116:119], v2, s[12:15], s38 offen nt
    s_add_u32 s38, s51, 0x28000
    buffer_load_dwordx4 v[180:183], v2, s[12:15], s38 offen nt
    s_add_u32 s38, s51, 0x2c000
    buffer_load_dwordx4 v[116:119], v2, s[12:15], s38 offen nt
    s_waitcnt lgkmcnt(4)
    ds_write_b128 v8, v[36:39] offset:9216
    ds_read_b64_tr_b16 a[80:81], v3 offset:0
    ds_read_b64_tr_b16 a[82:83], v3 offset:256
    ds_read_b64_tr_b16 a[84:85], v3 offset:32
    ds_read_b64_tr_b16 a[86:87], v3 offset:288
    ds_read_b64_tr_b16 v[164:165], v3 offset:64
    ds_read_b64_tr_b16 v[166:167], v3 offset:320
    ds_read_b64_tr_b16 v[32:33], v3 offset:96
    ds_read_b64_tr_b16 v[34:35], v3 offset:352
    s_waitcnt vmcnt(12)
    ds_write_b128 v5, a[88:91] offset:4096
    ds_write_b128 v5, a[92:95] offset:5120
    ds_write_b128 v5, v[168:171] offset:6144
    ds_write_b128 v5, v[104:107] offset:7168
    s_add_u32 s38, s51, 0x30000
    buffer_load_dwordx4 a[120:123], v2, s[12:15], s38 offen nt
    s_add_u32 s38, s51, 0x34000
    buffer_load_dwordx4 a[124:127], v2, s[12:15], s38 offen nt
    s_add_u32 s38, s51, 0x38000
    buffer_load_dwordx4 v[184:187], v2, s[12:15], s38 offen nt
    s_add_u32 s38, s51, 0x3c000
    buffer_load_dwordx4 v[120:123], v2, s[12:15], s38 offen nt
    s_waitcnt lgkmcnt(4)
    ds_write_b128 v8, v[32:35] offset:10240
    ds_read_b64_tr_b16 a[88:89], v3 offset:4096
    ds_read_b64_tr_b16 a[90:91], v3 offset:4352
    ds_read_b64_tr_b16 a[92:93], v3 offset:4128
    ds_read_b64_tr_b16 a[94:95], v3 offset:4384
    ds_read_b64_tr_b16 v[168:169], v3 offset:4160
    ds_read_b64_tr_b16 v[170:171], v3 offset:4416
    ds_read_b64_tr_b16 v[36:37], v3 offset:4192
    ds_read_b64_tr_b16 v[38:39], v3 offset:4448
    s_waitcnt vmcnt(12)
    ds_write_b128 v5, a[96:99] offset:0
    ds_write_b128 v5, a[100:103] offset:1024
    ds_write_b128 v5, v[172:175] offset:2048
    ds_write_b128 v5, v[108:111] offset:3072
    s_add_u32 s38, s52, 0x0
    buffer_load_dwordx4 a[128:131], v2, s[12:15], s38 offen nt
    s_add_u32 s38, s52, 0x4000
    buffer_load_dwordx4 a[132:135], v2, s[12:15], s38 offen nt
    s_add_u32 s38, s52, 0x8000
    buffer_load_dwordx4 v[188:191], v2, s[12:15], s38 offen nt
    s_add_u32 s38, s52, 0xc000
    buffer_load_dwordx4 v[60:63], v2, s[12:15], s38 offen nt
    s_waitcnt lgkmcnt(4)
    ds_write_b128 v8, v[36:39] offset:11264
    ds_read_b64_tr_b16 a[96:97], v3 offset:0
    ds_read_b64_tr_b16 a[98:99], v3 offset:256
    ds_read_b64_tr_b16 a[100:101], v3 offset:32
    ds_read_b64_tr_b16 a[102:103], v3 offset:288
    ds_read_b64_tr_b16 v[172:173], v3 offset:64
    ds_read_b64_tr_b16 v[174:175], v3 offset:320
    ds_read_b64_tr_b16 v[32:33], v3 offset:96
    ds_read_b64_tr_b16 v[34:35], v3 offset:352
    s_waitcnt vmcnt(12)
    ds_write_b128 v5, a[104:107] offset:4096
    ds_write_b128 v5, a[108:111] offset:5120
    ds_write_b128 v5, v[176:179] offset:6144
    ds_write_b128 v5, v[112:115] offset:7168
    s_add_u32 s38, s52, 0x10000
    buffer_load_dwordx4 a[136:139], v2, s[12:15], s38 offen nt
    s_add_u32 s38, s52, 0x14000
    buffer_load_dwordx4 a[140:143], v2, s[12:15], s38 offen nt
    s_add_u32 s38, s52, 0x18000
    buffer_load_dwordx4 v[192:195], v2, s[12:15], s38 offen nt
    s_add_u32 s38, s52, 0x1c000
    buffer_load_dwordx4 v[64:67], v2, s[12:15], s38 offen nt
    s_waitcnt lgkmcnt(4)
    ds_write_b128 v8, v[32:35] offset:12288
    ds_read_b64_tr_b16 a[104:105], v3 offset:4096
    ds_read_b64_tr_b16 a[106:107], v3 offset:4352
    ds_read_b64_tr_b16 a[108:109], v3 offset:4128
    ds_read_b64_tr_b16 a[110:111], v3 offset:4384
    ds_read_b64_tr_b16 v[176:177], v3 offset:4160
    ds_read_b64_tr_b16 v[178:179], v3 offset:4416
    ds_read_b64_tr_b16 v[36:37], v3 offset:4192
    ds_read_b64_tr_b16 v[38:39], v3 offset:4448
    s_waitcnt vmcnt(12)
    ds_write_b128 v5, a[112:115] offset:0
    ds_write_b128 v5, a[116:119] offset:1024
    ds_write_b128 v5, v[180:183] offset:2048
    ds_write_b128 v5, v[116:119] offset:3072
    s_add_u32 s38, s52, 0x20000
    buffer_load_dwordx4 a[144:147], v2, s[12:15], s38 offen nt
    s_add_u32 s38, s52, 0x24000
    buffer_load_dwordx4 a[148:151], v2, s[12:15], s38 offen nt
    s_add_u32 s38, s52, 0x28000
    buffer_load_dwordx4 v[196:199], v2, s[12:15], s38 offen nt
    s_add_u32 s38, s52, 0x2c000
    buffer_load_dwordx4 v[68:71], v2, s[12:15], s38 offen nt
    s_waitcnt lgkmcnt(4)
    ds_write_b128 v8, v[36:39] offset:13312
    ds_read_b64_tr_b16 a[112:113], v3 offset:0
    ds_read_b64_tr_b16 a[114:115], v3 offset:256
    ds_read_b64_tr_b16 a[116:117], v3 offset:32
    ds_read_b64_tr_b16 a[118:119], v3 offset:288
    ds_read_b64_tr_b16 v[180:181], v3 offset:64
    ds_read_b64_tr_b16 v[182:183], v3 offset:320
    ds_read_b64_tr_b16 v[32:33], v3 offset:96
    ds_read_b64_tr_b16 v[34:35], v3 offset:352
    s_waitcnt vmcnt(12)
    ds_write_b128 v5, a[120:123] offset:4096
    ds_write_b128 v5, a[124:127] offset:5120
    ds_write_b128 v5, v[184:187] offset:6144
    ds_write_b128 v5, v[120:123] offset:7168
    s_add_u32 s38, s52, 0x30000
    buffer_load_dwordx4 a[152:155], v2, s[12:15], s38 offen nt
    s_add_u32 s38, s52, 0x34000
    buffer_load_dwordx4 a[156:159], v2, s[12:15], s38 offen nt
    s_add_u32 s38, s52, 0x38000
    buffer_load_dwordx4 v[200:203], v2, s[12:15], s38 offen nt
    s_add_u32 s38, s52, 0x3c000
    buffer_load_dwordx4 v[72:75], v2, s[12:15], s38 offen nt
    s_waitcnt lgkmcnt(4)
    ds_write_b128 v8, v[32:35] offset:14336
    ds_read_b64_tr_b16 a[120:121], v3 offset:4096
    ds_read_b64_tr_b16 a[122:123], v3 offset:4352
    ds_read_b64_tr_b16 a[124:125], v3 offset:4128
    ds_read_b64_tr_b16 a[126:127], v3 offset:4384
    ds_read_b64_tr_b16 v[184:185], v3 offset:4160
    ds_read_b64_tr_b16 v[186:187], v3 offset:4416
    ds_read_b64_tr_b16 v[36:37], v3 offset:4192
    ds_read_b64_tr_b16 v[38:39], v3 offset:4448
    s_waitcnt vmcnt(12)
    ds_write_b128 v5, a[128:131] offset:0
    ds_write_b128 v5, a[132:135] offset:1024
    ds_write_b128 v5, v[188:191] offset:2048
    ds_write_b128 v5, v[60:63] offset:3072
    s_add_u32 s38, s53, 0x0
    buffer_load_dwordx4 a[160:163], v2, s[12:15], s38 offen nt
    s_add_u32 s38, s53, 0x4000
    buffer_load_dwordx4 a[164:167], v2, s[12:15], s38 offen nt
    s_add_u32 s38, s53, 0x8000
    buffer_load_dwordx4 v[204:207], v2, s[12:15], s38 offen nt
    s_add_u32 s38, s53, 0xc000
    buffer_load_dwordx4 v[76:79], v2, s[12:15], s38 offen nt
    s_waitcnt lgkmcnt(4)
    ds_write_b128 v8, v[36:39] offset:15360
    ds_read_b64_tr_b16 a[128:129], v3 offset:0
    ds_read_b64_tr_b16 a[130:131], v3 offset:256
    ds_read_b64_tr_b16 a[132:133], v3 offset:32
    ds_read_b64_tr_b16 a[134:135], v3 offset:288
    ds_read_b64_tr_b16 v[188:189], v3 offset:64
    ds_read_b64_tr_b16 v[190:191], v3 offset:320
    ds_read_b64_tr_b16 v[32:33], v3 offset:96
    ds_read_b64_tr_b16 v[34:35], v3 offset:352
    s_waitcnt vmcnt(12)
    ds_write_b128 v5, a[136:139] offset:4096
    ds_write_b128 v5, a[140:143] offset:5120
    ds_write_b128 v5, v[192:195] offset:6144
    ds_write_b128 v5, v[64:67] offset:7168
    s_add_u32 s38, s53, 0x10000
    buffer_load_dwordx4 a[168:171], v2, s[12:15], s38 offen nt
    s_add_u32 s38, s53, 0x14000
    buffer_load_dwordx4 a[172:175], v2, s[12:15], s38 offen nt
    s_add_u32 s38, s53, 0x18000
    buffer_load_dwordx4 v[208:211], v2, s[12:15], s38 offen nt
    s_add_u32 s38, s53, 0x1c000
    buffer_load_dwordx4 v[80:83], v2, s[12:15], s38 offen nt
    s_waitcnt lgkmcnt(4)
    ds_write_b128 v8, v[32:35] offset:16384
    ds_read_b64_tr_b16 a[136:137], v3 offset:4096
    ds_read_b64_tr_b16 a[138:139], v3 offset:4352
    ds_read_b64_tr_b16 a[140:141], v3 offset:4128
    ds_read_b64_tr_b16 a[142:143], v3 offset:4384
    ds_read_b64_tr_b16 v[192:193], v3 offset:4160
    ds_read_b64_tr_b16 v[194:195], v3 offset:4416
    ds_read_b64_tr_b16 v[36:37], v3 offset:4192
    ds_read_b64_tr_b16 v[38:39], v3 offset:4448
    s_waitcnt vmcnt(12)
    ds_write_b128 v5, a[144:147] offset:0
    ds_write_b128 v5, a[148:151] offset:1024
    ds_write_b128 v5, v[196:199] offset:2048
    ds_write_b128 v5, v[68:71] offset:3072
    s_add_u32 s38, s53, 0x20000
    buffer_load_dwordx4 a[176:179], v2, s[12:15], s38 offen nt
    s_add_u32 s38, s53, 0x24000
    buffer_load_dwordx4 a[180:183], v2, s[12:15], s38 offen nt
    s_add_u32 s38, s53, 0x28000
    buffer_load_dwordx4 v[212:215], v2, s[12:15], s38 offen nt
    s_add_u32 s38, s53, 0x2c000
    buffer_load_dwordx4 v[84:87], v2, s[12:15], s38 offen nt
    s_waitcnt lgkmcnt(4)
    ds_write_b128 v8, v[36:39] offset:17408
    ds_read_b64_tr_b16 a[144:145], v3 offset:0
    ds_read_b64_tr_b16 a[146:147], v3 offset:256
    ds_read_b64_tr_b16 a[148:149], v3 offset:32
    ds_read_b64_tr_b16 a[150:151], v3 offset:288
    ds_read_b64_tr_b16 v[196:197], v3 offset:64
    ds_read_b64_tr_b16 v[198:199], v3 offset:320
    ds_read_b64_tr_b16 v[32:33], v3 offset:96
    ds_read_b64_tr_b16 v[34:35], v3 offset:352
    s_waitcnt vmcnt(12)
    ds_write_b128 v5, a[152:155] offset:4096
    ds_write_b128 v5, a[156:159] offset:5120
    ds_write_b128 v5, v[200:203] offset:6144
    ds_write_b128 v5, v[72:75] offset:7168
    s_add_u32 s38, s53, 0x30000
    buffer_load_dwordx4 a[184:187], v2, s[12:15], s38 offen nt
    s_add_u32 s38, s53, 0x34000
    buffer_load_dwordx4 a[188:191], v2, s[12:15], s38 offen nt
    s_add_u32 s38, s53, 0x38000
    buffer_load_dwordx4 v[216:219], v2, s[12:15], s38 offen nt
    s_add_u32 s38, s53, 0x3c000
    buffer_load_dwordx4 v[88:91], v2, s[12:15], s38 offen nt
    s_waitcnt lgkmcnt(4)
    ds_write_b128 v8, v[32:35] offset:18432
    ds_read_b64_tr_b16 a[152:153], v3 offset:4096
    ds_read_b64_tr_b16 a[154:155], v3 offset:4352
    ds_read_b64_tr_b16 a[156:157], v3 offset:4128
    ds_read_b64_tr_b16 a[158:159], v3 offset:4384
    ds_read_b64_tr_b16 v[200:201], v3 offset:4160
    ds_read_b64_tr_b16 v[202:203], v3 offset:4416
    ds_read_b64_tr_b16 v[36:37], v3 offset:4192
    ds_read_b64_tr_b16 v[38:39], v3 offset:4448
    s_waitcnt vmcnt(12)
    ds_write_b128 v5, a[160:163] offset:0
    ds_write_b128 v5, a[164:167] offset:1024
    ds_write_b128 v5, v[204:207] offset:2048
    ds_write_b128 v5, v[76:79] offset:3072
    s_add_u32 s38, s54, 0x0
    buffer_load_dwordx4 a[192:195], v2, s[12:15], s38 offen nt
    s_add_u32 s38, s54, 0x4000
    buffer_load_dwordx4 a[196:199], v2, s[12:15], s38 offen nt
    s_add_u32 s38, s54, 0x8000
    buffer_load_dwordx4 v[220:223], v2, s[12:15], s38 offen nt
    s_add_u32 s38, s54, 0xc000
    buffer_load_dwordx4 v[92:95], v2, s[12:15], s38 offen nt
    s_waitcnt lgkmcnt(4)
    ds_write_b128 v8, v[36:39] offset:19456
    ds_read_b64_tr_b16 a[160:161], v3 offset:0
    ds_read_b64_tr_b16 a[162:163], v3 offset:256
    ds_read_b64_tr_b16 a[164:165], v3 offset:32
    ds_read_b64_tr_b16 a[166:167], v3 offset:288
    ds_read_b64_tr_b16 v[204:205], v3 offset:64
    ds_read_b64_tr_b16 v[206:207], v3 offset:320
    ds_read_b64_tr_b16 v[32:33], v3 offset:96
    ds_read_b64_tr_b16 v[34:35], v3 offset:352
    s_waitcnt vmcnt(12)
    ds_write_b128 v5, a[168:171] offset:4096
    ds_write_b128 v5, a[172:175] offset:5120
    ds_write_b128 v5, v[208:211] offset:6144
    ds_write_b128 v5, v[80:83] offset:7168
    s_add_u32 s38, s54, 0x10000
    buffer_load_dwordx4 a[200:203], v2, s[12:15], s38 offen nt
    s_add_u32 s38, s54, 0x14000
    buffer_load_dwordx4 a[204:207], v2, s[12:15], s38 offen nt
    s_add_u32 s38, s54, 0x18000
    buffer_load_dwordx4 v[224:227], v2, s[12:15], s38 offen nt
    s_add_u32 s38, s54, 0x1c000
    buffer_load_dwordx4 v[96:99], v2, s[12:15], s38 offen nt
    s_waitcnt lgkmcnt(4)
    ds_write_b128 v8, v[32:35] offset:20480
    ds_read_b64_tr_b16 a[168:169], v3 offset:4096
    ds_read_b64_tr_b16 a[170:171], v3 offset:4352
    ds_read_b64_tr_b16 a[172:173], v3 offset:4128
    ds_read_b64_tr_b16 a[174:175], v3 offset:4384
    ds_read_b64_tr_b16 v[208:209], v3 offset:4160
    ds_read_b64_tr_b16 v[210:211], v3 offset:4416
    ds_read_b64_tr_b16 v[36:37], v3 offset:4192
    ds_read_b64_tr_b16 v[38:39], v3 offset:4448
    s_waitcnt vmcnt(12)
    ds_write_b128 v5, a[176:179] offset:0
    ds_write_b128 v5, a[180:183] offset:1024
    ds_write_b128 v5, v[212:215] offset:2048
    ds_write_b128 v5, v[84:87] offset:3072
    s_add_u32 s38, s54, 0x20000
    buffer_load_dwordx4 a[208:211], v2, s[12:15], s38 offen nt
    s_add_u32 s38, s54, 0x24000
    buffer_load_dwordx4 a[212:215], v2, s[12:15], s38 offen nt
    s_add_u32 s38, s54, 0x28000
    buffer_load_dwordx4 v[228:231], v2, s[12:15], s38 offen nt
    s_add_u32 s38, s54, 0x2c000
    buffer_load_dwordx4 v[100:103], v2, s[12:15], s38 offen nt
    s_waitcnt lgkmcnt(4)
    ds_write_b128 v8, v[36:39] offset:21504
    ds_read_b64_tr_b16 a[176:177], v3 offset:0
    ds_read_b64_tr_b16 a[178:179], v3 offset:256
    ds_read_b64_tr_b16 a[180:181], v3 offset:32
    ds_read_b64_tr_b16 a[182:183], v3 offset:288
    ds_read_b64_tr_b16 v[212:213], v3 offset:64
    ds_read_b64_tr_b16 v[214:215], v3 offset:320
    ds_read_b64_tr_b16 v[32:33], v3 offset:96
    ds_read_b64_tr_b16 v[34:35], v3 offset:352
    s_waitcnt vmcnt(12)
    ds_write_b128 v5, a[184:187] offset:4096
    ds_write_b128 v5, a[188:191] offset:5120
    ds_write_b128 v5, v[216:219] offset:6144
    ds_write_b128 v5, v[88:91] offset:7168
    s_add_u32 s38, s54, 0x30000
    buffer_load_dwordx4 a[216:219], v2, s[12:15], s38 offen nt
    s_add_u32 s38, s54, 0x34000
    buffer_load_dwordx4 a[220:223], v2, s[12:15], s38 offen nt
    s_add_u32 s38, s54, 0x38000
    buffer_load_dwordx4 v[232:235], v2, s[12:15], s38 offen nt
    s_add_u32 s38, s54, 0x3c000
    buffer_load_dwordx4 v[104:107], v2, s[12:15], s38 offen nt
    s_waitcnt lgkmcnt(4)
    ds_write_b128 v8, v[32:35] offset:22528
    ds_read_b64_tr_b16 a[184:185], v3 offset:4096
    ds_read_b64_tr_b16 a[186:187], v3 offset:4352
    ds_read_b64_tr_b16 a[188:189], v3 offset:4128
    ds_read_b64_tr_b16 a[190:191], v3 offset:4384
    ds_read_b64_tr_b16 v[216:217], v3 offset:4160
    ds_read_b64_tr_b16 v[218:219], v3 offset:4416
    ds_read_b64_tr_b16 v[36:37], v3 offset:4192
    ds_read_b64_tr_b16 v[38:39], v3 offset:4448
    s_waitcnt vmcnt(12)
    ds_write_b128 v5, a[192:195] offset:0
    ds_write_b128 v5, a[196:199] offset:1024
    ds_write_b128 v5, v[220:223] offset:2048
    ds_write_b128 v5, v[92:95] offset:3072
    s_add_u32 s38, s55, 0x0
    buffer_load_dwordx4 a[224:227], v2, s[12:15], s38 offen nt
    s_add_u32 s38, s55, 0x4000
    buffer_load_dwordx4 a[228:231], v2, s[12:15], s38 offen nt
    s_add_u32 s38, s55, 0x8000
    buffer_load_dwordx4 v[236:239], v2, s[12:15], s38 offen nt
    s_add_u32 s38, s55, 0xc000
    buffer_load_dwordx4 v[108:111], v2, s[12:15], s38 offen nt
    s_waitcnt lgkmcnt(4)
    ds_write_b128 v8, v[36:39] offset:23552
    ds_read_b64_tr_b16 a[192:193], v3 offset:0
    ds_read_b64_tr_b16 a[194:195], v3 offset:256
    ds_read_b64_tr_b16 a[196:197], v3 offset:32
    ds_read_b64_tr_b16 a[198:199], v3 offset:288
    ds_read_b64_tr_b16 v[220:221], v3 offset:64
    ds_read_b64_tr_b16 v[222:223], v3 offset:320
    ds_read_b64_tr_b16 v[32:33], v3 offset:96
    ds_read_b64_tr_b16 v[34:35], v3 offset:352
    s_waitcnt vmcnt(12)
    ds_write_b128 v5, a[200:203] offset:4096
    ds_write_b128 v5, a[204:207] offset:5120
    ds_write_b128 v5, v[224:227] offset:6144
    ds_write_b128 v5, v[96:99] offset:7168
    s_add_u32 s38, s55, 0x10000
    buffer_load_dwordx4 a[232:235], v2, s[12:15], s38 offen nt
    s_add_u32 s38, s55, 0x14000
    buffer_load_dwordx4 a[236:239], v2, s[12:15], s38 offen nt
    s_add_u32 s38, s55, 0x18000
    buffer_load_dwordx4 v[240:243], v2, s[12:15], s38 offen nt
    s_add_u32 s38, s55, 0x1c000
    buffer_load_dwordx4 v[112:115], v2, s[12:15], s38 offen nt
    s_waitcnt lgkmcnt(4)
    ds_write_b128 v8, v[32:35] offset:24576
    ds_read_b64_tr_b16 a[200:201], v3 offset:4096
    ds_read_b64_tr_b16 a[202:203], v3 offset:4352
    ds_read_b64_tr_b16 a[204:205], v3 offset:4128
    ds_read_b64_tr_b16 a[206:207], v3 offset:4384
    ds_read_b64_tr_b16 v[224:225], v3 offset:4160
    ds_read_b64_tr_b16 v[226:227], v3 offset:4416
    ds_read_b64_tr_b16 v[36:37], v3 offset:4192
    ds_read_b64_tr_b16 v[38:39], v3 offset:4448
    s_waitcnt vmcnt(12)
    ds_write_b128 v5, a[208:211] offset:0
    ds_write_b128 v5, a[212:215] offset:1024
    ds_write_b128 v5, v[228:231] offset:2048
    ds_write_b128 v5, v[100:103] offset:3072
    s_add_u32 s38, s55, 0x20000
    buffer_load_dwordx4 a[240:243], v2, s[12:15], s38 offen nt
    s_add_u32 s38, s55, 0x24000
    buffer_load_dwordx4 a[244:247], v2, s[12:15], s38 offen nt
    s_add_u32 s38, s55, 0x28000
    buffer_load_dwordx4 v[244:247], v2, s[12:15], s38 offen nt
    s_add_u32 s38, s55, 0x2c000
    buffer_load_dwordx4 v[116:119], v2, s[12:15], s38 offen nt
    s_waitcnt lgkmcnt(4)
    ds_write_b128 v8, v[36:39] offset:25600
    ds_read_b64_tr_b16 a[208:209], v3 offset:0
    ds_read_b64_tr_b16 a[210:211], v3 offset:256
    ds_read_b64_tr_b16 a[212:213], v3 offset:32
    ds_read_b64_tr_b16 a[214:215], v3 offset:288
    ds_read_b64_tr_b16 v[228:229], v3 offset:64
    ds_read_b64_tr_b16 v[230:231], v3 offset:320
    ds_read_b64_tr_b16 v[32:33], v3 offset:96
    ds_read_b64_tr_b16 v[34:35], v3 offset:352
    s_waitcnt vmcnt(12)
    ds_write_b128 v5, a[216:219] offset:4096
    ds_write_b128 v5, a[220:223] offset:5120
    ds_write_b128 v5, v[232:235] offset:6144
    ds_write_b128 v5, v[104:107] offset:7168
    s_add_u32 s38, s55, 0x30000
    buffer_load_dwordx4 a[248:251], v2, s[12:15], s38 offen nt
    s_add_u32 s38, s55, 0x34000
    buffer_load_dwordx4 a[252:255], v2, s[12:15], s38 offen nt
    s_add_u32 s38, s55, 0x38000
    buffer_load_dwordx4 v[248:251], v2, s[12:15], s38 offen nt
    s_add_u32 s38, s55, 0x3c000
    buffer_load_dwordx4 v[120:123], v2, s[12:15], s38 offen nt
    s_waitcnt lgkmcnt(4)
    ds_write_b128 v8, v[32:35] offset:26624
    ds_read_b64_tr_b16 a[216:217], v3 offset:4096
    ds_read_b64_tr_b16 a[218:219], v3 offset:4352
    ds_read_b64_tr_b16 a[220:221], v3 offset:4128
    ds_read_b64_tr_b16 a[222:223], v3 offset:4384
    ds_read_b64_tr_b16 v[232:233], v3 offset:4160
    ds_read_b64_tr_b16 v[234:235], v3 offset:4416
    ds_read_b64_tr_b16 v[36:37], v3 offset:4192
    ds_read_b64_tr_b16 v[38:39], v3 offset:4448
    s_waitcnt vmcnt(12)
    ds_write_b128 v5, a[224:227] offset:0
    ds_write_b128 v5, a[228:231] offset:1024
    ds_write_b128 v5, v[236:239] offset:2048
    ds_write_b128 v5, v[108:111] offset:3072
    s_waitcnt lgkmcnt(4)
    ds_write_b128 v8, v[36:39] offset:27648
    ds_read_b64_tr_b16 a[224:225], v3 offset:0
    ds_read_b64_tr_b16 a[226:227], v3 offset:256
    ds_read_b64_tr_b16 a[228:229], v3 offset:32
    ds_read_b64_tr_b16 a[230:231], v3 offset:288
    ds_read_b64_tr_b16 v[236:237], v3 offset:64
    ds_read_b64_tr_b16 v[238:239], v3 offset:320
    ds_read_b64_tr_b16 v[32:33], v3 offset:96
    ds_read_b64_tr_b16 v[34:35], v3 offset:352
    s_waitcnt vmcnt(8)
    ds_write_b128 v5, a[232:235] offset:4096
    ds_write_b128 v5, a[236:239] offset:5120
    ds_write_b128 v5, v[240:243] offset:6144
    ds_write_b128 v5, v[112:115] offset:7168
    s_waitcnt lgkmcnt(4)
    ds_write_b128 v8, v[32:35] offset:28672
    ds_read_b64_tr_b16 a[232:233], v3 offset:4096
    ds_read_b64_tr_b16 a[234:235], v3 offset:4352
    ds_read_b64_tr_b16 a[236:237], v3 offset:4128
    ds_read_b64_tr_b16 a[238:239], v3 offset:4384
    ds_read_b64_tr_b16 v[240:241], v3 offset:4160
    ds_read_b64_tr_b16 v[242:243], v3 offset:4416
    ds_read_b64_tr_b16 v[36:37], v3 offset:4192
    ds_read_b64_tr_b16 v[38:39], v3 offset:4448
    s_waitcnt vmcnt(4)
    ds_write_b128 v5, a[240:243] offset:0
    ds_write_b128 v5, a[244:247] offset:1024
    ds_write_b128 v5, v[244:247] offset:2048
    ds_write_b128 v5, v[116:119] offset:3072
    s_waitcnt lgkmcnt(4)
    ds_write_b128 v8, v[36:39] offset:29696
    ds_read_b64_tr_b16 a[240:241], v3 offset:0
    ds_read_b64_tr_b16 a[242:243], v3 offset:256
    ds_read_b64_tr_b16 a[244:245], v3 offset:32
    ds_read_b64_tr_b16 a[246:247], v3 offset:288
    ds_read_b64_tr_b16 v[244:245], v3 offset:64
    ds_read_b64_tr_b16 v[246:247], v3 offset:320
    ds_read_b64_tr_b16 v[32:33], v3 offset:96
    ds_read_b64_tr_b16 v[34:35], v3 offset:352
    s_waitcnt vmcnt(0)
    ds_write_b128 v5, a[248:251] offset:4096
    ds_write_b128 v5, a[252:255] offset:5120
    ds_write_b128 v5, v[248:251] offset:6144
    ds_write_b128 v5, v[120:123] offset:7168
    s_waitcnt lgkmcnt(4)
    ds_write_b128 v8, v[32:35] offset:30720
    ds_read_b64_tr_b16 a[248:249], v3 offset:4096
    ds_read_b64_tr_b16 a[250:251], v3 offset:4352
    ds_read_b64_tr_b16 a[252:253], v3 offset:4128
    ds_read_b64_tr_b16 a[254:255], v3 offset:4384
    ds_read_b64_tr_b16 v[248:249], v3 offset:4160
    ds_read_b64_tr_b16 v[250:251], v3 offset:4416
    ds_read_b64_tr_b16 v[36:37], v3 offset:4192
    ds_read_b64_tr_b16 v[38:39], v3 offset:4448
    s_waitcnt lgkmcnt(0)
    ds_write_b128 v8, v[36:39] offset:31744
    s_lshl_b32 s37, s36, 12
    s_add_u32 s37, s37, 0xe420000
    s_lshl_b32 s38, s36, 8
    s_add_u32 s38, s38, 0xe400000
    v_bfe_u32 v10, v0, 0, 4
    v_lshlrev_b32 v11, 4, v10
    v_lshlrev_b32 v12, 2, v0
L_pd_40:
    buffer_load_dwordx4 v[60:63], v11, s[4:7], s37 offen offset:0 sc1
    buffer_load_dwordx4 v[64:67], v11, s[4:7], s37 offen offset:256 sc1
    buffer_load_dwordx4 v[68:71], v11, s[4:7], s37 offen offset:512 sc1
    buffer_load_dwordx4 v[72:75], v11, s[4:7], s37 offen offset:768 sc1
    buffer_load_dwordx4 v[76:79], v11, s[4:7], s37 offen offset:1024 sc1
    buffer_load_dwordx4 v[80:83], v11, s[4:7], s37 offen offset:1280 sc1
    buffer_load_dwordx4 v[84:87], v11, s[4:7], s37 offen offset:1536 sc1
    buffer_load_dwordx4 v[88:91], v11, s[4:7], s37 offen offset:1792 sc1
    buffer_load_dwordx4 v[92:95], v11, s[4:7], s37 offen offset:2048 sc1
    buffer_load_dwordx4 v[96:99], v11, s[4:7], s37 offen offset:2304 sc1
    buffer_load_dwordx4 v[100:103], v11, s[4:7], s37 offen offset:2560 sc1
    buffer_load_dwordx4 v[104:107], v11, s[4:7], s37 offen offset:2816 sc1
    buffer_load_dwordx4 v[108:111], v11, s[4:7], s37 offen offset:3072 sc1
    buffer_load_dwordx4 v[112:115], v11, s[4:7], s37 offen offset:3328 sc1
    buffer_load_dwordx4 v[116:119], v11, s[4:7], s37 offen offset:3584 sc1
    buffer_load_dwordx4 v[120:123], v11, s[4:7], s37 offen offset:3840 sc1
    buffer_load_dword v13, v12, s[4:7], s38 offen sc1
    s_waitcnt vmcnt(0)
    v_max_u32 v10, v60, v13
    v_max3_u32 v10, v10, v61, v62
    v_max3_u32 v10, v10, v63, v64
    v_max3_u32 v10, v10, v65, v66
    v_max3_u32 v10, v10, v67, v68
    v_max3_u32 v10, v10, v69, v70
    v_max3_u32 v10, v10, v71, v72
    v_max3_u32 v10, v10, v73, v74
    v_max3_u32 v10, v10, v75, v76
    v_max3_u32 v10, v10, v77, v78
    v_max3_u32 v10, v10, v79, v80
    v_max3_u32 v10, v10, v81, v82
    v_max3_u32 v10, v10, v83, v84
    v_max3_u32 v10, v10, v85, v86
    v_max3_u32 v10, v10, v87, v88
    v_max3_u32 v10, v10, v89, v90
    v_max3_u32 v10, v10, v91, v92
    v_max3_u32 v10, v10, v93, v94
    v_max3_u32 v10, v10, v95, v96
    v_max3_u32 v10, v10, v97, v98
    v_max3_u32 v10, v10, v99, v100
    v_max3_u32 v10, v10, v101, v102
    v_max3_u32 v10, v10, v103, v104
    v_max3_u32 v10, v10, v105, v106
    v_max3_u32 v10, v10, v107, v108
    v_max3_u32 v10, v10, v109, v110
    v_max3_u32 v10, v10, v111, v112
    v_max3_u32 v10, v10, v113, v114
    v_max3_u32 v10, v10, v115, v116
    v_max3_u32 v10, v10, v117, v118
    v_max3_u32 v10, v10, v119, v120
    v_max3_u32 v10, v10, v121, v122
    v_max3_u32 v10, v10, v123, v123
    v_cmp_eq_u32 vcc, -1, v10
    s_cbranch_vccz L_pdok_41
    s_sleep 16
    s_sub_u32 s35, s35, 1
    s_cbranch_scc0 L_pd_40
    s_endpgm
L_pdok_41:
    v_not_b32 v11, v13
    v_ashrrev_i32 v11, 31, v11
    v_or_b32 v11, 0x80000000, v11
    v_xor_b32 v11, v13, v11
    v_and_b32 v11, s44, v11
    v_mul_f32 v11, 0xbfb8aa3b, v11
    v_exp_f32 v11, v11
    s_nop 0
    v_add_f32 v11, 1.0, v11
    v_rcp_f32 v11, v11
    s_nop 0
    v_cvt_pk_bf16_f32 v11, v11, v11
    v_and_b32 v11, s44, v11
    v_and_b32 v13, 0x7ff, v13
    v_sub_u32 v13, 2047, v13
    v_readlane_b32 s37, v11, 0
    v_readlane_b32 s48, v13, 0
    v_pk_add_f32 v[60:61], v[60:61], v[92:93]
    v_cvt_pk_bf16_f32 v10, v60, v61
    v_lshlrev_b32 v60, 16, v10
    v_and_b32 v61, s44, v10
    v_mul_f32 v60, s37, v60
    v_mul_f32 v61, s37, v61
    v_cvt_pk_bf16_f32 v16, v60, v61
    v_pk_add_f32 v[62:63], v[62:63], v[94:95]
    v_cvt_pk_bf16_f32 v10, v62, v63
    v_lshlrev_b32 v62, 16, v10
    v_and_b32 v63, s44, v10
    v_mul_f32 v62, s37, v62
    v_mul_f32 v63, s37, v63
    v_cvt_pk_bf16_f32 v17, v62, v63
    v_readlane_b32 s37, v11, 1
    v_readlane_b32 s49, v13, 1
    v_pk_add_f32 v[64:65], v[64:65], v[96:97]
    v_cvt_pk_bf16_f32 v10, v64, v65
    v_lshlrev_b32 v64, 16, v10
    v_and_b32 v65, s44, v10
    v_mul_f32 v64, s37, v64
    v_mul_f32 v65, s37, v65
    v_cvt_pk_bf16_f32 v18, v64, v65
    v_pk_add_f32 v[66:67], v[66:67], v[98:99]
    v_cvt_pk_bf16_f32 v10, v66, v67
    v_lshlrev_b32 v66, 16, v10
    v_and_b32 v67, s44, v10
    v_mul_f32 v66, s37, v66
    v_mul_f32 v67, s37, v67
    v_cvt_pk_bf16_f32 v19, v66, v67
    v_readlane_b32 s37, v11, 2
    v_readlane_b32 s50, v13, 2
    v_pk_add_f32 v[68:69], v[68:69], v[100:101]
    v_cvt_pk_bf16_f32 v10, v68, v69
    v_lshlrev_b32 v68, 16, v10
    v_and_b32 v69, s44, v10
    v_mul_f32 v68, s37, v68
    v_mul_f32 v69, s37, v69
    v_cvt_pk_bf16_f32 v20, v68, v69
    v_pk_add_f32 v[70:71], v[70:71], v[102:103]
    v_cvt_pk_bf16_f32 v10, v70, v71
    v_lshlrev_b32 v70, 16, v10
    v_and_b32 v71, s44, v10
    v_mul_f32 v70, s37, v70
    v_mul_f32 v71, s37, v71
    v_cvt_pk_bf16_f32 v21, v70, v71
    v_readlane_b32 s37, v11, 3
    v_readlane_b32 s51, v13, 3
    v_pk_add_f32 v[72:73], v[72:73], v[104:105]
    v_cvt_pk_bf16_f32 v10, v72, v73
    v_lshlrev_b32 v72, 16, v10
    v_and_b32 v73, s44, v10
    v_mul_f32 v72, s37, v72
    v_mul_f32 v73, s37, v73
    v_cvt_pk_bf16_f32 v22, v72, v73
    v_pk_add_f32 v[74:75], v[74:75], v[106:107]
    v_cvt_pk_bf16_f32 v10, v74, v75
    v_lshlrev_b32 v74, 16, v10
    v_and_b32 v75, s44, v10
    v_mul_f32 v74, s37, v74
    v_mul_f32 v75, s37, v75
    v_cvt_pk_bf16_f32 v23, v74, v75
    v_readlane_b32 s37, v11, 4
    v_readlane_b32 s52, v13, 4
    v_pk_add_f32 v[76:77], v[76:77], v[108:109]
    v_cvt_pk_bf16_f32 v10, v76, v77
    v_lshlrev_b32 v76, 16, v10
    v_and_b32 v77, s44, v10
    v_mul_f32 v76, s37, v76
    v_mul_f32 v77, s37, v77
    v_cvt_pk_bf16_f32 v24, v76, v77
    v_pk_add_f32 v[78:79], v[78:79], v[110:111]
    v_cvt_pk_bf16_f32 v10, v78, v79
    v_lshlrev_b32 v78, 16, v10
    v_and_b32 v79, s44, v10
    v_mul_f32 v78, s37, v78
    v_mul_f32 v79, s37, v79
    v_cvt_pk_bf16_f32 v25, v78, v79
    v_readlane_b32 s37, v11, 5
    v_readlane_b32 s53, v13, 5
    v_pk_add_f32 v[80:81], v[80:81], v[112:113]
    v_cvt_pk_bf16_f32 v10, v80, v81
    v_lshlrev_b32 v80, 16, v10
    v_and_b32 v81, s44, v10
    v_mul_f32 v80, s37, v80
    v_mul_f32 v81, s37, v81
    v_cvt_pk_bf16_f32 v26, v80, v81
    v_pk_add_f32 v[82:83], v[82:83], v[114:115]
    v_cvt_pk_bf16_f32 v10, v82, v83
    v_lshlrev_b32 v82, 16, v10
    v_and_b32 v83, s44, v10
    v_mul_f32 v82, s37, v82
    v_mul_f32 v83, s37, v83
    v_cvt_pk_bf16_f32 v27, v82, v83
    v_readlane_b32 s37, v11, 6
    v_readlane_b32 s54, v13, 6
    v_pk_add_f32 v[84:85], v[84:85], v[116:117]
    v_cvt_pk_bf16_f32 v10, v84, v85
    v_lshlrev_b32 v84, 16, v10
    v_and_b32 v85, s44, v10
    v_mul_f32 v84, s37, v84
    v_mul_f32 v85, s37, v85
    v_cvt_pk_bf16_f32 v28, v84, v85
    v_pk_add_f32 v[86:87], v[86:87], v[118:119]
    v_cvt_pk_bf16_f32 v10, v86, v87
    v_lshlrev_b32 v86, 16, v10
    v_and_b32 v87, s44, v10
    v_mul_f32 v86, s37, v86
    v_mul_f32 v87, s37, v87
    v_cvt_pk_bf16_f32 v29, v86, v87
    v_readlane_b32 s37, v11, 7
    v_readlane_b32 s55, v13, 7
    v_pk_add_f32 v[88:89], v[88:89], v[120:121]
    v_cvt_pk_bf16_f32 v10, v88, v89
    v_lshlrev_b32 v88, 16, v10
    v_and_b32 v89, s44, v10
    v_mul_f32 v88, s37, v88
    v_mul_f32 v89, s37, v89
    v_cvt_pk_bf16_f32 v30, v88, v89
    v_pk_add_f32 v[90:91], v[90:91], v[122:123]
    v_cvt_pk_bf16_f32 v10, v90, v91
    v_lshlrev_b32 v90, 16, v10
    v_and_b32 v91, s44, v10
    v_mul_f32 v90, s37, v90
    v_mul_f32 v91, s37, v91
    v_cvt_pk_bf16_f32 v31, v90, v91
    s_and_b32 s37, s100, 1
    s_lshl_b32 s37, s37, 2
    s_add_u32 s37, s37, s32
    s_lshl_b32 s37, s37, 10
    s_and_b32 s38, s100, 2
    s_lshl_b32 s38, s38, 13
    s_add_u32 s37, s37, s38
    s_add_u32 s37, s37, 0xe40a000
    s_lshr_b32 s38, s37, 8
    s_xor_b32 s38, s38, s62
    s_and_b32 s38, s38, 0x2000
    s_xor_b32 s37, s37, s38
    v_bfe_u32 v10, v0, 0, 3
    v_lshlrev_b32 v2, 7, v10
    v_add_u32 v2, s37, v2
    s_lshl_b32 s37, s32, 12
    s_add_u32 s37, s37, 131072
    v_and_b32 v10, 0x30, v0
    v_xor_b32 v10, v10, v1
    v_add_u32 v5, s37, v10
    s_lshl_b32 s37, s32, 2
    v_lshrrev_b32 v10, 4, v0
    v_add_u32 v10, s37, v10
    v_and_b32 v11, 15, v0
    v_xor_b32 v10, v10, v11
    v_lshlrev_b32 v10, 4, v10
    v_lshl_add_u32 v10, v11, 8, v10
    v_add_u32 v6, 131072, v10
    s_lshl_b32 s37, s32, 13
    s_lshl_b32 s38, s36, 7
    s_add_u32 s37, s37, s38
    v_bfe_u32 v10, v0, 4, 2
    v_lshlrev_b32 v7, 11, v10
    v_bfe_u32 v10, v0, 0, 4
    v_lshl_add_u32 v7, v10, 3, v7
    v_add_u32 v7, s37, v7
    s_lshl_b32 s37, s32, 4
    s_add_u32 s37, s37, 0xe406000
    v_bfe_u32 v10, v0, 4, 2
    v_lshlrev_b32 v255, 2, v10
    v_add_u32 v255, s37, v255
    v_mov_b32 v3, 0
    s_cmp_lt_u32 s45, 2
    s_cselect_b32 s56, 0, 60
    s_add_u32 s56, s56, s45
    s_mov_b32 s58, 0
    s_mov_b32 s46, 0
    s_waitcnt lgkmcnt(0)
    s_barrier
    s_add_u32 s37, s43, 0
    s_and_b32 s37, s37, 7
    s_lshl_b32 s38, s32, 3
    s_add_u32 s37, s37, s38
    s_mul_i32 s37, s37, 0x208000
    s_add_u32 s64, s37, 0x4002000
    s_lshr_b32 s37, s64, 8
    s_xor_b32 s37, s37, s62
    s_and_b32 s37, s37, 0x2000
    s_xor_b32 s64, s64, s37
    s_add_u32 s37, s43, 1
    s_and_b32 s37, s37, 7
    s_lshl_b32 s38, s32, 3
    s_add_u32 s37, s37, s38
    s_mul_i32 s37, s37, 0x208000
    s_add_u32 s65, s37, 0x4002000
    s_lshr_b32 s37, s65, 8
    s_xor_b32 s37, s37, s62
    s_and_b32 s37, s37, 0x2000
    s_xor_b32 s65, s65, s37
    s_add_u32 s37, s43, 2
    s_and_b32 s37, s37, 7
    s_lshl_b32 s38, s32, 3
    s_add_u32 s37, s37, s38
    s_mul_i32 s37, s37, 0x208000
    s_add_u32 s66, s37, 0x4002000
    s_lshr_b32 s37, s66, 8
    s_xor_b32 s37, s37, s62
    s_and_b32 s37, s37, 0x2000
    s_xor_b32 s66, s66, s37
    s_add_u32 s37, s43, 3
    s_and_b32 s37, s37, 7
    s_lshl_b32 s38, s32, 3
    s_add_u32 s37, s37, s38
    s_mul_i32 s37, s37, 0x208000
    s_add_u32 s67, s37, 0x4002000
    s_lshr_b32 s37, s67, 8
    s_xor_b32 s37, s37, s62
    s_and_b32 s37, s37, 0x2000
    s_xor_b32 s67, s67, s37
    s_add_u32 s37, s43, 4
    s_and_b32 s37, s37, 7
    s_lshl_b32 s38, s32, 3
    s_add_u32 s37, s37, s38
    s_mul_i32 s37, s37, 0x208000
    s_add_u32 s68, s37, 0x4002000
    s_lshr_b32 s37, s68, 8
    s_xor_b32 s37, s37, s62
    s_and_b32 s37, s37, 0x2000
    s_xor_b32 s68, s68, s37
    s_add_u32 s37, s43, 5
    s_and_b32 s37, s37, 7
    s_lshl_b32 s38, s32, 3
    s_add_u32 s37, s37, s38
    s_mul_i32 s37, s37, 0x208000
    s_add_u32 s69, s37, 0x4002000
    s_lshr_b32 s37, s69, 8
    s_xor_b32 s37, s37, s62
    s_and_b32 s37, s37, 0x2000
    s_xor_b32 s69, s69, s37
    s_add_u32 s37, s43, 6
    s_and_b32 s37, s37, 7
    s_lshl_b32 s38, s32, 3
    s_add_u32 s37, s37, s38
    s_mul_i32 s37, s37, 0x208000
    s_add_u32 s70, s37, 0x4002000
    s_lshr_b32 s37, s70, 8
    s_xor_b32 s37, s37, s62
    s_and_b32 s37, s37, 0x2000
    s_xor_b32 s70, s70, s37
    s_add_u32 s37, s43, 7
    s_and_b32 s37, s37, 7
    s_lshl_b32 s38, s32, 3
    s_add_u32 s37, s37, s38
    s_mul_i32 s37, s37, 0x208000
    s_add_u32 s71, s37, 0x4002000
    s_lshr_b32 s37, s71, 8
    s_xor_b32 s37, s37, s62
    s_and_b32 s37, s37, 0x2000
    s_xor_b32 s71, s71, s37
    ds_read_b128 v[48:51], v8 offset:0
    ds_read_b128 v[52:55], v8 offset:1024
    .p2align 6
L_o_loop:
    s_mov_b32 s41, s56
    s_cmp_ge_u32 s41, 128
    s_cbranch_scc1 L_o_end
    s_cmp_lt_u32 s41, 60
    s_cselect_b32 s37, 2, 6
    s_add_u32 s56, s41, s37
    s_lshr_b32 s42, s41, 1
    s_lshl_b32 s42, s42, 14
    s_and_b32 s37, s41, 1
    s_lshl_b32 s37, s37, 12
    s_add_u32 s42, s42, s37
    s_cmp_eq_u32 s58, 1
    s_cbranch_scc1 L_o_go
    s_lshr_b32 s40, s41, 1
    s_add_u32 s40, s40, 1
    s_lshl_b32 s37, s41, 15
    buffer_load_dwordx2 v[252:253], v7, s[16:19], s37 offen
    s_lshl_b32 s37, s41, 6
    buffer_load_dword v254, v255, s[4:7], s37 offen sc1
L_wf_42:
    buffer_load_dword v3, v2, s[4:7], 0 offen sc1
    s_waitcnt vmcnt(0)
    v_cmp_gt_i32 vcc, s40, v3
    s_cbranch_vccz L_wfok_43
    s_sleep 1
    s_sub_u32 s35, s35, 1
    s_cbranch_scc0 L_wf_42
    s_endpgm
L_wfok_43:
    s_add_u32 s38, s64, s42
    buffer_load_dwordx4 v[60:63], v1, s[4:7], s38 offen offset:0 sc1
    buffer_load_dwordx4 v[64:67], v1, s[4:7], s38 offen offset:1024 sc1
    buffer_load_dwordx4 v[68:71], v1, s[4:7], s38 offen offset:2048 sc1
    buffer_load_dwordx4 v[72:75], v1, s[4:7], s38 offen offset:3072 sc1
    s_add_u32 s38, s65, s42
    buffer_load_dwordx4 v[76:79], v1, s[4:7], s38 offen offset:0 sc1
    buffer_load_dwordx4 v[80:83], v1, s[4:7], s38 offen offset:1024 sc1
    buffer_load_dwordx4 v[84:87], v1, s[4:7], s38 offen offset:2048 sc1
    buffer_load_dwordx4 v[88:91], v1, s[4:7], s38 offen offset:3072 sc1
    s_add_u32 s38, s66, s42
    buffer_load_dwordx4 v[92:95], v1, s[4:7], s38 offen offset:0 sc1
    buffer_load_dwordx4 v[96:99], v1, s[4:7], s38 offen offset:1024 sc1
    buffer_load_dwordx4 v[100:103], v1, s[4:7], s38 offen offset:2048 sc1
    buffer_load_dwordx4 v[104:107], v1, s[4:7], s38 offen offset:3072 sc1
    s_add_u32 s38, s67, s42
    buffer_load_dwordx4 v[108:111], v1, s[4:7], s38 offen offset:0 sc1
    buffer_load_dwordx4 v[112:115], v1, s[4:7], s38 offen offset:1024 sc1
    buffer_load_dwordx4 v[116:119], v1, s[4:7], s38 offen offset:2048 sc1
    buffer_load_dwordx4 v[120:123], v1, s[4:7], s38 offen offset:3072 sc1
    v_mov_b32 v10, 0x40000000
    buffer_store_dword v10, v10, s[4:7], 0 offen
L_o_go:
    s_waitcnt vmcnt(16) lgkmcnt(1)
    v_mfma_f32_16x16x32_bf16 v[32:35], a[0:3], v[60:63], 0
    ds_read_b128 v[56:59], v8 offset:2048
    s_add_u32 s38, s68, s42
    s_lshr_b32 s40, s56, 1
    v_mfma_f32_16x16x32_bf16 v[36:39], a[4:7], v[60:63], 0
    s_add_u32 s40, s40, 1
    v_cmp_gt_i32 vcc, s40, v3
    s_lshl_b32 s39, s41, 15
    v_mfma_f32_16x16x32_bf16 v[40:43], v[124:127], v[60:63], 0
    s_waitcnt vmcnt(15) lgkmcnt(1)
    s_lshl_b32 s37, s41, 2
    s_add_u32 s37, s37, s32
    v_mfma_f32_16x16x32_bf16 v[44:47], v[48:51], v[60:63], 0
    buffer_load_dwordx4 v[60:63], v1, s[4:7], s38 offen offset:0 sc1
    v_mfma_f32_16x16x32_bf16 v[32:35], a[8:11], v[64:67], v[32:35]
    ds_read_b128 v[48:51], v8 offset:3072
    s_lshl_b32 s37, s37, 2
    v_lshrrev_b32 v11, 4, v0
    v_mfma_f32_16x16x32_bf16 v[36:39], a[12:15], v[64:67], v[36:39]
    v_add_u32 v11, s37, v11
    v_mov_b32 v14, 0
    v_mfma_f32_16x16x32_bf16 v[40:43], v[128:131], v[64:67], v[40:43]
    s_waitcnt vmcnt(15) lgkmcnt(1)
    v_mov_b32 v15, 0
    v_mov_b32 v4, -1
    v_mfma_f32_16x16x32_bf16 v[44:47], v[52:55], v[64:67], v[44:47]
    buffer_load_dwordx4 v[64:67], v1, s[4:7], s38 offen offset:1024 sc1
    v_mfma_f32_16x16x32_bf16 v[32:35], a[16:19], v[68:71], v[32:35]
    ds_read_b128 v[52:55], v8 offset:4096
    s_cmp_lg_u64 vcc, 0
    s_cselect_b32 s37, 0, 0x40000000
    v_mfma_f32_16x16x32_bf16 v[36:39], a[20:23], v[68:71], v[36:39]
    buffer_load_dword v4, v2, s[4:7], s37 offen sc1
    v_mfma_f32_16x16x32_bf16 v[40:43], v[132:135], v[68:71], v[40:43]
    s_waitcnt vmcnt(16) lgkmcnt(1)
    v_mov_b32 v12, v252
    v_mov_b32 v13, v253
    v_mfma_f32_16x16x32_bf16 v[44:47], v[56:59], v[68:71], v[44:47]
    buffer_load_dwordx4 v[68:71], v1, s[4:7], s38 offen offset:2048 sc1
    v_mfma_f32_16x16x32_bf16 v[32:35], a[24:27], v[72:75], v[32:35]
    ds_read_b128 v[56:59], v8 offset:5120
    v_mov_b32 v9, v254
    v_cmp_eq_u32 vcc, s48, v11
    v_mfma_f32_16x16x32_bf16 v[36:39], a[28:31], v[72:75], v[36:39]
    s_nop 0
    v_cndmask_b32 v14, v14, v16, vcc
    v_cndmask_b32 v15, v15, v17, vcc
    v_mfma_f32_16x16x32_bf16 v[40:43], v[136:139], v[72:75], v[40:43]
    s_waitcnt vmcnt(16) lgkmcnt(1)
    v_cmp_eq_u32 vcc, s49, v11
    v_mfma_f32_16x16x32_bf16 v[44:47], v[48:51], v[72:75], v[44:47]
    buffer_load_dwordx4 v[72:75], v1, s[4:7], s38 offen offset:3072 sc1
    v_mfma_f32_16x16x32_bf16 v[32:35], a[32:35], v[76:79], v[32:35]
    ds_read_b128 v[48:51], v8 offset:6144
    s_add_u32 s38, s69, s42
    v_cndmask_b32 v14, v14, v18, vcc
    v_mfma_f32_16x16x32_bf16 v[36:39], a[36:39], v[76:79], v[36:39]
    v_cndmask_b32 v15, v15, v19, vcc
    v_cmp_eq_u32 vcc, s50, v11
    v_mfma_f32_16x16x32_bf16 v[40:43], v[140:143], v[76:79], v[40:43]
    s_waitcnt vmcnt(16) lgkmcnt(1)
    v_cndmask_b32 v14, v14, v20, vcc
    v_cndmask_b32 v15, v15, v21, vcc
    v_mfma_f32_16x16x32_bf16 v[44:47], v[52:55], v[76:79], v[44:47]
    buffer_load_dwordx4 v[76:79], v1, s[4:7], s38 offen offset:0 sc1
    v_mfma_f32_16x16x32_bf16 v[32:35], a[40:43], v[80:83], v[32:35]
    ds_read_b128 v[52:55], v8 offset:7168
    v_cmp_eq_u32 vcc, s51, v11
    v_mfma_f32_16x16x32_bf16 v[36:39], a[44:47], v[80:83], v[36:39]
    s_nop 0
    v_cndmask_b32 v14, v14, v22, vcc
    v_cndmask_b32 v15, v15, v23, vcc
    v_mfma_f32_16x16x32_bf16 v[40:43], v[144:147], v[80:83], v[40:43]
    s_waitcnt vmcnt(16) lgkmcnt(1)
    v_cmp_eq_u32 vcc, s52, v11
    v_mfma_f32_16x16x32_bf16 v[44:47], v[56:59], v[80:83], v[44:47]
    buffer_load_dwordx4 v[80:83], v1, s[4:7], s38 offen offset:1024 sc1
    v_mfma_f32_16x16x32_bf16 v[32:35], a[48:51], v[84:87], v[32:35]
    ds_read_b128 v[56:59], v8 offset:8192
    v_cndmask_b32 v14, v14, v24, vcc
    v_cndmask_b32 v15, v15, v25, vcc
    v_mfma_f32_16x16x32_bf16 v[36:39], a[52:55], v[84:87], v[36:39]
    v_cmp_eq_u32 vcc, s53, v11
    v_mfma_f32_16x16x32_bf16 v[40:43], v[148:151], v[84:87], v[40:43]
    s_waitcnt vmcnt(16) lgkmcnt(1)
    v_cndmask_b32 v14, v14, v26, vcc
    v_cndmask_b32 v15, v15, v27, vcc
    v_mfma_f32_16x16x32_bf16 v[44:47], v[48:51], v[84:87], v[44:47]
    buffer_load_dwordx4 v[84:87], v1, s[4:7], s38 offen offset:2048 sc1
    v_mfma_f32_16x16x32_bf16 v[32:35], a[56:59], v[88:91], v[32:35]
    ds_read_b128 v[48:51], v8 offset:9216
    v_cmp_eq_u32 vcc, s54, v11
    v_mfma_f32_16x16x32_bf16 v[36:39], a[60:63], v[88:91], v[36:39]
    s_nop 0
    v_cndmask_b32 v14, v14, v28, vcc
    v_cndmask_b32 v15, v15, v29, vcc
    v_mfma_f32_16x16x32_bf16 v[40:43], v[152:155], v[88:91], v[40:43]
    s_waitcnt vmcnt(16) lgkmcnt(1)
    v_cmp_eq_u32 vcc, s55, v11
    v_mfma_f32_16x16x32_bf16 v[44:47], v[52:55], v[88:91], v[44:47]
    buffer_load_dwordx4 v[88:91], v1, s[4:7], s38 offen offset:3072 sc1
    v_mfma_f32_16x16x32_bf16 v[32:35], a[64:67], v[92:95], v[32:35]
    ds_read_b128 v[52:55], v8 offset:10240
    s_add_u32 s38, s70, s42
    v_cndmask_b32 v14, v14, v30, vcc
    v_mfma_f32_16x16x32_bf16 v[36:39], a[68:71], v[92:95], v[36:39]
    v_cndmask_b32 v15, v15, v31, vcc
    s_lshr_b32 s57, s56, 1
    v_mfma_f32_16x16x32_bf16 v[40:43], v[156:159], v[92:95], v[40:43]
    s_waitcnt vmcnt(16) lgkmcnt(1)
    s_lshl_b32 s57, s57, 14
    s_and_b32 s37, s56, 1
    v_mfma_f32_16x16x32_bf16 v[44:47], v[56:59], v[92:95], v[44:47]
    buffer_load_dwordx4 v[92:95], v1, s[4:7], s38 offen offset:0 sc1
    v_mfma_f32_16x16x32_bf16 v[32:35], a[72:75], v[96:99], v[32:35]
    ds_read_b128 v[56:59], v8 offset:11264
    s_lshl_b32 s37, s37, 12
    s_add_u32 s57, s57, s37
    v_mfma_f32_16x16x32_bf16 v[36:39], a[76:79], v[96:99], v[36:39]
    v_mfma_f32_16x16x32_bf16 v[40:43], v[160:163], v[96:99], v[40:43]
    s_waitcnt vmcnt(16) lgkmcnt(1)
    v_mfma_f32_16x16x32_bf16 v[44:47], v[48:51], v[96:99], v[44:47]
    buffer_load_dwordx4 v[96:99], v1, s[4:7], s38 offen offset:1024 sc1
    v_mfma_f32_16x16x32_bf16 v[32:35], a[80:83], v[100:103], v[32:35]
    ds_read_b128 v[48:51], v8 offset:12288
    v_mfma_f32_16x16x32_bf16 v[36:39], a[84:87], v[100:103], v[36:39]
    v_mfma_f32_16x16x32_bf16 v[40:43], v[164:167], v[100:103], v[40:43]
    s_waitcnt vmcnt(16) lgkmcnt(1)
    v_mfma_f32_16x16x32_bf16 v[44:47], v[52:55], v[100:103], v[44:47]
    buffer_load_dwordx4 v[100:103], v1, s[4:7], s38 offen offset:2048 sc1
    v_mfma_f32_16x16x32_bf16 v[32:35], a[88:91], v[104:107], v[32:35]
    ds_read_b128 v[52:55], v8 offset:13312
    v_mfma_f32_16x16x32_bf16 v[36:39], a[92:95], v[104:107], v[36:39]
    v_mfma_f32_16x16x32_bf16 v[40:43], v[168:171], v[104:107], v[40:43]
    s_waitcnt vmcnt(16) lgkmcnt(1)
    v_mfma_f32_16x16x32_bf16 v[44:47], v[56:59], v[104:107], v[44:47]
    buffer_load_dwordx4 v[104:107], v1, s[4:7], s38 offen offset:3072 sc1
    v_mfma_f32_16x16x32_bf16 v[32:35], a[96:99], v[108:111], v[32:35]
    ds_read_b128 v[56:59], v8 offset:14336
    s_add_u32 s38, s71, s42
    v_mfma_f32_16x16x32_bf16 v[36:39], a[100:103], v[108:111], v[36:39]
    v_mfma_f32_16x16x32_bf16 v[40:43], v[172:175], v[108:111], v[40:43]
    s_waitcnt vmcnt(16) lgkmcnt(1)
    v_mfma_f32_16x16x32_bf16 v[44:47], v[48:51], v[108:111], v[44:47]
    buffer_load_dwordx4 v[108:111], v1, s[4:7], s38 offen offset:0 sc1
    v_mfma_f32_16x16x32_bf16 v[32:35], a[104:107], v[112:115], v[32:35]
    ds_read_b128 v[48:51], v8 offset:15360
    v_mfma_f32_16x16x32_bf16 v[36:39], a[108:111], v[112:115], v[36:39]
    v_mfma_f32_16x16x32_bf16 v[40:43], v[176:179], v[112:115], v[40:43]
    s_waitcnt vmcnt(16) lgkmcnt(1)
    v_mfma_f32_16x16x32_bf16 v[44:47], v[52:55], v[112:115], v[44:47]
    buffer_load_dwordx4 v[112:115], v1, s[4:7], s38 offen offset:1024 sc1
    v_mfma_f32_16x16x32_bf16 v[32:35], a[112:115], v[116:119], v[32:35]
    ds_read_b128 v[52:55], v8 offset:16384
    s_waitcnt vmcnt(12)
    v_max_i32 v3, v3, v4
    v_mfma_f32_16x16x32_bf16 v[36:39], a[116:119], v[116:119], v[36:39]
    v_cmp_gt_i32 vcc, s40, v3
    v_mfma_f32_16x16x32_bf16 v[40:43], v[180:183], v[116:119], v[40:43]
    s_waitcnt vmcnt(16) lgkmcnt(1)
    v_mfma_f32_16x16x32_bf16 v[44:47], v[56:59], v[116:119], v[44:47]
    buffer_load_dwordx4 v[116:119], v1, s[4:7], s38 offen offset:2048 sc1
    v_mfma_f32_16x16x32_bf16 v[32:35], a[120:123], v[120:123], v[32:35]
    ds_read_b128 v[56:59], v8 offset:17408
    s_cmp_eq_u64 vcc, 0
    s_cselect_b32 s58, 1, 0
    v_mfma_f32_16x16x32_bf16 v[36:39], a[124:127], v[120:123], v[36:39]
    s_cselect_b32 s57, s57, 0x40000000
    v_mfma_f32_16x16x32_bf16 v[40:43], v[184:187], v[120:123], v[40:43]
    s_waitcnt vmcnt(15) lgkmcnt(1)
    v_mfma_f32_16x16x32_bf16 v[44:47], v[48:51], v[120:123], v[44:47]
    buffer_load_dwordx4 v[120:123], v1, s[4:7], s38 offen offset:3072 sc1
    v_mfma_f32_16x16x32_bf16 v[32:35], a[128:131], v[60:63], v[32:35]
    ds_read_b128 v[48:51], v8 offset:18432
    s_add_u32 s38, s64, s57
    s_lshl_b32 s37, s56, 15
    v_mfma_f32_16x16x32_bf16 v[36:39], a[132:135], v[60:63], v[36:39]
    s_and_b32 s59, s57, 0x40000000
    s_or_b32 s37, s37, s59
    v_mfma_f32_16x16x32_bf16 v[40:43], v[188:191], v[60:63], v[40:43]
    s_waitcnt vmcnt(15) lgkmcnt(1)
    v_mfma_f32_16x16x32_bf16 v[44:47], v[52:55], v[60:63], v[44:47]
    buffer_load_dwordx4 v[60:63], v1, s[4:7], s38 offen offset:0 sc1
    v_mfma_f32_16x16x32_bf16 v[32:35], a[136:139], v[64:67], v[32:35]
    ds_read_b128 v[52:55], v8 offset:19456
    v_mfma_f32_16x16x32_bf16 v[36:39], a[140:143], v[64:67], v[36:39]
    buffer_load_dwordx2 v[252:253], v7, s[16:19], s37 offen
    v_mfma_f32_16x16x32_bf16 v[40:43], v[192:195], v[64:67], v[40:43]
    s_waitcnt vmcnt(15) lgkmcnt(1)
    s_lshl_b32 s37, s56, 6
    s_or_b32 s37, s37, s59
    v_mfma_f32_16x16x32_bf16 v[44:47], v[56:59], v[64:67], v[44:47]
    buffer_load_dwordx4 v[64:67], v1, s[4:7], s38 offen offset:1024 sc1
    v_mfma_f32_16x16x32_bf16 v[32:35], a[144:147], v[68:71], v[32:35]
    ds_read_b128 v[56:59], v8 offset:20480
    v_mfma_f32_16x16x32_bf16 v[36:39], a[148:151], v[68:71], v[36:39]
    buffer_load_dword v254, v255, s[4:7], s37 offen sc1
    v_mfma_f32_16x16x32_bf16 v[40:43], v[196:199], v[68:71], v[40:43]
    s_waitcnt vmcnt(16) lgkmcnt(1)
    v_sub_f32 v4, 1.0, v9
    v_cvt_pk_bf16_f32 v4, v4, v4
    v_mfma_f32_16x16x32_bf16 v[44:47], v[48:51], v[68:71], v[44:47]
    buffer_load_dwordx4 v[68:71], v1, s[4:7], s38 offen offset:2048 sc1
    v_mfma_f32_16x16x32_bf16 v[32:35], a[152:155], v[72:75], v[32:35]
    ds_read_b128 v[48:51], v8 offset:21504
    v_and_b32 v4, s44, v4
    v_lshlrev_b32 v10, 16, v12
    v_mfma_f32_16x16x32_bf16 v[36:39], a[156:159], v[72:75], v[36:39]
    v_lshlrev_b32 v11, 16, v14
    v_add_f32 v10, v10, v11
    v_mfma_f32_16x16x32_bf16 v[40:43], v[200:203], v[72:75], v[40:43]
    s_waitcnt vmcnt(16) lgkmcnt(1)
    v_and_b32 v12, s44, v12
    v_and_b32 v14, s44, v14
    v_mfma_f32_16x16x32_bf16 v[44:47], v[52:55], v[72:75], v[44:47]
    buffer_load_dwordx4 v[72:75], v1, s[4:7], s38 offen offset:3072 sc1
    v_mfma_f32_16x16x32_bf16 v[32:35], a[160:163], v[76:79], v[32:35]
    ds_read_b128 v[52:55], v8 offset:22528
    s_add_u32 s38, s65, s57
    v_add_f32 v12, v12, v14
    v_mfma_f32_16x16x32_bf16 v[36:39], a[164:167], v[76:79], v[36:39]
    v_cvt_pk_bf16_f32 v12, v10, v12
    v_lshlrev_b32 v10, 16, v12
    v_mfma_f32_16x16x32_bf16 v[40:43], v[204:207], v[76:79], v[40:43]
    s_waitcnt vmcnt(16) lgkmcnt(1)
    v_and_b32 v12, s44, v12
    v_mul_f32 v10, v10, v4
    v_mfma_f32_16x16x32_bf16 v[44:47], v[56:59], v[76:79], v[44:47]
    buffer_load_dwordx4 v[76:79], v1, s[4:7], s38 offen offset:0 sc1
    v_mfma_f32_16x16x32_bf16 v[32:35], a[168:171], v[80:83], v[32:35]
    ds_read_b128 v[56:59], v8 offset:23552
    v_mul_f32 v12, v12, v4
    v_cvt_pk_bf16_f32 v12, v10, v12
    v_mfma_f32_16x16x32_bf16 v[36:39], a[172:175], v[80:83], v[36:39]
    v_lshlrev_b32 v10, 16, v13
    v_lshlrev_b32 v11, 16, v15
    v_mfma_f32_16x16x32_bf16 v[40:43], v[208:211], v[80:83], v[40:43]
    s_waitcnt vmcnt(16) lgkmcnt(1)
    v_add_f32 v10, v10, v11
    v_and_b32 v13, s44, v13
    v_mfma_f32_16x16x32_bf16 v[44:47], v[48:51], v[80:83], v[44:47]
    buffer_load_dwordx4 v[80:83], v1, s[4:7], s38 offen offset:1024 sc1
    v_mfma_f32_16x16x32_bf16 v[32:35], a[176:179], v[84:87], v[32:35]
    ds_read_b128 v[48:51], v8 offset:24576
    v_and_b32 v15, s44, v15
    v_add_f32 v13, v13, v15
    v_mfma_f32_16x16x32_bf16 v[36:39], a[180:183], v[84:87], v[36:39]
    v_cvt_pk_bf16_f32 v13, v10, v13
    v_lshlrev_b32 v10, 16, v13
    v_mfma_f32_16x16x32_bf16 v[40:43], v[212:215], v[84:87], v[40:43]
    s_waitcnt vmcnt(16) lgkmcnt(1)
    v_and_b32 v13, s44, v13
    v_mul_f32 v10, v10, v4
    v_mfma_f32_16x16x32_bf16 v[44:47], v[52:55], v[84:87], v[44:47]
    buffer_load_dwordx4 v[84:87], v1, s[4:7], s38 offen offset:2048 sc1
    v_mfma_f32_16x16x32_bf16 v[32:35], a[184:187], v[88:91], v[32:35]
    ds_read_b128 v[52:55], v8 offset:25600
    v_mul_f32 v13, v13, v4
    v_cvt_pk_bf16_f32 v13, v10, v13
    v_mfma_f32_16x16x32_bf16 v[36:39], a[188:191], v[88:91], v[36:39]
    v_mfma_f32_16x16x32_bf16 v[40:43], v[216:219], v[88:91], v[40:43]
    s_waitcnt vmcnt(16) lgkmcnt(1)
    v_mfma_f32_16x16x32_bf16 v[44:47], v[56:59], v[88:91], v[44:47]
    buffer_load_dwordx4 v[88:91], v1, s[4:7], s38 offen offset:3072 sc1
    v_mfma_f32_16x16x32_bf16 v[32:35], a[192:195], v[92:95], v[32:35]
    ds_read_b128 v[56:59], v8 offset:26624
    s_add_u32 s38, s66, s57
    v_mfma_f32_16x16x32_bf16 v[36:39], a[196:199], v[92:95], v[36:39]
    v_mfma_f32_16x16x32_bf16 v[40:43], v[220:223], v[92:95], v[40:43]
    s_waitcnt vmcnt(16) lgkmcnt(1)
    v_mfma_f32_16x16x32_bf16 v[44:47], v[48:51], v[92:95], v[44:47]
    buffer_load_dwordx4 v[92:95], v1, s[4:7], s38 offen offset:0 sc1
    v_mfma_f32_16x16x32_bf16 v[32:35], a[200:203], v[96:99], v[32:35]
    ds_read_b128 v[48:51], v8 offset:27648
    v_mfma_f32_16x16x32_bf16 v[36:39], a[204:207], v[96:99], v[36:39]
    v_mfma_f32_16x16x32_bf16 v[40:43], v[224:227], v[96:99], v[40:43]
    s_waitcnt vmcnt(16) lgkmcnt(1)
    v_mfma_f32_16x16x32_bf16 v[44:47], v[52:55], v[96:99], v[44:47]
    buffer_load_dwordx4 v[96:99], v1, s[4:7], s38 offen offset:1024 sc1
    v_mfma_f32_16x16x32_bf16 v[32:35], a[208:211], v[100:103], v[32:35]
    ds_read_b128 v[52:55], v8 offset:28672
    v_mfma_f32_16x16x32_bf16 v[36:39], a[212:215], v[100:103], v[36:39]
    v_mfma_f32_16x16x32_bf16 v[40:43], v[228:231], v[100:103], v[40:43]
    s_waitcnt vmcnt(16) lgkmcnt(1)
    v_mfma_f32_16x16x32_bf16 v[44:47], v[56:59], v[100:103], v[44:47]
    buffer_load_dwordx4 v[100:103], v1, s[4:7], s38 offen offset:2048 sc1
    v_mfma_f32_16x16x32_bf16 v[32:35], a[216:219], v[104:107], v[32:35]
    ds_read_b128 v[56:59], v8 offset:29696
    v_mfma_f32_16x16x32_bf16 v[36:39], a[220:223], v[104:107], v[36:39]
    v_mfma_f32_16x16x32_bf16 v[40:43], v[232:235], v[104:107], v[40:43]
    s_waitcnt vmcnt(16) lgkmcnt(1)
    v_mfma_f32_16x16x32_bf16 v[44:47], v[48:51], v[104:107], v[44:47]
    buffer_load_dwordx4 v[104:107], v1, s[4:7], s38 offen offset:3072 sc1
    v_mfma_f32_16x16x32_bf16 v[32:35], a[224:227], v[108:111], v[32:35]
    ds_read_b128 v[48:51], v8 offset:30720
    s_add_u32 s38, s67, s57
    v_mfma_f32_16x16x32_bf16 v[36:39], a[228:231], v[108:111], v[36:39]
    v_mfma_f32_16x16x32_bf16 v[40:43], v[236:239], v[108:111], v[40:43]
    s_waitcnt vmcnt(16) lgkmcnt(1)
    v_mfma_f32_16x16x32_bf16 v[44:47], v[52:55], v[108:111], v[44:47]
    buffer_load_dwordx4 v[108:111], v1, s[4:7], s38 offen offset:0 sc1
    v_mfma_f32_16x16x32_bf16 v[32:35], a[232:235], v[112:115], v[32:35]
    ds_read_b128 v[52:55], v8 offset:31744
    v_mfma_f32_16x16x32_bf16 v[36:39], a[236:239], v[112:115], v[36:39]
    v_mfma_f32_16x16x32_bf16 v[40:43], v[240:243], v[112:115], v[40:43]
    s_waitcnt vmcnt(16) lgkmcnt(1)
    v_mfma_f32_16x16x32_bf16 v[44:47], v[56:59], v[112:115], v[44:47]
    buffer_load_dwordx4 v[112:115], v1, s[4:7], s38 offen offset:1024 sc1
    v_mfma_f32_16x16x32_bf16 v[32:35], a[240:243], v[116:119], v[32:35]
    v_mfma_f32_16x16x32_bf16 v[36:39], a[244:247], v[116:119], v[36:39]
    v_mfma_f32_16x16x32_bf16 v[40:43], v[244:247], v[116:119], v[40:43]
    s_waitcnt vmcnt(16) lgkmcnt(0)
    v_mfma_f32_16x16x32_bf16 v[44:47], v[48:51], v[116:119], v[44:47]
    buffer_load_dwordx4 v[116:119], v1, s[4:7], s38 offen offset:2048 sc1
    v_mfma_f32_16x16x32_bf16 v[32:35], a[248:251], v[120:123], v[32:35]
    v_mfma_f32_16x16x32_bf16 v[36:39], a[252:255], v[120:123], v[36:39]
    v_mfma_f32_16x16x32_bf16 v[40:43], v[248:251], v[120:123], v[40:43]
    v_mfma_f32_16x16x32_bf16 v[44:47], v[52:55], v[120:123], v[44:47]
    buffer_load_dwordx4 v[120:123], v1, s[4:7], s38 offen offset:3072 sc1
    ds_write_b128 v5, v[32:35] offset:0
    v_xor_b32 v5, 0x40, v5
    ds_write_b128 v5, v[36:39] offset:1024
    v_xor_b32 v5, 0xc0, v5
    ds_write_b128 v5, v[40:43] offset:2048
    v_xor_b32 v5, 0x40, v5
    ds_write_b128 v5, v[44:47] offset:3072
    v_xor_b32 v5, 0x40c0, v5
    s_waitcnt lgkmcnt(0)
    s_barrier
    ds_read_b128 v[32:35], v6 offset:0
    ds_read_b128 v[36:39], v6 offset:4096
    ds_read_b128 v[40:43], v6 offset:8192
    ds_read_b128 v[44:47], v6 offset:12288
    ds_read_b128 v[48:51], v8 offset:0
    ds_read_b128 v[52:55], v8 offset:1024
    v_lshlrev_b32 v56, 16, v12
    v_and_b32 v57, s44, v12
    v_lshlrev_b32 v58, 16, v13
    v_and_b32 v59, s44, v13
    v_xor_b32 v6, 0x4000, v6
    s_waitcnt lgkmcnt(4)
    v_pk_add_f32 v[32:33], v[32:33], v[36:37]
    v_pk_add_f32 v[34:35], v[34:35], v[38:39]
    s_waitcnt lgkmcnt(3)
    v_pk_add_f32 v[32:33], v[32:33], v[40:41]
    v_pk_add_f32 v[34:35], v[34:35], v[42:43]
    s_waitcnt lgkmcnt(2)
    v_pk_add_f32 v[32:33], v[32:33], v[44:45]
    v_pk_add_f32 v[34:35], v[34:35], v[46:47]
    v_cvt_pk_bf16_f32 v10, v32, v33
    v_lshlrev_b32 v32, 16, v10
    v_and_b32 v33, s44, v10
    v_cvt_pk_bf16_f32 v11, v34, v35
    v_lshlrev_b32 v34, 16, v11
    v_and_b32 v35, s44, v11
    s_nop 0
    v_mul_f32 v32, v32, v9
    v_mul_f32 v33, v33, v9
    v_mul_f32 v34, v34, v9
    v_mul_f32 v35, v35, v9
    s_nop 0
    v_cvt_pk_bf16_f32 v10, v32, v33
    v_lshlrev_b32 v32, 16, v10
    v_and_b32 v33, s44, v10
    v_cvt_pk_bf16_f32 v11, v34, v35
    v_lshlrev_b32 v34, 16, v11
    v_and_b32 v35, s44, v11
    v_pk_add_f32 v[32:33], v[32:33], v[56:57]
    v_cvt_pk_bf16_f32 v14, v32, v33
    v_pk_add_f32 v[34:35], v[34:35], v[58:59]
    v_cvt_pk_bf16_f32 v15, v34, v35
    buffer_store_dwordx2 v[14:15], v7, s[20:23], s39 offen
    s_branch L_o_loop
L_o_end:
    s_endpgm
L_code1:
    s_endpgm
.section .rodata,"a"
.p2align 6
.amdhsa_kernel gated_mix__memory_aug_recurrent_mem_tr__moe_arch_mod__prompt_kernel
  .amdhsa_next_free_vgpr 512
  .amdhsa_next_free_sgpr 102
  .amdhsa_accum_offset 256
  .amdhsa_group_segment_fixed_size 0
  .amdhsa_kernarg_size 128
  .amdhsa_user_sgpr_count 2
  .amdhsa_user_sgpr_kernarg_segment_ptr 1
  .amdhsa_system_sgpr_workgroup_id_x 1
  .amdhsa_float_denorm_mode_32 3
.end_amdhsa_kernel
```
